```python
import torch

def _softmax(x, axis=-1):
    return torch.softmax(x, dim=axis)
def _gelu(x):
    return torch.nn.functional.gelu(x, approximate="tanh")
def _silu(x):
    return torch.nn.functional.silu(x)
def _sigmoid(x):
    return torch.sigmoid(x)
def _layernorm(x, axis=-1, eps=1e-5):
    m = x.mean(dim=axis, keepdim=True)
    v = x.var(dim=axis, keepdim=True, unbiased=False)
    return (x - m) / torch.sqrt(v + eps)
def _scatter_add(tgt, idx, src, axis=0):
    return tgt.clone().index_add_(axis, idx, src)
def _segment_sum(src, seg, n):
    out = torch.zeros((n,) + src.shape[1:], dtype=src.dtype)
    return out.index_add_(0, seg, src)
def _pad(x, pw):
    flat = tuple(v for pair in reversed(pw) for v in pair)
    return torch.nn.functional.pad(x, flat)

kernel_name = 'recurrent_scan__spectral_gfnet__geglu_ffn__prompt'

def setup_inputs():

    _w = (lambda a: (lambda t: t.to(torch.bfloat16) if t.is_floating_point() else t)(torch.as_tensor(a)))
    def _A_setup():
        B, S, D = 1, 2048, 1024
        Df = D // 2 + 1
        return {
            "x": _w((lambda *s: torch.randn(*s, dtype=torch.bfloat16) * 0.05)(B, S, D)),
            "w_r": _w((lambda *s: torch.randn(*s, dtype=torch.bfloat16) * 0.05)(S, Df) * 0.02),
            "w_i": _w((lambda *s: torch.randn(*s, dtype=torch.bfloat16) * 0.05)(S, Df) * 0.02),
        }
    _A_in = _A_setup()

    def _B_setup():
        B, S, D, F = 1, 2048, 1024, 3584
        return {
            "x": _w((lambda *s: torch.randn(*s, dtype=torch.bfloat16) * 0.05)(B, S, D)),
            "w_gate": _w((lambda *s: torch.randn(*s, dtype=torch.bfloat16) * 0.05)(D, F)),
            "w_up": _w((lambda *s: torch.randn(*s, dtype=torch.bfloat16) * 0.05)(D, F)),
            "w_down": _w((lambda *s: torch.randn(*s, dtype=torch.bfloat16) * 0.05)(F, D)),
        }
    _B_in = _B_setup()

    return {
        "A_x": _A_in["x"],
        "A_w_r": _A_in["w_r"],
        "A_w_i": _A_in["w_i"],
        "B_x": _B_in["x"],
        "B_w_gate": _B_in["w_gate"],
        "B_w_up": _B_in["w_up"],
        "B_w_down": _B_in["w_down"],
    }

def reference(A_x, A_w_r, A_w_i, B_x, B_w_gate, B_w_up, B_w_down):
    def _A_ref(x, w_r, w_i):
        B, S, D = x.shape
        X = (lambda x, axes=(-2,-1): torch.fft.rfft2(x.float(), dim=axes))(x, axes=(-2, -1))
        W = w_r + 1j * w_i
        X = X * W
        y = (lambda x, s, axes=(-2,-1): torch.fft.irfft2(x, s=s, dim=axes).to(torch.bfloat16))(X, (S, D), axes=(-2, -1))
        return y

    def _B_ref(x, w_gate, w_up, w_down):
        return (_gelu(x @ w_gate) * (x @ w_up)) @ w_down

    x = A_x
    xn = _layernorm(x, axis=-1)
    s = _A_ref(xn, A_w_r, A_w_i)
    g = _silu(_B_ref(xn, B_w_gate, B_w_up, B_w_down))
    return x + s * g
```

```asm
; @launch grid=(256,1,1) block=(512,1,1) lds=163840
.amdgcn_target "amdgcn-amd-amdhsa--gfx950"
.text
.globl recurrent_scan__spectral_gfnet__geglu_ffn__prompt_kernel
.p2align 8
.type recurrent_scan__spectral_gfnet__geglu_ffn__prompt_kernel,@function
recurrent_scan__spectral_gfnet__geglu_ffn__prompt_kernel:
    s_cmp_ge_u32 s2, 256
    s_cbranch_scc1 L_kb_exit
    s_and_b32 s3, s2, 7
    s_lshr_b32 s4, s2, 3
    s_cmp_lt_u32 s4, 4
    s_cbranch_scc1 L_kb_spec
    s_sub_u32 s4, s4, 4
    s_load_dwordx2 s[32:33], s[0:1], 0
    s_load_dwordx4 s[48:51], s[0:1], 32
    s_load_dwordx4 s[52:55], s[0:1], 64
    s_and_b32 s5, s3, 1
    s_lshl_b32 s6, s5, 2
    s_and_b32 s7, s4, 3
    s_add_u32 s28, s6, s7
    s_lshr_b32 s6, s3, 1
    s_mul_i32 s6, s6, 7
    s_lshr_b32 s7, s4, 2
    s_add_u32 s29, s6, s7
    s_lshl_b32 s6, s28, 2
    s_lshr_b32 s44, 0x73453456, s6
    s_and_b32 s44, s44, 15
    s_mul_i32 s40, s5, 12
    s_mul_i32 s41, s5, -24
    s_mov_b32 s38, 0
    s_mov_b32 s39, 0
    v_lshrrev_b32 v3, 6, v0
    v_and_b32 v1, 63, v0
    v_readfirstlane_b32 s30, v3
    v_lshrrev_b32 v2, 4, v1
    s_and_b32 s31, s30, 3
    s_cmp_ge_u32 s30, 4
    s_cbranch_scc1 L_g1_touch
    v_lshrrev_b32 v3, 3, v1
    v_xor_b32 v4, v3, v1
    v_and_b32 v4, 7, v4
    v_lshlrev_b32 v4, 4, v4
    v_lshl_add_u32 v4, v3, 11, v4
    s_lshl_b32 s5, s28, 19
    s_lshl_b32 s6, s30, 17
    s_add_u32 s5, s5, s6
    v_add_u32 v12, s5, v4
    v_add_u32 v13, 15360, v12
    v_add_u32 v14, 30720, v12
    v_add_u32 v15, 46080, v12
    v_and_b32 v3, 15, v1
    s_and_b32 s6, s30, 1
    s_lshl_b32 s6, s6, 2
    v_or_b32 v4, s6, v2
    v_lshlrev_b32 v4, 1, v4
    v_xor_b32 v4, v4, v3
    v_lshlrev_b32 v4, 4, v4
    s_lshl_b32 s6, s30, 3
    v_add_u32 v5, s6, v2
    v_mul_u32_u24 v5, 7168, v5
    s_lshl_b32 s6, s29, 8
    v_add3_u32 v16, v4, v5, s6
    v_add_u32 v17, 26624, v16
    s_lshl_b32 s42, s30, 12
    s_mov_b32 s36, 0x14314314
    s_mov_b32 s37, 0x53143143
    s_mul_i32 s46, s40, 64
    s_waitcnt lgkmcnt(0)
    s_mov_b32 s8, s32
    s_mov_b32 s9, s33
    s_mov_b32 s10, 0x400000
    s_mov_b32 s11, 0x20000
    s_mov_b32 s12, s48
    s_mov_b32 s13, s49
    s_mov_b32 s14, 0x700000
    s_mov_b32 s15, 0x20000
    s_sub_u32 s16, s50, 0x400
    s_subb_u32 s17, s51, 0
    s_mov_b32 s18, 0x700400
    s_mov_b32 s19, 0x20000
    s_add_u32 m0, s42, 0
    s_nop 0
    buffer_load_dwordx4 v16, s[12:15], s39 offen  lds
    buffer_load_dwordx4 v16, s[16:19], s39 offen offset:1024  lds
    buffer_load_dwordx4 v17, s[12:15], s39 offen offset:2048  lds
    buffer_load_dwordx4 v17, s[16:19], s39 offen offset:3072  lds
    s_add_u32 s39, s39, 229376
    s_lshl_b32 s5, s42, 1
    s_add_u32 s47, s5, 98304
    s_mov_b32 m0, s47
    s_nop 0
    buffer_load_dwordx4 v12, s[8:11], s38 offen offset:0 lds
    buffer_load_dwordx4 v13, s[8:11], s38 offen offset:1024 lds
    buffer_load_dwordx4 v14, s[8:11], s38 offen offset:2048 lds
    buffer_load_dwordx4 v15, s[8:11], s38 offen offset:3072 lds
    s_add_u32 s38, s38, 65536
    s_add_u32 m0, s47, 4096
    s_nop 0
    buffer_load_dwordx4 v12, s[8:11], s38 offen offset:0 lds
    buffer_load_dwordx4 v13, s[8:11], s38 offen offset:1024 lds
    buffer_load_dwordx4 v14, s[8:11], s38 offen offset:2048 lds
    buffer_load_dwordx4 v15, s[8:11], s38 offen offset:3072 lds
    s_sub_u32 s38, s38, 65408
    s_add_u32 m0, s42, 16384
    s_nop 0
    buffer_load_dwordx4 v16, s[12:15], s39 offen  lds
    buffer_load_dwordx4 v16, s[16:19], s39 offen offset:1024  lds
    buffer_load_dwordx4 v17, s[12:15], s39 offen offset:2048  lds
    buffer_load_dwordx4 v17, s[16:19], s39 offen offset:3072  lds
    s_add_u32 s39, s39, 229376
    s_lshr_b32 s5, s30, 2
    v_and_b32 v3, 15, v1
    v_xor_b32 v4, v3, v2
    v_and_b32 v4, 7, v4
    v_lshlrev_b32 v4, 4, v4
    v_lshl_add_u32 v4, v3, 7, v4
    s_lshl_b32 s7, s5, 14
    v_add_u32 v7, s7, v4
    s_mov_b32 s34, 0x43143143
    s_mov_b32 s35, 0x31431431
    v_bfe_u32 v5, v1, 2, 2
    v_and_b32 v3, 1, v2
    v_lshl_or_b32 v3, v3, 2, v5
    v_lshlrev_b32 v4, 12, v2
    v_lshl_add_u32 v4, v5, 8, v4
    v_and_b32 v5, 3, v1
    v_lshl_add_u32 v4, v5, 3, v4
    s_lshl_b32 s7, s31, 1
    s_add_u32 s6, s7, 0
    v_xor_b32 v5, s6, v3
    v_lshl_add_u32 v8, v5, 5, v4
    v_add_u32 v10, 0x10000, v8
    s_add_u32 s6, s7, 1
    v_xor_b32 v5, s6, v3
    v_lshl_add_u32 v9, v5, 5, v4
    v_add_u32 v11, 0x10000, v9
    s_add_u32 s20, s54, 0x400000
    s_addc_u32 s21, s55, 0
    s_mov_b32 s22, 0xe00000
    s_mov_b32 s23, 0x20000
    s_mov_b32 s24, s52
    s_mov_b32 s25, s53
    s_mov_b32 s26, 0x100
    s_mov_b32 s27, 0x20000
    v_mov_b32 v128, 0
    v_mov_b32 v129, 0
    v_mov_b32 v130, 0
    v_mov_b32 v131, 0
    v_mov_b32 v132, 0
    v_mov_b32 v133, 0
    v_mov_b32 v134, 0
    v_mov_b32 v135, 0
    v_mov_b32 v136, 0
    v_mov_b32 v137, 0
    v_mov_b32 v138, 0
    v_mov_b32 v139, 0
    v_mov_b32 v140, 0
    v_mov_b32 v141, 0
    v_mov_b32 v142, 0
    v_mov_b32 v143, 0
    v_mov_b32 v144, 0
    v_mov_b32 v145, 0
    v_mov_b32 v146, 0
    v_mov_b32 v147, 0
    v_mov_b32 v148, 0
    v_mov_b32 v149, 0
    v_mov_b32 v150, 0
    v_mov_b32 v151, 0
    v_mov_b32 v152, 0
    v_mov_b32 v153, 0
    v_mov_b32 v154, 0
    v_mov_b32 v155, 0
    v_mov_b32 v156, 0
    v_mov_b32 v157, 0
    v_mov_b32 v158, 0
    v_mov_b32 v159, 0
    v_mov_b32 v160, 0
    v_mov_b32 v161, 0
    v_mov_b32 v162, 0
    v_mov_b32 v163, 0
    v_mov_b32 v164, 0
    v_mov_b32 v165, 0
    v_mov_b32 v166, 0
    v_mov_b32 v167, 0
    v_mov_b32 v168, 0
    v_mov_b32 v169, 0
    v_mov_b32 v170, 0
    v_mov_b32 v171, 0
    v_mov_b32 v172, 0
    v_mov_b32 v173, 0
    v_mov_b32 v174, 0
    v_mov_b32 v175, 0
    v_mov_b32 v176, 0
    v_mov_b32 v177, 0
    v_mov_b32 v178, 0
    v_mov_b32 v179, 0
    v_mov_b32 v180, 0
    v_mov_b32 v181, 0
    v_mov_b32 v182, 0
    v_mov_b32 v183, 0
    v_mov_b32 v184, 0
    v_mov_b32 v185, 0
    v_mov_b32 v186, 0
    v_mov_b32 v187, 0
    v_mov_b32 v188, 0
    v_mov_b32 v189, 0
    v_mov_b32 v190, 0
    v_mov_b32 v191, 0
    v_mov_b32 v192, 0
    v_mov_b32 v193, 0
    v_mov_b32 v194, 0
    v_mov_b32 v195, 0
    v_mov_b32 v196, 0
    v_mov_b32 v197, 0
    v_mov_b32 v198, 0
    v_mov_b32 v199, 0
    v_mov_b32 v200, 0
    v_mov_b32 v201, 0
    v_mov_b32 v202, 0
    v_mov_b32 v203, 0
    v_mov_b32 v204, 0
    v_mov_b32 v205, 0
    v_mov_b32 v206, 0
    v_mov_b32 v207, 0
    v_mov_b32 v208, 0
    v_mov_b32 v209, 0
    v_mov_b32 v210, 0
    v_mov_b32 v211, 0
    v_mov_b32 v212, 0
    v_mov_b32 v213, 0
    v_mov_b32 v214, 0
    v_mov_b32 v215, 0
    v_mov_b32 v216, 0
    v_mov_b32 v217, 0
    v_mov_b32 v218, 0
    v_mov_b32 v219, 0
    v_mov_b32 v220, 0
    v_mov_b32 v221, 0
    v_mov_b32 v222, 0
    v_mov_b32 v223, 0
    v_mov_b32 v224, 0
    v_mov_b32 v225, 0
    v_mov_b32 v226, 0
    v_mov_b32 v227, 0
    v_mov_b32 v228, 0
    v_mov_b32 v229, 0
    v_mov_b32 v230, 0
    v_mov_b32 v231, 0
    v_mov_b32 v232, 0
    v_mov_b32 v233, 0
    v_mov_b32 v234, 0
    v_mov_b32 v235, 0
    v_mov_b32 v236, 0
    v_mov_b32 v237, 0
    v_mov_b32 v238, 0
    v_mov_b32 v239, 0
    v_mov_b32 v240, 0
    v_mov_b32 v241, 0
    v_mov_b32 v242, 0
    v_mov_b32 v243, 0
    v_mov_b32 v244, 0
    v_mov_b32 v245, 0
    v_mov_b32 v246, 0
    v_mov_b32 v247, 0
    v_mov_b32 v248, 0
    v_mov_b32 v249, 0
    v_mov_b32 v250, 0
    v_mov_b32 v251, 0
    v_mov_b32 v252, 0
    v_mov_b32 v253, 0
    v_mov_b32 v254, 0
    v_mov_b32 v255, 0
    s_load_dwordx2 s[92:93], s[0:1], 48
    s_lshr_b32 s5, s2, 5
    s_lshl_b32 s5, s5, 8
    v_lshrrev_b32 v28, 4, v1
    v_lshlrev_b32 v29, 1, v28
    v_xor_b32 v29, v29, v1
    v_and_b32 v29, 15, v29
    v_lshlrev_b32 v28, 11, v28
    v_lshl_add_u32 v28, v29, 4, v28
    v_add_u32 v24, s5, v28
    v_xor_b32 v25, 128, v24
    v_add_u32 v25, 7168, v25
    v_add_u32 v26, 14336, v24
    v_add_u32 v27, 14336, v25
    s_and_b32 s5, s2, 1
    s_mul_i32 s5, s5, 3670016
    s_lshl_b32 s6, s30, 15
    s_add_u32 s96, s5, s6
    s_lshl_b32 s97, s30, 12
    s_mov_b32 s94, 7340032
    s_mov_b32 s95, 0x20000
    s_waitcnt vmcnt(4)
    s_barrier
    ds_read_b64_tr_b16 v[64:65], v8 offset:0
    s_and_b32 s6, s34, 15
    s_lshl_b32 s6, s6, 15
    ds_read_b64_tr_b16 v[66:67], v8 offset:2048
    s_lshr_b64 s[34:35], s[34:35], 4
    v_add_u32 v6, s6, v7
    ds_read_b128 v[32:35], v6 offset:0
    ds_read_b128 v[36:39], v6 offset:2048
    ds_read_b128 v[40:43], v6 offset:4096
    ds_read_b128 v[44:47], v6 offset:6144
    ds_read_b128 v[48:51], v6 offset:8192
    ds_read_b128 v[52:55], v6 offset:10240
    ds_read_b128 v[56:59], v6 offset:12288
    ds_read_b128 v[60:63], v6 offset:14336
    ds_read_b64_tr_b16 v[72:73], v8 offset:1024
    ds_read_b64_tr_b16 v[74:75], v8 offset:3072
    ds_read_b64_tr_b16 v[68:69], v9 offset:0
    ds_read_b64_tr_b16 v[70:71], v9 offset:2048
    ds_read_b64_tr_b16 v[76:77], v9 offset:1024
    ds_read_b64_tr_b16 v[78:79], v9 offset:3072
    s_mov_b32 s45, 0
    s_waitcnt lgkmcnt(0) vmcnt(0)
    s_barrier
    v_mfma_f32_16x16x32_bf16 v[128:131], v[64:67], v[32:35], v[128:131]
    ds_read_b64_tr_b16 v[112:113], v8 offset:16384
    v_mfma_f32_16x16x32_bf16 v[132:135], v[64:67], v[36:39], v[132:135]
    ds_read_b64_tr_b16 v[114:115], v8 offset:18432
    v_xor_b32 v6, 64, v6
    s_add_u32 m0, s42, 65536
    s_nop 0
    buffer_load_dwordx4 v16, s[12:15], s39 offen  lds
    v_mfma_f32_16x16x32_bf16 v[136:139], v[64:67], v[40:43], v[136:139]
    ds_read_b128 v[80:83], v6 offset:0
    v_mfma_f32_16x16x32_bf16 v[140:143], v[64:67], v[44:47], v[140:143]
    ds_read_b128 v[84:87], v6 offset:2048
    buffer_load_dwordx4 v16, s[16:19], s39 offen offset:1024  lds
    v_mfma_f32_16x16x32_bf16 v[144:147], v[64:67], v[48:51], v[144:147]
    ds_read_b128 v[88:91], v6 offset:4096
    v_mfma_f32_16x16x32_bf16 v[148:151], v[64:67], v[52:55], v[148:151]
    ds_read_b128 v[92:95], v6 offset:6144
    buffer_load_dwordx4 v17, s[12:15], s39 offen offset:2048  lds
    v_mfma_f32_16x16x32_bf16 v[152:155], v[64:67], v[56:59], v[152:155]
    ds_read_b128 v[96:99], v6 offset:8192
    v_mfma_f32_16x16x32_bf16 v[156:159], v[64:67], v[60:63], v[156:159]
    ds_read_b128 v[100:103], v6 offset:10240
    buffer_load_dwordx4 v17, s[16:19], s39 offen offset:3072  lds
    s_add_u32 s39, s39, 229376
    v_mfma_f32_16x16x32_bf16 v[192:195], v[72:75], v[32:35], v[192:195]
    ds_read_b128 v[104:107], v6 offset:12288
    v_mfma_f32_16x16x32_bf16 v[196:199], v[72:75], v[36:39], v[196:199]
    ds_read_b128 v[108:111], v6 offset:14336
    s_and_b32 s47, s36, 15
    s_lshl_b32 s47, s47, 15
    s_lshr_b64 s[36:37], s[36:37], 4
    s_lshl_b32 s5, s42, 1
    s_add_u32 s47, s47, s5
    s_mov_b32 m0, s47
    s_nop 0
    buffer_load_dwordx4 v12, s[8:11], s38 offen offset:0 lds
    v_mfma_f32_16x16x32_bf16 v[200:203], v[72:75], v[40:43], v[200:203]
    ds_read_b64_tr_b16 v[120:121], v8 offset:17408
    v_mfma_f32_16x16x32_bf16 v[204:207], v[72:75], v[44:47], v[204:207]
    ds_read_b64_tr_b16 v[122:123], v8 offset:19456
    buffer_load_dwordx4 v13, s[8:11], s38 offen offset:1024 lds
    v_mfma_f32_16x16x32_bf16 v[208:211], v[72:75], v[48:51], v[208:211]
    ds_read_b64_tr_b16 v[116:117], v9 offset:16384
    v_mfma_f32_16x16x32_bf16 v[212:215], v[72:75], v[52:55], v[212:215]
    ds_read_b64_tr_b16 v[118:119], v9 offset:18432
    buffer_load_dwordx4 v14, s[8:11], s38 offen offset:2048 lds
    v_mfma_f32_16x16x32_bf16 v[216:219], v[72:75], v[56:59], v[216:219]
    ds_read_b64_tr_b16 v[124:125], v9 offset:17408
    v_mfma_f32_16x16x32_bf16 v[220:223], v[72:75], v[60:63], v[220:223]
    ds_read_b64_tr_b16 v[126:127], v9 offset:19456
    buffer_load_dwordx4 v15, s[8:11], s38 offen offset:3072 lds
    s_add_u32 s38, s38, 65536
    v_mfma_f32_16x16x32_bf16 v[160:163], v[68:71], v[32:35], v[160:163]
    v_mfma_f32_16x16x32_bf16 v[164:167], v[68:71], v[36:39], v[164:167]
    s_add_u32 m0, s47, 4096
    s_nop 0
    buffer_load_dwordx4 v12, s[8:11], s38 offen offset:0 lds
    v_mfma_f32_16x16x32_bf16 v[168:171], v[68:71], v[40:43], v[168:171]
    v_mfma_f32_16x16x32_bf16 v[172:175], v[68:71], v[44:47], v[172:175]
    buffer_load_dwordx4 v13, s[8:11], s38 offen offset:1024 lds
    v_mfma_f32_16x16x32_bf16 v[176:179], v[68:71], v[48:51], v[176:179]
    v_mfma_f32_16x16x32_bf16 v[180:183], v[68:71], v[52:55], v[180:183]
    buffer_load_dwordx4 v14, s[8:11], s38 offen offset:2048 lds
    v_mfma_f32_16x16x32_bf16 v[184:187], v[68:71], v[56:59], v[184:187]
    v_mfma_f32_16x16x32_bf16 v[188:191], v[68:71], v[60:63], v[188:191]
    buffer_load_dwordx4 v15, s[8:11], s38 offen offset:3072 lds
    s_sub_u32 s38, s38, 65408
    v_mfma_f32_16x16x32_bf16 v[224:227], v[76:79], v[32:35], v[224:227]
    v_mfma_f32_16x16x32_bf16 v[228:231], v[76:79], v[36:39], v[228:231]
    s_add_u32 m0, s42, 81920
    s_nop 0
    buffer_load_dwordx4 v16, s[12:15], s39 offen  lds
    v_mfma_f32_16x16x32_bf16 v[232:235], v[76:79], v[40:43], v[232:235]
    v_mfma_f32_16x16x32_bf16 v[236:239], v[76:79], v[44:47], v[236:239]
    buffer_load_dwordx4 v16, s[16:19], s39 offen offset:1024  lds
    v_mfma_f32_16x16x32_bf16 v[240:243], v[76:79], v[48:51], v[240:243]
    v_mfma_f32_16x16x32_bf16 v[244:247], v[76:79], v[52:55], v[244:247]
    buffer_load_dwordx4 v17, s[12:15], s39 offen offset:2048  lds
    v_mfma_f32_16x16x32_bf16 v[248:251], v[76:79], v[56:59], v[248:251]
    v_mfma_f32_16x16x32_bf16 v[252:255], v[76:79], v[60:63], v[252:255]
    buffer_load_dwordx4 v17, s[16:19], s39 offen offset:3072  lds
    s_add_u32 s39, s39, 229376
    s_waitcnt lgkmcnt(0) vmcnt(4)
    s_barrier
    v_mfma_f32_16x16x32_bf16 v[128:131], v[112:115], v[80:83], v[128:131]
    ds_read_b64_tr_b16 v[64:65], v10 offset:0
    s_and_b32 s6, s34, 15
    s_lshl_b32 s6, s6, 15
    v_mfma_f32_16x16x32_bf16 v[132:135], v[112:115], v[84:87], v[132:135]
    ds_read_b64_tr_b16 v[66:67], v10 offset:2048
    s_lshr_b64 s[34:35], s[34:35], 4
    v_add_u32 v6, s6, v7
    s_add_u32 m0, s42, 0
    s_nop 0
    buffer_load_dwordx4 v16, s[12:15], s39 offen  lds
    v_mfma_f32_16x16x32_bf16 v[136:139], v[112:115], v[88:91], v[136:139]
    ds_read_b128 v[32:35], v6 offset:0
    v_mfma_f32_16x16x32_bf16 v[140:143], v[112:115], v[92:95], v[140:143]
    ds_read_b128 v[36:39], v6 offset:2048
    buffer_load_dwordx4 v16, s[16:19], s39 offen offset:1024  lds
    v_mfma_f32_16x16x32_bf16 v[144:147], v[112:115], v[96:99], v[144:147]
    ds_read_b128 v[40:43], v6 offset:4096
    v_mfma_f32_16x16x32_bf16 v[148:151], v[112:115], v[100:103], v[148:151]
    ds_read_b128 v[44:47], v6 offset:6144
    buffer_load_dwordx4 v17, s[12:15], s39 offen offset:2048  lds
    v_mfma_f32_16x16x32_bf16 v[152:155], v[112:115], v[104:107], v[152:155]
    ds_read_b128 v[48:51], v6 offset:8192
    v_mfma_f32_16x16x32_bf16 v[156:159], v[112:115], v[108:111], v[156:159]
    ds_read_b128 v[52:55], v6 offset:10240
    buffer_load_dwordx4 v17, s[16:19], s39 offen offset:3072  lds
    s_add_u32 s39, s39, 229376
    v_mfma_f32_16x16x32_bf16 v[192:195], v[120:123], v[80:83], v[192:195]
    ds_read_b128 v[56:59], v6 offset:12288
    v_mfma_f32_16x16x32_bf16 v[196:199], v[120:123], v[84:87], v[196:199]
    ds_read_b128 v[60:63], v6 offset:14336
    s_and_b32 s47, s36, 15
    s_lshl_b32 s47, s47, 15
    s_lshr_b64 s[36:37], s[36:37], 4
    s_lshl_b32 s5, s42, 1
    s_add_u32 s47, s47, s5
    s_mov_b32 m0, s47
    s_nop 0
    buffer_load_dwordx4 v12, s[8:11], s38 offen offset:0 lds
    v_mfma_f32_16x16x32_bf16 v[200:203], v[120:123], v[88:91], v[200:203]
    ds_read_b64_tr_b16 v[72:73], v10 offset:1024
    v_mfma_f32_16x16x32_bf16 v[204:207], v[120:123], v[92:95], v[204:207]
    ds_read_b64_tr_b16 v[74:75], v10 offset:3072
    buffer_load_dwordx4 v13, s[8:11], s38 offen offset:1024 lds
    v_mfma_f32_16x16x32_bf16 v[208:211], v[120:123], v[96:99], v[208:211]
    ds_read_b64_tr_b16 v[68:69], v11 offset:0
    v_mfma_f32_16x16x32_bf16 v[212:215], v[120:123], v[100:103], v[212:215]
    ds_read_b64_tr_b16 v[70:71], v11 offset:2048
    buffer_load_dwordx4 v14, s[8:11], s38 offen offset:2048 lds
    v_mfma_f32_16x16x32_bf16 v[216:219], v[120:123], v[104:107], v[216:219]
    ds_read_b64_tr_b16 v[76:77], v11 offset:1024
    v_mfma_f32_16x16x32_bf16 v[220:223], v[120:123], v[108:111], v[220:223]
    ds_read_b64_tr_b16 v[78:79], v11 offset:3072
    buffer_load_dwordx4 v15, s[8:11], s38 offen offset:3072 lds
    s_add_u32 s38, s38, 65536
    v_mfma_f32_16x16x32_bf16 v[160:163], v[116:119], v[80:83], v[160:163]
    v_mfma_f32_16x16x32_bf16 v[164:167], v[116:119], v[84:87], v[164:167]
    s_add_u32 m0, s47, 4096
    s_nop 0
    buffer_load_dwordx4 v12, s[8:11], s38 offen offset:0 lds
    v_mfma_f32_16x16x32_bf16 v[168:171], v[116:119], v[88:91], v[168:171]
    v_mfma_f32_16x16x32_bf16 v[172:175], v[116:119], v[92:95], v[172:175]
    buffer_load_dwordx4 v13, s[8:11], s38 offen offset:1024 lds
    v_mfma_f32_16x16x32_bf16 v[176:179], v[116:119], v[96:99], v[176:179]
    v_mfma_f32_16x16x32_bf16 v[180:183], v[116:119], v[100:103], v[180:183]
    buffer_load_dwordx4 v14, s[8:11], s38 offen offset:2048 lds
    v_mfma_f32_16x16x32_bf16 v[184:187], v[116:119], v[104:107], v[184:187]
    v_mfma_f32_16x16x32_bf16 v[188:191], v[116:119], v[108:111], v[188:191]
    buffer_load_dwordx4 v15, s[8:11], s38 offen offset:3072 lds
    s_sub_u32 s38, s38, 65408
    v_mfma_f32_16x16x32_bf16 v[224:227], v[124:127], v[80:83], v[224:227]
    v_mfma_f32_16x16x32_bf16 v[228:231], v[124:127], v[84:87], v[228:231]
    s_add_u32 m0, s42, 16384
    s_nop 0
    buffer_load_dwordx4 v16, s[12:15], s39 offen  lds
    v_mfma_f32_16x16x32_bf16 v[232:235], v[124:127], v[88:91], v[232:235]
    v_mfma_f32_16x16x32_bf16 v[236:239], v[124:127], v[92:95], v[236:239]
    buffer_load_dwordx4 v16, s[16:19], s39 offen offset:1024  lds
    v_mfma_f32_16x16x32_bf16 v[240:243], v[124:127], v[96:99], v[240:243]
    v_mfma_f32_16x16x32_bf16 v[244:247], v[124:127], v[100:103], v[244:247]
    buffer_load_dwordx4 v17, s[12:15], s39 offen offset:2048  lds
    v_mfma_f32_16x16x32_bf16 v[248:251], v[124:127], v[104:107], v[248:251]
    v_mfma_f32_16x16x32_bf16 v[252:255], v[124:127], v[108:111], v[252:255]
    buffer_load_dwordx4 v17, s[16:19], s39 offen offset:3072  lds
    s_add_u32 s39, s39, 229376
    s_waitcnt lgkmcnt(0) vmcnt(16)
    s_barrier
    v_mfma_f32_16x16x32_bf16 v[128:131], v[64:67], v[32:35], v[128:131]
    ds_read_b64_tr_b16 v[112:113], v10 offset:16384
    v_mfma_f32_16x16x32_bf16 v[132:135], v[64:67], v[36:39], v[132:135]
    ds_read_b64_tr_b16 v[114:115], v10 offset:18432
    v_xor_b32 v6, 64, v6
    s_add_u32 m0, s42, 65536
    s_nop 0
    buffer_load_dwordx4 v16, s[12:15], s39 offen  lds
    v_mfma_f32_16x16x32_bf16 v[136:139], v[64:67], v[40:43], v[136:139]
    ds_read_b128 v[80:83], v6 offset:0
    v_mfma_f32_16x16x32_bf16 v[140:143], v[64:67], v[44:47], v[140:143]
    ds_read_b128 v[84:87], v6 offset:2048
    buffer_load_dwordx4 v16, s[16:19], s39 offen offset:1024  lds
    v_mfma_f32_16x16x32_bf16 v[144:147], v[64:67], v[48:51], v[144:147]
    ds_read_b128 v[88:91], v6 offset:4096
    v_mfma_f32_16x16x32_bf16 v[148:151], v[64:67], v[52:55], v[148:151]
    ds_read_b128 v[92:95], v6 offset:6144
    buffer_load_dwordx4 v17, s[12:15], s39 offen offset:2048  lds
    v_mfma_f32_16x16x32_bf16 v[152:155], v[64:67], v[56:59], v[152:155]
    ds_read_b128 v[96:99], v6 offset:8192
    v_mfma_f32_16x16x32_bf16 v[156:159], v[64:67], v[60:63], v[156:159]
    ds_read_b128 v[100:103], v6 offset:10240
    buffer_load_dwordx4 v17, s[16:19], s39 offen offset:3072  lds
    s_add_u32 s39, s39, 229376
    v_mfma_f32_16x16x32_bf16 v[192:195], v[72:75], v[32:35], v[192:195]
    ds_read_b128 v[104:107], v6 offset:12288
    v_mfma_f32_16x16x32_bf16 v[196:199], v[72:75], v[36:39], v[196:199]
    ds_read_b128 v[108:111], v6 offset:14336
    s_and_b32 s47, s36, 15
    s_lshl_b32 s47, s47, 15
    s_lshr_b64 s[36:37], s[36:37], 4
    s_lshl_b32 s5, s42, 1
    s_add_u32 s47, s47, s5
    s_mov_b32 m0, s47
    s_nop 0
    buffer_load_dwordx4 v12, s[8:11], s38 offen offset:0 lds
    v_mfma_f32_16x16x32_bf16 v[200:203], v[72:75], v[40:43], v[200:203]
    ds_read_b64_tr_b16 v[120:121], v10 offset:17408
    v_mfma_f32_16x16x32_bf16 v[204:207], v[72:75], v[44:47], v[204:207]
    ds_read_b64_tr_b16 v[122:123], v10 offset:19456
    buffer_load_dwordx4 v13, s[8:11], s38 offen offset:1024 lds
    v_mfma_f32_16x16x32_bf16 v[208:211], v[72:75], v[48:51], v[208:211]
    ds_read_b64_tr_b16 v[116:117], v11 offset:16384
    v_mfma_f32_16x16x32_bf16 v[212:215], v[72:75], v[52:55], v[212:215]
    ds_read_b64_tr_b16 v[118:119], v11 offset:18432
    buffer_load_dwordx4 v14, s[8:11], s38 offen offset:2048 lds
    v_mfma_f32_16x16x32_bf16 v[216:219], v[72:75], v[56:59], v[216:219]
    ds_read_b64_tr_b16 v[124:125], v11 offset:17408
    v_mfma_f32_16x16x32_bf16 v[220:223], v[72:75], v[60:63], v[220:223]
    ds_read_b64_tr_b16 v[126:127], v11 offset:19456
    buffer_load_dwordx4 v15, s[8:11], s38 offen offset:3072 lds
    s_add_u32 s38, s38, 65536
    v_mfma_f32_16x16x32_bf16 v[160:163], v[68:71], v[32:35], v[160:163]
    v_mfma_f32_16x16x32_bf16 v[164:167], v[68:71], v[36:39], v[164:167]
    s_add_u32 m0, s47, 4096
    s_nop 0
    buffer_load_dwordx4 v12, s[8:11], s38 offen offset:0 lds
    v_mfma_f32_16x16x32_bf16 v[168:171], v[68:71], v[40:43], v[168:171]
    v_mfma_f32_16x16x32_bf16 v[172:175], v[68:71], v[44:47], v[172:175]
    buffer_load_dwordx4 v13, s[8:11], s38 offen offset:1024 lds
    v_mfma_f32_16x16x32_bf16 v[176:179], v[68:71], v[48:51], v[176:179]
    v_mfma_f32_16x16x32_bf16 v[180:183], v[68:71], v[52:55], v[180:183]
    buffer_load_dwordx4 v14, s[8:11], s38 offen offset:2048 lds
    v_mfma_f32_16x16x32_bf16 v[184:187], v[68:71], v[56:59], v[184:187]
    v_mfma_f32_16x16x32_bf16 v[188:191], v[68:71], v[60:63], v[188:191]
    buffer_load_dwordx4 v15, s[8:11], s38 offen offset:3072 lds
    s_sub_u32 s38, s38, 65408
    s_add_u32 s38, s38, s46
    v_mfma_f32_16x16x32_bf16 v[224:227], v[76:79], v[32:35], v[224:227]
    v_mfma_f32_16x16x32_bf16 v[228:231], v[76:79], v[36:39], v[228:231]
    v_mfma_f32_16x16x32_bf16 v[232:235], v[76:79], v[40:43], v[232:235]
    v_mfma_f32_16x16x32_bf16 v[236:239], v[76:79], v[44:47], v[236:239]
    v_mfma_f32_16x16x32_bf16 v[240:243], v[76:79], v[48:51], v[240:243]
    v_mfma_f32_16x16x32_bf16 v[244:247], v[76:79], v[52:55], v[244:247]
    v_mfma_f32_16x16x32_bf16 v[248:251], v[76:79], v[56:59], v[248:251]
    v_mfma_f32_16x16x32_bf16 v[252:255], v[76:79], v[60:63], v[252:255]
    s_waitcnt lgkmcnt(0) vmcnt(16)
    s_barrier
    v_mfma_f32_16x16x32_bf16 v[128:131], v[112:115], v[80:83], v[128:131]
    ds_read_b64_tr_b16 v[64:65], v8 offset:0
    s_and_b32 s6, s34, 15
    s_lshl_b32 s6, s6, 15
    v_mfma_f32_16x16x32_bf16 v[132:135], v[112:115], v[84:87], v[132:135]
    ds_read_b64_tr_b16 v[66:67], v8 offset:2048
    s_lshr_b64 s[34:35], s[34:35], 4
    v_add_u32 v6, s6, v7
    s_add_u32 m0, s42, 81920
    s_nop 0
    buffer_load_dwordx4 v16, s[12:15], s39 offen  lds
    v_mfma_f32_16x16x32_bf16 v[136:139], v[112:115], v[88:91], v[136:139]
    ds_read_b128 v[32:35], v6 offset:0
    v_mfma_f32_16x16x32_bf16 v[140:143], v[112:115], v[92:95], v[140:143]
    ds_read_b128 v[36:39], v6 offset:2048
    v_mfma_f32_16x16x32_bf16 v[144:147], v[112:115], v[96:99], v[144:147]
    ds_read_b128 v[40:43], v6 offset:4096
    v_mfma_f32_16x16x32_bf16 v[148:151], v[112:115], v[100:103], v[148:151]
    ds_read_b128 v[44:47], v6 offset:6144
    buffer_load_dwordx4 v16, s[16:19], s39 offen offset:1024  lds
    v_mfma_f32_16x16x32_bf16 v[152:155], v[112:115], v[104:107], v[152:155]
    ds_read_b128 v[48:51], v6 offset:8192
    v_mfma_f32_16x16x32_bf16 v[156:159], v[112:115], v[108:111], v[156:159]
    ds_read_b128 v[52:55], v6 offset:10240
    v_mfma_f32_16x16x32_bf16 v[192:195], v[120:123], v[80:83], v[192:195]
    ds_read_b128 v[56:59], v6 offset:12288
    v_mfma_f32_16x16x32_bf16 v[196:199], v[120:123], v[84:87], v[196:199]
    ds_read_b128 v[60:63], v6 offset:14336
    buffer_load_dwordx4 v17, s[12:15], s39 offen offset:2048  lds
    v_mfma_f32_16x16x32_bf16 v[200:203], v[120:123], v[88:91], v[200:203]
    ds_read_b64_tr_b16 v[72:73], v8 offset:1024
    v_mfma_f32_16x16x32_bf16 v[204:207], v[120:123], v[92:95], v[204:207]
    ds_read_b64_tr_b16 v[74:75], v8 offset:3072
    v_mfma_f32_16x16x32_bf16 v[208:211], v[120:123], v[96:99], v[208:211]
    ds_read_b64_tr_b16 v[68:69], v9 offset:0
    v_mfma_f32_16x16x32_bf16 v[212:215], v[120:123], v[100:103], v[212:215]
    ds_read_b64_tr_b16 v[70:71], v9 offset:2048
    buffer_load_dwordx4 v17, s[16:19], s39 offen offset:3072  lds
    s_add_u32 s39, s39, 229376
    v_mfma_f32_16x16x32_bf16 v[216:219], v[120:123], v[104:107], v[216:219]
    ds_read_b64_tr_b16 v[76:77], v9 offset:1024
    v_mfma_f32_16x16x32_bf16 v[220:223], v[120:123], v[108:111], v[220:223]
    ds_read_b64_tr_b16 v[78:79], v9 offset:3072
    v_mfma_f32_16x16x32_bf16 v[160:163], v[116:119], v[80:83], v[160:163]
    v_mfma_f32_16x16x32_bf16 v[164:167], v[116:119], v[84:87], v[164:167]
    s_and_b32 s47, s36, 15
    s_lshl_b32 s47, s47, 15
    s_lshr_b64 s[36:37], s[36:37], 4
    s_lshl_b32 s5, s42, 1
    s_add_u32 s47, s47, s5
    s_mov_b32 m0, s47
    s_nop 0
    buffer_load_dwordx4 v12, s[8:11], s38 offen offset:0 lds
    v_mfma_f32_16x16x32_bf16 v[168:171], v[116:119], v[88:91], v[168:171]
    v_mfma_f32_16x16x32_bf16 v[172:175], v[116:119], v[92:95], v[172:175]
    v_mfma_f32_16x16x32_bf16 v[176:179], v[116:119], v[96:99], v[176:179]
    v_mfma_f32_16x16x32_bf16 v[180:183], v[116:119], v[100:103], v[180:183]
    buffer_load_dwordx4 v13, s[8:11], s38 offen offset:1024 lds
    v_mfma_f32_16x16x32_bf16 v[184:187], v[116:119], v[104:107], v[184:187]
    v_mfma_f32_16x16x32_bf16 v[188:191], v[116:119], v[108:111], v[188:191]
    v_mfma_f32_16x16x32_bf16 v[224:227], v[124:127], v[80:83], v[224:227]
    v_mfma_f32_16x16x32_bf16 v[228:231], v[124:127], v[84:87], v[228:231]
    buffer_load_dwordx4 v14, s[8:11], s38 offen offset:2048 lds
    v_mfma_f32_16x16x32_bf16 v[232:235], v[124:127], v[88:91], v[232:235]
    v_mfma_f32_16x16x32_bf16 v[236:239], v[124:127], v[92:95], v[236:239]
    v_mfma_f32_16x16x32_bf16 v[240:243], v[124:127], v[96:99], v[240:243]
    v_mfma_f32_16x16x32_bf16 v[244:247], v[124:127], v[100:103], v[244:247]
    buffer_load_dwordx4 v15, s[8:11], s38 offen offset:3072 lds
    s_add_u32 s38, s38, 65536
    v_mfma_f32_16x16x32_bf16 v[248:251], v[124:127], v[104:107], v[248:251]
    v_mfma_f32_16x16x32_bf16 v[252:255], v[124:127], v[108:111], v[252:255]
    s_mov_b32 s43, 6
    s_mul_i32 s7, s40, 229376
    s_add_u32 s39, s39, s7
    s_mov_b32 s46, 0
.p2align 6
L_g1_dloop:
    s_waitcnt lgkmcnt(0) vmcnt(16)
    s_barrier
    v_mfma_f32_16x16x32_bf16 v[128:131], v[64:67], v[32:35], v[128:131]
    ds_read_b64_tr_b16 v[112:113], v8 offset:16384
    v_mfma_f32_16x16x32_bf16 v[132:135], v[64:67], v[36:39], v[132:135]
    ds_read_b64_tr_b16 v[114:115], v8 offset:18432
    v_xor_b32 v6, 64, v6
    s_add_u32 m0, s42, 0
    s_nop 0
    buffer_load_dwordx4 v16, s[12:15], s39 offen  lds
    v_mfma_f32_16x16x32_bf16 v[136:139], v[64:67], v[40:43], v[136:139]
    ds_read_b128 v[80:83], v6 offset:0
    v_mfma_f32_16x16x32_bf16 v[140:143], v[64:67], v[44:47], v[140:143]
    ds_read_b128 v[84:87], v6 offset:2048
    v_mfma_f32_16x16x32_bf16 v[144:147], v[64:67], v[48:51], v[144:147]
    ds_read_b128 v[88:91], v6 offset:4096
    v_mfma_f32_16x16x32_bf16 v[148:151], v[64:67], v[52:55], v[148:151]
    ds_read_b128 v[92:95], v6 offset:6144
    buffer_load_dwordx4 v16, s[16:19], s39 offen offset:1024  lds
    v_mfma_f32_16x16x32_bf16 v[152:155], v[64:67], v[56:59], v[152:155]
    ds_read_b128 v[96:99], v6 offset:8192
    v_mfma_f32_16x16x32_bf16 v[156:159], v[64:67], v[60:63], v[156:159]
    ds_read_b128 v[100:103], v6 offset:10240
    v_mfma_f32_16x16x32_bf16 v[192:195], v[72:75], v[32:35], v[192:195]
    ds_read_b128 v[104:107], v6 offset:12288
    v_mfma_f32_16x16x32_bf16 v[196:199], v[72:75], v[36:39], v[196:199]
    ds_read_b128 v[108:111], v6 offset:14336
    buffer_load_dwordx4 v17, s[12:15], s39 offen offset:2048  lds
    v_mfma_f32_16x16x32_bf16 v[200:203], v[72:75], v[40:43], v[200:203]
    ds_read_b64_tr_b16 v[120:121], v8 offset:17408
    v_mfma_f32_16x16x32_bf16 v[204:207], v[72:75], v[44:47], v[204:207]
    ds_read_b64_tr_b16 v[122:123], v8 offset:19456
    v_mfma_f32_16x16x32_bf16 v[208:211], v[72:75], v[48:51], v[208:211]
    ds_read_b64_tr_b16 v[116:117], v9 offset:16384
    v_mfma_f32_16x16x32_bf16 v[212:215], v[72:75], v[52:55], v[212:215]
    ds_read_b64_tr_b16 v[118:119], v9 offset:18432
    buffer_load_dwordx4 v17, s[16:19], s39 offen offset:3072  lds
    s_add_u32 s39, s39, 229376
    v_mfma_f32_16x16x32_bf16 v[216:219], v[72:75], v[56:59], v[216:219]
    ds_read_b64_tr_b16 v[124:125], v9 offset:17408
    v_mfma_f32_16x16x32_bf16 v[220:223], v[72:75], v[60:63], v[220:223]
    ds_read_b64_tr_b16 v[126:127], v9 offset:19456
    v_mfma_f32_16x16x32_bf16 v[160:163], v[68:71], v[32:35], v[160:163]
    v_mfma_f32_16x16x32_bf16 v[164:167], v[68:71], v[36:39], v[164:167]
    s_add_u32 m0, s47, 4096
    s_nop 0
    buffer_load_dwordx4 v12, s[8:11], s38 offen offset:0 lds
    v_mfma_f32_16x16x32_bf16 v[168:171], v[68:71], v[40:43], v[168:171]
    v_mfma_f32_16x16x32_bf16 v[172:175], v[68:71], v[44:47], v[172:175]
    v_mfma_f32_16x16x32_bf16 v[176:179], v[68:71], v[48:51], v[176:179]
    v_mfma_f32_16x16x32_bf16 v[180:183], v[68:71], v[52:55], v[180:183]
    buffer_load_dwordx4 v13, s[8:11], s38 offen offset:1024 lds
    v_mfma_f32_16x16x32_bf16 v[184:187], v[68:71], v[56:59], v[184:187]
    v_mfma_f32_16x16x32_bf16 v[188:191], v[68:71], v[60:63], v[188:191]
    v_mfma_f32_16x16x32_bf16 v[224:227], v[76:79], v[32:35], v[224:227]
    v_mfma_f32_16x16x32_bf16 v[228:231], v[76:79], v[36:39], v[228:231]
    buffer_load_dwordx4 v14, s[8:11], s38 offen offset:2048 lds
    v_mfma_f32_16x16x32_bf16 v[232:235], v[76:79], v[40:43], v[232:235]
    v_mfma_f32_16x16x32_bf16 v[236:239], v[76:79], v[44:47], v[236:239]
    v_mfma_f32_16x16x32_bf16 v[240:243], v[76:79], v[48:51], v[240:243]
    v_mfma_f32_16x16x32_bf16 v[244:247], v[76:79], v[52:55], v[244:247]
    buffer_load_dwordx4 v15, s[8:11], s38 offen offset:3072 lds
    s_sub_u32 s38, s38, 65408
    v_mfma_f32_16x16x32_bf16 v[248:251], v[76:79], v[56:59], v[248:251]
    v_mfma_f32_16x16x32_bf16 v[252:255], v[76:79], v[60:63], v[252:255]
    s_waitcnt lgkmcnt(0) vmcnt(16)
    s_barrier
    v_mfma_f32_16x16x32_bf16 v[128:131], v[112:115], v[80:83], v[128:131]
    ds_read_b64_tr_b16 v[64:65], v10 offset:0
    s_and_b32 s6, s34, 15
    s_lshl_b32 s6, s6, 15
    v_mfma_f32_16x16x32_bf16 v[132:135], v[112:115], v[84:87], v[132:135]
    ds_read_b64_tr_b16 v[66:67], v10 offset:2048
    s_lshr_b64 s[34:35], s[34:35], 4
    v_add_u32 v6, s6, v7
    s_add_u32 m0, s42, 16384
    s_nop 0
    buffer_load_dwordx4 v16, s[12:15], s39 offen  lds
    v_mfma_f32_16x16x32_bf16 v[136:139], v[112:115], v[88:91], v[136:139]
    ds_read_b128 v[32:35], v6 offset:0
    v_mfma_f32_16x16x32_bf16 v[140:143], v[112:115], v[92:95], v[140:143]
    ds_read_b128 v[36:39], v6 offset:2048
    v_mfma_f32_16x16x32_bf16 v[144:147], v[112:115], v[96:99], v[144:147]
    ds_read_b128 v[40:43], v6 offset:4096
    v_mfma_f32_16x16x32_bf16 v[148:151], v[112:115], v[100:103], v[148:151]
    ds_read_b128 v[44:47], v6 offset:6144
    buffer_load_dwordx4 v16, s[16:19], s39 offen offset:1024  lds
    v_mfma_f32_16x16x32_bf16 v[152:155], v[112:115], v[104:107], v[152:155]
    ds_read_b128 v[48:51], v6 offset:8192
    v_mfma_f32_16x16x32_bf16 v[156:159], v[112:115], v[108:111], v[156:159]
    ds_read_b128 v[52:55], v6 offset:10240
    v_mfma_f32_16x16x32_bf16 v[192:195], v[120:123], v[80:83], v[192:195]
    ds_read_b128 v[56:59], v6 offset:12288
    v_mfma_f32_16x16x32_bf16 v[196:199], v[120:123], v[84:87], v[196:199]
    ds_read_b128 v[60:63], v6 offset:14336
    buffer_load_dwordx4 v17, s[12:15], s39 offen offset:2048  lds
    v_mfma_f32_16x16x32_bf16 v[200:203], v[120:123], v[88:91], v[200:203]
    ds_read_b64_tr_b16 v[72:73], v10 offset:1024
    v_mfma_f32_16x16x32_bf16 v[204:207], v[120:123], v[92:95], v[204:207]
    ds_read_b64_tr_b16 v[74:75], v10 offset:3072
    v_mfma_f32_16x16x32_bf16 v[208:211], v[120:123], v[96:99], v[208:211]
    ds_read_b64_tr_b16 v[68:69], v11 offset:0
    v_mfma_f32_16x16x32_bf16 v[212:215], v[120:123], v[100:103], v[212:215]
    ds_read_b64_tr_b16 v[70:71], v11 offset:2048
    buffer_load_dwordx4 v17, s[16:19], s39 offen offset:3072  lds
    s_add_u32 s39, s39, 229376
    v_mfma_f32_16x16x32_bf16 v[216:219], v[120:123], v[104:107], v[216:219]
    ds_read_b64_tr_b16 v[76:77], v11 offset:1024
    v_mfma_f32_16x16x32_bf16 v[220:223], v[120:123], v[108:111], v[220:223]
    ds_read_b64_tr_b16 v[78:79], v11 offset:3072
    v_mfma_f32_16x16x32_bf16 v[160:163], v[116:119], v[80:83], v[160:163]
    v_mfma_f32_16x16x32_bf16 v[164:167], v[116:119], v[84:87], v[164:167]
    s_and_b32 s47, s36, 15
    s_lshl_b32 s47, s47, 15
    s_lshr_b64 s[36:37], s[36:37], 4
    s_lshl_b32 s5, s42, 1
    s_add_u32 s47, s47, s5
    s_mov_b32 m0, s47
    s_nop 0
    buffer_load_dwordx4 v12, s[8:11], s38 offen offset:0 lds
    v_mfma_f32_16x16x32_bf16 v[168:171], v[116:119], v[88:91], v[168:171]
    v_mfma_f32_16x16x32_bf16 v[172:175], v[116:119], v[92:95], v[172:175]
    v_mfma_f32_16x16x32_bf16 v[176:179], v[116:119], v[96:99], v[176:179]
    v_mfma_f32_16x16x32_bf16 v[180:183], v[116:119], v[100:103], v[180:183]
    buffer_load_dwordx4 v13, s[8:11], s38 offen offset:1024 lds
    v_mfma_f32_16x16x32_bf16 v[184:187], v[116:119], v[104:107], v[184:187]
    v_mfma_f32_16x16x32_bf16 v[188:191], v[116:119], v[108:111], v[188:191]
    v_mfma_f32_16x16x32_bf16 v[224:227], v[124:127], v[80:83], v[224:227]
    v_mfma_f32_16x16x32_bf16 v[228:231], v[124:127], v[84:87], v[228:231]
    buffer_load_dwordx4 v14, s[8:11], s38 offen offset:2048 lds
    v_mfma_f32_16x16x32_bf16 v[232:235], v[124:127], v[88:91], v[232:235]
    v_mfma_f32_16x16x32_bf16 v[236:239], v[124:127], v[92:95], v[236:239]
    v_mfma_f32_16x16x32_bf16 v[240:243], v[124:127], v[96:99], v[240:243]
    v_mfma_f32_16x16x32_bf16 v[244:247], v[124:127], v[100:103], v[244:247]
    buffer_load_dwordx4 v15, s[8:11], s38 offen offset:3072 lds
    s_add_u32 s38, s38, 65536
    v_mfma_f32_16x16x32_bf16 v[248:251], v[124:127], v[104:107], v[248:251]
    v_mfma_f32_16x16x32_bf16 v[252:255], v[124:127], v[108:111], v[252:255]
    s_waitcnt lgkmcnt(0) vmcnt(16)
    s_barrier
    v_mfma_f32_16x16x32_bf16 v[128:131], v[64:67], v[32:35], v[128:131]
    ds_read_b64_tr_b16 v[112:113], v10 offset:16384
    v_mfma_f32_16x16x32_bf16 v[132:135], v[64:67], v[36:39], v[132:135]
    ds_read_b64_tr_b16 v[114:115], v10 offset:18432
    v_xor_b32 v6, 64, v6
    s_add_u32 m0, s42, 65536
    s_nop 0
    buffer_load_dwordx4 v16, s[12:15], s39 offen  lds
    v_mfma_f32_16x16x32_bf16 v[136:139], v[64:67], v[40:43], v[136:139]
    ds_read_b128 v[80:83], v6 offset:0
    v_mfma_f32_16x16x32_bf16 v[140:143], v[64:67], v[44:47], v[140:143]
    ds_read_b128 v[84:87], v6 offset:2048
    v_mfma_f32_16x16x32_bf16 v[144:147], v[64:67], v[48:51], v[144:147]
    ds_read_b128 v[88:91], v6 offset:4096
    v_mfma_f32_16x16x32_bf16 v[148:151], v[64:67], v[52:55], v[148:151]
    ds_read_b128 v[92:95], v6 offset:6144
    buffer_load_dwordx4 v16, s[16:19], s39 offen offset:1024  lds
    v_mfma_f32_16x16x32_bf16 v[152:155], v[64:67], v[56:59], v[152:155]
    ds_read_b128 v[96:99], v6 offset:8192
    v_mfma_f32_16x16x32_bf16 v[156:159], v[64:67], v[60:63], v[156:159]
    ds_read_b128 v[100:103], v6 offset:10240
    v_mfma_f32_16x16x32_bf16 v[192:195], v[72:75], v[32:35], v[192:195]
    ds_read_b128 v[104:107], v6 offset:12288
    v_mfma_f32_16x16x32_bf16 v[196:199], v[72:75], v[36:39], v[196:199]
    ds_read_b128 v[108:111], v6 offset:14336
    buffer_load_dwordx4 v17, s[12:15], s39 offen offset:2048  lds
    v_mfma_f32_16x16x32_bf16 v[200:203], v[72:75], v[40:43], v[200:203]
    ds_read_b64_tr_b16 v[120:121], v10 offset:17408
    v_mfma_f32_16x16x32_bf16 v[204:207], v[72:75], v[44:47], v[204:207]
    ds_read_b64_tr_b16 v[122:123], v10 offset:19456
    v_mfma_f32_16x16x32_bf16 v[208:211], v[72:75], v[48:51], v[208:211]
    ds_read_b64_tr_b16 v[116:117], v11 offset:16384
    v_mfma_f32_16x16x32_bf16 v[212:215], v[72:75], v[52:55], v[212:215]
    ds_read_b64_tr_b16 v[118:119], v11 offset:18432
    buffer_load_dwordx4 v17, s[16:19], s39 offen offset:3072  lds
    s_add_u32 s39, s39, 229376
    v_mfma_f32_16x16x32_bf16 v[216:219], v[72:75], v[56:59], v[216:219]
    ds_read_b64_tr_b16 v[124:125], v11 offset:17408
    v_mfma_f32_16x16x32_bf16 v[220:223], v[72:75], v[60:63], v[220:223]
    ds_read_b64_tr_b16 v[126:127], v11 offset:19456
    v_mfma_f32_16x16x32_bf16 v[160:163], v[68:71], v[32:35], v[160:163]
    v_mfma_f32_16x16x32_bf16 v[164:167], v[68:71], v[36:39], v[164:167]
    s_add_u32 m0, s47, 4096
    s_nop 0
    buffer_load_dwordx4 v12, s[8:11], s38 offen offset:0 lds
    v_mfma_f32_16x16x32_bf16 v[168:171], v[68:71], v[40:43], v[168:171]
    v_mfma_f32_16x16x32_bf16 v[172:175], v[68:71], v[44:47], v[172:175]
    v_mfma_f32_16x16x32_bf16 v[176:179], v[68:71], v[48:51], v[176:179]
    v_mfma_f32_16x16x32_bf16 v[180:183], v[68:71], v[52:55], v[180:183]
    buffer_load_dwordx4 v13, s[8:11], s38 offen offset:1024 lds
    v_mfma_f32_16x16x32_bf16 v[184:187], v[68:71], v[56:59], v[184:187]
    v_mfma_f32_16x16x32_bf16 v[188:191], v[68:71], v[60:63], v[188:191]
    v_mfma_f32_16x16x32_bf16 v[224:227], v[76:79], v[32:35], v[224:227]
    v_mfma_f32_16x16x32_bf16 v[228:231], v[76:79], v[36:39], v[228:231]
    buffer_load_dwordx4 v14, s[8:11], s38 offen offset:2048 lds
    v_mfma_f32_16x16x32_bf16 v[232:235], v[76:79], v[40:43], v[232:235]
    v_mfma_f32_16x16x32_bf16 v[236:239], v[76:79], v[44:47], v[236:239]
    v_mfma_f32_16x16x32_bf16 v[240:243], v[76:79], v[48:51], v[240:243]
    v_mfma_f32_16x16x32_bf16 v[244:247], v[76:79], v[52:55], v[244:247]
    buffer_load_dwordx4 v15, s[8:11], s38 offen offset:3072 lds
    s_sub_u32 s38, s38, 65408
    s_add_u32 s38, s38, s46
    v_mfma_f32_16x16x32_bf16 v[248:251], v[76:79], v[56:59], v[248:251]
    v_mfma_f32_16x16x32_bf16 v[252:255], v[76:79], v[60:63], v[252:255]
    s_waitcnt lgkmcnt(0) vmcnt(16)
    s_barrier
    v_mfma_f32_16x16x32_bf16 v[128:131], v[112:115], v[80:83], v[128:131]
    ds_read_b64_tr_b16 v[64:65], v8 offset:0
    s_and_b32 s6, s34, 15
    s_lshl_b32 s6, s6, 15
    v_mfma_f32_16x16x32_bf16 v[132:135], v[112:115], v[84:87], v[132:135]
    ds_read_b64_tr_b16 v[66:67], v8 offset:2048
    s_lshr_b64 s[34:35], s[34:35], 4
    v_add_u32 v6, s6, v7
    s_add_u32 m0, s42, 81920
    s_nop 0
    buffer_load_dwordx4 v16, s[12:15], s39 offen  lds
    v_mfma_f32_16x16x32_bf16 v[136:139], v[112:115], v[88:91], v[136:139]
    ds_read_b128 v[32:35], v6 offset:0
    v_mfma_f32_16x16x32_bf16 v[140:143], v[112:115], v[92:95], v[140:143]
    ds_read_b128 v[36:39], v6 offset:2048
    v_mfma_f32_16x16x32_bf16 v[144:147], v[112:115], v[96:99], v[144:147]
    ds_read_b128 v[40:43], v6 offset:4096
    v_mfma_f32_16x16x32_bf16 v[148:151], v[112:115], v[100:103], v[148:151]
    ds_read_b128 v[44:47], v6 offset:6144
    buffer_load_dwordx4 v16, s[16:19], s39 offen offset:1024  lds
    v_mfma_f32_16x16x32_bf16 v[152:155], v[112:115], v[104:107], v[152:155]
    ds_read_b128 v[48:51], v6 offset:8192
    v_mfma_f32_16x16x32_bf16 v[156:159], v[112:115], v[108:111], v[156:159]
    ds_read_b128 v[52:55], v6 offset:10240
    v_mfma_f32_16x16x32_bf16 v[192:195], v[120:123], v[80:83], v[192:195]
    ds_read_b128 v[56:59], v6 offset:12288
    v_mfma_f32_16x16x32_bf16 v[196:199], v[120:123], v[84:87], v[196:199]
    ds_read_b128 v[60:63], v6 offset:14336
    buffer_load_dwordx4 v17, s[12:15], s39 offen offset:2048  lds
    v_mfma_f32_16x16x32_bf16 v[200:203], v[120:123], v[88:91], v[200:203]
    ds_read_b64_tr_b16 v[72:73], v8 offset:1024
    v_mfma_f32_16x16x32_bf16 v[204:207], v[120:123], v[92:95], v[204:207]
    ds_read_b64_tr_b16 v[74:75], v8 offset:3072
    v_mfma_f32_16x16x32_bf16 v[208:211], v[120:123], v[96:99], v[208:211]
    ds_read_b64_tr_b16 v[68:69], v9 offset:0
    v_mfma_f32_16x16x32_bf16 v[212:215], v[120:123], v[100:103], v[212:215]
    ds_read_b64_tr_b16 v[70:71], v9 offset:2048
    buffer_load_dwordx4 v17, s[16:19], s39 offen offset:3072  lds
    s_add_u32 s39, s39, 229376
    v_mfma_f32_16x16x32_bf16 v[216:219], v[120:123], v[104:107], v[216:219]
    ds_read_b64_tr_b16 v[76:77], v9 offset:1024
    v_mfma_f32_16x16x32_bf16 v[220:223], v[120:123], v[108:111], v[220:223]
    ds_read_b64_tr_b16 v[78:79], v9 offset:3072
    v_mfma_f32_16x16x32_bf16 v[160:163], v[116:119], v[80:83], v[160:163]
    v_mfma_f32_16x16x32_bf16 v[164:167], v[116:119], v[84:87], v[164:167]
    s_and_b32 s47, s36, 15
    s_lshl_b32 s47, s47, 15
    s_lshr_b64 s[36:37], s[36:37], 4
    s_lshl_b32 s5, s42, 1
    s_add_u32 s47, s47, s5
    s_mov_b32 m0, s47
    s_nop 0
    buffer_load_dwordx4 v12, s[8:11], s38 offen offset:0 lds
    v_mfma_f32_16x16x32_bf16 v[168:171], v[116:119], v[88:91], v[168:171]
    v_mfma_f32_16x16x32_bf16 v[172:175], v[116:119], v[92:95], v[172:175]
    v_mfma_f32_16x16x32_bf16 v[176:179], v[116:119], v[96:99], v[176:179]
    v_mfma_f32_16x16x32_bf16 v[180:183], v[116:119], v[100:103], v[180:183]
    buffer_load_dwordx4 v13, s[8:11], s38 offen offset:1024 lds
    v_mfma_f32_16x16x32_bf16 v[184:187], v[116:119], v[104:107], v[184:187]
    v_mfma_f32_16x16x32_bf16 v[188:191], v[116:119], v[108:111], v[188:191]
    v_mfma_f32_16x16x32_bf16 v[224:227], v[124:127], v[80:83], v[224:227]
    v_mfma_f32_16x16x32_bf16 v[228:231], v[124:127], v[84:87], v[228:231]
    buffer_load_dwordx4 v14, s[8:11], s38 offen offset:2048 lds
    v_mfma_f32_16x16x32_bf16 v[232:235], v[124:127], v[88:91], v[232:235]
    v_mfma_f32_16x16x32_bf16 v[236:239], v[124:127], v[92:95], v[236:239]
    v_mfma_f32_16x16x32_bf16 v[240:243], v[124:127], v[96:99], v[240:243]
    v_mfma_f32_16x16x32_bf16 v[244:247], v[124:127], v[100:103], v[244:247]
    buffer_load_dwordx4 v15, s[8:11], s38 offen offset:3072 lds
    s_add_u32 s38, s38, 65536
    v_mfma_f32_16x16x32_bf16 v[248:251], v[124:127], v[104:107], v[248:251]
    v_mfma_f32_16x16x32_bf16 v[252:255], v[124:127], v[108:111], v[252:255]
    s_sub_u32 s43, s43, 1
    s_cmp_eq_u32 s43, 3
    s_cselect_b32 s5, s41, 0
    s_mul_i32 s7, s5, 229376
    s_add_u32 s39, s39, s7
    s_cmp_eq_u32 s43, 4
    s_cselect_b32 s5, s41, 0
    s_mul_i32 s46, s5, 64
    s_cmp_lg_u32 s43, 0
    s_cbranch_scc1 L_g1_dloop
    s_waitcnt lgkmcnt(0) vmcnt(16)
    s_barrier
    v_mfma_f32_16x16x32_bf16 v[128:131], v[64:67], v[32:35], v[128:131]
    ds_read_b64_tr_b16 v[112:113], v8 offset:16384
    v_mfma_f32_16x16x32_bf16 v[132:135], v[64:67], v[36:39], v[132:135]
    ds_read_b64_tr_b16 v[114:115], v8 offset:18432
    v_xor_b32 v6, 64, v6
    s_getpc_b64 s[8:9]
L_p3_pcg:
    s_add_u32 s8, s8, spec_tables-L_p3_pcg
    s_addc_u32 s9, s9, 0
    s_mov_b32 s10, 67584
    s_mov_b32 s11, 0x20000
    v_lshlrev_b32 v28, 4, v1
    s_lshl_b32 s5, s31, 12
    s_add_u32 m0, s5, 131072
    s_add_u32 s5, s5, 51200
    buffer_load_dwordx4 v28, s[8:11], s5 offen offset:0 lds
    v_mfma_f32_16x16x32_bf16 v[136:139], v[64:67], v[40:43], v[136:139]
    ds_read_b128 v[80:83], v6 offset:0
    v_mfma_f32_16x16x32_bf16 v[140:143], v[64:67], v[44:47], v[140:143]
    ds_read_b128 v[84:87], v6 offset:2048
    v_mfma_f32_16x16x32_bf16 v[144:147], v[64:67], v[48:51], v[144:147]
    ds_read_b128 v[88:91], v6 offset:4096
    v_mfma_f32_16x16x32_bf16 v[148:151], v[64:67], v[52:55], v[148:151]
    ds_read_b128 v[92:95], v6 offset:6144
    buffer_load_dwordx4 v28, s[8:11], s5 offen offset:1024 lds
    v_mfma_f32_16x16x32_bf16 v[152:155], v[64:67], v[56:59], v[152:155]
    ds_read_b128 v[96:99], v6 offset:8192
    v_mfma_f32_16x16x32_bf16 v[156:159], v[64:67], v[60:63], v[156:159]
    ds_read_b128 v[100:103], v6 offset:10240
    v_mfma_f32_16x16x32_bf16 v[192:195], v[72:75], v[32:35], v[192:195]
    ds_read_b128 v[104:107], v6 offset:12288
    v_mfma_f32_16x16x32_bf16 v[196:199], v[72:75], v[36:39], v[196:199]
    ds_read_b128 v[108:111], v6 offset:14336
    buffer_load_dwordx4 v28, s[8:11], s5 offen offset:2048 lds
    v_mfma_f32_16x16x32_bf16 v[200:203], v[72:75], v[40:43], v[200:203]
    ds_read_b64_tr_b16 v[120:121], v8 offset:17408
    v_mfma_f32_16x16x32_bf16 v[204:207], v[72:75], v[44:47], v[204:207]
    ds_read_b64_tr_b16 v[122:123], v8 offset:19456
    v_mfma_f32_16x16x32_bf16 v[208:211], v[72:75], v[48:51], v[208:211]
    ds_read_b64_tr_b16 v[116:117], v9 offset:16384
    v_mfma_f32_16x16x32_bf16 v[212:215], v[72:75], v[52:55], v[212:215]
    ds_read_b64_tr_b16 v[118:119], v9 offset:18432
    buffer_load_dwordx4 v28, s[8:11], s5 offen offset:3072 lds
    v_mfma_f32_16x16x32_bf16 v[216:219], v[72:75], v[56:59], v[216:219]
    ds_read_b64_tr_b16 v[124:125], v9 offset:17408
    v_mfma_f32_16x16x32_bf16 v[220:223], v[72:75], v[60:63], v[220:223]
    ds_read_b64_tr_b16 v[126:127], v9 offset:19456
    v_mfma_f32_16x16x32_bf16 v[160:163], v[68:71], v[32:35], v[160:163]
    v_mfma_f32_16x16x32_bf16 v[164:167], v[68:71], v[36:39], v[164:167]
    v_mfma_f32_16x16x32_bf16 v[168:171], v[68:71], v[40:43], v[168:171]
    v_mfma_f32_16x16x32_bf16 v[172:175], v[68:71], v[44:47], v[172:175]
    v_mfma_f32_16x16x32_bf16 v[176:179], v[68:71], v[48:51], v[176:179]
    v_mfma_f32_16x16x32_bf16 v[180:183], v[68:71], v[52:55], v[180:183]
    v_mfma_f32_16x16x32_bf16 v[184:187], v[68:71], v[56:59], v[184:187]
    v_mfma_f32_16x16x32_bf16 v[188:191], v[68:71], v[60:63], v[188:191]
    v_mfma_f32_16x16x32_bf16 v[224:227], v[76:79], v[32:35], v[224:227]
    v_mfma_f32_16x16x32_bf16 v[228:231], v[76:79], v[36:39], v[228:231]
    v_mfma_f32_16x16x32_bf16 v[232:235], v[76:79], v[40:43], v[232:235]
    v_mfma_f32_16x16x32_bf16 v[236:239], v[76:79], v[44:47], v[236:239]
    v_mfma_f32_16x16x32_bf16 v[240:243], v[76:79], v[48:51], v[240:243]
    v_mfma_f32_16x16x32_bf16 v[244:247], v[76:79], v[52:55], v[244:247]
    v_mfma_f32_16x16x32_bf16 v[248:251], v[76:79], v[56:59], v[248:251]
    v_mfma_f32_16x16x32_bf16 v[252:255], v[76:79], v[60:63], v[252:255]
    s_waitcnt lgkmcnt(0) vmcnt(0)
    s_barrier
    v_mfma_f32_16x16x32_bf16 v[128:131], v[112:115], v[80:83], v[128:131]
    ds_read_b64_tr_b16 v[64:65], v10 offset:0
    s_and_b32 s6, s34, 15
    s_lshl_b32 s6, s6, 15
    v_mfma_f32_16x16x32_bf16 v[132:135], v[112:115], v[84:87], v[132:135]
    ds_read_b64_tr_b16 v[66:67], v10 offset:2048
    s_lshr_b64 s[34:35], s[34:35], 4
    v_add_u32 v6, s6, v7
    s_add_u32 m0, s97, 0
    s_nop 0
    buffer_load_dwordx4 v24, s[92:95], s96 offen lds
    v_mfma_f32_16x16x32_bf16 v[136:139], v[112:115], v[88:91], v[136:139]
    ds_read_b128 v[32:35], v6 offset:0
    v_mfma_f32_16x16x32_bf16 v[140:143], v[112:115], v[92:95], v[140:143]
    ds_read_b128 v[36:39], v6 offset:2048
    v_mfma_f32_16x16x32_bf16 v[144:147], v[112:115], v[96:99], v[144:147]
    ds_read_b128 v[40:43], v6 offset:4096
    v_mfma_f32_16x16x32_bf16 v[148:151], v[112:115], v[100:103], v[148:151]
    ds_read_b128 v[44:47], v6 offset:6144
    buffer_load_dwordx4 v25, s[92:95], s96 offen offset:1024 lds
    v_mfma_f32_16x16x32_bf16 v[152:155], v[112:115], v[104:107], v[152:155]
    ds_read_b128 v[48:51], v6 offset:8192
    v_mfma_f32_16x16x32_bf16 v[156:159], v[112:115], v[108:111], v[156:159]
    ds_read_b128 v[52:55], v6 offset:10240
    v_mfma_f32_16x16x32_bf16 v[192:195], v[120:123], v[80:83], v[192:195]
    ds_read_b128 v[56:59], v6 offset:12288
    v_mfma_f32_16x16x32_bf16 v[196:199], v[120:123], v[84:87], v[196:199]
    ds_read_b128 v[60:63], v6 offset:14336
    buffer_load_dwordx4 v26, s[92:95], s96 offen offset:2048 lds
    v_mfma_f32_16x16x32_bf16 v[200:203], v[120:123], v[88:91], v[200:203]
    ds_read_b64_tr_b16 v[72:73], v10 offset:1024
    v_mfma_f32_16x16x32_bf16 v[204:207], v[120:123], v[92:95], v[204:207]
    ds_read_b64_tr_b16 v[74:75], v10 offset:3072
    v_mfma_f32_16x16x32_bf16 v[208:211], v[120:123], v[96:99], v[208:211]
    ds_read_b64_tr_b16 v[68:69], v11 offset:0
    v_mfma_f32_16x16x32_bf16 v[212:215], v[120:123], v[100:103], v[212:215]
    ds_read_b64_tr_b16 v[70:71], v11 offset:2048
    buffer_load_dwordx4 v27, s[92:95], s96 offen offset:3072 lds
    s_add_u32 s5, s96, 131072
    v_mfma_f32_16x16x32_bf16 v[216:219], v[120:123], v[104:107], v[216:219]
    ds_read_b64_tr_b16 v[76:77], v11 offset:1024
    v_mfma_f32_16x16x32_bf16 v[220:223], v[120:123], v[108:111], v[220:223]
    ds_read_b64_tr_b16 v[78:79], v11 offset:3072
    v_mfma_f32_16x16x32_bf16 v[160:163], v[116:119], v[80:83], v[160:163]
    v_mfma_f32_16x16x32_bf16 v[164:167], v[116:119], v[84:87], v[164:167]
    s_add_u32 m0, s97, 16384
    s_nop 0
    buffer_load_dwordx4 v24, s[92:95], s5 offen lds
    v_mfma_f32_16x16x32_bf16 v[168:171], v[116:119], v[88:91], v[168:171]
    v_mfma_f32_16x16x32_bf16 v[172:175], v[116:119], v[92:95], v[172:175]
    v_mfma_f32_16x16x32_bf16 v[176:179], v[116:119], v[96:99], v[176:179]
    v_mfma_f32_16x16x32_bf16 v[180:183], v[116:119], v[100:103], v[180:183]
    buffer_load_dwordx4 v25, s[92:95], s5 offen offset:1024 lds
    v_mfma_f32_16x16x32_bf16 v[184:187], v[116:119], v[104:107], v[184:187]
    v_mfma_f32_16x16x32_bf16 v[188:191], v[116:119], v[108:111], v[188:191]
    v_mfma_f32_16x16x32_bf16 v[224:227], v[124:127], v[80:83], v[224:227]
    v_mfma_f32_16x16x32_bf16 v[228:231], v[124:127], v[84:87], v[228:231]
    buffer_load_dwordx4 v26, s[92:95], s5 offen offset:2048 lds
    v_mfma_f32_16x16x32_bf16 v[232:235], v[124:127], v[88:91], v[232:235]
    v_mfma_f32_16x16x32_bf16 v[236:239], v[124:127], v[92:95], v[236:239]
    v_mfma_f32_16x16x32_bf16 v[240:243], v[124:127], v[96:99], v[240:243]
    v_mfma_f32_16x16x32_bf16 v[244:247], v[124:127], v[100:103], v[244:247]
    buffer_load_dwordx4 v27, s[92:95], s5 offen offset:3072 lds
    s_add_u32 s96, s96, 262144
    v_mfma_f32_16x16x32_bf16 v[248:251], v[124:127], v[104:107], v[248:251]
    v_mfma_f32_16x16x32_bf16 v[252:255], v[124:127], v[108:111], v[252:255]
    s_waitcnt lgkmcnt(0)
    v_mfma_f32_16x16x32_bf16 v[128:131], v[64:67], v[32:35], v[128:131]
    ds_read_b64_tr_b16 v[112:113], v10 offset:16384
    v_mfma_f32_16x16x32_bf16 v[132:135], v[64:67], v[36:39], v[132:135]
    ds_read_b64_tr_b16 v[114:115], v10 offset:18432
    v_xor_b32 v6, 64, v6
    s_add_u32 m0, s97, 32768
    s_nop 0
    buffer_load_dwordx4 v24, s[92:95], s96 offen lds
    v_mfma_f32_16x16x32_bf16 v[136:139], v[64:67], v[40:43], v[136:139]
    ds_read_b128 v[80:83], v6 offset:0
    v_mfma_f32_16x16x32_bf16 v[140:143], v[64:67], v[44:47], v[140:143]
    ds_read_b128 v[84:87], v6 offset:2048
    v_mfma_f32_16x16x32_bf16 v[144:147], v[64:67], v[48:51], v[144:147]
    ds_read_b128 v[88:91], v6 offset:4096
    v_mfma_f32_16x16x32_bf16 v[148:151], v[64:67], v[52:55], v[148:151]
    ds_read_b128 v[92:95], v6 offset:6144
    buffer_load_dwordx4 v25, s[92:95], s96 offen offset:1024 lds
    v_mfma_f32_16x16x32_bf16 v[152:155], v[64:67], v[56:59], v[152:155]
    ds_read_b128 v[96:99], v6 offset:8192
    v_mfma_f32_16x16x32_bf16 v[156:159], v[64:67], v[60:63], v[156:159]
    ds_read_b128 v[100:103], v6 offset:10240
    v_mfma_f32_16x16x32_bf16 v[192:195], v[72:75], v[32:35], v[192:195]
    ds_read_b128 v[104:107], v6 offset:12288
    v_mfma_f32_16x16x32_bf16 v[196:199], v[72:75], v[36:39], v[196:199]
    ds_read_b128 v[108:111], v6 offset:14336
    buffer_load_dwordx4 v26, s[92:95], s96 offen offset:2048 lds
    v_mfma_f32_16x16x32_bf16 v[200:203], v[72:75], v[40:43], v[200:203]
    ds_read_b64_tr_b16 v[120:121], v10 offset:17408
    v_mfma_f32_16x16x32_bf16 v[204:207], v[72:75], v[44:47], v[204:207]
    ds_read_b64_tr_b16 v[122:123], v10 offset:19456
    v_mfma_f32_16x16x32_bf16 v[208:211], v[72:75], v[48:51], v[208:211]
    ds_read_b64_tr_b16 v[116:117], v11 offset:16384
    v_mfma_f32_16x16x32_bf16 v[212:215], v[72:75], v[52:55], v[212:215]
    ds_read_b64_tr_b16 v[118:119], v11 offset:18432
    buffer_load_dwordx4 v27, s[92:95], s96 offen offset:3072 lds
    s_add_u32 s5, s96, 131072
    v_mfma_f32_16x16x32_bf16 v[216:219], v[72:75], v[56:59], v[216:219]
    ds_read_b64_tr_b16 v[124:125], v11 offset:17408
    v_mfma_f32_16x16x32_bf16 v[220:223], v[72:75], v[60:63], v[220:223]
    ds_read_b64_tr_b16 v[126:127], v11 offset:19456
    v_mfma_f32_16x16x32_bf16 v[160:163], v[68:71], v[32:35], v[160:163]
    v_mfma_f32_16x16x32_bf16 v[164:167], v[68:71], v[36:39], v[164:167]
    s_add_u32 m0, s97, 49152
    s_nop 0
    buffer_load_dwordx4 v24, s[92:95], s5 offen lds
    v_mfma_f32_16x16x32_bf16 v[168:171], v[68:71], v[40:43], v[168:171]
    v_mfma_f32_16x16x32_bf16 v[172:175], v[68:71], v[44:47], v[172:175]
    v_mfma_f32_16x16x32_bf16 v[176:179], v[68:71], v[48:51], v[176:179]
    v_mfma_f32_16x16x32_bf16 v[180:183], v[68:71], v[52:55], v[180:183]
    buffer_load_dwordx4 v25, s[92:95], s5 offen offset:1024 lds
    v_mfma_f32_16x16x32_bf16 v[184:187], v[68:71], v[56:59], v[184:187]
    v_mfma_f32_16x16x32_bf16 v[188:191], v[68:71], v[60:63], v[188:191]
    v_mfma_f32_16x16x32_bf16 v[224:227], v[76:79], v[32:35], v[224:227]
    v_mfma_f32_16x16x32_bf16 v[228:231], v[76:79], v[36:39], v[228:231]
    buffer_load_dwordx4 v26, s[92:95], s5 offen offset:2048 lds
    v_mfma_f32_16x16x32_bf16 v[232:235], v[76:79], v[40:43], v[232:235]
    v_mfma_f32_16x16x32_bf16 v[236:239], v[76:79], v[44:47], v[236:239]
    v_mfma_f32_16x16x32_bf16 v[240:243], v[76:79], v[48:51], v[240:243]
    v_mfma_f32_16x16x32_bf16 v[244:247], v[76:79], v[52:55], v[244:247]
    buffer_load_dwordx4 v27, s[92:95], s5 offen offset:3072 lds
    s_add_u32 s96, s96, 262144
    v_mfma_f32_16x16x32_bf16 v[248:251], v[76:79], v[56:59], v[248:251]
    v_mfma_f32_16x16x32_bf16 v[252:255], v[76:79], v[60:63], v[252:255]
    s_branch L_g1_tail
L_g1_touch:
    s_load_dwordx4 s[12:15], s[0:1], 8
    s_load_dwordx2 s[16:17], s[0:1], 48
    s_getpc_b64 s[64:65]
L_g1_pc:
    s_sub_u32 s5, s2, 32
    s_add_u32 s6, s3, s4
    s_and_b32 s45, s6, 7
    s_lshl_b32 s46, s4, 13
    s_lshl_b32 s6, s45, 6
    s_lshl_b32 s7, s31, 4
    s_add_u32 s6, s6, s7
    s_add_u32 s6, s6, touch_tab-L_g1_pc
    s_load_dwordx4 s[68:71], s[64:65], s6
    v_lshlrev_b32 v28, 7, v1
    s_mov_b32 s67, 0x20000
    s_cmp_eq_u32 s31, 3
    s_cbranch_scc0 L_g1_tp0
    s_mov_b32 s66, spec_tables+67584-L_g1_pc
    buffer_load_dword v0, v28, s[64:67], s46 offen
    s_waitcnt lgkmcnt(0)
    s_branch L_g1_tpj
L_g1_tp0:
    s_waitcnt lgkmcnt(0)
    s_cmp_eq_u32 s31, 1
    s_cselect_b32 s64, s50, s48
    s_cselect_b32 s65, s51, s49
    s_mov_b32 s66, 7340032
    s_mov_b32 s6, 0x4030201
    s_mov_b32 s7, 0x8070605
    s_lshl_b32 s47, s3, 3
    s_lshr_b64 s[6:7], s[6:7], s47
    s_and_b32 s6, s6, 255
    s_mul_i32 s6, s6, 229376
    s_add_u32 s6, s6, s46
    s_lshr_b32 s7, s5, 5
    s_add_u32 s7, s7, 1
    s_cmp_le_u32 s7, 4
    s_cselect_b32 s47, 4194304, 0
    s_lshl_b32 s7, s7, 7
    s_and_b32 s5, s5, 31
    s_lshl_b32 s5, s5, 17
    s_add_u32 s7, s7, s5
    s_cmp_eq_u32 s31, 2
    s_cselect_b32 s64, s32, s64
    s_cselect_b32 s65, s33, s65
    s_cselect_b32 s66, s47, s66
    s_cselect_b32 s6, s7, s6
    s_cselect_b32 s7, 11, 7
    v_lshlrev_b32 v29, s7, v1
    buffer_load_dword v0, v29, s[64:67], s6 offen
L_g1_tpj:
    s_mov_b64 s[34:35], s[12:13]
    s_mov_b64 s[36:37], s[14:15]
    s_lshr_b32 s5, s30, 2
    v_and_b32 v3, 15, v1
    v_xor_b32 v4, v3, v2
    v_and_b32 v4, 7, v4
    v_lshlrev_b32 v4, 4, v4
    v_lshl_add_u32 v4, v3, 7, v4
    s_lshl_b32 s7, s5, 14
    v_add_u32 v7, s7, v4
    s_mov_b32 s38, 0x43143143
    s_mov_b32 s39, 0x31431431
    v_bfe_u32 v5, v1, 2, 2
    v_and_b32 v3, 1, v2
    v_lshl_or_b32 v3, v3, 2, v5
    v_lshlrev_b32 v4, 12, v2
    v_lshl_add_u32 v4, v5, 8, v4
    v_and_b32 v5, 3, v1
    v_lshl_add_u32 v4, v5, 3, v4
    s_lshl_b32 s7, s31, 1
    s_add_u32 s6, s7, 0
    v_xor_b32 v5, s6, v3
    v_lshl_add_u32 v8, v5, 5, v4
    v_add_u32 v10, 0x10000, v8
    s_add_u32 s6, s7, 1
    v_xor_b32 v5, s6, v3
    v_lshl_add_u32 v9, v5, 5, v4
    v_add_u32 v11, 0x10000, v9
    s_add_u32 s20, s54, 0x400000
    s_addc_u32 s21, s55, 0
    s_mov_b32 s22, 0xe00000
    s_mov_b32 s23, 0x20000
    s_mov_b32 s24, s52
    s_mov_b32 s25, s53
    s_mov_b32 s26, 0x100
    s_mov_b32 s27, 0x20000
    v_mov_b32 v128, 0
    v_mov_b32 v129, 0
    v_mov_b32 v130, 0
    v_mov_b32 v131, 0
    v_mov_b32 v132, 0
    v_mov_b32 v133, 0
    v_mov_b32 v134, 0
    v_mov_b32 v135, 0
    v_mov_b32 v136, 0
    v_mov_b32 v137, 0
    v_mov_b32 v138, 0
    v_mov_b32 v139, 0
    v_mov_b32 v140, 0
    v_mov_b32 v141, 0
    v_mov_b32 v142, 0
    v_mov_b32 v143, 0
    v_mov_b32 v144, 0
    v_mov_b32 v145, 0
    v_mov_b32 v146, 0
    v_mov_b32 v147, 0
    v_mov_b32 v148, 0
    v_mov_b32 v149, 0
    v_mov_b32 v150, 0
    v_mov_b32 v151, 0
    v_mov_b32 v152, 0
    v_mov_b32 v153, 0
    v_mov_b32 v154, 0
    v_mov_b32 v155, 0
    v_mov_b32 v156, 0
    v_mov_b32 v157, 0
    v_mov_b32 v158, 0
    v_mov_b32 v159, 0
    v_mov_b32 v160, 0
    v_mov_b32 v161, 0
    v_mov_b32 v162, 0
    v_mov_b32 v163, 0
    v_mov_b32 v164, 0
    v_mov_b32 v165, 0
    v_mov_b32 v166, 0
    v_mov_b32 v167, 0
    v_mov_b32 v168, 0
    v_mov_b32 v169, 0
    v_mov_b32 v170, 0
    v_mov_b32 v171, 0
    v_mov_b32 v172, 0
    v_mov_b32 v173, 0
    v_mov_b32 v174, 0
    v_mov_b32 v175, 0
    v_mov_b32 v176, 0
    v_mov_b32 v177, 0
    v_mov_b32 v178, 0
    v_mov_b32 v179, 0
    v_mov_b32 v180, 0
    v_mov_b32 v181, 0
    v_mov_b32 v182, 0
    v_mov_b32 v183, 0
    v_mov_b32 v184, 0
    v_mov_b32 v185, 0
    v_mov_b32 v186, 0
    v_mov_b32 v187, 0
    v_mov_b32 v188, 0
    v_mov_b32 v189, 0
    v_mov_b32 v190, 0
    v_mov_b32 v191, 0
    v_mov_b32 v192, 0
    v_mov_b32 v193, 0
    v_mov_b32 v194, 0
    v_mov_b32 v195, 0
    v_mov_b32 v196, 0
    v_mov_b32 v197, 0
    v_mov_b32 v198, 0
    v_mov_b32 v199, 0
    v_mov_b32 v200, 0
    v_mov_b32 v201, 0
    v_mov_b32 v202, 0
    v_mov_b32 v203, 0
    v_mov_b32 v204, 0
    v_mov_b32 v205, 0
    v_mov_b32 v206, 0
    v_mov_b32 v207, 0
    v_mov_b32 v208, 0
    v_mov_b32 v209, 0
    v_mov_b32 v210, 0
    v_mov_b32 v211, 0
    v_mov_b32 v212, 0
    v_mov_b32 v213, 0
    v_mov_b32 v214, 0
    v_mov_b32 v215, 0
    v_mov_b32 v216, 0
    v_mov_b32 v217, 0
    v_mov_b32 v218, 0
    v_mov_b32 v219, 0
    v_mov_b32 v220, 0
    v_mov_b32 v221, 0
    v_mov_b32 v222, 0
    v_mov_b32 v223, 0
    v_mov_b32 v224, 0
    v_mov_b32 v225, 0
    v_mov_b32 v226, 0
    v_mov_b32 v227, 0
    v_mov_b32 v228, 0
    v_mov_b32 v229, 0
    v_mov_b32 v230, 0
    v_mov_b32 v231, 0
    v_mov_b32 v232, 0
    v_mov_b32 v233, 0
    v_mov_b32 v234, 0
    v_mov_b32 v235, 0
    v_mov_b32 v236, 0
    v_mov_b32 v237, 0
    v_mov_b32 v238, 0
    v_mov_b32 v239, 0
    v_mov_b32 v240, 0
    v_mov_b32 v241, 0
    v_mov_b32 v242, 0
    v_mov_b32 v243, 0
    v_mov_b32 v244, 0
    v_mov_b32 v245, 0
    v_mov_b32 v246, 0
    v_mov_b32 v247, 0
    v_mov_b32 v248, 0
    v_mov_b32 v249, 0
    v_mov_b32 v250, 0
    v_mov_b32 v251, 0
    v_mov_b32 v252, 0
    v_mov_b32 v253, 0
    v_mov_b32 v254, 0
    v_mov_b32 v255, 0
    s_add_u32 s12, s54, 0x2200000
    s_addc_u32 s13, s55, 0
    s_mov_b32 s14, 0x70000
    s_mov_b32 s15, 0x20000
    v_mov_b32 v12, 0
    v_mov_b32 v13, 0
    v_mov_b32 v14, 0
    v_mov_b32 v15, 0
    v_mov_b32 v16, 0
    v_mov_b32 v17, 0
    v_mov_b32 v18, 0
    v_mov_b32 v19, 0
    v_mov_b32 v20, 0
    v_mov_b32 v21, 0
    v_mov_b32 v22, 0
    v_mov_b32 v23, 0
    v_mov_b32 v24, 0
    v_mov_b32 v25, 0
    v_mov_b32 v26, 0
    v_mov_b32 v27, 0
    v_mov_b32 v3, v28
    v_mov_b32 v28, 0x3f803f80
    v_mov_b32 v29, 0x3f803f80
    v_mov_b32 v30, 0x3f803f80
    v_mov_b32 v31, 0x3f803f80
    s_lshl_b32 s5, s29, 14
    s_lshl_b32 s6, s31, 12
    s_add_u32 s5, s5, s6
    s_lshl_b32 s6, s28, 9
    s_add_u32 s5, s5, s6
    v_lshl_add_u32 v5, v2, 4, s5
    s_barrier
    buffer_load_dword v4, off, s[24:27], 0 offset:8 sc1
    ds_read_b64_tr_b16 v[64:65], v8 offset:0
    s_and_b32 s6, s38, 15
    s_lshl_b32 s6, s6, 15
    ds_read_b64_tr_b16 v[66:67], v8 offset:2048
    s_lshr_b64 s[38:39], s[38:39], 4
    v_add_u32 v6, s6, v7
    ds_read_b128 v[32:35], v6 offset:0
    ds_read_b128 v[36:39], v6 offset:2048
    ds_read_b128 v[40:43], v6 offset:4096
    ds_read_b128 v[44:47], v6 offset:6144
    ds_read_b128 v[48:51], v6 offset:8192
    ds_read_b128 v[52:55], v6 offset:10240
    ds_read_b128 v[56:59], v6 offset:12288
    ds_read_b128 v[60:63], v6 offset:14336
    ds_read_b64_tr_b16 v[72:73], v8 offset:1024
    ds_read_b64_tr_b16 v[74:75], v8 offset:3072
    ds_read_b64_tr_b16 v[68:69], v9 offset:0
    ds_read_b64_tr_b16 v[70:71], v9 offset:2048
    ds_read_b64_tr_b16 v[76:77], v9 offset:1024
    ds_read_b64_tr_b16 v[78:79], v9 offset:3072
    s_add_u32 s8, s54, 0x2100000
    s_addc_u32 s9, s55, 0
    s_mov_b32 s10, 0x8000
    s_mov_b32 s11, 0x20000
    s_mov_b32 s43, 7
.p2align 6
L_g1_tloop:
    s_waitcnt lgkmcnt(0)
    s_barrier
    v_mfma_f32_16x16x32_bf16 v[128:131], v[64:67], v[32:35], v[128:131]
    ds_read_b64_tr_b16 v[112:113], v8 offset:16384
    v_mfma_f32_16x16x32_bf16 v[132:135], v[64:67], v[36:39], v[132:135]
    ds_read_b64_tr_b16 v[114:115], v8 offset:18432
    v_xor_b32 v6, 64, v6
    s_cmp_lg_u32 s43, 7
    s_cbranch_scc1 L_g1_nrq
    s_waitcnt vmcnt(0)
    s_mov_b32 s99, 0
L_fl_lng:
    v_readfirstlane_b32 s98, v4
    s_cmp_lg_u32 s98, 0
    s_cbranch_scc1 L_fl_ldg
    s_add_u32 s99, s99, 1
    s_cmp_ge_u32 s99, 0x40000
    s_cbranch_scc1 L_fl_ldg
    s_sleep 8
    buffer_load_dword v4, off, s[24:27], 0 offset:8 sc1
    s_waitcnt vmcnt(0)
    s_branch L_fl_lng
L_fl_ldg:
L_g1_nrq:
    v_mfma_f32_16x16x32_bf16 v[136:139], v[64:67], v[40:43], v[136:139]
    ds_read_b128 v[80:83], v6 offset:0
    s_cmp_lg_u32 s43, s44
    s_cbranch_scc1 L_g1_ncs0
    v_mfma_f32_16x16x32_bf16 v[12:15], v[64:67], v[28:31], v[12:15]
    v_mfma_f32_16x16x32_bf16 v[20:23], v[72:75], v[28:31], v[20:23]
    v_mfma_f32_16x16x32_bf16 v[16:19], v[68:71], v[28:31], v[16:19]
    v_mfma_f32_16x16x32_bf16 v[24:27], v[76:79], v[28:31], v[24:27]
L_g1_ncs0:
    v_mfma_f32_16x16x32_bf16 v[140:143], v[64:67], v[44:47], v[140:143]
    ds_read_b128 v[84:87], v6 offset:2048
    v_mfma_f32_16x16x32_bf16 v[144:147], v[64:67], v[48:51], v[144:147]
    ds_read_b128 v[88:91], v6 offset:4096
    s_sub_u32 s45, s45, 1
    s_cbranch_scc0 L_g1_nf0
    s_mov_b32 s45, 7
    s_lshr_b32 s5, s68, 8
    s_and_b32 s6, s68, 255
    s_mul_i32 s47, s6, 229376
    s_add_u32 s47, s47, s46
    s_mov_b64 s[64:65], s[16:17]
    s_mov_b32 s66, 7340032
    s_cmp_eq_u32 s5, 0
    s_cselect_b64 s[64:65], s[48:49], s[64:65]
    s_cmp_eq_u32 s5, 1
    s_cselect_b64 s[64:65], s[50:51], s[64:65]
    s_cmp_eq_u32 s5, 2
    s_cselect_b64 s[64:65], s[34:35], s[64:65]
    s_cmp_eq_u32 s5, 3
    s_cselect_b64 s[64:65], s[36:37], s[64:65]
    s_bitcmp1_b32 s5, 1
    s_cselect_b32 s66, 2101248, s66
    buffer_load_dword v0, v3, s[64:67], s47 offen
    s_mov_b32 s68, s69
    s_mov_b32 s69, s70
    s_mov_b32 s70, s71
L_g1_nf0:
    v_mfma_f32_16x16x32_bf16 v[148:151], v[64:67], v[52:55], v[148:151]
    ds_read_b128 v[92:95], v6 offset:6144
    v_mfma_f32_16x16x32_bf16 v[152:155], v[64:67], v[56:59], v[152:155]
    ds_read_b128 v[96:99], v6 offset:8192
    v_mfma_f32_16x16x32_bf16 v[156:159], v[64:67], v[60:63], v[156:159]
    ds_read_b128 v[100:103], v6 offset:10240
    v_mfma_f32_16x16x32_bf16 v[192:195], v[72:75], v[32:35], v[192:195]
    ds_read_b128 v[104:107], v6 offset:12288
    v_mfma_f32_16x16x32_bf16 v[196:199], v[72:75], v[36:39], v[196:199]
    ds_read_b128 v[108:111], v6 offset:14336
    v_mfma_f32_16x16x32_bf16 v[200:203], v[72:75], v[40:43], v[200:203]
    ds_read_b64_tr_b16 v[120:121], v8 offset:17408
    v_mfma_f32_16x16x32_bf16 v[204:207], v[72:75], v[44:47], v[204:207]
    ds_read_b64_tr_b16 v[122:123], v8 offset:19456
    v_mfma_f32_16x16x32_bf16 v[208:211], v[72:75], v[48:51], v[208:211]
    ds_read_b64_tr_b16 v[116:117], v9 offset:16384
    v_mfma_f32_16x16x32_bf16 v[212:215], v[72:75], v[52:55], v[212:215]
    ds_read_b64_tr_b16 v[118:119], v9 offset:18432
    v_mfma_f32_16x16x32_bf16 v[216:219], v[72:75], v[56:59], v[216:219]
    ds_read_b64_tr_b16 v[124:125], v9 offset:17408
    v_mfma_f32_16x16x32_bf16 v[220:223], v[72:75], v[60:63], v[220:223]
    ds_read_b64_tr_b16 v[126:127], v9 offset:19456
    v_mfma_f32_16x16x32_bf16 v[160:163], v[68:71], v[32:35], v[160:163]
    v_mfma_f32_16x16x32_bf16 v[164:167], v[68:71], v[36:39], v[164:167]
    v_mfma_f32_16x16x32_bf16 v[168:171], v[68:71], v[40:43], v[168:171]
    v_mfma_f32_16x16x32_bf16 v[172:175], v[68:71], v[44:47], v[172:175]
    v_mfma_f32_16x16x32_bf16 v[176:179], v[68:71], v[48:51], v[176:179]
    v_mfma_f32_16x16x32_bf16 v[180:183], v[68:71], v[52:55], v[180:183]
    v_mfma_f32_16x16x32_bf16 v[184:187], v[68:71], v[56:59], v[184:187]
    v_mfma_f32_16x16x32_bf16 v[188:191], v[68:71], v[60:63], v[188:191]
    v_mfma_f32_16x16x32_bf16 v[224:227], v[76:79], v[32:35], v[224:227]
    v_mfma_f32_16x16x32_bf16 v[228:231], v[76:79], v[36:39], v[228:231]
    v_mfma_f32_16x16x32_bf16 v[232:235], v[76:79], v[40:43], v[232:235]
    v_mfma_f32_16x16x32_bf16 v[236:239], v[76:79], v[44:47], v[236:239]
    v_mfma_f32_16x16x32_bf16 v[240:243], v[76:79], v[48:51], v[240:243]
    v_mfma_f32_16x16x32_bf16 v[244:247], v[76:79], v[52:55], v[244:247]
    v_mfma_f32_16x16x32_bf16 v[248:251], v[76:79], v[56:59], v[248:251]
    v_mfma_f32_16x16x32_bf16 v[252:255], v[76:79], v[60:63], v[252:255]
    s_waitcnt lgkmcnt(0)
    s_barrier
    v_mfma_f32_16x16x32_bf16 v[128:131], v[112:115], v[80:83], v[128:131]
    ds_read_b64_tr_b16 v[64:65], v10 offset:0
    s_and_b32 s6, s38, 15
    s_lshl_b32 s6, s6, 15
    v_mfma_f32_16x16x32_bf16 v[132:135], v[112:115], v[84:87], v[132:135]
    ds_read_b64_tr_b16 v[66:67], v10 offset:2048
    s_lshr_b64 s[38:39], s[38:39], 4
    v_add_u32 v6, s6, v7
    v_mfma_f32_16x16x32_bf16 v[136:139], v[112:115], v[88:91], v[136:139]
    ds_read_b128 v[32:35], v6 offset:0
    s_cmp_lg_u32 s43, s44
    s_cbranch_scc1 L_g1_ncs1
    v_mfma_f32_16x16x32_bf16 v[12:15], v[112:115], v[28:31], v[12:15]
    v_mfma_f32_16x16x32_bf16 v[20:23], v[120:123], v[28:31], v[20:23]
    v_mfma_f32_16x16x32_bf16 v[16:19], v[116:119], v[28:31], v[16:19]
    v_mfma_f32_16x16x32_bf16 v[24:27], v[124:127], v[28:31], v[24:27]
L_g1_ncs1:
    v_mfma_f32_16x16x32_bf16 v[140:143], v[112:115], v[92:95], v[140:143]
    ds_read_b128 v[36:39], v6 offset:2048
    v_mfma_f32_16x16x32_bf16 v[144:147], v[112:115], v[96:99], v[144:147]
    ds_read_b128 v[40:43], v6 offset:4096
    s_sub_u32 s45, s45, 1
    s_cbranch_scc0 L_g1_nf1
    s_mov_b32 s45, 7
    s_lshr_b32 s5, s68, 8
    s_and_b32 s6, s68, 255
    s_mul_i32 s47, s6, 229376
    s_add_u32 s47, s47, s46
    s_mov_b64 s[64:65], s[16:17]
    s_mov_b32 s66, 7340032
    s_cmp_eq_u32 s5, 0
    s_cselect_b64 s[64:65], s[48:49], s[64:65]
    s_cmp_eq_u32 s5, 1
    s_cselect_b64 s[64:65], s[50:51], s[64:65]
    s_cmp_eq_u32 s5, 2
    s_cselect_b64 s[64:65], s[34:35], s[64:65]
    s_cmp_eq_u32 s5, 3
    s_cselect_b64 s[64:65], s[36:37], s[64:65]
    s_bitcmp1_b32 s5, 1
    s_cselect_b32 s66, 2101248, s66
    buffer_load_dword v0, v3, s[64:67], s47 offen
    s_mov_b32 s68, s69
    s_mov_b32 s69, s70
    s_mov_b32 s70, s71
L_g1_nf1:
    v_mfma_f32_16x16x32_bf16 v[148:151], v[112:115], v[100:103], v[148:151]
    ds_read_b128 v[44:47], v6 offset:6144
    v_mfma_f32_16x16x32_bf16 v[152:155], v[112:115], v[104:107], v[152:155]
    ds_read_b128 v[48:51], v6 offset:8192
    v_mfma_f32_16x16x32_bf16 v[156:159], v[112:115], v[108:111], v[156:159]
    ds_read_b128 v[52:55], v6 offset:10240
    v_mfma_f32_16x16x32_bf16 v[192:195], v[120:123], v[80:83], v[192:195]
    ds_read_b128 v[56:59], v6 offset:12288
    v_mfma_f32_16x16x32_bf16 v[196:199], v[120:123], v[84:87], v[196:199]
    ds_read_b128 v[60:63], v6 offset:14336
    v_mfma_f32_16x16x32_bf16 v[200:203], v[120:123], v[88:91], v[200:203]
    ds_read_b64_tr_b16 v[72:73], v10 offset:1024
    v_mfma_f32_16x16x32_bf16 v[204:207], v[120:123], v[92:95], v[204:207]
    ds_read_b64_tr_b16 v[74:75], v10 offset:3072
    v_mfma_f32_16x16x32_bf16 v[208:211], v[120:123], v[96:99], v[208:211]
    ds_read_b64_tr_b16 v[68:69], v11 offset:0
    v_mfma_f32_16x16x32_bf16 v[212:215], v[120:123], v[100:103], v[212:215]
    ds_read_b64_tr_b16 v[70:71], v11 offset:2048
    v_mfma_f32_16x16x32_bf16 v[216:219], v[120:123], v[104:107], v[216:219]
    ds_read_b64_tr_b16 v[76:77], v11 offset:1024
    v_mfma_f32_16x16x32_bf16 v[220:223], v[120:123], v[108:111], v[220:223]
    ds_read_b64_tr_b16 v[78:79], v11 offset:3072
    v_mfma_f32_16x16x32_bf16 v[160:163], v[116:119], v[80:83], v[160:163]
    v_mfma_f32_16x16x32_bf16 v[164:167], v[116:119], v[84:87], v[164:167]
    v_mfma_f32_16x16x32_bf16 v[168:171], v[116:119], v[88:91], v[168:171]
    v_mfma_f32_16x16x32_bf16 v[172:175], v[116:119], v[92:95], v[172:175]
    v_mfma_f32_16x16x32_bf16 v[176:179], v[116:119], v[96:99], v[176:179]
    v_mfma_f32_16x16x32_bf16 v[180:183], v[116:119], v[100:103], v[180:183]
    v_mfma_f32_16x16x32_bf16 v[184:187], v[116:119], v[104:107], v[184:187]
    v_mfma_f32_16x16x32_bf16 v[188:191], v[116:119], v[108:111], v[188:191]
    v_mfma_f32_16x16x32_bf16 v[224:227], v[124:127], v[80:83], v[224:227]
    v_mfma_f32_16x16x32_bf16 v[228:231], v[124:127], v[84:87], v[228:231]
    v_mfma_f32_16x16x32_bf16 v[232:235], v[124:127], v[88:91], v[232:235]
    v_mfma_f32_16x16x32_bf16 v[236:239], v[124:127], v[92:95], v[236:239]
    v_mfma_f32_16x16x32_bf16 v[240:243], v[124:127], v[96:99], v[240:243]
    v_mfma_f32_16x16x32_bf16 v[244:247], v[124:127], v[100:103], v[244:247]
    v_mfma_f32_16x16x32_bf16 v[248:251], v[124:127], v[104:107], v[248:251]
    v_mfma_f32_16x16x32_bf16 v[252:255], v[124:127], v[108:111], v[252:255]
    s_waitcnt lgkmcnt(0)
    s_barrier
    v_mfma_f32_16x16x32_bf16 v[128:131], v[64:67], v[32:35], v[128:131]
    ds_read_b64_tr_b16 v[112:113], v10 offset:16384
    v_mfma_f32_16x16x32_bf16 v[132:135], v[64:67], v[36:39], v[132:135]
    ds_read_b64_tr_b16 v[114:115], v10 offset:18432
    v_xor_b32 v6, 64, v6
    v_mfma_f32_16x16x32_bf16 v[136:139], v[64:67], v[40:43], v[136:139]
    ds_read_b128 v[80:83], v6 offset:0
    s_cmp_lg_u32 s43, s44
    s_cbranch_scc1 L_g1_ncs2
    v_mfma_f32_16x16x32_bf16 v[12:15], v[64:67], v[28:31], v[12:15]
    v_mfma_f32_16x16x32_bf16 v[20:23], v[72:75], v[28:31], v[20:23]
    v_mfma_f32_16x16x32_bf16 v[16:19], v[68:71], v[28:31], v[16:19]
    v_mfma_f32_16x16x32_bf16 v[24:27], v[76:79], v[28:31], v[24:27]
L_g1_ncs2:
    v_mfma_f32_16x16x32_bf16 v[140:143], v[64:67], v[44:47], v[140:143]
    ds_read_b128 v[84:87], v6 offset:2048
    v_mfma_f32_16x16x32_bf16 v[144:147], v[64:67], v[48:51], v[144:147]
    ds_read_b128 v[88:91], v6 offset:4096
    s_sub_u32 s45, s45, 1
    s_cbranch_scc0 L_g1_nf2
    s_mov_b32 s45, 7
    s_lshr_b32 s5, s68, 8
    s_and_b32 s6, s68, 255
    s_mul_i32 s47, s6, 229376
    s_add_u32 s47, s47, s46
    s_mov_b64 s[64:65], s[16:17]
    s_mov_b32 s66, 7340032
    s_cmp_eq_u32 s5, 0
    s_cselect_b64 s[64:65], s[48:49], s[64:65]
    s_cmp_eq_u32 s5, 1
    s_cselect_b64 s[64:65], s[50:51], s[64:65]
    s_cmp_eq_u32 s5, 2
    s_cselect_b64 s[64:65], s[34:35], s[64:65]
    s_cmp_eq_u32 s5, 3
    s_cselect_b64 s[64:65], s[36:37], s[64:65]
    s_bitcmp1_b32 s5, 1
    s_cselect_b32 s66, 2101248, s66
    buffer_load_dword v0, v3, s[64:67], s47 offen
    s_mov_b32 s68, s69
    s_mov_b32 s69, s70
    s_mov_b32 s70, s71
L_g1_nf2:
    v_mfma_f32_16x16x32_bf16 v[148:151], v[64:67], v[52:55], v[148:151]
    ds_read_b128 v[92:95], v6 offset:6144
    v_mfma_f32_16x16x32_bf16 v[152:155], v[64:67], v[56:59], v[152:155]
    ds_read_b128 v[96:99], v6 offset:8192
    s_cmp_lg_u32 s43, 1
    s_cbranch_scc1 L_g1_npre
    s_lshl_b32 s5, s28, 12
    s_lshl_b32 s6, s31, 10
    s_add_u32 s40, s5, s6
    v_lshlrev_b32 v3, 4, v1
    s_mov_b32 s45, 100
    s_lshl_b32 s5, s29, 14
    s_lshl_b32 s6, s31, 12
    s_add_u32 s41, s5, s6
    v_and_b32 v4, 7, v1
    v_lshlrev_b32 v4, 9, v4
    v_bfe_u32 v5, v1, 3, 1
    v_lshl_add_u32 v4, v5, 8, v4
    v_lshl_add_u32 v4, v2, 4, v4
    buffer_load_dwordx4 v[28:31], v3, s[8:11], s40 offen sc1
    buffer_load_dwordx4 v[12:15], v4, s[12:15], s41 offen offset:0 sc1
    buffer_load_dwordx4 v[16:19], v4, s[12:15], s41 offen offset:64 sc1
    buffer_load_dwordx4 v[20:23], v4, s[12:15], s41 offen offset:128 sc1
    buffer_load_dwordx4 v[24:27], v4, s[12:15], s41 offen offset:192 sc1
    v_lshlrev_b32 v5, 7, v5
    v_lshl_add_u32 v5, v2, 4, v5
    s_lshl_b32 s6, s31, 8
    s_add_u32 s6, s6, 155648
    v_add_u32 v5, s6, v5
    s_mov_b32 s7, 0
L_g1_npre:
    v_mfma_f32_16x16x32_bf16 v[156:159], v[64:67], v[60:63], v[156:159]
    ds_read_b128 v[100:103], v6 offset:10240
    v_mfma_f32_16x16x32_bf16 v[192:195], v[72:75], v[32:35], v[192:195]
    ds_read_b128 v[104:107], v6 offset:12288
    v_mfma_f32_16x16x32_bf16 v[196:199], v[72:75], v[36:39], v[196:199]
    ds_read_b128 v[108:111], v6 offset:14336
    v_mfma_f32_16x16x32_bf16 v[200:203], v[72:75], v[40:43], v[200:203]
    ds_read_b64_tr_b16 v[120:121], v10 offset:17408
    v_mfma_f32_16x16x32_bf16 v[204:207], v[72:75], v[44:47], v[204:207]
    ds_read_b64_tr_b16 v[122:123], v10 offset:19456
    v_mfma_f32_16x16x32_bf16 v[208:211], v[72:75], v[48:51], v[208:211]
    ds_read_b64_tr_b16 v[116:117], v11 offset:16384
    v_mfma_f32_16x16x32_bf16 v[212:215], v[72:75], v[52:55], v[212:215]
    ds_read_b64_tr_b16 v[118:119], v11 offset:18432
    v_mfma_f32_16x16x32_bf16 v[216:219], v[72:75], v[56:59], v[216:219]
    ds_read_b64_tr_b16 v[124:125], v11 offset:17408
    v_mfma_f32_16x16x32_bf16 v[220:223], v[72:75], v[60:63], v[220:223]
    ds_read_b64_tr_b16 v[126:127], v11 offset:19456
    v_mfma_f32_16x16x32_bf16 v[160:163], v[68:71], v[32:35], v[160:163]
    v_mfma_f32_16x16x32_bf16 v[164:167], v[68:71], v[36:39], v[164:167]
    v_mfma_f32_16x16x32_bf16 v[168:171], v[68:71], v[40:43], v[168:171]
    v_mfma_f32_16x16x32_bf16 v[172:175], v[68:71], v[44:47], v[172:175]
    v_mfma_f32_16x16x32_bf16 v[176:179], v[68:71], v[48:51], v[176:179]
    v_mfma_f32_16x16x32_bf16 v[180:183], v[68:71], v[52:55], v[180:183]
    v_mfma_f32_16x16x32_bf16 v[184:187], v[68:71], v[56:59], v[184:187]
    v_mfma_f32_16x16x32_bf16 v[188:191], v[68:71], v[60:63], v[188:191]
    v_mfma_f32_16x16x32_bf16 v[224:227], v[76:79], v[32:35], v[224:227]
    v_mfma_f32_16x16x32_bf16 v[228:231], v[76:79], v[36:39], v[228:231]
    v_mfma_f32_16x16x32_bf16 v[232:235], v[76:79], v[40:43], v[232:235]
    v_mfma_f32_16x16x32_bf16 v[236:239], v[76:79], v[44:47], v[236:239]
    v_mfma_f32_16x16x32_bf16 v[240:243], v[76:79], v[48:51], v[240:243]
    v_mfma_f32_16x16x32_bf16 v[244:247], v[76:79], v[52:55], v[244:247]
    v_mfma_f32_16x16x32_bf16 v[248:251], v[76:79], v[56:59], v[248:251]
    v_mfma_f32_16x16x32_bf16 v[252:255], v[76:79], v[60:63], v[252:255]
    s_waitcnt lgkmcnt(0)
    s_barrier
    v_mfma_f32_16x16x32_bf16 v[128:131], v[112:115], v[80:83], v[128:131]
    ds_read_b64_tr_b16 v[64:65], v8 offset:0
    s_and_b32 s6, s38, 15
    s_lshl_b32 s6, s6, 15
    v_mfma_f32_16x16x32_bf16 v[132:135], v[112:115], v[84:87], v[132:135]
    ds_read_b64_tr_b16 v[66:67], v8 offset:2048
    s_lshr_b64 s[38:39], s[38:39], 4
    v_add_u32 v6, s6, v7
    v_mfma_f32_16x16x32_bf16 v[136:139], v[112:115], v[88:91], v[136:139]
    ds_read_b128 v[32:35], v6 offset:0
    s_cmp_lg_u32 s43, s44
    s_cbranch_scc1 L_g1_ncs3
    v_mfma_f32_16x16x32_bf16 v[12:15], v[112:115], v[28:31], v[12:15]
    v_mfma_f32_16x16x32_bf16 v[20:23], v[120:123], v[28:31], v[20:23]
    v_mfma_f32_16x16x32_bf16 v[16:19], v[116:119], v[28:31], v[16:19]
    v_mfma_f32_16x16x32_bf16 v[24:27], v[124:127], v[28:31], v[24:27]
L_g1_ncs3:
    v_mfma_f32_16x16x32_bf16 v[140:143], v[112:115], v[92:95], v[140:143]
    ds_read_b128 v[36:39], v6 offset:2048
    v_mfma_f32_16x16x32_bf16 v[144:147], v[112:115], v[96:99], v[144:147]
    ds_read_b128 v[40:43], v6 offset:4096
    s_sub_u32 s45, s45, 1
    s_cbranch_scc0 L_g1_nf3
    s_mov_b32 s45, 7
    s_lshr_b32 s5, s68, 8
    s_and_b32 s6, s68, 255
    s_mul_i32 s47, s6, 229376
    s_add_u32 s47, s47, s46
    s_mov_b64 s[64:65], s[16:17]
    s_mov_b32 s66, 7340032
    s_cmp_eq_u32 s5, 0
    s_cselect_b64 s[64:65], s[48:49], s[64:65]
    s_cmp_eq_u32 s5, 1
    s_cselect_b64 s[64:65], s[50:51], s[64:65]
    s_cmp_eq_u32 s5, 2
    s_cselect_b64 s[64:65], s[34:35], s[64:65]
    s_cmp_eq_u32 s5, 3
    s_cselect_b64 s[64:65], s[36:37], s[64:65]
    s_bitcmp1_b32 s5, 1
    s_cselect_b32 s66, 2101248, s66
    buffer_load_dword v0, v3, s[64:67], s47 offen
    s_mov_b32 s68, s69
    s_mov_b32 s69, s70
    s_mov_b32 s70, s71
L_g1_nf3:
    v_mfma_f32_16x16x32_bf16 v[148:151], v[112:115], v[100:103], v[148:151]
    ds_read_b128 v[44:47], v6 offset:6144
    v_mfma_f32_16x16x32_bf16 v[152:155], v[112:115], v[104:107], v[152:155]
    ds_read_b128 v[48:51], v6 offset:8192
    v_mfma_f32_16x16x32_bf16 v[156:159], v[112:115], v[108:111], v[156:159]
    ds_read_b128 v[52:55], v6 offset:10240
    v_mfma_f32_16x16x32_bf16 v[192:195], v[120:123], v[80:83], v[192:195]
    ds_read_b128 v[56:59], v6 offset:12288
    v_mfma_f32_16x16x32_bf16 v[196:199], v[120:123], v[84:87], v[196:199]
    ds_read_b128 v[60:63], v6 offset:14336
    s_cmp_lg_u32 s43, s44
    s_cbranch_scc1 L_g1_nst
    v_mov_b32 v29, s98
    v_mov_b32 v31, s98
    s_mov_b32 exec_lo, 0x00010001
    s_mov_b32 exec_hi, 0x00010001
    v_mov_b32 v28, v12
    v_mov_b32 v30, v13
    buffer_store_dwordx4 v[28:31], v5, s[12:15], 0 offen offset:0 sc1
    s_nop 1
    v_mov_b32 v28, v14
    v_mov_b32 v30, v15
    buffer_store_dwordx4 v[28:31], v5, s[12:15], 0 offen offset:64 sc1
    s_nop 1
    v_mov_b32 v28, v16
    v_mov_b32 v30, v17
    buffer_store_dwordx4 v[28:31], v5, s[12:15], 0 offen offset:128 sc1
    s_nop 1
    v_mov_b32 v28, v18
    v_mov_b32 v30, v19
    buffer_store_dwordx4 v[28:31], v5, s[12:15], 0 offen offset:192 sc1
    s_nop 1
    v_mov_b32 v28, v20
    v_mov_b32 v30, v21
    buffer_store_dwordx4 v[28:31], v5, s[12:15], 0 offen offset:256 sc1
    s_nop 1
    v_mov_b32 v28, v22
    v_mov_b32 v30, v23
    buffer_store_dwordx4 v[28:31], v5, s[12:15], 0 offen offset:320 sc1
    s_nop 1
    v_mov_b32 v28, v24
    v_mov_b32 v30, v25
    buffer_store_dwordx4 v[28:31], v5, s[12:15], 0 offen offset:384 sc1
    s_nop 1
    v_mov_b32 v28, v26
    v_mov_b32 v30, v27
    buffer_store_dwordx4 v[28:31], v5, s[12:15], 0 offen offset:448 sc1
    s_mov_b64 exec, -1
L_g1_nst:
    v_mfma_f32_16x16x32_bf16 v[200:203], v[120:123], v[88:91], v[200:203]
    ds_read_b64_tr_b16 v[72:73], v8 offset:1024
    v_mfma_f32_16x16x32_bf16 v[204:207], v[120:123], v[92:95], v[204:207]
    ds_read_b64_tr_b16 v[74:75], v8 offset:3072
    v_mfma_f32_16x16x32_bf16 v[208:211], v[120:123], v[96:99], v[208:211]
    ds_read_b64_tr_b16 v[68:69], v9 offset:0
    v_mfma_f32_16x16x32_bf16 v[212:215], v[120:123], v[100:103], v[212:215]
    ds_read_b64_tr_b16 v[70:71], v9 offset:2048
    v_mfma_f32_16x16x32_bf16 v[216:219], v[120:123], v[104:107], v[216:219]
    ds_read_b64_tr_b16 v[76:77], v9 offset:1024
    v_mfma_f32_16x16x32_bf16 v[220:223], v[120:123], v[108:111], v[220:223]
    ds_read_b64_tr_b16 v[78:79], v9 offset:3072
    v_mfma_f32_16x16x32_bf16 v[160:163], v[116:119], v[80:83], v[160:163]
    v_mfma_f32_16x16x32_bf16 v[164:167], v[116:119], v[84:87], v[164:167]
    v_mfma_f32_16x16x32_bf16 v[168:171], v[116:119], v[88:91], v[168:171]
    v_mfma_f32_16x16x32_bf16 v[172:175], v[116:119], v[92:95], v[172:175]
    v_mfma_f32_16x16x32_bf16 v[176:179], v[116:119], v[96:99], v[176:179]
    v_mfma_f32_16x16x32_bf16 v[180:183], v[116:119], v[100:103], v[180:183]
    v_mfma_f32_16x16x32_bf16 v[184:187], v[116:119], v[104:107], v[184:187]
    v_mfma_f32_16x16x32_bf16 v[188:191], v[116:119], v[108:111], v[188:191]
    v_mfma_f32_16x16x32_bf16 v[224:227], v[124:127], v[80:83], v[224:227]
    v_mfma_f32_16x16x32_bf16 v[228:231], v[124:127], v[84:87], v[228:231]
    v_mfma_f32_16x16x32_bf16 v[232:235], v[124:127], v[88:91], v[232:235]
    v_mfma_f32_16x16x32_bf16 v[236:239], v[124:127], v[92:95], v[236:239]
    v_mfma_f32_16x16x32_bf16 v[240:243], v[124:127], v[96:99], v[240:243]
    v_mfma_f32_16x16x32_bf16 v[244:247], v[124:127], v[100:103], v[244:247]
    v_mfma_f32_16x16x32_bf16 v[248:251], v[124:127], v[104:107], v[248:251]
    v_mfma_f32_16x16x32_bf16 v[252:255], v[124:127], v[108:111], v[252:255]
    s_sub_u32 s43, s43, 1
    s_cmp_lg_u32 s43, 0
    s_cbranch_scc1 L_g1_tloop
    s_waitcnt lgkmcnt(0)
    s_barrier
    v_mfma_f32_16x16x32_bf16 v[128:131], v[64:67], v[32:35], v[128:131]
    ds_read_b64_tr_b16 v[112:113], v8 offset:16384
    v_mfma_f32_16x16x32_bf16 v[132:135], v[64:67], v[36:39], v[132:135]
    ds_read_b64_tr_b16 v[114:115], v8 offset:18432
    v_xor_b32 v6, 64, v6
L_g1_chk:
    s_waitcnt vmcnt(0)
    v_xor_b32 v0, s98, v29
    v_xor_b32 v31, s98, v31
    v_or_b32 v0, v0, v31
    v_xor_b32 v13, s98, v13
    v_or_b32 v0, v0, v13
    v_xor_b32 v15, s98, v15
    v_or_b32 v0, v0, v15
    v_xor_b32 v17, s98, v17
    v_or_b32 v0, v0, v17
    v_xor_b32 v19, s98, v19
    v_or_b32 v0, v0, v19
    v_xor_b32 v21, s98, v21
    v_or_b32 v0, v0, v21
    v_xor_b32 v23, s98, v23
    v_or_b32 v0, v0, v23
    v_xor_b32 v25, s98, v25
    v_or_b32 v0, v0, v25
    v_xor_b32 v27, s98, v27
    v_or_b32 v0, v0, v27
    v_cmp_ne_u32 vcc, 0, v0
    s_cbranch_vccz L_g1_ok
    s_add_u32 s7, s7, 1
    s_cmp_ge_u32 s7, 0x40000
    s_cbranch_scc1 L_g1_ok
    s_sleep 8
    buffer_load_dwordx4 v[28:31], v3, s[8:11], s40 offen sc1
    buffer_load_dwordx4 v[12:15], v4, s[12:15], s41 offen offset:0 sc1
    buffer_load_dwordx4 v[16:19], v4, s[12:15], s41 offen offset:64 sc1
    buffer_load_dwordx4 v[20:23], v4, s[12:15], s41 offen offset:128 sc1
    buffer_load_dwordx4 v[24:27], v4, s[12:15], s41 offen offset:192 sc1
    s_branch L_g1_chk
L_g1_ok:
    v_lshl_add_u32 v0, s30, 6, v1
    v_mfma_f32_16x16x32_bf16 v[136:139], v[64:67], v[40:43], v[136:139]
    ds_read_b128 v[80:83], v6 offset:0
    s_lshl_b32 s6, s31, 11
    s_add_u32 s6, s6, 147456
    v_mfma_f32_16x16x32_bf16 v[140:143], v[64:67], v[44:47], v[140:143]
    ds_read_b128 v[84:87], v6 offset:2048
    v_lshl_add_u32 v3, v1, 5, s6
    s_mov_b32 s5, 0xc0135761
    v_mfma_f32_16x16x32_bf16 v[144:147], v[64:67], v[48:51], v[144:147]
    ds_read_b128 v[88:91], v6 offset:4096
    s_mov_b32 s6, 0xbdd2d3e8
    v_add_f32_dpp v12, v12, v12 quad_perm:[1,0,3,2] row_mask:0xf bank_mask:0xf
    v_mfma_f32_16x16x32_bf16 v[148:151], v[64:67], v[52:55], v[148:151]
    ds_read_b128 v[92:95], v6 offset:6144
    v_add_f32_dpp v13, v14, v14 quad_perm:[1,0,3,2] row_mask:0xf bank_mask:0xf
    v_add_f32_dpp v14, v16, v16 quad_perm:[1,0,3,2] row_mask:0xf bank_mask:0xf
    v_mfma_f32_16x16x32_bf16 v[152:155], v[64:67], v[56:59], v[152:155]
    ds_read_b128 v[96:99], v6 offset:8192
    v_add_f32_dpp v15, v18, v18 quad_perm:[1,0,3,2] row_mask:0xf bank_mask:0xf
    v_add_f32_dpp v16, v20, v20 quad_perm:[1,0,3,2] row_mask:0xf bank_mask:0xf
    v_mfma_f32_16x16x32_bf16 v[156:159], v[64:67], v[60:63], v[156:159]
    ds_read_b128 v[100:103], v6 offset:10240
    v_add_f32_dpp v17, v22, v22 quad_perm:[1,0,3,2] row_mask:0xf bank_mask:0xf
    v_add_f32_dpp v18, v24, v24 quad_perm:[1,0,3,2] row_mask:0xf bank_mask:0xf
    v_mfma_f32_16x16x32_bf16 v[192:195], v[72:75], v[32:35], v[192:195]
    ds_read_b128 v[104:107], v6 offset:12288
    v_add_f32_dpp v19, v26, v26 quad_perm:[1,0,3,2] row_mask:0xf bank_mask:0xf
    v_mul_f32 v26, v30, v30
    v_mfma_f32_16x16x32_bf16 v[196:199], v[72:75], v[36:39], v[196:199]
    ds_read_b128 v[108:111], v6 offset:14336
    v_mul_f32 v24, v26, v30
    v_mul_f32 v30, s5, v30
    v_mfma_f32_16x16x32_bf16 v[200:203], v[72:75], v[40:43], v[200:203]
    ds_read_b64_tr_b16 v[120:121], v8 offset:17408
    v_rcp_f32 v26, v26
    v_mul_f32 v24, s6, v24
    v_mfma_f32_16x16x32_bf16 v[204:207], v[72:75], v[44:47], v[204:207]
    ds_read_b64_tr_b16 v[122:123], v8 offset:19456
    v_add_f32_dpp v12, v12, v12 quad_perm:[2,3,0,1] row_mask:0xf bank_mask:0xf
    v_add_f32_dpp v13, v13, v13 quad_perm:[2,3,0,1] row_mask:0xf bank_mask:0xf
    v_mfma_f32_16x16x32_bf16 v[208:211], v[72:75], v[48:51], v[208:211]
    ds_read_b64_tr_b16 v[116:117], v9 offset:16384
    v_add_f32_dpp v14, v14, v14 quad_perm:[2,3,0,1] row_mask:0xf bank_mask:0xf
    v_add_f32_dpp v15, v15, v15 quad_perm:[2,3,0,1] row_mask:0xf bank_mask:0xf
    v_mfma_f32_16x16x32_bf16 v[212:215], v[72:75], v[52:55], v[212:215]
    ds_read_b64_tr_b16 v[118:119], v9 offset:18432
    v_add_f32_dpp v16, v16, v16 quad_perm:[2,3,0,1] row_mask:0xf bank_mask:0xf
    v_add_f32_dpp v17, v17, v17 quad_perm:[2,3,0,1] row_mask:0xf bank_mask:0xf
    v_mfma_f32_16x16x32_bf16 v[216:219], v[72:75], v[56:59], v[216:219]
    ds_read_b64_tr_b16 v[124:125], v9 offset:17408
    v_add_f32_dpp v18, v18, v18 quad_perm:[2,3,0,1] row_mask:0xf bank_mask:0xf
    v_add_f32_dpp v19, v19, v19 quad_perm:[2,3,0,1] row_mask:0xf bank_mask:0xf
    v_mfma_f32_16x16x32_bf16 v[220:223], v[72:75], v[60:63], v[220:223]
    ds_read_b64_tr_b16 v[126:127], v9 offset:19456
    v_add_f32_dpp v12, v12, v12 row_half_mirror row_mask:0xf bank_mask:0xf
    v_add_f32_dpp v13, v13, v13 row_half_mirror row_mask:0xf bank_mask:0xf
    v_mfma_f32_16x16x32_bf16 v[160:163], v[68:71], v[32:35], v[160:163]
    v_add_f32_dpp v14, v14, v14 row_half_mirror row_mask:0xf bank_mask:0xf
    v_add_f32_dpp v15, v15, v15 row_half_mirror row_mask:0xf bank_mask:0xf
    v_mfma_f32_16x16x32_bf16 v[164:167], v[68:71], v[36:39], v[164:167]
    v_add_f32_dpp v16, v16, v16 row_half_mirror row_mask:0xf bank_mask:0xf
    v_add_f32_dpp v17, v17, v17 row_half_mirror row_mask:0xf bank_mask:0xf
    v_mfma_f32_16x16x32_bf16 v[168:171], v[68:71], v[40:43], v[168:171]
    v_add_f32_dpp v18, v18, v18 row_half_mirror row_mask:0xf bank_mask:0xf
    v_add_f32_dpp v19, v19, v19 row_half_mirror row_mask:0xf bank_mask:0xf
    v_mfma_f32_16x16x32_bf16 v[172:175], v[68:71], v[44:47], v[172:175]
    v_mov_b32 v31, s98
    ds_write_b128 v3, v[28:31]
    v_mfma_f32_16x16x32_bf16 v[176:179], v[68:71], v[48:51], v[176:179]
    ds_write_b128 v3, v[24:27] offset:16
    ds_write_b128 v5, v[12:15]
    v_mfma_f32_16x16x32_bf16 v[180:183], v[68:71], v[52:55], v[180:183]
    ds_write_b128 v5, v[16:19] offset:64
    v_mfma_f32_16x16x32_bf16 v[184:187], v[68:71], v[56:59], v[184:187]
    v_mfma_f32_16x16x32_bf16 v[188:191], v[68:71], v[60:63], v[188:191]
    v_mfma_f32_16x16x32_bf16 v[224:227], v[76:79], v[32:35], v[224:227]
    v_mfma_f32_16x16x32_bf16 v[228:231], v[76:79], v[36:39], v[228:231]
    v_mfma_f32_16x16x32_bf16 v[232:235], v[76:79], v[40:43], v[232:235]
    v_mfma_f32_16x16x32_bf16 v[236:239], v[76:79], v[44:47], v[236:239]
    v_mfma_f32_16x16x32_bf16 v[240:243], v[76:79], v[48:51], v[240:243]
    v_mfma_f32_16x16x32_bf16 v[244:247], v[76:79], v[52:55], v[244:247]
    v_mfma_f32_16x16x32_bf16 v[248:251], v[76:79], v[56:59], v[248:251]
    v_mfma_f32_16x16x32_bf16 v[252:255], v[76:79], v[60:63], v[252:255]
    s_waitcnt lgkmcnt(0)
    s_barrier
    v_mfma_f32_16x16x32_bf16 v[128:131], v[112:115], v[80:83], v[128:131]
    ds_read_b64_tr_b16 v[64:65], v10 offset:0
    s_and_b32 s6, s38, 15
    s_lshl_b32 s6, s6, 15
    v_mfma_f32_16x16x32_bf16 v[132:135], v[112:115], v[84:87], v[132:135]
    ds_read_b64_tr_b16 v[66:67], v10 offset:2048
    s_lshr_b64 s[38:39], s[38:39], 4
    v_add_u32 v6, s6, v7
    v_mfma_f32_16x16x32_bf16 v[136:139], v[112:115], v[88:91], v[136:139]
    ds_read_b128 v[32:35], v6 offset:0
    v_mfma_f32_16x16x32_bf16 v[140:143], v[112:115], v[92:95], v[140:143]
    ds_read_b128 v[36:39], v6 offset:2048
    v_mfma_f32_16x16x32_bf16 v[144:147], v[112:115], v[96:99], v[144:147]
    ds_read_b128 v[40:43], v6 offset:4096
    v_mfma_f32_16x16x32_bf16 v[148:151], v[112:115], v[100:103], v[148:151]
    ds_read_b128 v[44:47], v6 offset:6144
    v_mfma_f32_16x16x32_bf16 v[152:155], v[112:115], v[104:107], v[152:155]
    ds_read_b128 v[48:51], v6 offset:8192
    v_mfma_f32_16x16x32_bf16 v[156:159], v[112:115], v[108:111], v[156:159]
    ds_read_b128 v[52:55], v6 offset:10240
    v_mfma_f32_16x16x32_bf16 v[192:195], v[120:123], v[80:83], v[192:195]
    ds_read_b128 v[56:59], v6 offset:12288
    v_mfma_f32_16x16x32_bf16 v[196:199], v[120:123], v[84:87], v[196:199]
    ds_read_b128 v[60:63], v6 offset:14336
    v_mfma_f32_16x16x32_bf16 v[200:203], v[120:123], v[88:91], v[200:203]
    ds_read_b64_tr_b16 v[72:73], v10 offset:1024
    v_mfma_f32_16x16x32_bf16 v[204:207], v[120:123], v[92:95], v[204:207]
    ds_read_b64_tr_b16 v[74:75], v10 offset:3072
    v_mfma_f32_16x16x32_bf16 v[208:211], v[120:123], v[96:99], v[208:211]
    ds_read_b64_tr_b16 v[68:69], v11 offset:0
    v_mfma_f32_16x16x32_bf16 v[212:215], v[120:123], v[100:103], v[212:215]
    ds_read_b64_tr_b16 v[70:71], v11 offset:2048
    v_mfma_f32_16x16x32_bf16 v[216:219], v[120:123], v[104:107], v[216:219]
    ds_read_b64_tr_b16 v[76:77], v11 offset:1024
    v_mfma_f32_16x16x32_bf16 v[220:223], v[120:123], v[108:111], v[220:223]
    ds_read_b64_tr_b16 v[78:79], v11 offset:3072
    v_mfma_f32_16x16x32_bf16 v[160:163], v[116:119], v[80:83], v[160:163]
    s_load_dwordx2 s[92:93], s[0:1], 48
    s_lshr_b32 s5, s2, 5
    v_mfma_f32_16x16x32_bf16 v[164:167], v[116:119], v[84:87], v[164:167]
    s_lshl_b32 s5, s5, 8
    v_lshrrev_b32 v28, 4, v1
    v_mfma_f32_16x16x32_bf16 v[168:171], v[116:119], v[88:91], v[168:171]
    v_lshlrev_b32 v29, 1, v28
    v_xor_b32 v29, v29, v1
    v_mfma_f32_16x16x32_bf16 v[172:175], v[116:119], v[92:95], v[172:175]
    v_and_b32 v29, 15, v29
    v_lshlrev_b32 v28, 11, v28
    v_mfma_f32_16x16x32_bf16 v[176:179], v[116:119], v[96:99], v[176:179]
    v_lshl_add_u32 v28, v29, 4, v28
    v_add_u32 v24, s5, v28
    v_mfma_f32_16x16x32_bf16 v[180:183], v[116:119], v[100:103], v[180:183]
    v_xor_b32 v25, 128, v24
    v_add_u32 v25, 7168, v25
    v_mfma_f32_16x16x32_bf16 v[184:187], v[116:119], v[104:107], v[184:187]
    v_add_u32 v26, 14336, v24
    v_add_u32 v27, 14336, v25
    v_mfma_f32_16x16x32_bf16 v[188:191], v[116:119], v[108:111], v[188:191]
    s_and_b32 s5, s2, 1
    s_mul_i32 s5, s5, 3670016
    v_mfma_f32_16x16x32_bf16 v[224:227], v[124:127], v[80:83], v[224:227]
    s_lshl_b32 s6, s30, 15
    s_add_u32 s96, s5, s6
    v_mfma_f32_16x16x32_bf16 v[228:231], v[124:127], v[84:87], v[228:231]
    s_lshl_b32 s97, s30, 12
    s_mov_b32 s94, 7340032
    v_mfma_f32_16x16x32_bf16 v[232:235], v[124:127], v[88:91], v[232:235]
    s_mov_b32 s95, 0x20000
    s_add_u32 s96, s96, 524288
    v_mfma_f32_16x16x32_bf16 v[236:239], v[124:127], v[92:95], v[236:239]
    v_mfma_f32_16x16x32_bf16 v[240:243], v[124:127], v[96:99], v[240:243]
    v_mfma_f32_16x16x32_bf16 v[244:247], v[124:127], v[100:103], v[244:247]
    v_mfma_f32_16x16x32_bf16 v[248:251], v[124:127], v[104:107], v[248:251]
    v_mfma_f32_16x16x32_bf16 v[252:255], v[124:127], v[108:111], v[252:255]
    s_waitcnt lgkmcnt(0)
    v_mfma_f32_16x16x32_bf16 v[128:131], v[64:67], v[32:35], v[128:131]
    ds_read_b64_tr_b16 v[112:113], v10 offset:16384
    v_mfma_f32_16x16x32_bf16 v[132:135], v[64:67], v[36:39], v[132:135]
    ds_read_b64_tr_b16 v[114:115], v10 offset:18432
    v_xor_b32 v6, 64, v6
    v_mfma_f32_16x16x32_bf16 v[136:139], v[64:67], v[40:43], v[136:139]
    ds_read_b128 v[80:83], v6 offset:0
    v_mfma_f32_16x16x32_bf16 v[140:143], v[64:67], v[44:47], v[140:143]
    ds_read_b128 v[84:87], v6 offset:2048
    v_mfma_f32_16x16x32_bf16 v[144:147], v[64:67], v[48:51], v[144:147]
    ds_read_b128 v[88:91], v6 offset:4096
    v_mfma_f32_16x16x32_bf16 v[148:151], v[64:67], v[52:55], v[148:151]
    ds_read_b128 v[92:95], v6 offset:6144
    v_mfma_f32_16x16x32_bf16 v[152:155], v[64:67], v[56:59], v[152:155]
    ds_read_b128 v[96:99], v6 offset:8192
    v_mfma_f32_16x16x32_bf16 v[156:159], v[64:67], v[60:63], v[156:159]
    ds_read_b128 v[100:103], v6 offset:10240
    v_mfma_f32_16x16x32_bf16 v[192:195], v[72:75], v[32:35], v[192:195]
    ds_read_b128 v[104:107], v6 offset:12288
    v_mfma_f32_16x16x32_bf16 v[196:199], v[72:75], v[36:39], v[196:199]
    ds_read_b128 v[108:111], v6 offset:14336
    v_mfma_f32_16x16x32_bf16 v[200:203], v[72:75], v[40:43], v[200:203]
    ds_read_b64_tr_b16 v[120:121], v10 offset:17408
    v_mfma_f32_16x16x32_bf16 v[204:207], v[72:75], v[44:47], v[204:207]
    ds_read_b64_tr_b16 v[122:123], v10 offset:19456
    v_mfma_f32_16x16x32_bf16 v[208:211], v[72:75], v[48:51], v[208:211]
    ds_read_b64_tr_b16 v[116:117], v11 offset:16384
    v_mfma_f32_16x16x32_bf16 v[212:215], v[72:75], v[52:55], v[212:215]
    ds_read_b64_tr_b16 v[118:119], v11 offset:18432
    v_mfma_f32_16x16x32_bf16 v[216:219], v[72:75], v[56:59], v[216:219]
    ds_read_b64_tr_b16 v[124:125], v11 offset:17408
    v_mfma_f32_16x16x32_bf16 v[220:223], v[72:75], v[60:63], v[220:223]
    ds_read_b64_tr_b16 v[126:127], v11 offset:19456
    v_mfma_f32_16x16x32_bf16 v[160:163], v[68:71], v[32:35], v[160:163]
    v_mfma_f32_16x16x32_bf16 v[164:167], v[68:71], v[36:39], v[164:167]
    v_mfma_f32_16x16x32_bf16 v[168:171], v[68:71], v[40:43], v[168:171]
    v_mfma_f32_16x16x32_bf16 v[172:175], v[68:71], v[44:47], v[172:175]
    v_mfma_f32_16x16x32_bf16 v[176:179], v[68:71], v[48:51], v[176:179]
    v_mfma_f32_16x16x32_bf16 v[180:183], v[68:71], v[52:55], v[180:183]
    v_mfma_f32_16x16x32_bf16 v[184:187], v[68:71], v[56:59], v[184:187]
    v_mfma_f32_16x16x32_bf16 v[188:191], v[68:71], v[60:63], v[188:191]
    v_mfma_f32_16x16x32_bf16 v[224:227], v[76:79], v[32:35], v[224:227]
    v_mfma_f32_16x16x32_bf16 v[228:231], v[76:79], v[36:39], v[228:231]
    v_mfma_f32_16x16x32_bf16 v[232:235], v[76:79], v[40:43], v[232:235]
    v_mfma_f32_16x16x32_bf16 v[236:239], v[76:79], v[44:47], v[236:239]
    v_mfma_f32_16x16x32_bf16 v[240:243], v[76:79], v[48:51], v[240:243]
    v_mfma_f32_16x16x32_bf16 v[244:247], v[76:79], v[52:55], v[244:247]
    v_mfma_f32_16x16x32_bf16 v[248:251], v[76:79], v[56:59], v[248:251]
    v_mfma_f32_16x16x32_bf16 v[252:255], v[76:79], v[60:63], v[252:255]
L_g1_tail:
    s_waitcnt lgkmcnt(0)
    v_mfma_f32_16x16x32_bf16 v[128:131], v[112:115], v[80:83], v[128:131]
    s_lshl_b32 s7, s28, 1
    v_mfma_f32_16x16x32_bf16 v[132:135], v[112:115], v[84:87], v[132:135]
    s_lshr_b32 s6, s30, 2
    v_mfma_f32_16x16x32_bf16 v[136:139], v[112:115], v[88:91], v[136:139]
    s_add_u32 s7, s7, s6
    v_mfma_f32_16x16x32_bf16 v[140:143], v[112:115], v[92:95], v[140:143]
    s_mul_i32 s7, s7, 112
    v_mfma_f32_16x16x32_bf16 v[144:147], v[112:115], v[96:99], v[144:147]
    s_lshl_b32 s3, s29, 2
    v_mfma_f32_16x16x32_bf16 v[148:151], v[112:115], v[100:103], v[148:151]
    s_add_u32 s7, s7, s3
    v_mfma_f32_16x16x32_bf16 v[152:155], v[112:115], v[104:107], v[152:155]
    s_add_u32 s7, s7, s31
    v_mfma_f32_16x16x32_bf16 v[156:159], v[112:115], v[108:111], v[156:159]
    s_lshl_b32 s7, s7, 13
    v_mfma_f32_16x16x32_bf16 v[192:195], v[120:123], v[80:83], v[192:195]
    v_lshl_add_u32 v10, v1, 4, s7
    v_mfma_f32_16x16x32_bf16 v[196:199], v[120:123], v[84:87], v[196:199]
    v_add_u32 v11, 4096, v10
    v_mfma_f32_16x16x32_bf16 v[200:203], v[120:123], v[88:91], v[200:203]
    s_lshl_b32 s6, s6, 12
    v_mfma_f32_16x16x32_bf16 v[204:207], v[120:123], v[92:95], v[204:207]
    s_add_u32 s6, s6, 147456
    v_mfma_f32_16x16x32_bf16 v[208:211], v[120:123], v[96:99], v[208:211]
    v_and_b32 v6, 15, v1
    v_mfma_f32_16x16x32_bf16 v[212:215], v[120:123], v[100:103], v[212:215]
    v_lshl_add_u32 v6, v6, 5, s6
    v_mfma_f32_16x16x32_bf16 v[216:219], v[120:123], v[104:107], v[216:219]
    s_lshl_b32 s6, s31, 8
    v_mfma_f32_16x16x32_bf16 v[220:223], v[120:123], v[108:111], v[220:223]
    s_add_u32 s6, s6, 155648
    v_mfma_f32_16x16x32_bf16 v[160:163], v[116:119], v[80:83], v[160:163]
    v_lshl_add_u32 v8, v2, 4, s6
    v_mfma_f32_16x16x32_bf16 v[164:167], v[116:119], v[84:87], v[164:167]
    ds_read_b128 v[32:35], v8 offset:0
    v_mfma_f32_16x16x32_bf16 v[168:171], v[116:119], v[88:91], v[168:171]
    ds_read_b128 v[36:39], v8 offset:64
    v_mfma_f32_16x16x32_bf16 v[172:175], v[116:119], v[92:95], v[172:175]
    ds_read_b128 v[40:43], v8 offset:128
    v_mfma_f32_16x16x32_bf16 v[176:179], v[116:119], v[96:99], v[176:179]
    ds_read_b128 v[44:47], v8 offset:192
    v_mfma_f32_16x16x32_bf16 v[180:183], v[116:119], v[100:103], v[180:183]
    ds_read_b128 v[48:51], v6 offset:0
    v_mfma_f32_16x16x32_bf16 v[184:187], v[116:119], v[104:107], v[184:187]
    ds_read_b128 v[52:55], v6 offset:16
    v_mfma_f32_16x16x32_bf16 v[188:191], v[116:119], v[108:111], v[188:191]
    ds_read_b128 v[56:59], v6 offset:512
    v_mfma_f32_16x16x32_bf16 v[224:227], v[124:127], v[80:83], v[224:227]
    ds_read_b128 v[60:63], v6 offset:528
    v_mfma_f32_16x16x32_bf16 v[228:231], v[124:127], v[84:87], v[228:231]
    v_mfma_f32_16x16x32_bf16 v[232:235], v[124:127], v[88:91], v[232:235]
    v_mfma_f32_16x16x32_bf16 v[236:239], v[124:127], v[92:95], v[236:239]
    v_mfma_f32_16x16x32_bf16 v[240:243], v[124:127], v[96:99], v[240:243]
    v_mfma_f32_16x16x32_bf16 v[244:247], v[124:127], v[100:103], v[244:247]
    v_mfma_f32_16x16x32_bf16 v[248:251], v[124:127], v[104:107], v[248:251]
    v_mfma_f32_16x16x32_bf16 v[252:255], v[124:127], v[108:111], v[252:255]
    ds_read_b128 v[64:67], v6 offset:1024
    ds_read_b128 v[68:71], v6 offset:1040
    s_waitcnt lgkmcnt(4)
    v_readfirstlane_b32 s98, v51
    v_pk_fma_f32 v[128:129], v[48:49], v[32:33], v[128:129] op_sel_hi:[0,1,1] neg_lo:[1,0,0] neg_hi:[1,0,0]
    v_pk_fma_f32 v[130:131], v[48:49], v[34:35], v[130:131] op_sel_hi:[0,1,1] neg_lo:[1,0,0] neg_hi:[1,0,0]
    v_pk_fma_f32 v[160:161], v[48:49], v[36:37], v[160:161] op_sel_hi:[0,1,1] neg_lo:[1,0,0] neg_hi:[1,0,0]
    v_pk_fma_f32 v[162:163], v[48:49], v[38:39], v[162:163] op_sel_hi:[0,1,1] neg_lo:[1,0,0] neg_hi:[1,0,0]
    v_pk_mul_f32 v[80:81], v[128:129], v[128:129]
    v_pk_mul_f32 v[82:83], v[130:131], v[130:131]
    v_pk_mul_f32 v[84:85], v[160:161], v[160:161]
    v_pk_mul_f32 v[86:87], v[162:163], v[162:163]
    v_pk_fma_f32 v[80:81], v[80:81], v[52:53], v[50:51] op_sel_hi:[1,0,0]
    v_pk_fma_f32 v[82:83], v[82:83], v[52:53], v[50:51] op_sel_hi:[1,0,0]
    v_pk_fma_f32 v[84:85], v[84:85], v[52:53], v[50:51] op_sel_hi:[1,0,0]
    v_pk_fma_f32 v[86:87], v[86:87], v[52:53], v[50:51] op_sel_hi:[1,0,0]
    v_pk_mul_f32 v[80:81], v[80:81], v[128:129]
    v_pk_mul_f32 v[82:83], v[82:83], v[130:131]
    v_pk_mul_f32 v[84:85], v[84:85], v[160:161]
    v_pk_mul_f32 v[86:87], v[86:87], v[162:163]
    v_exp_f32 v80, v80
    v_exp_f32 v81, v81
    v_pk_fma_f32 v[192:193], v[48:49], v[40:41], v[192:193] op_sel_hi:[0,1,1] neg_lo:[1,0,0] neg_hi:[1,0,0]
    v_exp_f32 v82, v82
    v_exp_f32 v83, v83
    v_pk_fma_f32 v[194:195], v[48:49], v[42:43], v[194:195] op_sel_hi:[0,1,1] neg_lo:[1,0,0] neg_hi:[1,0,0]
    v_exp_f32 v84, v84
    v_exp_f32 v85, v85
    v_pk_fma_f32 v[224:225], v[48:49], v[44:45], v[224:225] op_sel_hi:[0,1,1] neg_lo:[1,0,0] neg_hi:[1,0,0]
    v_exp_f32 v86, v86
    v_exp_f32 v87, v87
    v_pk_fma_f32 v[226:227], v[48:49], v[46:47], v[226:227] op_sel_hi:[0,1,1] neg_lo:[1,0,0] neg_hi:[1,0,0]
    v_pk_fma_f32 v[80:81], v[80:81], v[54:55], v[54:55] op_sel_hi:[1,0,0]
    v_pk_fma_f32 v[82:83], v[82:83], v[54:55], v[54:55] op_sel_hi:[1,0,0]
    v_pk_fma_f32 v[84:85], v[84:85], v[54:55], v[54:55] op_sel_hi:[1,0,0]
    v_pk_fma_f32 v[86:87], v[86:87], v[54:55], v[54:55] op_sel_hi:[1,0,0]
    v_rcp_f32 v80, v80
    v_rcp_f32 v81, v81
    v_pk_mul_f32 v[128:129], v[128:129], v[192:193]
    v_rcp_f32 v82, v82
    v_rcp_f32 v83, v83
    v_pk_mul_f32 v[130:131], v[130:131], v[194:195]
    v_rcp_f32 v84, v84
    v_rcp_f32 v85, v85
    v_pk_mul_f32 v[160:161], v[160:161], v[224:225]
    v_rcp_f32 v86, v86
    v_rcp_f32 v87, v87
    v_pk_mul_f32 v[162:163], v[162:163], v[226:227]
    v_pk_mul_f32 v[128:129], v[128:129], v[80:81]
    v_pk_mul_f32 v[130:131], v[130:131], v[82:83]
    v_pk_mul_f32 v[160:161], v[160:161], v[84:85]
    v_pk_mul_f32 v[162:163], v[162:163], v[86:87]
    v_cvt_pk_bf16_f32 v112, v128, v129
    v_cvt_pk_bf16_f32 v113, v130, v131
    v_cvt_pk_bf16_f32 v114, v160, v161
    v_cvt_pk_bf16_f32 v115, v162, v163
    buffer_store_dwordx4 v[112:115], v10, s[20:23], 0 offen offset:0 sc1
    ds_read_b128 v[48:51], v6 offset:1536
    ds_read_b128 v[52:55], v6 offset:1552
    s_waitcnt lgkmcnt(4)
    v_pk_fma_f32 v[132:133], v[56:57], v[32:33], v[132:133] op_sel_hi:[0,1,1] neg_lo:[1,0,0] neg_hi:[1,0,0]
    v_pk_fma_f32 v[134:135], v[56:57], v[34:35], v[134:135] op_sel_hi:[0,1,1] neg_lo:[1,0,0] neg_hi:[1,0,0]
    v_pk_fma_f32 v[164:165], v[56:57], v[36:37], v[164:165] op_sel_hi:[0,1,1] neg_lo:[1,0,0] neg_hi:[1,0,0]
    v_pk_fma_f32 v[166:167], v[56:57], v[38:39], v[166:167] op_sel_hi:[0,1,1] neg_lo:[1,0,0] neg_hi:[1,0,0]
    v_pk_mul_f32 v[96:97], v[132:133], v[132:133]
    v_pk_mul_f32 v[98:99], v[134:135], v[134:135]
    v_pk_mul_f32 v[100:101], v[164:165], v[164:165]
    v_pk_mul_f32 v[102:103], v[166:167], v[166:167]
    v_pk_fma_f32 v[96:97], v[96:97], v[60:61], v[58:59] op_sel_hi:[1,0,0]
    v_pk_fma_f32 v[98:99], v[98:99], v[60:61], v[58:59] op_sel_hi:[1,0,0]
    v_pk_fma_f32 v[100:101], v[100:101], v[60:61], v[58:59] op_sel_hi:[1,0,0]
    v_pk_fma_f32 v[102:103], v[102:103], v[60:61], v[58:59] op_sel_hi:[1,0,0]
    v_pk_mul_f32 v[96:97], v[96:97], v[132:133]
    v_pk_mul_f32 v[98:99], v[98:99], v[134:135]
    v_pk_mul_f32 v[100:101], v[100:101], v[164:165]
    v_pk_mul_f32 v[102:103], v[102:103], v[166:167]
    v_exp_f32 v96, v96
    v_exp_f32 v97, v97
    v_pk_fma_f32 v[196:197], v[56:57], v[40:41], v[196:197] op_sel_hi:[0,1,1] neg_lo:[1,0,0] neg_hi:[1,0,0]
    v_exp_f32 v98, v98
    v_exp_f32 v99, v99
    v_pk_fma_f32 v[198:199], v[56:57], v[42:43], v[198:199] op_sel_hi:[0,1,1] neg_lo:[1,0,0] neg_hi:[1,0,0]
    v_exp_f32 v100, v100
    v_exp_f32 v101, v101
    v_pk_fma_f32 v[228:229], v[56:57], v[44:45], v[228:229] op_sel_hi:[0,1,1] neg_lo:[1,0,0] neg_hi:[1,0,0]
    v_exp_f32 v102, v102
    v_exp_f32 v103, v103
    v_pk_fma_f32 v[230:231], v[56:57], v[46:47], v[230:231] op_sel_hi:[0,1,1] neg_lo:[1,0,0] neg_hi:[1,0,0]
    v_pk_fma_f32 v[96:97], v[96:97], v[62:63], v[62:63] op_sel_hi:[1,0,0]
    v_pk_fma_f32 v[98:99], v[98:99], v[62:63], v[62:63] op_sel_hi:[1,0,0]
    v_pk_fma_f32 v[100:101], v[100:101], v[62:63], v[62:63] op_sel_hi:[1,0,0]
    v_pk_fma_f32 v[102:103], v[102:103], v[62:63], v[62:63] op_sel_hi:[1,0,0]
    v_rcp_f32 v96, v96
    v_rcp_f32 v97, v97
    v_pk_mul_f32 v[132:133], v[132:133], v[196:197]
    v_rcp_f32 v98, v98
    v_rcp_f32 v99, v99
    v_pk_mul_f32 v[134:135], v[134:135], v[198:199]
    v_rcp_f32 v100, v100
    v_rcp_f32 v101, v101
    v_pk_mul_f32 v[164:165], v[164:165], v[228:229]
    v_rcp_f32 v102, v102
    v_rcp_f32 v103, v103
    v_pk_mul_f32 v[166:167], v[166:167], v[230:231]
    v_pk_mul_f32 v[132:133], v[132:133], v[96:97]
    v_pk_mul_f32 v[134:135], v[134:135], v[98:99]
    v_pk_mul_f32 v[164:165], v[164:165], v[100:101]
    v_pk_mul_f32 v[166:167], v[166:167], v[102:103]
    v_cvt_pk_bf16_f32 v116, v132, v133
    v_cvt_pk_bf16_f32 v117, v134, v135
    v_cvt_pk_bf16_f32 v118, v164, v165
    v_cvt_pk_bf16_f32 v119, v166, v167
    buffer_store_dwordx4 v[116:119], v10, s[20:23], 0 offen offset:1024 sc1
    ds_read_b128 v[56:59], v6 offset:2048
    ds_read_b128 v[60:63], v6 offset:2064
    s_waitcnt lgkmcnt(4)
    v_pk_fma_f32 v[136:137], v[64:65], v[32:33], v[136:137] op_sel_hi:[0,1,1] neg_lo:[1,0,0] neg_hi:[1,0,0]
    v_pk_fma_f32 v[138:139], v[64:65], v[34:35], v[138:139] op_sel_hi:[0,1,1] neg_lo:[1,0,0] neg_hi:[1,0,0]
    v_pk_fma_f32 v[168:169], v[64:65], v[36:37], v[168:169] op_sel_hi:[0,1,1] neg_lo:[1,0,0] neg_hi:[1,0,0]
    v_pk_fma_f32 v[170:171], v[64:65], v[38:39], v[170:171] op_sel_hi:[0,1,1] neg_lo:[1,0,0] neg_hi:[1,0,0]
    v_pk_mul_f32 v[80:81], v[136:137], v[136:137]
    v_pk_mul_f32 v[82:83], v[138:139], v[138:139]
    v_pk_mul_f32 v[84:85], v[168:169], v[168:169]
    v_pk_mul_f32 v[86:87], v[170:171], v[170:171]
    v_pk_fma_f32 v[80:81], v[80:81], v[68:69], v[66:67] op_sel_hi:[1,0,0]
    v_pk_fma_f32 v[82:83], v[82:83], v[68:69], v[66:67] op_sel_hi:[1,0,0]
    v_pk_fma_f32 v[84:85], v[84:85], v[68:69], v[66:67] op_sel_hi:[1,0,0]
    v_pk_fma_f32 v[86:87], v[86:87], v[68:69], v[66:67] op_sel_hi:[1,0,0]
    v_pk_mul_f32 v[80:81], v[80:81], v[136:137]
    v_pk_mul_f32 v[82:83], v[82:83], v[138:139]
    v_pk_mul_f32 v[84:85], v[84:85], v[168:169]
    v_pk_mul_f32 v[86:87], v[86:87], v[170:171]
    v_exp_f32 v80, v80
    v_exp_f32 v81, v81
    v_pk_fma_f32 v[200:201], v[64:65], v[40:41], v[200:201] op_sel_hi:[0,1,1] neg_lo:[1,0,0] neg_hi:[1,0,0]
    v_exp_f32 v82, v82
    v_exp_f32 v83, v83
    v_pk_fma_f32 v[202:203], v[64:65], v[42:43], v[202:203] op_sel_hi:[0,1,1] neg_lo:[1,0,0] neg_hi:[1,0,0]
    v_exp_f32 v84, v84
    v_exp_f32 v85, v85
    v_pk_fma_f32 v[232:233], v[64:65], v[44:45], v[232:233] op_sel_hi:[0,1,1] neg_lo:[1,0,0] neg_hi:[1,0,0]
    v_exp_f32 v86, v86
    v_exp_f32 v87, v87
    v_pk_fma_f32 v[234:235], v[64:65], v[46:47], v[234:235] op_sel_hi:[0,1,1] neg_lo:[1,0,0] neg_hi:[1,0,0]
    v_pk_fma_f32 v[80:81], v[80:81], v[70:71], v[70:71] op_sel_hi:[1,0,0]
    v_pk_fma_f32 v[82:83], v[82:83], v[70:71], v[70:71] op_sel_hi:[1,0,0]
    v_pk_fma_f32 v[84:85], v[84:85], v[70:71], v[70:71] op_sel_hi:[1,0,0]
    v_pk_fma_f32 v[86:87], v[86:87], v[70:71], v[70:71] op_sel_hi:[1,0,0]
    v_rcp_f32 v80, v80
    v_rcp_f32 v81, v81
    v_pk_mul_f32 v[136:137], v[136:137], v[200:201]
    v_rcp_f32 v82, v82
    v_rcp_f32 v83, v83
    v_pk_mul_f32 v[138:139], v[138:139], v[202:203]
    v_rcp_f32 v84, v84
    v_rcp_f32 v85, v85
    v_pk_mul_f32 v[168:169], v[168:169], v[232:233]
    v_rcp_f32 v86, v86
    v_rcp_f32 v87, v87
    v_pk_mul_f32 v[170:171], v[170:171], v[234:235]
    v_pk_mul_f32 v[136:137], v[136:137], v[80:81]
    v_pk_mul_f32 v[138:139], v[138:139], v[82:83]
    v_pk_mul_f32 v[168:169], v[168:169], v[84:85]
    v_pk_mul_f32 v[170:171], v[170:171], v[86:87]
    v_cvt_pk_bf16_f32 v112, v136, v137
    v_cvt_pk_bf16_f32 v113, v138, v139
    v_cvt_pk_bf16_f32 v114, v168, v169
    v_cvt_pk_bf16_f32 v115, v170, v171
    buffer_store_dwordx4 v[112:115], v10, s[20:23], 0 offen offset:2048 sc1
    ds_read_b128 v[64:67], v6 offset:2560
    ds_read_b128 v[68:71], v6 offset:2576
    s_waitcnt lgkmcnt(4)
    v_pk_fma_f32 v[140:141], v[48:49], v[32:33], v[140:141] op_sel_hi:[0,1,1] neg_lo:[1,0,0] neg_hi:[1,0,0]
    v_pk_fma_f32 v[142:143], v[48:49], v[34:35], v[142:143] op_sel_hi:[0,1,1] neg_lo:[1,0,0] neg_hi:[1,0,0]
    v_pk_fma_f32 v[172:173], v[48:49], v[36:37], v[172:173] op_sel_hi:[0,1,1] neg_lo:[1,0,0] neg_hi:[1,0,0]
    v_pk_fma_f32 v[174:175], v[48:49], v[38:39], v[174:175] op_sel_hi:[0,1,1] neg_lo:[1,0,0] neg_hi:[1,0,0]
    v_pk_mul_f32 v[96:97], v[140:141], v[140:141]
    v_pk_mul_f32 v[98:99], v[142:143], v[142:143]
    v_pk_mul_f32 v[100:101], v[172:173], v[172:173]
    v_pk_mul_f32 v[102:103], v[174:175], v[174:175]
    v_pk_fma_f32 v[96:97], v[96:97], v[52:53], v[50:51] op_sel_hi:[1,0,0]
    v_pk_fma_f32 v[98:99], v[98:99], v[52:53], v[50:51] op_sel_hi:[1,0,0]
    v_pk_fma_f32 v[100:101], v[100:101], v[52:53], v[50:51] op_sel_hi:[1,0,0]
    v_pk_fma_f32 v[102:103], v[102:103], v[52:53], v[50:51] op_sel_hi:[1,0,0]
    v_pk_mul_f32 v[96:97], v[96:97], v[140:141]
    v_pk_mul_f32 v[98:99], v[98:99], v[142:143]
    v_pk_mul_f32 v[100:101], v[100:101], v[172:173]
    v_pk_mul_f32 v[102:103], v[102:103], v[174:175]
    v_exp_f32 v96, v96
    v_exp_f32 v97, v97
    v_pk_fma_f32 v[204:205], v[48:49], v[40:41], v[204:205] op_sel_hi:[0,1,1] neg_lo:[1,0,0] neg_hi:[1,0,0]
    v_exp_f32 v98, v98
    v_exp_f32 v99, v99
    v_pk_fma_f32 v[206:207], v[48:49], v[42:43], v[206:207] op_sel_hi:[0,1,1] neg_lo:[1,0,0] neg_hi:[1,0,0]
    v_exp_f32 v100, v100
    v_exp_f32 v101, v101
    v_pk_fma_f32 v[236:237], v[48:49], v[44:45], v[236:237] op_sel_hi:[0,1,1] neg_lo:[1,0,0] neg_hi:[1,0,0]
    v_exp_f32 v102, v102
    v_exp_f32 v103, v103
    v_pk_fma_f32 v[238:239], v[48:49], v[46:47], v[238:239] op_sel_hi:[0,1,1] neg_lo:[1,0,0] neg_hi:[1,0,0]
    v_pk_fma_f32 v[96:97], v[96:97], v[54:55], v[54:55] op_sel_hi:[1,0,0]
    v_pk_fma_f32 v[98:99], v[98:99], v[54:55], v[54:55] op_sel_hi:[1,0,0]
    v_pk_fma_f32 v[100:101], v[100:101], v[54:55], v[54:55] op_sel_hi:[1,0,0]
    v_pk_fma_f32 v[102:103], v[102:103], v[54:55], v[54:55] op_sel_hi:[1,0,0]
    v_rcp_f32 v96, v96
    v_rcp_f32 v97, v97
    v_pk_mul_f32 v[140:141], v[140:141], v[204:205]
    v_rcp_f32 v98, v98
    v_rcp_f32 v99, v99
    v_pk_mul_f32 v[142:143], v[142:143], v[206:207]
    v_rcp_f32 v100, v100
    v_rcp_f32 v101, v101
    v_pk_mul_f32 v[172:173], v[172:173], v[236:237]
    v_rcp_f32 v102, v102
    v_rcp_f32 v103, v103
    v_pk_mul_f32 v[174:175], v[174:175], v[238:239]
    v_pk_mul_f32 v[140:141], v[140:141], v[96:97]
    v_pk_mul_f32 v[142:143], v[142:143], v[98:99]
    v_pk_mul_f32 v[172:173], v[172:173], v[100:101]
    v_pk_mul_f32 v[174:175], v[174:175], v[102:103]
    v_cvt_pk_bf16_f32 v116, v140, v141
    v_cvt_pk_bf16_f32 v117, v142, v143
    v_cvt_pk_bf16_f32 v118, v172, v173
    v_cvt_pk_bf16_f32 v119, v174, v175
    buffer_store_dwordx4 v[116:119], v10, s[20:23], 0 offen offset:3072 sc1
    ds_read_b128 v[48:51], v6 offset:3072
    ds_read_b128 v[52:55], v6 offset:3088
    s_waitcnt lgkmcnt(4)
    v_pk_fma_f32 v[144:145], v[56:57], v[32:33], v[144:145] op_sel_hi:[0,1,1] neg_lo:[1,0,0] neg_hi:[1,0,0]
    v_pk_fma_f32 v[146:147], v[56:57], v[34:35], v[146:147] op_sel_hi:[0,1,1] neg_lo:[1,0,0] neg_hi:[1,0,0]
    v_pk_fma_f32 v[176:177], v[56:57], v[36:37], v[176:177] op_sel_hi:[0,1,1] neg_lo:[1,0,0] neg_hi:[1,0,0]
    v_pk_fma_f32 v[178:179], v[56:57], v[38:39], v[178:179] op_sel_hi:[0,1,1] neg_lo:[1,0,0] neg_hi:[1,0,0]
    v_pk_mul_f32 v[80:81], v[144:145], v[144:145]
    v_pk_mul_f32 v[82:83], v[146:147], v[146:147]
    v_pk_mul_f32 v[84:85], v[176:177], v[176:177]
    v_pk_mul_f32 v[86:87], v[178:179], v[178:179]
    v_pk_fma_f32 v[80:81], v[80:81], v[60:61], v[58:59] op_sel_hi:[1,0,0]
    v_pk_fma_f32 v[82:83], v[82:83], v[60:61], v[58:59] op_sel_hi:[1,0,0]
    v_pk_fma_f32 v[84:85], v[84:85], v[60:61], v[58:59] op_sel_hi:[1,0,0]
    v_pk_fma_f32 v[86:87], v[86:87], v[60:61], v[58:59] op_sel_hi:[1,0,0]
    v_pk_mul_f32 v[80:81], v[80:81], v[144:145]
    v_pk_mul_f32 v[82:83], v[82:83], v[146:147]
    v_pk_mul_f32 v[84:85], v[84:85], v[176:177]
    v_pk_mul_f32 v[86:87], v[86:87], v[178:179]
    v_exp_f32 v80, v80
    v_exp_f32 v81, v81
    v_pk_fma_f32 v[208:209], v[56:57], v[40:41], v[208:209] op_sel_hi:[0,1,1] neg_lo:[1,0,0] neg_hi:[1,0,0]
    v_exp_f32 v82, v82
    v_exp_f32 v83, v83
    v_pk_fma_f32 v[210:211], v[56:57], v[42:43], v[210:211] op_sel_hi:[0,1,1] neg_lo:[1,0,0] neg_hi:[1,0,0]
    v_exp_f32 v84, v84
    v_exp_f32 v85, v85
    v_pk_fma_f32 v[240:241], v[56:57], v[44:45], v[240:241] op_sel_hi:[0,1,1] neg_lo:[1,0,0] neg_hi:[1,0,0]
    v_exp_f32 v86, v86
    v_exp_f32 v87, v87
    v_pk_fma_f32 v[242:243], v[56:57], v[46:47], v[242:243] op_sel_hi:[0,1,1] neg_lo:[1,0,0] neg_hi:[1,0,0]
    v_pk_fma_f32 v[80:81], v[80:81], v[62:63], v[62:63] op_sel_hi:[1,0,0]
    v_pk_fma_f32 v[82:83], v[82:83], v[62:63], v[62:63] op_sel_hi:[1,0,0]
    v_pk_fma_f32 v[84:85], v[84:85], v[62:63], v[62:63] op_sel_hi:[1,0,0]
    v_pk_fma_f32 v[86:87], v[86:87], v[62:63], v[62:63] op_sel_hi:[1,0,0]
    v_rcp_f32 v80, v80
    v_rcp_f32 v81, v81
    v_pk_mul_f32 v[144:145], v[144:145], v[208:209]
    v_rcp_f32 v82, v82
    v_rcp_f32 v83, v83
    v_pk_mul_f32 v[146:147], v[146:147], v[210:211]
    v_rcp_f32 v84, v84
    v_rcp_f32 v85, v85
    v_pk_mul_f32 v[176:177], v[176:177], v[240:241]
    v_rcp_f32 v86, v86
    v_rcp_f32 v87, v87
    v_pk_mul_f32 v[178:179], v[178:179], v[242:243]
    v_pk_mul_f32 v[144:145], v[144:145], v[80:81]
    v_pk_mul_f32 v[146:147], v[146:147], v[82:83]
    v_pk_mul_f32 v[176:177], v[176:177], v[84:85]
    v_pk_mul_f32 v[178:179], v[178:179], v[86:87]
    v_cvt_pk_bf16_f32 v112, v144, v145
    v_cvt_pk_bf16_f32 v113, v146, v147
    v_cvt_pk_bf16_f32 v114, v176, v177
    v_cvt_pk_bf16_f32 v115, v178, v179
    buffer_store_dwordx4 v[112:115], v11, s[20:23], 0 offen offset:0 sc1
    ds_read_b128 v[56:59], v6 offset:3584
    ds_read_b128 v[60:63], v6 offset:3600
    s_waitcnt lgkmcnt(4)
    v_pk_fma_f32 v[148:149], v[64:65], v[32:33], v[148:149] op_sel_hi:[0,1,1] neg_lo:[1,0,0] neg_hi:[1,0,0]
    v_pk_fma_f32 v[150:151], v[64:65], v[34:35], v[150:151] op_sel_hi:[0,1,1] neg_lo:[1,0,0] neg_hi:[1,0,0]
    v_pk_fma_f32 v[180:181], v[64:65], v[36:37], v[180:181] op_sel_hi:[0,1,1] neg_lo:[1,0,0] neg_hi:[1,0,0]
    v_pk_fma_f32 v[182:183], v[64:65], v[38:39], v[182:183] op_sel_hi:[0,1,1] neg_lo:[1,0,0] neg_hi:[1,0,0]
    v_pk_mul_f32 v[96:97], v[148:149], v[148:149]
    v_pk_mul_f32 v[98:99], v[150:151], v[150:151]
    v_pk_mul_f32 v[100:101], v[180:181], v[180:181]
    v_pk_mul_f32 v[102:103], v[182:183], v[182:183]
    v_pk_fma_f32 v[96:97], v[96:97], v[68:69], v[66:67] op_sel_hi:[1,0,0]
    v_pk_fma_f32 v[98:99], v[98:99], v[68:69], v[66:67] op_sel_hi:[1,0,0]
    v_pk_fma_f32 v[100:101], v[100:101], v[68:69], v[66:67] op_sel_hi:[1,0,0]
    v_pk_fma_f32 v[102:103], v[102:103], v[68:69], v[66:67] op_sel_hi:[1,0,0]
    v_pk_mul_f32 v[96:97], v[96:97], v[148:149]
    v_pk_mul_f32 v[98:99], v[98:99], v[150:151]
    v_pk_mul_f32 v[100:101], v[100:101], v[180:181]
    v_pk_mul_f32 v[102:103], v[102:103], v[182:183]
    v_exp_f32 v96, v96
    v_exp_f32 v97, v97
    v_pk_fma_f32 v[212:213], v[64:65], v[40:41], v[212:213] op_sel_hi:[0,1,1] neg_lo:[1,0,0] neg_hi:[1,0,0]
    v_exp_f32 v98, v98
    v_exp_f32 v99, v99
    v_pk_fma_f32 v[214:215], v[64:65], v[42:43], v[214:215] op_sel_hi:[0,1,1] neg_lo:[1,0,0] neg_hi:[1,0,0]
    v_exp_f32 v100, v100
    v_exp_f32 v101, v101
    v_pk_fma_f32 v[244:245], v[64:65], v[44:45], v[244:245] op_sel_hi:[0,1,1] neg_lo:[1,0,0] neg_hi:[1,0,0]
    v_exp_f32 v102, v102
    v_exp_f32 v103, v103
    v_pk_fma_f32 v[246:247], v[64:65], v[46:47], v[246:247] op_sel_hi:[0,1,1] neg_lo:[1,0,0] neg_hi:[1,0,0]
    v_pk_fma_f32 v[96:97], v[96:97], v[70:71], v[70:71] op_sel_hi:[1,0,0]
    v_pk_fma_f32 v[98:99], v[98:99], v[70:71], v[70:71] op_sel_hi:[1,0,0]
    v_pk_fma_f32 v[100:101], v[100:101], v[70:71], v[70:71] op_sel_hi:[1,0,0]
    v_pk_fma_f32 v[102:103], v[102:103], v[70:71], v[70:71] op_sel_hi:[1,0,0]
    v_rcp_f32 v96, v96
    v_rcp_f32 v97, v97
    v_pk_mul_f32 v[148:149], v[148:149], v[212:213]
    v_rcp_f32 v98, v98
    v_rcp_f32 v99, v99
    v_pk_mul_f32 v[150:151], v[150:151], v[214:215]
    v_rcp_f32 v100, v100
    v_rcp_f32 v101, v101
    v_pk_mul_f32 v[180:181], v[180:181], v[244:245]
    v_rcp_f32 v102, v102
    v_rcp_f32 v103, v103
    v_pk_mul_f32 v[182:183], v[182:183], v[246:247]
    v_pk_mul_f32 v[148:149], v[148:149], v[96:97]
    v_pk_mul_f32 v[150:151], v[150:151], v[98:99]
    v_pk_mul_f32 v[180:181], v[180:181], v[100:101]
    v_pk_mul_f32 v[182:183], v[182:183], v[102:103]
    v_cvt_pk_bf16_f32 v116, v148, v149
    v_cvt_pk_bf16_f32 v117, v150, v151
    v_cvt_pk_bf16_f32 v118, v180, v181
    v_cvt_pk_bf16_f32 v119, v182, v183
    buffer_store_dwordx4 v[116:119], v11, s[20:23], 0 offen offset:1024 sc1
    s_waitcnt lgkmcnt(2)
    v_pk_fma_f32 v[152:153], v[48:49], v[32:33], v[152:153] op_sel_hi:[0,1,1] neg_lo:[1,0,0] neg_hi:[1,0,0]
    v_pk_fma_f32 v[154:155], v[48:49], v[34:35], v[154:155] op_sel_hi:[0,1,1] neg_lo:[1,0,0] neg_hi:[1,0,0]
    v_pk_fma_f32 v[184:185], v[48:49], v[36:37], v[184:185] op_sel_hi:[0,1,1] neg_lo:[1,0,0] neg_hi:[1,0,0]
    v_pk_fma_f32 v[186:187], v[48:49], v[38:39], v[186:187] op_sel_hi:[0,1,1] neg_lo:[1,0,0] neg_hi:[1,0,0]
    v_pk_mul_f32 v[80:81], v[152:153], v[152:153]
    v_pk_mul_f32 v[82:83], v[154:155], v[154:155]
    v_pk_mul_f32 v[84:85], v[184:185], v[184:185]
    v_pk_mul_f32 v[86:87], v[186:187], v[186:187]
    v_pk_fma_f32 v[80:81], v[80:81], v[52:53], v[50:51] op_sel_hi:[1,0,0]
    v_pk_fma_f32 v[82:83], v[82:83], v[52:53], v[50:51] op_sel_hi:[1,0,0]
    v_pk_fma_f32 v[84:85], v[84:85], v[52:53], v[50:51] op_sel_hi:[1,0,0]
    v_pk_fma_f32 v[86:87], v[86:87], v[52:53], v[50:51] op_sel_hi:[1,0,0]
    v_pk_mul_f32 v[80:81], v[80:81], v[152:153]
    v_pk_mul_f32 v[82:83], v[82:83], v[154:155]
    v_pk_mul_f32 v[84:85], v[84:85], v[184:185]
    v_pk_mul_f32 v[86:87], v[86:87], v[186:187]
    v_exp_f32 v80, v80
    v_exp_f32 v81, v81
    v_pk_fma_f32 v[216:217], v[48:49], v[40:41], v[216:217] op_sel_hi:[0,1,1] neg_lo:[1,0,0] neg_hi:[1,0,0]
    v_exp_f32 v82, v82
    v_exp_f32 v83, v83
    v_pk_fma_f32 v[218:219], v[48:49], v[42:43], v[218:219] op_sel_hi:[0,1,1] neg_lo:[1,0,0] neg_hi:[1,0,0]
    v_exp_f32 v84, v84
    v_exp_f32 v85, v85
    v_pk_fma_f32 v[248:249], v[48:49], v[44:45], v[248:249] op_sel_hi:[0,1,1] neg_lo:[1,0,0] neg_hi:[1,0,0]
    v_exp_f32 v86, v86
    v_exp_f32 v87, v87
    v_pk_fma_f32 v[250:251], v[48:49], v[46:47], v[250:251] op_sel_hi:[0,1,1] neg_lo:[1,0,0] neg_hi:[1,0,0]
    v_pk_fma_f32 v[80:81], v[80:81], v[54:55], v[54:55] op_sel_hi:[1,0,0]
    v_pk_fma_f32 v[82:83], v[82:83], v[54:55], v[54:55] op_sel_hi:[1,0,0]
    v_pk_fma_f32 v[84:85], v[84:85], v[54:55], v[54:55] op_sel_hi:[1,0,0]
    v_pk_fma_f32 v[86:87], v[86:87], v[54:55], v[54:55] op_sel_hi:[1,0,0]
    v_rcp_f32 v80, v80
    v_rcp_f32 v81, v81
    v_pk_mul_f32 v[152:153], v[152:153], v[216:217]
    v_rcp_f32 v82, v82
    v_rcp_f32 v83, v83
    v_pk_mul_f32 v[154:155], v[154:155], v[218:219]
    v_rcp_f32 v84, v84
    v_rcp_f32 v85, v85
    v_pk_mul_f32 v[184:185], v[184:185], v[248:249]
    v_rcp_f32 v86, v86
    v_rcp_f32 v87, v87
    v_pk_mul_f32 v[186:187], v[186:187], v[250:251]
    v_pk_mul_f32 v[152:153], v[152:153], v[80:81]
    v_pk_mul_f32 v[154:155], v[154:155], v[82:83]
    v_pk_mul_f32 v[184:185], v[184:185], v[84:85]
    v_pk_mul_f32 v[186:187], v[186:187], v[86:87]
    v_cvt_pk_bf16_f32 v112, v152, v153
    v_cvt_pk_bf16_f32 v113, v154, v155
    v_cvt_pk_bf16_f32 v114, v184, v185
    v_cvt_pk_bf16_f32 v115, v186, v187
    buffer_store_dwordx4 v[112:115], v11, s[20:23], 0 offen offset:2048 sc1
    s_waitcnt lgkmcnt(0)
    v_pk_fma_f32 v[156:157], v[56:57], v[32:33], v[156:157] op_sel_hi:[0,1,1] neg_lo:[1,0,0] neg_hi:[1,0,0]
    v_pk_fma_f32 v[158:159], v[56:57], v[34:35], v[158:159] op_sel_hi:[0,1,1] neg_lo:[1,0,0] neg_hi:[1,0,0]
    v_pk_fma_f32 v[188:189], v[56:57], v[36:37], v[188:189] op_sel_hi:[0,1,1] neg_lo:[1,0,0] neg_hi:[1,0,0]
    v_pk_fma_f32 v[190:191], v[56:57], v[38:39], v[190:191] op_sel_hi:[0,1,1] neg_lo:[1,0,0] neg_hi:[1,0,0]
    v_pk_mul_f32 v[96:97], v[156:157], v[156:157]
    v_pk_mul_f32 v[98:99], v[158:159], v[158:159]
    v_pk_mul_f32 v[100:101], v[188:189], v[188:189]
    v_pk_mul_f32 v[102:103], v[190:191], v[190:191]
    v_pk_fma_f32 v[96:97], v[96:97], v[60:61], v[58:59] op_sel_hi:[1,0,0]
    v_pk_fma_f32 v[98:99], v[98:99], v[60:61], v[58:59] op_sel_hi:[1,0,0]
    v_pk_fma_f32 v[100:101], v[100:101], v[60:61], v[58:59] op_sel_hi:[1,0,0]
    v_pk_fma_f32 v[102:103], v[102:103], v[60:61], v[58:59] op_sel_hi:[1,0,0]
    v_pk_mul_f32 v[96:97], v[96:97], v[156:157]
    v_pk_mul_f32 v[98:99], v[98:99], v[158:159]
    v_pk_mul_f32 v[100:101], v[100:101], v[188:189]
    v_pk_mul_f32 v[102:103], v[102:103], v[190:191]
    v_exp_f32 v96, v96
    v_exp_f32 v97, v97
    v_pk_fma_f32 v[220:221], v[56:57], v[40:41], v[220:221] op_sel_hi:[0,1,1] neg_lo:[1,0,0] neg_hi:[1,0,0]
    v_exp_f32 v98, v98
    v_exp_f32 v99, v99
    v_pk_fma_f32 v[222:223], v[56:57], v[42:43], v[222:223] op_sel_hi:[0,1,1] neg_lo:[1,0,0] neg_hi:[1,0,0]
    v_exp_f32 v100, v100
    v_exp_f32 v101, v101
    v_pk_fma_f32 v[252:253], v[56:57], v[44:45], v[252:253] op_sel_hi:[0,1,1] neg_lo:[1,0,0] neg_hi:[1,0,0]
    v_exp_f32 v102, v102
    v_exp_f32 v103, v103
    v_pk_fma_f32 v[254:255], v[56:57], v[46:47], v[254:255] op_sel_hi:[0,1,1] neg_lo:[1,0,0] neg_hi:[1,0,0]
    v_pk_fma_f32 v[96:97], v[96:97], v[62:63], v[62:63] op_sel_hi:[1,0,0]
    v_pk_fma_f32 v[98:99], v[98:99], v[62:63], v[62:63] op_sel_hi:[1,0,0]
    v_pk_fma_f32 v[100:101], v[100:101], v[62:63], v[62:63] op_sel_hi:[1,0,0]
    v_pk_fma_f32 v[102:103], v[102:103], v[62:63], v[62:63] op_sel_hi:[1,0,0]
    v_rcp_f32 v96, v96
    v_rcp_f32 v97, v97
    v_pk_mul_f32 v[156:157], v[156:157], v[220:221]
    v_rcp_f32 v98, v98
    v_rcp_f32 v99, v99
    v_pk_mul_f32 v[158:159], v[158:159], v[222:223]
    v_rcp_f32 v100, v100
    v_rcp_f32 v101, v101
    v_pk_mul_f32 v[188:189], v[188:189], v[252:253]
    v_rcp_f32 v102, v102
    v_rcp_f32 v103, v103
    v_pk_mul_f32 v[190:191], v[190:191], v[254:255]
    v_pk_mul_f32 v[156:157], v[156:157], v[96:97]
    v_pk_mul_f32 v[158:159], v[158:159], v[98:99]
    v_pk_mul_f32 v[188:189], v[188:189], v[100:101]
    v_pk_mul_f32 v[190:191], v[190:191], v[102:103]
    v_cvt_pk_bf16_f32 v116, v156, v157
    v_cvt_pk_bf16_f32 v117, v158, v159
    v_cvt_pk_bf16_f32 v118, v188, v189
    v_cvt_pk_bf16_f32 v119, v190, v191
    buffer_store_dwordx4 v[116:119], v11, s[20:23], 0 offen offset:3072 sc1
    s_setprio 0
    s_cmp_ge_u32 s29, 14
    s_cselect_b32 s4, 456, 0
    s_lshl_b32 s43, s28, 10
    s_add_u32 s43, s43, s4
    s_lshl_b32 s4, s29, 2
    s_add_u32 s43, s43, s4
    s_mov_b32 s44, 15
L_post:
    s_load_dwordx2 s[48:49], s[0:1], 0
    s_load_dwordx2 s[50:51], s[0:1], 56
    v_lshrrev_b32 v2, 6, v0
    v_and_b32 v1, 63, v0
    v_readfirstlane_b32 s30, v2
    s_and_b32 s5, s2, 6
    s_lshl_b32 s5, s5, 1
    s_bfe_u32 s6, s2, 0x20003
    s_add_u32 s28, s5, s6
    v_lshrrev_b32 v5, 4, v1
    s_and_b32 s5, s30, 3
    s_lshl_b32 s6, s5, 11
    v_lshl_add_u32 v6, v1, 4, s6
    v_add_u32 v7, 8192, v6
    s_mul_i32 s31, s28, 112
    s_and_b32 s6, s2, 1
    s_mul_i32 s7, s6, 56
    s_add_u32 s31, s31, s7
    s_lshr_b32 s7, s30, 2
    s_lshl_b32 s3, s7, 1
    s_add_u32 s31, s31, s3
    s_lshl_b32 s31, s31, 13
    v_lshrrev_b32 v2, 2, v1
    v_and_b32 v3, 7, v2
    s_lshl_b32 s6, s6, 2
    v_xor_b32 v3, s6, v3
    v_lshlrev_b32 v2, 8, v2
    v_and_b32 v4, 3, v1
    v_lshl_add_u32 v2, v4, 3, v2
    s_lshl_b32 s7, s7, 14
    v_add_u32 v2, s7, v2
    v_xor_b32 v4, 0, v3
    v_lshl_add_u32 v8, v4, 5, v2
    v_xor_b32 v4, 1, v3
    v_lshl_add_u32 v9, v4, 5, v2
    v_xor_b32 v4, 2, v3
    v_lshl_add_u32 v10, v4, 5, v2
    v_xor_b32 v4, 3, v3
    v_lshl_add_u32 v11, v4, 5, v2
    v_xor_b32 v4, 4, v3
    v_lshl_add_u32 v12, v4, 5, v2
    v_xor_b32 v4, 5, v3
    v_lshl_add_u32 v13, v4, 5, v2
    v_xor_b32 v4, 6, v3
    v_lshl_add_u32 v14, v4, 5, v2
    v_xor_b32 v4, 7, v3
    v_lshl_add_u32 v15, v4, 5, v2
    s_add_u32 s8, s54, 0x400000
    s_addc_u32 s9, s55, 0
    s_mov_b32 s10, 0xe00000
    s_mov_b32 s11, 0x20000
    s_add_u32 s36, s54, 0x1800000
    s_addc_u32 s37, s55, 0
    s_mov_b32 s38, 0x400000
    s_mov_b32 s39, 0x20000
    s_and_b32 s4, s2, 15
    s_bfe_u32 s5, s2, 0x20004
    s_lshr_b32 s6, s2, 6
    s_lshl_b32 s3, s4, 18
    s_lshl_b32 s7, s5, 16
    s_add_u32 s3, s3, s7
    s_lshl_b32 s7, s30, 13
    s_add_u32 s46, s3, s7
    s_add_u32 s47, s46, 4096
    s_lshl_b32 s3, s5, 6
    s_add_u32 s3, s3, s4
    s_lshl_b32 s7, s6, 9
    s_add_u32 s24, s3, s7
    s_lshr_b32 s3, s30, 1
    s_lshl_b32 s5, s3, 4
    s_and_b32 s7, s30, 1
    s_lshl_b32 s6, s7, 8
    s_add_u32 s5, s5, s6
    s_add_u32 s5, s5, s24
    s_lshl_b32 s45, s5, 11
    s_lshl_b32 s3, s3, 8
    s_lshl_b32 s7, s7, 3
    s_add_u32 s3, s3, s7
    s_add_u32 s25, s3, 147456
    s_lshl_b32 s3, s30, 11
    s_add_u32 s26, s3, 147456
    s_mov_b32 s27, 0x3a000000
    s_mov_b32 s29, 0x35000000
    s_add_u32 s32, s54, 0x2300000
    s_addc_u32 s33, s55, 0
    s_mov_b32 s34, 0x28000
    s_mov_b32 s35, 0x20000
    v_mov_b32 v2, s98
    v_lshlrev_b32 v3, 7, v1
    s_lshr_b32 s85, s28, 1
    s_lshl_b32 s85, s85, 10
    s_and_b32 s4, s2, 1
    s_lshl_b32 s4, s4, 9
    s_add_u32 s85, s85, s4
    s_lshr_b32 s4, s2, 6
    s_lshl_b32 s4, s4, 7
    s_add_u32 s85, s85, s4
    v_and_b32 v29, 31, v1
    v_lshlrev_b32 v29, 2, v29
    s_waitcnt vmcnt(0) lgkmcnt(0)
    s_barrier
    s_cmp_lg_u32 s30, 7
    s_cbranch_scc1 L_g2_nsig
    s_mov_b32 exec_lo, s44
    s_mov_b32 exec_hi, 0
    buffer_store_dword v2, v3, s[32:35], s43 offen sc1
    s_mov_b64 exec, -1
L_g2_nsig:
    s_cmp_ge_u32 s2, 32
    s_cbranch_scc1 L_g2_nsp
    s_add_u32 m0, s97, 0
    s_nop 0
    buffer_load_dwordx4 v24, s[92:95], s96 offen lds
    buffer_load_dwordx4 v25, s[92:95], s96 offen offset:1024 lds
    buffer_load_dwordx4 v26, s[92:95], s96 offen offset:2048 lds
    buffer_load_dwordx4 v27, s[92:95], s96 offen offset:3072 lds
    s_add_u32 s96, s96, 262144
    s_add_u32 m0, s97, 32768
    s_nop 0
    buffer_load_dwordx4 v24, s[92:95], s96 offen lds
    buffer_load_dwordx4 v25, s[92:95], s96 offen offset:1024 lds
    buffer_load_dwordx4 v26, s[92:95], s96 offen offset:2048 lds
    buffer_load_dwordx4 v27, s[92:95], s96 offen offset:3072 lds
    s_add_u32 s96, s96, 262144
    s_getpc_b64 s[32:33]
L_p3_pcs:
    s_add_u32 s32, s32, spec_tables-L_p3_pcs
    s_addc_u32 s33, s33, 0
    s_mov_b32 s34, 67584
    s_mov_b32 s35, 0x20000
    v_lshlrev_b32 v30, 4, v1
    s_lshl_b32 s5, s30, 11
    s_add_u32 m0, s5, 131072
    s_add_u32 s5, s5, 51200
    buffer_load_dwordx4 v30, s[32:35], s5 offen lds
    buffer_load_dwordx4 v30, s[32:35], s5 offen offset:1024 lds
    s_add_u32 s32, s54, 0x2300000
    s_addc_u32 s33, s55, 0
    s_mov_b32 s34, 0x28000
    s_mov_b32 s35, 0x20000
L_g2_nsp:
    s_cmp_lg_u32 s30, 7
    s_cbranch_scc1 L_fl_wh_done
    s_add_u32 s32, s54, 0x2300000
    s_addc_u32 s33, s55, 0
    s_mov_b32 s34, 0x28000
    s_mov_b32 s35, 0x20000
    s_lshr_b32 s3, s28, 1
    s_lshl_b32 s3, s3, 10
    s_and_b32 s4, s2, 1
    s_lshl_b32 s4, s4, 9
    s_add_u32 s3, s3, s4
    s_lshr_b32 s4, s2, 6
    s_lshl_b32 s4, s4, 7
    s_add_u32 s3, s3, s4
    v_and_b32 v3, 31, v1
    v_lshlrev_b32 v3, 2, v3
    s_mov_b32 s7, 0
L_fl_wh:
    buffer_load_dword v2, v3, s[32:35], s3 offen sc1
    s_add_u32 s7, s7, 1
    s_waitcnt vmcnt(0)
    v_cmp_ne_u32 vcc, s98, v2
    s_and_b32 s4, vcc_lo, 0x3fff
    s_cbranch_scc0 L_fl_wh_done
    s_cmp_ge_u32 s7, 0x40000
    s_cbranch_scc1 L_fl_wh_done
    s_sleep 2
    s_branch L_fl_wh
L_fl_wh_done:
    s_add_u32 m0, s97, 65536
    s_nop 0
    buffer_load_dwordx4 v24, s[92:95], s96 offen lds
    buffer_load_dwordx4 v25, s[92:95], s96 offen offset:1024 lds
    buffer_load_dwordx4 v26, s[92:95], s96 offen offset:2048 lds
    buffer_load_dwordx4 v27, s[92:95], s96 offen offset:3072 lds
    s_add_u32 s96, s96, 262144
    s_add_u32 m0, s97, 98304
    s_nop 0
    buffer_load_dwordx4 v24, s[92:95], s96 offen lds
    buffer_load_dwordx4 v25, s[92:95], s96 offen offset:1024 lds
    buffer_load_dwordx4 v26, s[92:95], s96 offen offset:2048 lds
    buffer_load_dwordx4 v27, s[92:95], s96 offen offset:3072 lds
    s_add_u32 s96, s96, 262144
    s_waitcnt vmcnt(8) lgkmcnt(0)
    s_barrier
    buffer_load_dwordx4 v[80:83], v6, s[8:11], s31 offen offset:0 sc1
    buffer_load_dwordx4 v[84:87], v6, s[8:11], s31 offen offset:1024 sc1
    buffer_load_dwordx4 v[88:91], v7, s[8:11], s31 offen offset:0 sc1
    buffer_load_dwordx4 v[92:95], v7, s[8:11], s31 offen offset:1024 sc1
    s_add_u32 s31, s31, 32768
    buffer_load_dwordx4 v[96:99], v6, s[8:11], s31 offen offset:0 sc1
    buffer_load_dwordx4 v[100:103], v6, s[8:11], s31 offen offset:1024 sc1
    buffer_load_dwordx4 v[104:107], v7, s[8:11], s31 offen offset:0 sc1
    buffer_load_dwordx4 v[108:111], v7, s[8:11], s31 offen offset:1024 sc1
    s_add_u32 s31, s31, 32768
    buffer_load_dwordx4 v[112:115], v6, s[8:11], s31 offen offset:0 sc1
    buffer_load_dwordx4 v[116:119], v6, s[8:11], s31 offen offset:1024 sc1
    buffer_load_dwordx4 v[120:123], v7, s[8:11], s31 offen offset:0 sc1
    buffer_load_dwordx4 v[124:127], v7, s[8:11], s31 offen offset:1024 sc1
    s_add_u32 s31, s31, 32768
    s_mov_b32 s12, s48
    s_mov_b32 s13, s49
    s_mov_b32 s14, 0x400000
    s_mov_b32 s15, 0x20000
    s_add_u32 s16, s54, 0x1c00000
    s_addc_u32 s17, s55, 0
    s_mov_b32 s18, 0x400000
    s_mov_b32 s19, 0x20000
    s_mov_b32 s20, s50
    s_mov_b32 s21, s51
    s_mov_b32 s22, 0x400000
    s_mov_b32 s23, 0x20000
    ds_read_b64_tr_b16 v[32:33], v12 offset:0
    ds_read_b64_tr_b16 v[34:35], v12 offset:4096
    ds_read_b64_tr_b16 v[36:37], v13 offset:0
    ds_read_b64_tr_b16 v[38:39], v13 offset:4096
    ds_read_b64_tr_b16 v[40:41], v14 offset:0
    ds_read_b64_tr_b16 v[42:43], v14 offset:4096
    ds_read_b64_tr_b16 v[44:45], v15 offset:0
    ds_read_b64_tr_b16 v[46:47], v15 offset:4096
    ds_read_b64_tr_b16 v[48:49], v8 offset:0
    ds_read_b64_tr_b16 v[50:51], v8 offset:4096
    ds_read_b64_tr_b16 v[52:53], v9 offset:0
    ds_read_b64_tr_b16 v[54:55], v9 offset:4096
    ds_read_b64_tr_b16 v[56:57], v10 offset:0
    ds_read_b64_tr_b16 v[58:59], v10 offset:4096
    ds_read_b64_tr_b16 v[60:61], v11 offset:0
    ds_read_b64_tr_b16 v[62:63], v11 offset:4096
    s_waitcnt lgkmcnt(8)
    s_waitcnt vmcnt(11)
    v_mfma_f32_16x16x32_bf16 v[224:227], v[32:35], v[80:83], 0
    ds_read_b64_tr_b16 v[64:65], v12 offset:8192
    v_mfma_f32_16x16x32_bf16 v[232:235], v[36:39], v[80:83], 0
    ds_read_b64_tr_b16 v[66:67], v12 offset:12288
    v_lshlrev_b32 v20, 4, v1
    v_mfma_f32_16x16x32_bf16 v[240:243], v[40:43], v[80:83], 0
    ds_read_b64_tr_b16 v[68:69], v13 offset:8192
    v_and_b32 v168, 15, v1
    v_mfma_f32_16x16x32_bf16 v[248:251], v[44:47], v[80:83], 0
    ds_read_b64_tr_b16 v[70:71], v13 offset:12288
    v_add_u32 v21, 131072, v20
    s_waitcnt vmcnt(10)
    v_mfma_f32_16x16x32_bf16 v[228:231], v[32:35], v[84:87], 0
    ds_read_b64_tr_b16 v[72:73], v14 offset:8192
    v_mfma_f32_16x16x32_bf16 v[236:239], v[36:39], v[84:87], 0
    ds_read_b64_tr_b16 v[74:75], v14 offset:12288
    v_lshrrev_b32 v169, 2, v168
    v_mfma_f32_16x16x32_bf16 v[244:247], v[40:43], v[84:87], 0
    ds_read_b64_tr_b16 v[76:77], v15 offset:8192
    v_bfe_u32 v170, v168, 1, 1
    v_mfma_f32_16x16x32_bf16 v[252:255], v[44:47], v[84:87], 0
    ds_read_b64_tr_b16 v[78:79], v15 offset:12288
    v_lshlrev_b32 v170, 8, v170
    s_waitcnt lgkmcnt(8)
    v_mfma_f32_16x16x32_bf16 v[192:195], v[48:51], v[80:83], 0
    ds_read_b64_tr_b16 v[32:33], v8 offset:8192
    v_mfma_f32_16x16x32_bf16 v[200:203], v[52:55], v[80:83], 0
    ds_read_b64_tr_b16 v[34:35], v8 offset:12288
    v_lshl_add_u32 v170, v169, 4, v170
    v_mfma_f32_16x16x32_bf16 v[208:211], v[56:59], v[80:83], 0
    ds_read_b64_tr_b16 v[36:37], v9 offset:8192
    v_add_u32 v170, s24, v170
    v_mfma_f32_16x16x32_bf16 v[216:219], v[60:63], v[80:83], 0
    ds_read_b64_tr_b16 v[38:39], v9 offset:12288
    v_lshlrev_b32 v17, 12, v5
    buffer_load_dwordx4 v[80:83], v6, s[8:11], s31 offen offset:0 sc1
    v_mfma_f32_16x16x32_bf16 v[196:199], v[48:51], v[84:87], 0
    ds_read_b64_tr_b16 v[40:41], v10 offset:8192
    v_lshl_add_u32 v17, v168, 4, v17
    v_mfma_f32_16x16x32_bf16 v[204:207], v[52:55], v[84:87], 0
    ds_read_b64_tr_b16 v[42:43], v10 offset:12288
    v_add_u32 v17, s25, v17
    v_mfma_f32_16x16x32_bf16 v[212:215], v[56:59], v[84:87], 0
    ds_read_b64_tr_b16 v[44:45], v11 offset:8192
    v_add_u32 v18, s26, v20
    v_mfma_f32_16x16x32_bf16 v[220:223], v[60:63], v[84:87], 0
    ds_read_b64_tr_b16 v[46:47], v11 offset:12288
    v_lshlrev_b32 v19, 5, v168
    buffer_load_dwordx4 v[84:87], v6, s[8:11], s31 offen offset:1024 sc1
    s_waitcnt lgkmcnt(8)
    s_barrier
    s_waitcnt vmcnt(11)
    v_mfma_f32_16x16x32_bf16 v[224:227], v[64:67], v[88:91], v[224:227]
    ds_read_b64_tr_b16 v[48:49], v12 offset:32768
    v_mfma_f32_16x16x32_bf16 v[232:235], v[68:71], v[88:91], v[232:235]
    ds_read_b64_tr_b16 v[50:51], v12 offset:36864
    v_lshl_add_u32 v19, v5, 3, v19
    v_mfma_f32_16x16x32_bf16 v[240:243], v[72:75], v[88:91], v[240:243]
    ds_read_b64_tr_b16 v[52:53], v13 offset:32768
    v_add_u32 v19, s26, v19
    v_mfma_f32_16x16x32_bf16 v[248:251], v[76:79], v[88:91], v[248:251]
    ds_read_b64_tr_b16 v[54:55], v13 offset:36864
    v_and_b32 v171, 1, v168
    s_waitcnt vmcnt(10)
    v_mfma_f32_16x16x32_bf16 v[228:231], v[64:67], v[92:95], v[228:231]
    ds_read_b64_tr_b16 v[56:57], v14 offset:32768
    v_mfma_f32_16x16x32_bf16 v[236:239], v[68:71], v[92:95], v[236:239]
    ds_read_b64_tr_b16 v[58:59], v14 offset:36864
    v_cmp_eq_u32 s[40:41], 1, v171
    v_mfma_f32_16x16x32_bf16 v[244:247], v[72:75], v[92:95], v[244:247]
    ds_read_b64_tr_b16 v[60:61], v15 offset:32768
    v_add_u32 v172, 0, v5
    v_mfma_f32_16x16x32_bf16 v[252:255], v[76:79], v[92:95], v[252:255]
    ds_read_b64_tr_b16 v[62:63], v15 offset:36864
    v_mul_u32_u24 v172, v172, v170
    s_waitcnt lgkmcnt(8)
    v_mfma_f32_16x16x32_bf16 v[192:195], v[32:35], v[88:91], v[192:195]
    ds_read_b64_tr_b16 v[64:65], v8 offset:32768
    v_mfma_f32_16x16x32_bf16 v[200:203], v[36:39], v[88:91], v[200:203]
    ds_read_b64_tr_b16 v[66:67], v8 offset:36864
    v_and_b32 v172, 0x7ff, v172
    v_mfma_f32_16x16x32_bf16 v[208:211], v[40:43], v[88:91], v[208:211]
    ds_read_b64_tr_b16 v[68:69], v9 offset:32768
    v_cvt_f32_u32 v172, v172
    v_mfma_f32_16x16x32_bf16 v[216:219], v[44:47], v[88:91], v[216:219]
    ds_read_b64_tr_b16 v[70:71], v9 offset:36864
    v_mul_f32 v172, s27, v172
    buffer_load_dwordx4 v[88:91], v7, s[8:11], s31 offen offset:0 sc1
    v_mfma_f32_16x16x32_bf16 v[196:199], v[32:35], v[92:95], v[196:199]
    ds_read_b64_tr_b16 v[72:73], v10 offset:32768
    v_cos_f32 v173, v172
    v_mfma_f32_16x16x32_bf16 v[204:207], v[36:39], v[92:95], v[204:207]
    ds_read_b64_tr_b16 v[74:75], v10 offset:36864
    v_sin_f32 v174, v172
    v_mfma_f32_16x16x32_bf16 v[212:215], v[40:43], v[92:95], v[212:215]
    ds_read_b64_tr_b16 v[76:77], v11 offset:32768
    v_mul_f32 v173, s29, v173
    v_mfma_f32_16x16x32_bf16 v[220:223], v[44:47], v[92:95], v[220:223]
    ds_read_b64_tr_b16 v[78:79], v11 offset:36864
    v_mul_f32 v174, s29, v174
    buffer_load_dwordx4 v[92:95], v7, s[8:11], s31 offen offset:1024 sc1
    s_add_u32 s31, s31, 32768
    s_waitcnt lgkmcnt(8)
    s_add_u32 s32, s54, 0x2300000
    s_addc_u32 s33, s55, 0
    s_mov_b32 s34, 0x28000
    s_mov_b32 s35, 0x20000
    s_and_b32 s42, s2, 15
    s_lshl_b32 s42, s42, 7
    s_add_u32 s42, s42, 8192
    v_and_b32 v3, 31, v1
    v_lshlrev_b32 v3, 2, v3
    buffer_load_dword v2, v3, s[32:35], s42 offen sc1
    s_waitcnt vmcnt(12)
    v_mfma_f32_16x16x32_bf16 v[224:227], v[48:51], v[96:99], v[224:227]
    ds_read_b64_tr_b16 v[32:33], v12 offset:40960
    v_mfma_f32_16x16x32_bf16 v[232:235], v[52:55], v[96:99], v[232:235]
    ds_read_b64_tr_b16 v[34:35], v12 offset:45056
    v_cvt_pk_bf16_f32 v175, v173, v174
    v_mfma_f32_16x16x32_bf16 v[240:243], v[56:59], v[96:99], v[240:243]
    ds_read_b64_tr_b16 v[36:37], v13 offset:40960
    v_cvt_pk_bf16_f32 v176, v174, -v173
    v_mfma_f32_16x16x32_bf16 v[248:251], v[60:63], v[96:99], v[248:251]
    ds_read_b64_tr_b16 v[38:39], v13 offset:45056
    v_cndmask_b32 v177, v175, v176, s[40:41]
    s_waitcnt vmcnt(11)
    v_mfma_f32_16x16x32_bf16 v[228:231], v[48:51], v[100:103], v[228:231]
    ds_read_b64_tr_b16 v[40:41], v14 offset:40960
    v_add_u32 v172, 4, v5
    v_mfma_f32_16x16x32_bf16 v[236:239], v[52:55], v[100:103], v[236:239]
    ds_read_b64_tr_b16 v[42:43], v14 offset:45056
    v_mul_u32_u24 v172, v172, v170
    v_mfma_f32_16x16x32_bf16 v[244:247], v[56:59], v[100:103], v[244:247]
    ds_read_b64_tr_b16 v[44:45], v15 offset:40960
    v_and_b32 v172, 0x7ff, v172
    v_mfma_f32_16x16x32_bf16 v[252:255], v[60:63], v[100:103], v[252:255]
    ds_read_b64_tr_b16 v[46:47], v15 offset:45056
    v_cvt_f32_u32 v172, v172
    s_waitcnt lgkmcnt(8)
    v_mfma_f32_16x16x32_bf16 v[192:195], v[64:67], v[96:99], v[192:195]
    ds_read_b64_tr_b16 v[48:49], v8 offset:40960
    v_mfma_f32_16x16x32_bf16 v[200:203], v[68:71], v[96:99], v[200:203]
    ds_read_b64_tr_b16 v[50:51], v8 offset:45056
    v_mul_f32 v172, s27, v172
    v_mfma_f32_16x16x32_bf16 v[208:211], v[72:75], v[96:99], v[208:211]
    ds_read_b64_tr_b16 v[52:53], v9 offset:40960
    v_cos_f32 v173, v172
    v_mfma_f32_16x16x32_bf16 v[216:219], v[76:79], v[96:99], v[216:219]
    ds_read_b64_tr_b16 v[54:55], v9 offset:45056
    v_sin_f32 v174, v172
    buffer_load_dwordx4 v[96:99], v6, s[8:11], s31 offen offset:0 sc1
    v_mfma_f32_16x16x32_bf16 v[196:199], v[64:67], v[100:103], v[196:199]
    ds_read_b64_tr_b16 v[56:57], v10 offset:40960
    v_mfma_f32_16x16x32_bf16 v[204:207], v[68:71], v[100:103], v[204:207]
    ds_read_b64_tr_b16 v[58:59], v10 offset:45056
    v_mul_f32 v173, s29, v173
    v_mfma_f32_16x16x32_bf16 v[212:215], v[72:75], v[100:103], v[212:215]
    ds_read_b64_tr_b16 v[60:61], v11 offset:40960
    v_mul_f32 v174, s29, v174
    v_mfma_f32_16x16x32_bf16 v[220:223], v[76:79], v[100:103], v[220:223]
    ds_read_b64_tr_b16 v[62:63], v11 offset:45056
    v_cvt_pk_bf16_f32 v175, v173, v174
    buffer_load_dwordx4 v[100:103], v6, s[8:11], s31 offen offset:1024 sc1
    s_waitcnt lgkmcnt(8) vmcnt(23)
    s_barrier
    v_xor_b32 v8, 0x10000, v8
    v_xor_b32 v9, 0x10000, v9
    v_xor_b32 v10, 0x10000, v10
    v_xor_b32 v11, 0x10000, v11
    v_xor_b32 v12, 0x10000, v12
    v_xor_b32 v13, 0x10000, v13
    v_xor_b32 v14, 0x10000, v14
    v_xor_b32 v15, 0x10000, v15
    s_waitcnt vmcnt(12)
    v_mfma_f32_16x16x32_bf16 v[224:227], v[32:35], v[104:107], v[224:227]
    ds_read_b64_tr_b16 v[64:65], v12 offset:0
    v_mfma_f32_16x16x32_bf16 v[232:235], v[36:39], v[104:107], v[232:235]
    ds_read_b64_tr_b16 v[66:67], v12 offset:4096
    v_cvt_pk_bf16_f32 v176, v174, -v173
    s_add_u32 m0, s97, 0
    s_nop 0
    buffer_load_dwordx4 v24, s[92:95], s96 offen lds
    v_mfma_f32_16x16x32_bf16 v[240:243], v[40:43], v[104:107], v[240:243]
    ds_read_b64_tr_b16 v[68:69], v13 offset:0
    v_cndmask_b32 v178, v175, v176, s[40:41]
    v_mfma_f32_16x16x32_bf16 v[248:251], v[44:47], v[104:107], v[248:251]
    ds_read_b64_tr_b16 v[70:71], v13 offset:4096
    v_cmp_eq_u32 s[86:87], 0, v169
    buffer_load_dwordx4 v25, s[92:95], s96 offen offset:1024 lds
    s_waitcnt vmcnt(13)
    v_mfma_f32_16x16x32_bf16 v[228:231], v[32:35], v[108:111], v[228:231]
    ds_read_b64_tr_b16 v[72:73], v14 offset:0
    v_cndmask_b32 v128, 0, v177, s[86:87]
    v_mfma_f32_16x16x32_bf16 v[236:239], v[36:39], v[108:111], v[236:239]
    ds_read_b64_tr_b16 v[74:75], v14 offset:4096
    v_cndmask_b32 v132, 0, v178, s[86:87]
    buffer_load_dwordx4 v26, s[92:95], s96 offen offset:2048 lds
    v_mfma_f32_16x16x32_bf16 v[244:247], v[40:43], v[108:111], v[244:247]
    ds_read_b64_tr_b16 v[76:77], v15 offset:0
    v_cmp_eq_u32 s[86:87], 1, v169
    v_mfma_f32_16x16x32_bf16 v[252:255], v[44:47], v[108:111], v[252:255]
    ds_read_b64_tr_b16 v[78:79], v15 offset:4096
    v_cndmask_b32 v129, 0, v177, s[86:87]
    buffer_load_dwordx4 v27, s[92:95], s96 offen offset:3072 lds
    s_add_u32 s96, s96, 262144
    s_waitcnt lgkmcnt(8)
    v_mfma_f32_16x16x32_bf16 v[192:195], v[48:51], v[104:107], v[192:195]
    ds_read_b64_tr_b16 v[32:33], v8 offset:0
    v_mfma_f32_16x16x32_bf16 v[200:203], v[52:55], v[104:107], v[200:203]
    ds_read_b64_tr_b16 v[34:35], v8 offset:4096
    v_cndmask_b32 v133, 0, v178, s[86:87]
    v_mfma_f32_16x16x32_bf16 v[208:211], v[56:59], v[104:107], v[208:211]
    ds_read_b64_tr_b16 v[36:37], v9 offset:0
    v_cmp_eq_u32 s[86:87], 2, v169
    v_mfma_f32_16x16x32_bf16 v[216:219], v[60:63], v[104:107], v[216:219]
    ds_read_b64_tr_b16 v[38:39], v9 offset:4096
    v_cndmask_b32 v130, 0, v177, s[86:87]
    buffer_load_dwordx4 v[104:107], v7, s[8:11], s31 offen offset:0 sc1
    v_mfma_f32_16x16x32_bf16 v[196:199], v[48:51], v[108:111], v[196:199]
    ds_read_b64_tr_b16 v[40:41], v10 offset:0
    v_cndmask_b32 v134, 0, v178, s[86:87]
    v_mfma_f32_16x16x32_bf16 v[204:207], v[52:55], v[108:111], v[204:207]
    ds_read_b64_tr_b16 v[42:43], v10 offset:4096
    v_cmp_eq_u32 s[86:87], 3, v169
    v_mfma_f32_16x16x32_bf16 v[212:215], v[56:59], v[108:111], v[212:215]
    ds_read_b64_tr_b16 v[44:45], v11 offset:0
    v_cndmask_b32 v131, 0, v177, s[86:87]
    v_mfma_f32_16x16x32_bf16 v[220:223], v[60:63], v[108:111], v[220:223]
    ds_read_b64_tr_b16 v[46:47], v11 offset:4096
    v_cndmask_b32 v135, 0, v178, s[86:87]
    buffer_load_dwordx4 v[108:111], v7, s[8:11], s31 offen offset:1024 sc1
    s_add_u32 s31, s31, 32768
    s_waitcnt lgkmcnt(8)
    s_waitcnt vmcnt(16)
    v_mfma_f32_16x16x32_bf16 v[224:227], v[64:67], v[112:115], v[224:227]
    ds_read_b64_tr_b16 v[48:49], v12 offset:8192
    v_mfma_f32_16x16x32_bf16 v[232:235], v[68:71], v[112:115], v[232:235]
    ds_read_b64_tr_b16 v[50:51], v12 offset:12288
    v_mfma_f32_16x16x32_bf16 v[240:243], v[72:75], v[112:115], v[240:243]
    ds_read_b64_tr_b16 v[52:53], v13 offset:8192
    v_mfma_f32_16x16x32_bf16 v[248:251], v[76:79], v[112:115], v[248:251]
    ds_read_b64_tr_b16 v[54:55], v13 offset:12288
    s_waitcnt vmcnt(15)
    v_mfma_f32_16x16x32_bf16 v[228:231], v[64:67], v[116:119], v[228:231]
    ds_read_b64_tr_b16 v[56:57], v14 offset:8192
    v_mfma_f32_16x16x32_bf16 v[236:239], v[68:71], v[116:119], v[236:239]
    ds_read_b64_tr_b16 v[58:59], v14 offset:12288
    v_mfma_f32_16x16x32_bf16 v[244:247], v[72:75], v[116:119], v[244:247]
    ds_read_b64_tr_b16 v[60:61], v15 offset:8192
    v_mfma_f32_16x16x32_bf16 v[252:255], v[76:79], v[116:119], v[252:255]
    ds_read_b64_tr_b16 v[62:63], v15 offset:12288
    s_waitcnt lgkmcnt(8)
    v_mfma_f32_16x16x32_bf16 v[192:195], v[32:35], v[112:115], v[192:195]
    ds_read_b64_tr_b16 v[64:65], v8 offset:8192
    v_mfma_f32_16x16x32_bf16 v[200:203], v[36:39], v[112:115], v[200:203]
    ds_read_b64_tr_b16 v[66:67], v8 offset:12288
    v_mfma_f32_16x16x32_bf16 v[208:211], v[40:43], v[112:115], v[208:211]
    ds_read_b64_tr_b16 v[68:69], v9 offset:8192
    v_mfma_f32_16x16x32_bf16 v[216:219], v[44:47], v[112:115], v[216:219]
    ds_read_b64_tr_b16 v[70:71], v9 offset:12288
    buffer_load_dwordx4 v[112:115], v6, s[8:11], s31 offen offset:0 sc1
    v_mfma_f32_16x16x32_bf16 v[196:199], v[32:35], v[116:119], v[196:199]
    ds_read_b64_tr_b16 v[72:73], v10 offset:8192
    v_mfma_f32_16x16x32_bf16 v[204:207], v[36:39], v[116:119], v[204:207]
    ds_read_b64_tr_b16 v[74:75], v10 offset:12288
    v_mfma_f32_16x16x32_bf16 v[212:215], v[40:43], v[116:119], v[212:215]
    ds_read_b64_tr_b16 v[76:77], v11 offset:8192
    v_mfma_f32_16x16x32_bf16 v[220:223], v[44:47], v[116:119], v[220:223]
    ds_read_b64_tr_b16 v[78:79], v11 offset:12288
    buffer_load_dwordx4 v[116:119], v6, s[8:11], s31 offen offset:1024 sc1
    s_waitcnt lgkmcnt(8) vmcnt(27)
    s_barrier
    s_waitcnt vmcnt(10)
    s_mov_b32 s7, 0
L_g2_v:
    v_cmp_ne_u32 vcc, s98, v2
    s_cmp_eq_u32 vcc_lo, 0
    s_cbranch_scc1 L_g2_v_done
    s_add_u32 s7, s7, 1
    s_cmp_ge_u32 s7, 0x40000
    s_cbranch_scc1 L_g2_v_done
    s_sleep 4
    buffer_load_dword v2, v3, s[32:35], s42 offen sc1
    s_waitcnt vmcnt(0)
    s_branch L_g2_v
L_g2_v_done:
    s_waitcnt vmcnt(16)
    v_mfma_f32_16x16x32_bf16 v[224:227], v[48:51], v[120:123], v[224:227]
    ds_read_b64_tr_b16 v[32:33], v12 offset:32768
    buffer_load_dwordx4 v[136:139], v20, s[36:39], s46 offen offset:0 sc1
    v_mfma_f32_16x16x32_bf16 v[232:235], v[52:55], v[120:123], v[232:235]
    ds_read_b64_tr_b16 v[34:35], v12 offset:36864
    buffer_load_dwordx4 v[140:143], v20, s[36:39], s46 offen offset:1024 sc1
    s_add_u32 m0, s97, 32768
    s_nop 0
    buffer_load_dwordx4 v24, s[92:95], s96 offen lds
    v_mfma_f32_16x16x32_bf16 v[240:243], v[56:59], v[120:123], v[240:243]
    ds_read_b64_tr_b16 v[36:37], v13 offset:32768
    buffer_load_dwordx4 v[144:147], v20, s[36:39], s46 offen offset:2048 sc1
    v_mfma_f32_16x16x32_bf16 v[248:251], v[60:63], v[120:123], v[248:251]
    ds_read_b64_tr_b16 v[38:39], v13 offset:36864
    buffer_load_dwordx4 v[148:151], v20, s[36:39], s46 offen offset:3072 sc1
    buffer_load_dwordx4 v25, s[92:95], s96 offen offset:1024 lds
    s_waitcnt vmcnt(21)
    v_mfma_f32_16x16x32_bf16 v[228:231], v[48:51], v[124:127], v[228:231]
    ds_read_b64_tr_b16 v[40:41], v14 offset:32768
    buffer_load_dwordx4 v[152:155], v20, s[36:39], s47 offen offset:0 sc1
    v_mfma_f32_16x16x32_bf16 v[236:239], v[52:55], v[124:127], v[236:239]
    ds_read_b64_tr_b16 v[42:43], v14 offset:36864
    buffer_load_dwordx4 v[156:159], v20, s[36:39], s47 offen offset:1024 sc1
    buffer_load_dwordx4 v26, s[92:95], s96 offen offset:2048 lds
    v_mfma_f32_16x16x32_bf16 v[244:247], v[56:59], v[124:127], v[244:247]
    ds_read_b64_tr_b16 v[44:45], v15 offset:32768
    buffer_load_dwordx4 v[160:163], v20, s[36:39], s47 offen offset:2048 sc1
    v_mfma_f32_16x16x32_bf16 v[252:255], v[60:63], v[124:127], v[252:255]
    ds_read_b64_tr_b16 v[46:47], v15 offset:36864
    buffer_load_dwordx4 v[164:167], v20, s[36:39], s47 offen offset:3072 sc1
    buffer_load_dwordx4 v27, s[92:95], s96 offen offset:3072 lds
    s_add_u32 s96, s96, 262144
    s_waitcnt lgkmcnt(8)
    v_mfma_f32_16x16x32_bf16 v[192:195], v[64:67], v[120:123], v[192:195]
    ds_read_b64_tr_b16 v[48:49], v8 offset:32768
    v_mfma_f32_16x16x32_bf16 v[200:203], v[68:71], v[120:123], v[200:203]
    ds_read_b64_tr_b16 v[50:51], v8 offset:36864
    v_mfma_f32_16x16x32_bf16 v[208:211], v[72:75], v[120:123], v[208:211]
    ds_read_b64_tr_b16 v[52:53], v9 offset:32768
    v_mfma_f32_16x16x32_bf16 v[216:219], v[76:79], v[120:123], v[216:219]
    ds_read_b64_tr_b16 v[54:55], v9 offset:36864
    buffer_load_dwordx4 v[120:123], v7, s[8:11], s31 offen offset:0 sc1
    v_mfma_f32_16x16x32_bf16 v[196:199], v[64:67], v[124:127], v[196:199]
    ds_read_b64_tr_b16 v[56:57], v10 offset:32768
    v_mfma_f32_16x16x32_bf16 v[204:207], v[68:71], v[124:127], v[204:207]
    ds_read_b64_tr_b16 v[58:59], v10 offset:36864
    v_mfma_f32_16x16x32_bf16 v[212:215], v[72:75], v[124:127], v[212:215]
    ds_read_b64_tr_b16 v[60:61], v11 offset:32768
    v_mfma_f32_16x16x32_bf16 v[220:223], v[76:79], v[124:127], v[220:223]
    ds_read_b64_tr_b16 v[62:63], v11 offset:36864
    buffer_load_dwordx4 v[124:127], v7, s[8:11], s31 offen offset:1024 sc1
    s_add_u32 s31, s31, 32768
    s_waitcnt lgkmcnt(8)
    s_waitcnt vmcnt(28)
    v_mfma_f32_16x16x32_bf16 v[224:227], v[32:35], v[80:83], v[224:227]
    ds_read_b64_tr_b16 v[64:65], v12 offset:40960
    v_mfma_f32_16x16x32_bf16 v[232:235], v[36:39], v[80:83], v[232:235]
    ds_read_b64_tr_b16 v[66:67], v12 offset:45056
    v_mfma_f32_16x16x32_bf16 v[240:243], v[40:43], v[80:83], v[240:243]
    ds_read_b64_tr_b16 v[68:69], v13 offset:40960
    v_mfma_f32_16x16x32_bf16 v[248:251], v[44:47], v[80:83], v[248:251]
    ds_read_b64_tr_b16 v[70:71], v13 offset:45056
    s_waitcnt vmcnt(27)
    v_mfma_f32_16x16x32_bf16 v[228:231], v[32:35], v[84:87], v[228:231]
    ds_read_b64_tr_b16 v[72:73], v14 offset:40960
    v_mfma_f32_16x16x32_bf16 v[236:239], v[36:39], v[84:87], v[236:239]
    ds_read_b64_tr_b16 v[74:75], v14 offset:45056
    v_mfma_f32_16x16x32_bf16 v[244:247], v[40:43], v[84:87], v[244:247]
    ds_read_b64_tr_b16 v[76:77], v15 offset:40960
    v_mfma_f32_16x16x32_bf16 v[252:255], v[44:47], v[84:87], v[252:255]
    ds_read_b64_tr_b16 v[78:79], v15 offset:45056
    s_waitcnt lgkmcnt(8)
    v_mfma_f32_16x16x32_bf16 v[192:195], v[48:51], v[80:83], v[192:195]
    ds_read_b64_tr_b16 v[32:33], v8 offset:40960
    v_mfma_f32_16x16x32_bf16 v[200:203], v[52:55], v[80:83], v[200:203]
    ds_read_b64_tr_b16 v[34:35], v8 offset:45056
    v_mfma_f32_16x16x32_bf16 v[208:211], v[56:59], v[80:83], v[208:211]
    ds_read_b64_tr_b16 v[36:37], v9 offset:40960
    v_mfma_f32_16x16x32_bf16 v[216:219], v[60:63], v[80:83], v[216:219]
    ds_read_b64_tr_b16 v[38:39], v9 offset:45056
    buffer_load_dwordx4 v[80:83], v6, s[8:11], s31 offen offset:0 sc1
    v_mfma_f32_16x16x32_bf16 v[196:199], v[48:51], v[84:87], v[196:199]
    ds_read_b64_tr_b16 v[40:41], v10 offset:40960
    v_mfma_f32_16x16x32_bf16 v[204:207], v[52:55], v[84:87], v[204:207]
    ds_read_b64_tr_b16 v[42:43], v10 offset:45056
    v_mfma_f32_16x16x32_bf16 v[212:215], v[56:59], v[84:87], v[212:215]
    ds_read_b64_tr_b16 v[44:45], v11 offset:40960
    v_mfma_f32_16x16x32_bf16 v[220:223], v[60:63], v[84:87], v[220:223]
    ds_read_b64_tr_b16 v[46:47], v11 offset:45056
    buffer_load_dwordx4 v[84:87], v6, s[8:11], s31 offen offset:1024 sc1
    s_waitcnt lgkmcnt(8) vmcnt(20)
    s_barrier
    v_xor_b32 v8, 0x10000, v8
    v_xor_b32 v9, 0x10000, v9
    v_xor_b32 v10, 0x10000, v10
    v_xor_b32 v11, 0x10000, v11
    v_xor_b32 v12, 0x10000, v12
    v_xor_b32 v13, 0x10000, v13
    v_xor_b32 v14, 0x10000, v14
    v_xor_b32 v15, 0x10000, v15
    s_waitcnt vmcnt(28)
    v_mfma_f32_16x16x32_bf16 v[224:227], v[64:67], v[88:91], v[224:227]
    ds_read_b64_tr_b16 v[48:49], v12 offset:0
    v_mfma_f32_16x16x32_bf16 v[232:235], v[68:71], v[88:91], v[232:235]
    ds_read_b64_tr_b16 v[50:51], v12 offset:4096
    s_add_u32 m0, s97, 65536
    s_nop 0
    buffer_load_dwordx4 v24, s[92:95], s96 offen lds
    v_mfma_f32_16x16x32_bf16 v[240:243], v[72:75], v[88:91], v[240:243]
    ds_read_b64_tr_b16 v[52:53], v13 offset:0
    v_mfma_f32_16x16x32_bf16 v[248:251], v[76:79], v[88:91], v[248:251]
    ds_read_b64_tr_b16 v[54:55], v13 offset:4096
    buffer_load_dwordx4 v25, s[92:95], s96 offen offset:1024 lds
    s_waitcnt vmcnt(29)
    v_mfma_f32_16x16x32_bf16 v[228:231], v[64:67], v[92:95], v[228:231]
    ds_read_b64_tr_b16 v[56:57], v14 offset:0
    v_mfma_f32_16x16x32_bf16 v[236:239], v[68:71], v[92:95], v[236:239]
    ds_read_b64_tr_b16 v[58:59], v14 offset:4096
    buffer_load_dwordx4 v26, s[92:95], s96 offen offset:2048 lds
    v_mfma_f32_16x16x32_bf16 v[244:247], v[72:75], v[92:95], v[244:247]
    ds_read_b64_tr_b16 v[60:61], v15 offset:0
    v_mfma_f32_16x16x32_bf16 v[252:255], v[76:79], v[92:95], v[252:255]
    ds_read_b64_tr_b16 v[62:63], v15 offset:4096
    buffer_load_dwordx4 v27, s[92:95], s96 offen offset:3072 lds
    s_add_u32 s96, s96, 262144
    s_waitcnt lgkmcnt(8)
    v_mfma_f32_16x16x32_bf16 v[192:195], v[32:35], v[88:91], v[192:195]
    ds_read_b64_tr_b16 v[64:65], v8 offset:0
    v_mfma_f32_16x16x32_bf16 v[200:203], v[36:39], v[88:91], v[200:203]
    ds_read_b64_tr_b16 v[66:67], v8 offset:4096
    v_mfma_f32_16x16x32_bf16 v[208:211], v[40:43], v[88:91], v[208:211]
    ds_read_b64_tr_b16 v[68:69], v9 offset:0
    v_mfma_f32_16x16x32_bf16 v[216:219], v[44:47], v[88:91], v[216:219]
    ds_read_b64_tr_b16 v[70:71], v9 offset:4096
    buffer_load_dwordx4 v[88:91], v7, s[8:11], s31 offen offset:0 sc1
    v_mfma_f32_16x16x32_bf16 v[196:199], v[32:35], v[92:95], v[196:199]
    ds_read_b64_tr_b16 v[72:73], v10 offset:0
    v_mfma_f32_16x16x32_bf16 v[204:207], v[36:39], v[92:95], v[204:207]
    ds_read_b64_tr_b16 v[74:75], v10 offset:4096
    v_mfma_f32_16x16x32_bf16 v[212:215], v[40:43], v[92:95], v[212:215]
    ds_read_b64_tr_b16 v[76:77], v11 offset:0
    v_mfma_f32_16x16x32_bf16 v[220:223], v[44:47], v[92:95], v[220:223]
    ds_read_b64_tr_b16 v[78:79], v11 offset:4096
    buffer_load_dwordx4 v[92:95], v7, s[8:11], s31 offen offset:1024 sc1
    s_add_u32 s31, s31, 32768
    s_waitcnt lgkmcnt(8)
    s_waitcnt vmcnt(11)
    v_mfma_f32_16x16x32_bf16 v[168:171], v[128:131], v[136:139], 0
    v_mfma_f32_16x16x32_bf16 v[172:175], v[128:131], v[144:147], 0
    v_mfma_f32_16x16x32_bf16 v[176:179], v[128:131], v[152:155], 0
    v_mfma_f32_16x16x32_bf16 v[180:183], v[128:131], v[160:163], 0
    v_mfma_f32_16x16x32_bf16 v[168:171], v[132:135], v[140:143], v[168:171]
    v_mfma_f32_16x16x32_bf16 v[172:175], v[132:135], v[148:151], v[172:175]
    v_mfma_f32_16x16x32_bf16 v[176:179], v[132:135], v[156:159], v[176:179]
    v_mfma_f32_16x16x32_bf16 v[180:183], v[132:135], v[164:167], v[180:183]
    s_waitcnt vmcnt(31)
    v_mfma_f32_16x16x32_bf16 v[224:227], v[48:51], v[96:99], v[224:227]
    ds_read_b64_tr_b16 v[32:33], v12 offset:8192
    v_mfma_f32_16x16x32_bf16 v[232:235], v[52:55], v[96:99], v[232:235]
    ds_read_b64_tr_b16 v[34:35], v12 offset:12288
    v_mfma_f32_16x16x32_bf16 v[240:243], v[56:59], v[96:99], v[240:243]
    ds_read_b64_tr_b16 v[36:37], v13 offset:8192
    v_mfma_f32_16x16x32_bf16 v[248:251], v[60:63], v[96:99], v[248:251]
    ds_read_b64_tr_b16 v[38:39], v13 offset:12288
    s_waitcnt vmcnt(30)
    v_mfma_f32_16x16x32_bf16 v[228:231], v[48:51], v[100:103], v[228:231]
    ds_read_b64_tr_b16 v[40:41], v14 offset:8192
    v_mfma_f32_16x16x32_bf16 v[236:239], v[52:55], v[100:103], v[236:239]
    ds_read_b64_tr_b16 v[42:43], v14 offset:12288
    v_mfma_f32_16x16x32_bf16 v[244:247], v[56:59], v[100:103], v[244:247]
    ds_read_b64_tr_b16 v[44:45], v15 offset:8192
    v_mfma_f32_16x16x32_bf16 v[252:255], v[60:63], v[100:103], v[252:255]
    ds_read_b64_tr_b16 v[46:47], v15 offset:12288
    s_waitcnt lgkmcnt(8)
    v_mfma_f32_16x16x32_bf16 v[192:195], v[64:67], v[96:99], v[192:195]
    ds_read_b64_tr_b16 v[48:49], v8 offset:8192
    v_cvt_pk_bf16_f32 v184, v168, v169
    v_mfma_f32_16x16x32_bf16 v[200:203], v[68:71], v[96:99], v[200:203]
    ds_read_b64_tr_b16 v[50:51], v8 offset:12288
    v_cvt_pk_bf16_f32 v185, v176, v177
    v_cvt_pk_bf16_f32 v186, v170, v171
    v_mfma_f32_16x16x32_bf16 v[208:211], v[72:75], v[96:99], v[208:211]
    ds_read_b64_tr_b16 v[52:53], v9 offset:8192
    v_cvt_pk_bf16_f32 v187, v178, v179
    v_mfma_f32_16x16x32_bf16 v[216:219], v[76:79], v[96:99], v[216:219]
    ds_read_b64_tr_b16 v[54:55], v9 offset:12288
    v_cvt_pk_bf16_f32 v188, v172, v173
    v_cvt_pk_bf16_f32 v189, v180, v181
    buffer_load_dwordx4 v[96:99], v6, s[8:11], s31 offen offset:0 sc1
    v_mfma_f32_16x16x32_bf16 v[196:199], v[64:67], v[100:103], v[196:199]
    ds_read_b64_tr_b16 v[56:57], v10 offset:8192
    v_cvt_pk_bf16_f32 v190, v174, v175
    v_mfma_f32_16x16x32_bf16 v[204:207], v[68:71], v[100:103], v[204:207]
    ds_read_b64_tr_b16 v[58:59], v10 offset:12288
    v_cvt_pk_bf16_f32 v191, v182, v183
    ds_write_b64 v17, v[184:185] offset:0
    v_mfma_f32_16x16x32_bf16 v[212:215], v[72:75], v[100:103], v[212:215]
    ds_read_b64_tr_b16 v[60:61], v11 offset:8192
    ds_write_b64 v17, v[186:187] offset:2048
    v_mfma_f32_16x16x32_bf16 v[220:223], v[76:79], v[100:103], v[220:223]
    ds_read_b64_tr_b16 v[62:63], v11 offset:12288
    ds_write_b64 v17, v[188:189] offset:1024
    ds_write_b64 v17, v[190:191] offset:3072
    buffer_load_dwordx4 v[100:103], v6, s[8:11], s31 offen offset:1024 sc1
    s_waitcnt lgkmcnt(0) vmcnt(12)
    s_barrier
    s_waitcnt vmcnt(27)
    v_mfma_f32_16x16x32_bf16 v[224:227], v[32:35], v[104:107], v[224:227]
    ds_read_b64_tr_b16 v[64:65], v12 offset:32768
    ds_read_b128 v[128:131], v18 offset:0
    v_mfma_f32_16x16x32_bf16 v[232:235], v[36:39], v[104:107], v[232:235]
    ds_read_b64_tr_b16 v[66:67], v12 offset:36864
    ds_read_b128 v[132:135], v18 offset:1024
    s_add_u32 m0, s97, 98304
    s_nop 0
    buffer_load_dwordx4 v24, s[92:95], s96 offen lds
    v_mfma_f32_16x16x32_bf16 v[240:243], v[40:43], v[104:107], v[240:243]
    ds_read_b64_tr_b16 v[68:69], v13 offset:32768
    ds_read_b128 v[136:139], v21 offset:0
    v_mfma_f32_16x16x32_bf16 v[248:251], v[44:47], v[104:107], v[248:251]
    ds_read_b64_tr_b16 v[70:71], v13 offset:36864
    ds_read_b128 v[140:143], v21 offset:1024
    ds_read_b128 v[144:147], v21 offset:2048
    buffer_load_dwordx4 v25, s[92:95], s96 offen offset:1024 lds
    s_waitcnt vmcnt(28)
    v_mfma_f32_16x16x32_bf16 v[228:231], v[32:35], v[108:111], v[228:231]
    ds_read_b64_tr_b16 v[72:73], v14 offset:32768
    ds_read_b128 v[148:151], v21 offset:3072
    v_mfma_f32_16x16x32_bf16 v[236:239], v[36:39], v[108:111], v[236:239]
    ds_read_b64_tr_b16 v[74:75], v14 offset:36864
    ds_read_b128 v[152:155], v21 offset:12288
    buffer_load_dwordx4 v26, s[92:95], s96 offen offset:2048 lds
    v_mfma_f32_16x16x32_bf16 v[244:247], v[40:43], v[108:111], v[244:247]
    ds_read_b64_tr_b16 v[76:77], v15 offset:32768
    ds_read_b128 v[156:159], v21 offset:13312
    v_mfma_f32_16x16x32_bf16 v[252:255], v[44:47], v[108:111], v[252:255]
    ds_read_b64_tr_b16 v[78:79], v15 offset:36864
    ds_read_b128 v[160:163], v21 offset:14336
    ds_read_b128 v[164:167], v21 offset:15360
    buffer_load_dwordx4 v27, s[92:95], s96 offen offset:3072 lds
    s_add_u32 s96, s96, 262144
    s_waitcnt lgkmcnt(15)
    v_mfma_f32_16x16x32_bf16 v[192:195], v[48:51], v[104:107], v[192:195]
    ds_read_b64_tr_b16 v[32:33], v8 offset:32768
    v_mfma_f32_16x16x32_bf16 v[200:203], v[52:55], v[104:107], v[200:203]
    ds_read_b64_tr_b16 v[34:35], v8 offset:36864
    v_mfma_f32_16x16x32_bf16 v[208:211], v[56:59], v[104:107], v[208:211]
    ds_read_b64_tr_b16 v[36:37], v9 offset:32768
    v_mfma_f32_16x16x32_bf16 v[216:219], v[60:63], v[104:107], v[216:219]
    ds_read_b64_tr_b16 v[38:39], v9 offset:36864
    buffer_load_dwordx4 v[104:107], v7, s[8:11], s31 offen offset:0 sc1
    v_mfma_f32_16x16x32_bf16 v[196:199], v[48:51], v[108:111], v[196:199]
    ds_read_b64_tr_b16 v[40:41], v10 offset:32768
    v_mfma_f32_16x16x32_bf16 v[204:207], v[52:55], v[108:111], v[204:207]
    ds_read_b64_tr_b16 v[42:43], v10 offset:36864
    v_mfma_f32_16x16x32_bf16 v[212:215], v[56:59], v[108:111], v[212:215]
    ds_read_b64_tr_b16 v[44:45], v11 offset:32768
    v_mfma_f32_16x16x32_bf16 v[220:223], v[60:63], v[108:111], v[220:223]
    ds_read_b64_tr_b16 v[46:47], v11 offset:36864
    buffer_load_dwordx4 v[108:111], v7, s[8:11], s31 offen offset:1024 sc1
    s_add_u32 s31, s31, 32768
    s_waitcnt lgkmcnt(8)
    v_mfma_f32_16x16x32_bf16 v[184:187], v[128:131], v[144:147], 0
    v_mfma_f32_16x16x32_bf16 v[188:191], v[128:131], v[148:151], 0
    v_mfma_f32_16x16x32_bf16 v[168:171], v[128:131], v[136:139], 0
    v_mfma_f32_16x16x32_bf16 v[172:175], v[128:131], v[140:143], 0
    v_mfma_f32_16x16x32_bf16 v[176:179], v[132:135], v[136:139], 0
    v_mfma_f32_16x16x32_bf16 v[180:183], v[132:135], v[140:143], 0
    s_waitcnt vmcnt(31)
    v_mfma_f32_16x16x32_bf16 v[224:227], v[64:67], v[112:115], v[224:227]
    ds_read_b64_tr_b16 v[48:49], v12 offset:40960
    v_mfma_f32_16x16x32_bf16 v[232:235], v[68:71], v[112:115], v[232:235]
    ds_read_b64_tr_b16 v[50:51], v12 offset:45056
    v_mfma_f32_16x16x32_bf16 v[240:243], v[72:75], v[112:115], v[240:243]
    ds_read_b64_tr_b16 v[52:53], v13 offset:40960
    v_mfma_f32_16x16x32_bf16 v[248:251], v[76:79], v[112:115], v[248:251]
    ds_read_b64_tr_b16 v[54:55], v13 offset:45056
    s_waitcnt vmcnt(30)
    v_mfma_f32_16x16x32_bf16 v[228:231], v[64:67], v[116:119], v[228:231]
    ds_read_b64_tr_b16 v[56:57], v14 offset:40960
    v_mfma_f32_16x16x32_bf16 v[236:239], v[68:71], v[116:119], v[236:239]
    ds_read_b64_tr_b16 v[58:59], v14 offset:45056
    v_mfma_f32_16x16x32_bf16 v[244:247], v[72:75], v[116:119], v[244:247]
    ds_read_b64_tr_b16 v[60:61], v15 offset:40960
    v_mfma_f32_16x16x32_bf16 v[252:255], v[76:79], v[116:119], v[252:255]
    ds_read_b64_tr_b16 v[62:63], v15 offset:45056
    s_waitcnt lgkmcnt(8)
    v_mfma_f32_16x16x32_bf16 v[192:195], v[32:35], v[112:115], v[192:195]
    ds_read_b64_tr_b16 v[64:65], v8 offset:40960
    s_mov_b64 s[40:41], 0xffff
    v_mfma_f32_16x16x32_bf16 v[200:203], v[36:39], v[112:115], v[200:203]
    ds_read_b64_tr_b16 v[66:67], v8 offset:45056
    v_cndmask_b32 v168, v168, v184, s[40:41]
    v_cndmask_b32 v172, v172, v188, s[40:41]
    v_mfma_f32_16x16x32_bf16 v[208:211], v[40:43], v[112:115], v[208:211]
    ds_read_b64_tr_b16 v[68:69], v9 offset:40960
    v_mul_f32 v128, v172, v156
    v_mul_f32 v132, v168, v156
    v_mfma_f32_16x16x32_bf16 v[216:219], v[44:47], v[112:115], v[216:219]
    ds_read_b64_tr_b16 v[70:71], v9 offset:45056
    v_mul_f32 v129, v173, v157
    v_mul_f32 v133, v169, v157
    buffer_load_dwordx4 v[112:115], v6, s[8:11], s31 offen offset:0 sc1
    v_mfma_f32_16x16x32_bf16 v[196:199], v[32:35], v[116:119], v[196:199]
    ds_read_b64_tr_b16 v[72:73], v10 offset:40960
    v_mul_f32 v130, v174, v158
    v_mul_f32 v134, v170, v158
    v_mfma_f32_16x16x32_bf16 v[204:207], v[36:39], v[116:119], v[204:207]
    ds_read_b64_tr_b16 v[74:75], v10 offset:45056
    v_mul_f32 v131, v175, v159
    v_mul_f32 v135, v171, v159
    v_mfma_f32_16x16x32_bf16 v[212:215], v[40:43], v[116:119], v[212:215]
    ds_read_b64_tr_b16 v[76:77], v11 offset:40960
    v_fma_f32 v168, v168, v152, -v128
    v_fma_f32 v172, v172, v152, v132
    v_mfma_f32_16x16x32_bf16 v[220:223], v[44:47], v[116:119], v[220:223]
    ds_read_b64_tr_b16 v[78:79], v11 offset:45056
    v_fma_f32 v169, v169, v153, -v129
    v_fma_f32 v173, v173, v153, v133
    buffer_load_dwordx4 v[116:119], v6, s[8:11], s31 offen offset:1024 sc1
    s_waitcnt lgkmcnt(8) vmcnt(12)
    s_barrier
    v_xor_b32 v8, 0x10000, v8
    v_xor_b32 v9, 0x10000, v9
    v_xor_b32 v10, 0x10000, v10
    v_xor_b32 v11, 0x10000, v11
    v_xor_b32 v12, 0x10000, v12
    v_xor_b32 v13, 0x10000, v13
    v_xor_b32 v14, 0x10000, v14
    v_xor_b32 v15, 0x10000, v15
    s_waitcnt vmcnt(19)
    v_mfma_f32_16x16x32_bf16 v[224:227], v[48:51], v[120:123], v[224:227]
    ds_read_b64_tr_b16 v[32:33], v12 offset:0
    v_fma_f32 v170, v170, v154, -v130
    v_mfma_f32_16x16x32_bf16 v[232:235], v[52:55], v[120:123], v[232:235]
    ds_read_b64_tr_b16 v[34:35], v12 offset:4096
    v_fma_f32 v174, v174, v154, v134
    v_fma_f32 v171, v171, v155, -v131
    s_add_u32 m0, s97, 0
    s_nop 0
    buffer_load_dwordx4 v24, s[92:95], s96 offen lds
    v_mfma_f32_16x16x32_bf16 v[240:243], v[56:59], v[120:123], v[240:243]
    ds_read_b64_tr_b16 v[36:37], v13 offset:0
    v_fma_f32 v175, v175, v155, v135
    v_cvt_pk_bf16_f32 v184, v168, v172
    v_mfma_f32_16x16x32_bf16 v[248:251], v[60:63], v[120:123], v[248:251]
    ds_read_b64_tr_b16 v[38:39], v13 offset:4096
    v_cvt_pk_bf16_f32 v185, v169, v173
    v_cvt_pk_bf16_f32 v186, v170, v174
    buffer_load_dwordx4 v25, s[92:95], s96 offen offset:1024 lds
    s_waitcnt vmcnt(20)
    v_mfma_f32_16x16x32_bf16 v[228:231], v[48:51], v[124:127], v[228:231]
    ds_read_b64_tr_b16 v[40:41], v14 offset:0
    v_cvt_pk_bf16_f32 v187, v171, v175
    v_mul_f32 v128, v180, v164
    v_mfma_f32_16x16x32_bf16 v[236:239], v[52:55], v[124:127], v[236:239]
    ds_read_b64_tr_b16 v[42:43], v14 offset:4096
    v_mul_f32 v132, v176, v164
    v_mul_f32 v129, v181, v165
    buffer_load_dwordx4 v26, s[92:95], s96 offen offset:2048 lds
    v_mfma_f32_16x16x32_bf16 v[244:247], v[56:59], v[124:127], v[244:247]
    ds_read_b64_tr_b16 v[44:45], v15 offset:0
    v_mul_f32 v133, v177, v165
    v_mul_f32 v130, v182, v166
    v_mfma_f32_16x16x32_bf16 v[252:255], v[60:63], v[124:127], v[252:255]
    ds_read_b64_tr_b16 v[46:47], v15 offset:4096
    v_mul_f32 v134, v178, v166
    v_mul_f32 v131, v183, v167
    buffer_load_dwordx4 v27, s[92:95], s96 offen offset:3072 lds
    s_add_u32 s96, s96, 262144
    s_waitcnt lgkmcnt(8)
    v_mfma_f32_16x16x32_bf16 v[192:195], v[64:67], v[120:123], v[192:195]
    ds_read_b64_tr_b16 v[48:49], v8 offset:0
    v_mul_f32 v135, v179, v167
    v_mfma_f32_16x16x32_bf16 v[200:203], v[68:71], v[120:123], v[200:203]
    ds_read_b64_tr_b16 v[50:51], v8 offset:4096
    v_fma_f32 v176, v176, v160, -v128
    v_fma_f32 v180, v180, v160, v132
    v_mfma_f32_16x16x32_bf16 v[208:211], v[72:75], v[120:123], v[208:211]
    ds_read_b64_tr_b16 v[52:53], v9 offset:0
    v_fma_f32 v177, v177, v161, -v129
    v_mfma_f32_16x16x32_bf16 v[216:219], v[76:79], v[120:123], v[216:219]
    ds_read_b64_tr_b16 v[54:55], v9 offset:4096
    v_fma_f32 v181, v181, v161, v133
    v_fma_f32 v178, v178, v162, -v130
    buffer_load_dwordx4 v[120:123], v7, s[8:11], s31 offen offset:0 sc1
    v_mfma_f32_16x16x32_bf16 v[196:199], v[64:67], v[124:127], v[196:199]
    ds_read_b64_tr_b16 v[56:57], v10 offset:0
    v_fma_f32 v182, v182, v162, v134
    v_fma_f32 v179, v179, v163, -v131
    v_mfma_f32_16x16x32_bf16 v[204:207], v[68:71], v[124:127], v[204:207]
    ds_read_b64_tr_b16 v[58:59], v10 offset:4096
    v_fma_f32 v183, v183, v163, v135
    v_mfma_f32_16x16x32_bf16 v[212:215], v[72:75], v[124:127], v[212:215]
    ds_read_b64_tr_b16 v[60:61], v11 offset:0
    v_cvt_pk_bf16_f32 v188, v176, v180
    v_cvt_pk_bf16_f32 v189, v177, v181
    v_mfma_f32_16x16x32_bf16 v[220:223], v[76:79], v[124:127], v[220:223]
    ds_read_b64_tr_b16 v[62:63], v11 offset:4096
    v_cvt_pk_bf16_f32 v190, v178, v182
    v_cvt_pk_bf16_f32 v191, v179, v183
    buffer_load_dwordx4 v[124:127], v7, s[8:11], s31 offen offset:1024 sc1
    s_add_u32 s31, s31, 32768
    s_waitcnt lgkmcnt(8)
    s_waitcnt vmcnt(23)
    v_mfma_f32_16x16x32_bf16 v[224:227], v[32:35], v[80:83], v[224:227]
    ds_read_b64_tr_b16 v[64:65], v12 offset:8192
    ds_read_b128 v[128:131], v21 offset:4096
    v_mfma_f32_16x16x32_bf16 v[232:235], v[36:39], v[80:83], v[232:235]
    ds_read_b64_tr_b16 v[66:67], v12 offset:12288
    ds_read_b128 v[132:135], v21 offset:5120
    v_mfma_f32_16x16x32_bf16 v[240:243], v[40:43], v[80:83], v[240:243]
    ds_read_b64_tr_b16 v[68:69], v13 offset:8192
    ds_read_b128 v[136:139], v21 offset:6144
    v_mfma_f32_16x16x32_bf16 v[248:251], v[44:47], v[80:83], v[248:251]
    ds_read_b64_tr_b16 v[70:71], v13 offset:12288
    ds_read_b128 v[140:143], v21 offset:7168
    s_waitcnt vmcnt(22)
    v_mfma_f32_16x16x32_bf16 v[228:231], v[32:35], v[84:87], v[228:231]
    ds_read_b64_tr_b16 v[72:73], v14 offset:8192
    ds_read_b128 v[144:147], v21 offset:8192
    v_mfma_f32_16x16x32_bf16 v[236:239], v[36:39], v[84:87], v[236:239]
    ds_read_b64_tr_b16 v[74:75], v14 offset:12288
    ds_read_b128 v[148:151], v21 offset:9216
    v_mfma_f32_16x16x32_bf16 v[244:247], v[40:43], v[84:87], v[244:247]
    ds_read_b64_tr_b16 v[76:77], v15 offset:8192
    ds_read_b128 v[152:155], v21 offset:10240
    v_mfma_f32_16x16x32_bf16 v[252:255], v[44:47], v[84:87], v[252:255]
    ds_read_b64_tr_b16 v[78:79], v15 offset:12288
    ds_read_b128 v[156:159], v21 offset:11264
    s_waitcnt lgkmcnt(15)
    v_mfma_f32_16x16x32_bf16 v[192:195], v[48:51], v[80:83], v[192:195]
    ds_read_b64_tr_b16 v[32:33], v8 offset:8192
    v_mfma_f32_16x16x32_bf16 v[200:203], v[52:55], v[80:83], v[200:203]
    ds_read_b64_tr_b16 v[34:35], v8 offset:12288
    v_mfma_f32_16x16x32_bf16 v[208:211], v[56:59], v[80:83], v[208:211]
    ds_read_b64_tr_b16 v[36:37], v9 offset:8192
    v_mfma_f32_16x16x32_bf16 v[216:219], v[60:63], v[80:83], v[216:219]
    ds_read_b64_tr_b16 v[38:39], v9 offset:12288
    buffer_load_dwordx4 v[80:83], v6, s[8:11], s31 offen offset:0 sc1
    v_mfma_f32_16x16x32_bf16 v[196:199], v[48:51], v[84:87], v[196:199]
    ds_read_b64_tr_b16 v[40:41], v10 offset:8192
    v_mfma_f32_16x16x32_bf16 v[204:207], v[52:55], v[84:87], v[204:207]
    ds_read_b64_tr_b16 v[42:43], v10 offset:12288
    v_mfma_f32_16x16x32_bf16 v[212:215], v[56:59], v[84:87], v[212:215]
    ds_read_b64_tr_b16 v[44:45], v11 offset:8192
    v_mfma_f32_16x16x32_bf16 v[220:223], v[60:63], v[84:87], v[220:223]
    ds_read_b64_tr_b16 v[46:47], v11 offset:12288
    buffer_load_dwordx4 v[84:87], v6, s[8:11], s31 offen offset:1024 sc1
    s_waitcnt lgkmcnt(8) vmcnt(12)
    s_barrier
    v_mfma_f32_16x16x32_bf16 v[160:163], v[184:187], v[128:131], 0
    v_mfma_f32_16x16x32_bf16 v[164:167], v[184:187], v[136:139], 0
    v_mfma_f32_16x16x32_bf16 v[168:171], v[184:187], v[144:147], 0
    v_mfma_f32_16x16x32_bf16 v[172:175], v[184:187], v[152:155], 0
    v_mfma_f32_16x16x32_bf16 v[160:163], v[188:191], v[132:135], v[160:163]
    v_mfma_f32_16x16x32_bf16 v[164:167], v[188:191], v[140:143], v[164:167]
    v_mfma_f32_16x16x32_bf16 v[168:171], v[188:191], v[148:151], v[168:171]
    v_mfma_f32_16x16x32_bf16 v[172:175], v[188:191], v[156:159], v[172:175]
    s_waitcnt vmcnt(19)
    v_mfma_f32_16x16x32_bf16 v[224:227], v[64:67], v[88:91], v[224:227]
    ds_read_b64_tr_b16 v[48:49], v12 offset:32768
    v_mfma_f32_16x16x32_bf16 v[232:235], v[68:71], v[88:91], v[232:235]
    ds_read_b64_tr_b16 v[50:51], v12 offset:36864
    s_add_u32 m0, s97, 32768
    s_nop 0
    buffer_load_dwordx4 v24, s[92:95], s96 offen lds
    v_mfma_f32_16x16x32_bf16 v[240:243], v[72:75], v[88:91], v[240:243]
    ds_read_b64_tr_b16 v[52:53], v13 offset:32768
    v_mfma_f32_16x16x32_bf16 v[248:251], v[76:79], v[88:91], v[248:251]
    ds_read_b64_tr_b16 v[54:55], v13 offset:36864
    buffer_load_dwordx4 v25, s[92:95], s96 offen offset:1024 lds
    s_waitcnt vmcnt(20)
    v_mfma_f32_16x16x32_bf16 v[228:231], v[64:67], v[92:95], v[228:231]
    ds_read_b64_tr_b16 v[56:57], v14 offset:32768
    v_mfma_f32_16x16x32_bf16 v[236:239], v[68:71], v[92:95], v[236:239]
    ds_read_b64_tr_b16 v[58:59], v14 offset:36864
    buffer_load_dwordx4 v26, s[92:95], s96 offen offset:2048 lds
    v_mfma_f32_16x16x32_bf16 v[244:247], v[72:75], v[92:95], v[244:247]
    ds_read_b64_tr_b16 v[60:61], v15 offset:32768
    v_mfma_f32_16x16x32_bf16 v[252:255], v[76:79], v[92:95], v[252:255]
    ds_read_b64_tr_b16 v[62:63], v15 offset:36864
    buffer_load_dwordx4 v27, s[92:95], s96 offen offset:3072 lds
    s_add_u32 s96, s96, 262144
    s_waitcnt lgkmcnt(8)
    v_mfma_f32_16x16x32_bf16 v[192:195], v[32:35], v[88:91], v[192:195]
    ds_read_b64_tr_b16 v[64:65], v8 offset:32768
    v_cvt_pk_bf16_f32 v176, v160, v161
    v_mfma_f32_16x16x32_bf16 v[200:203], v[36:39], v[88:91], v[200:203]
    ds_read_b64_tr_b16 v[66:67], v8 offset:36864
    v_cvt_pk_bf16_f32 v177, v162, v163
    ds_write_b64 v19, v[176:177] offset:0
    v_mfma_f32_16x16x32_bf16 v[208:211], v[40:43], v[88:91], v[208:211]
    ds_read_b64_tr_b16 v[68:69], v9 offset:32768
    v_cvt_pk_bf16_f32 v178, v164, v165
    v_mfma_f32_16x16x32_bf16 v[216:219], v[44:47], v[88:91], v[216:219]
    ds_read_b64_tr_b16 v[70:71], v9 offset:36864
    v_cvt_pk_bf16_f32 v179, v166, v167
    ds_write_b64 v19, v[178:179] offset:512
    buffer_load_dwordx4 v[88:91], v7, s[8:11], s31 offen offset:0 sc1
    v_mfma_f32_16x16x32_bf16 v[196:199], v[32:35], v[92:95], v[196:199]
    ds_read_b64_tr_b16 v[72:73], v10 offset:32768
    v_cvt_pk_bf16_f32 v180, v168, v169
    v_mfma_f32_16x16x32_bf16 v[204:207], v[36:39], v[92:95], v[204:207]
    ds_read_b64_tr_b16 v[74:75], v10 offset:36864
    v_cvt_pk_bf16_f32 v181, v170, v171
    ds_write_b64 v19, v[180:181] offset:1024
    v_mfma_f32_16x16x32_bf16 v[212:215], v[40:43], v[92:95], v[212:215]
    ds_read_b64_tr_b16 v[76:77], v11 offset:32768
    v_cvt_pk_bf16_f32 v182, v172, v173
    v_mfma_f32_16x16x32_bf16 v[220:223], v[44:47], v[92:95], v[220:223]
    ds_read_b64_tr_b16 v[78:79], v11 offset:36864
    v_cvt_pk_bf16_f32 v183, v174, v175
    ds_write_b64 v19, v[182:183] offset:1536
    buffer_load_dwordx4 v[92:95], v7, s[8:11], s31 offen offset:1024 sc1
    s_add_u32 s31, s31, 32768
    s_waitcnt lgkmcnt(12)
    s_waitcnt vmcnt(23)
    v_mfma_f32_16x16x32_bf16 v[224:227], v[48:51], v[96:99], v[224:227]
    ds_read_b64_tr_b16 v[32:33], v12 offset:40960
    v_mfma_f32_16x16x32_bf16 v[232:235], v[52:55], v[96:99], v[232:235]
    ds_read_b64_tr_b16 v[34:35], v12 offset:45056
    v_mfma_f32_16x16x32_bf16 v[240:243], v[56:59], v[96:99], v[240:243]
    ds_read_b64_tr_b16 v[36:37], v13 offset:40960
    v_mfma_f32_16x16x32_bf16 v[248:251], v[60:63], v[96:99], v[248:251]
    ds_read_b64_tr_b16 v[38:39], v13 offset:45056
    ds_read_b128 v[128:131], v18
    s_waitcnt vmcnt(22)
    v_mfma_f32_16x16x32_bf16 v[228:231], v[48:51], v[100:103], v[228:231]
    ds_read_b64_tr_b16 v[40:41], v14 offset:40960
    v_mfma_f32_16x16x32_bf16 v[236:239], v[52:55], v[100:103], v[236:239]
    ds_read_b64_tr_b16 v[42:43], v14 offset:45056
    v_mfma_f32_16x16x32_bf16 v[244:247], v[56:59], v[100:103], v[244:247]
    ds_read_b64_tr_b16 v[44:45], v15 offset:40960
    v_mfma_f32_16x16x32_bf16 v[252:255], v[60:63], v[100:103], v[252:255]
    ds_read_b64_tr_b16 v[46:47], v15 offset:45056
    ds_read_b128 v[132:135], v18 offset:1024
    s_waitcnt lgkmcnt(11)
    v_mfma_f32_16x16x32_bf16 v[192:195], v[64:67], v[96:99], v[192:195]
    ds_read_b64_tr_b16 v[48:49], v8 offset:40960
    v_mfma_f32_16x16x32_bf16 v[200:203], v[68:71], v[96:99], v[200:203]
    ds_read_b64_tr_b16 v[50:51], v8 offset:45056
    v_mfma_f32_16x16x32_bf16 v[208:211], v[72:75], v[96:99], v[208:211]
    ds_read_b64_tr_b16 v[52:53], v9 offset:40960
    v_mfma_f32_16x16x32_bf16 v[216:219], v[76:79], v[96:99], v[216:219]
    ds_read_b64_tr_b16 v[54:55], v9 offset:45056
    buffer_load_dwordx4 v[96:99], v6, s[8:11], s31 offen offset:0 sc1
    v_mfma_f32_16x16x32_bf16 v[196:199], v[64:67], v[100:103], v[196:199]
    ds_read_b64_tr_b16 v[56:57], v10 offset:40960
    v_mfma_f32_16x16x32_bf16 v[204:207], v[68:71], v[100:103], v[204:207]
    ds_read_b64_tr_b16 v[58:59], v10 offset:45056
    v_mfma_f32_16x16x32_bf16 v[212:215], v[72:75], v[100:103], v[212:215]
    ds_read_b64_tr_b16 v[60:61], v11 offset:40960
    v_mfma_f32_16x16x32_bf16 v[220:223], v[76:79], v[100:103], v[220:223]
    ds_read_b64_tr_b16 v[62:63], v11 offset:45056
    buffer_load_dwordx4 v[100:103], v6, s[8:11], s31 offen offset:1024 sc1
    s_waitcnt lgkmcnt(8) vmcnt(12)
    s_barrier
    v_xor_b32 v8, 0x10000, v8
    v_xor_b32 v9, 0x10000, v9
    v_xor_b32 v10, 0x10000, v10
    v_xor_b32 v11, 0x10000, v11
    v_xor_b32 v12, 0x10000, v12
    v_xor_b32 v13, 0x10000, v13
    v_xor_b32 v14, 0x10000, v14
    v_xor_b32 v15, 0x10000, v15
    s_waitcnt vmcnt(19)
    v_mfma_f32_16x16x32_bf16 v[224:227], v[32:35], v[104:107], v[224:227]
    ds_read_b64_tr_b16 v[64:65], v12 offset:0
    v_mfma_f32_16x16x32_bf16 v[232:235], v[36:39], v[104:107], v[232:235]
    ds_read_b64_tr_b16 v[66:67], v12 offset:4096
    s_add_u32 m0, s97, 65536
    s_nop 0
    buffer_load_dwordx4 v24, s[92:95], s96 offen lds
    v_mfma_f32_16x16x32_bf16 v[240:243], v[40:43], v[104:107], v[240:243]
    ds_read_b64_tr_b16 v[68:69], v13 offset:0
    v_mfma_f32_16x16x32_bf16 v[248:251], v[44:47], v[104:107], v[248:251]
    ds_read_b64_tr_b16 v[70:71], v13 offset:4096
    buffer_store_dwordx4 v[128:131], v20, s[16:19], s45 offen sc1
    buffer_load_dwordx4 v25, s[92:95], s96 offen offset:1024 lds
    s_waitcnt vmcnt(21)
    v_mfma_f32_16x16x32_bf16 v[228:231], v[32:35], v[108:111], v[228:231]
    ds_read_b64_tr_b16 v[72:73], v14 offset:0
    v_mfma_f32_16x16x32_bf16 v[236:239], v[36:39], v[108:111], v[236:239]
    ds_read_b64_tr_b16 v[74:75], v14 offset:4096
    buffer_load_dwordx4 v26, s[92:95], s96 offen offset:2048 lds
    v_mfma_f32_16x16x32_bf16 v[244:247], v[40:43], v[108:111], v[244:247]
    ds_read_b64_tr_b16 v[76:77], v15 offset:0
    v_mfma_f32_16x16x32_bf16 v[252:255], v[44:47], v[108:111], v[252:255]
    ds_read_b64_tr_b16 v[78:79], v15 offset:4096
    buffer_store_dwordx4 v[132:135], v20, s[16:19], s45 offen offset:1024 sc1
    buffer_load_dwordx4 v27, s[92:95], s96 offen offset:3072 lds
    s_add_u32 s96, s96, 262144
    s_waitcnt lgkmcnt(8)
    v_mfma_f32_16x16x32_bf16 v[192:195], v[48:51], v[104:107], v[192:195]
    ds_read_b64_tr_b16 v[32:33], v8 offset:0
    v_mfma_f32_16x16x32_bf16 v[200:203], v[52:55], v[104:107], v[200:203]
    ds_read_b64_tr_b16 v[34:35], v8 offset:4096
    v_mfma_f32_16x16x32_bf16 v[208:211], v[56:59], v[104:107], v[208:211]
    ds_read_b64_tr_b16 v[36:37], v9 offset:0
    v_mfma_f32_16x16x32_bf16 v[216:219], v[60:63], v[104:107], v[216:219]
    ds_read_b64_tr_b16 v[38:39], v9 offset:4096
    buffer_load_dwordx4 v[104:107], v7, s[8:11], s31 offen offset:0 sc1
    v_mfma_f32_16x16x32_bf16 v[196:199], v[48:51], v[108:111], v[196:199]
    ds_read_b64_tr_b16 v[40:41], v10 offset:0
    v_mfma_f32_16x16x32_bf16 v[204:207], v[52:55], v[108:111], v[204:207]
    ds_read_b64_tr_b16 v[42:43], v10 offset:4096
    v_mfma_f32_16x16x32_bf16 v[212:215], v[56:59], v[108:111], v[212:215]
    ds_read_b64_tr_b16 v[44:45], v11 offset:0
    v_mfma_f32_16x16x32_bf16 v[220:223], v[60:63], v[108:111], v[220:223]
    ds_read_b64_tr_b16 v[46:47], v11 offset:4096
    buffer_load_dwordx4 v[108:111], v7, s[8:11], s31 offen offset:1024 sc1
    s_add_u32 s31, s31, 32768
    s_waitcnt lgkmcnt(8)
    s_waitcnt vmcnt(25)
    v_mfma_f32_16x16x32_bf16 v[224:227], v[64:67], v[112:115], v[224:227]
    ds_read_b64_tr_b16 v[48:49], v12 offset:8192
    v_mfma_f32_16x16x32_bf16 v[232:235], v[68:71], v[112:115], v[232:235]
    ds_read_b64_tr_b16 v[50:51], v12 offset:12288
    v_mfma_f32_16x16x32_bf16 v[240:243], v[72:75], v[112:115], v[240:243]
    ds_read_b64_tr_b16 v[52:53], v13 offset:8192
    v_mfma_f32_16x16x32_bf16 v[248:251], v[76:79], v[112:115], v[248:251]
    ds_read_b64_tr_b16 v[54:55], v13 offset:12288
    s_waitcnt vmcnt(24)
    v_mfma_f32_16x16x32_bf16 v[228:231], v[64:67], v[116:119], v[228:231]
    ds_read_b64_tr_b16 v[56:57], v14 offset:8192
    v_mfma_f32_16x16x32_bf16 v[236:239], v[68:71], v[116:119], v[236:239]
    ds_read_b64_tr_b16 v[58:59], v14 offset:12288
    v_mfma_f32_16x16x32_bf16 v[244:247], v[72:75], v[116:119], v[244:247]
    ds_read_b64_tr_b16 v[60:61], v15 offset:8192
    v_mfma_f32_16x16x32_bf16 v[252:255], v[76:79], v[116:119], v[252:255]
    ds_read_b64_tr_b16 v[62:63], v15 offset:12288
    s_waitcnt lgkmcnt(8)
    v_mfma_f32_16x16x32_bf16 v[192:195], v[32:35], v[112:115], v[192:195]
    ds_read_b64_tr_b16 v[64:65], v8 offset:8192
    v_mfma_f32_16x16x32_bf16 v[200:203], v[36:39], v[112:115], v[200:203]
    ds_read_b64_tr_b16 v[66:67], v8 offset:12288
    v_mfma_f32_16x16x32_bf16 v[208:211], v[40:43], v[112:115], v[208:211]
    ds_read_b64_tr_b16 v[68:69], v9 offset:8192
    v_mfma_f32_16x16x32_bf16 v[216:219], v[44:47], v[112:115], v[216:219]
    ds_read_b64_tr_b16 v[70:71], v9 offset:12288
    buffer_load_dwordx4 v[112:115], v6, s[8:11], s31 offen offset:0 sc1
    v_mfma_f32_16x16x32_bf16 v[196:199], v[32:35], v[116:119], v[196:199]
    ds_read_b64_tr_b16 v[72:73], v10 offset:8192
    v_mfma_f32_16x16x32_bf16 v[204:207], v[36:39], v[116:119], v[204:207]
    ds_read_b64_tr_b16 v[74:75], v10 offset:12288
    v_mfma_f32_16x16x32_bf16 v[212:215], v[40:43], v[116:119], v[212:215]
    ds_read_b64_tr_b16 v[76:77], v11 offset:8192
    v_mfma_f32_16x16x32_bf16 v[220:223], v[44:47], v[116:119], v[220:223]
    ds_read_b64_tr_b16 v[78:79], v11 offset:12288
    buffer_load_dwordx4 v[116:119], v6, s[8:11], s31 offen offset:1024 sc1
    s_waitcnt lgkmcnt(8) vmcnt(14)
    s_barrier
    s_waitcnt vmcnt(21)
    v_mfma_f32_16x16x32_bf16 v[224:227], v[48:51], v[120:123], v[224:227]
    ds_read_b64_tr_b16 v[32:33], v12 offset:32768
    v_mfma_f32_16x16x32_bf16 v[232:235], v[52:55], v[120:123], v[232:235]
    ds_read_b64_tr_b16 v[34:35], v12 offset:36864
    s_add_u32 m0, s97, 98304
    s_nop 0
    buffer_load_dwordx4 v24, s[92:95], s96 offen lds
    v_mfma_f32_16x16x32_bf16 v[240:243], v[56:59], v[120:123], v[240:243]
    ds_read_b64_tr_b16 v[36:37], v13 offset:32768
    v_mfma_f32_16x16x32_bf16 v[248:251], v[60:63], v[120:123], v[248:251]
    ds_read_b64_tr_b16 v[38:39], v13 offset:36864
    buffer_load_dwordx4 v25, s[92:95], s96 offen offset:1024 lds
    s_waitcnt vmcnt(22)
    v_mfma_f32_16x16x32_bf16 v[228:231], v[48:51], v[124:127], v[228:231]
    ds_read_b64_tr_b16 v[40:41], v14 offset:32768
    v_mfma_f32_16x16x32_bf16 v[236:239], v[52:55], v[124:127], v[236:239]
    ds_read_b64_tr_b16 v[42:43], v14 offset:36864
    buffer_load_dwordx4 v26, s[92:95], s96 offen offset:2048 lds
    v_mfma_f32_16x16x32_bf16 v[244:247], v[56:59], v[124:127], v[244:247]
    ds_read_b64_tr_b16 v[44:45], v15 offset:32768
    v_mfma_f32_16x16x32_bf16 v[252:255], v[60:63], v[124:127], v[252:255]
    ds_read_b64_tr_b16 v[46:47], v15 offset:36864
    buffer_load_dwordx4 v27, s[92:95], s96 offen offset:3072 lds
    s_add_u32 s96, s96, 262144
    s_waitcnt lgkmcnt(8)
    v_mfma_f32_16x16x32_bf16 v[192:195], v[64:67], v[120:123], v[192:195]
    ds_read_b64_tr_b16 v[48:49], v8 offset:32768
    v_mfma_f32_16x16x32_bf16 v[200:203], v[68:71], v[120:123], v[200:203]
    ds_read_b64_tr_b16 v[50:51], v8 offset:36864
    v_mfma_f32_16x16x32_bf16 v[208:211], v[72:75], v[120:123], v[208:211]
    ds_read_b64_tr_b16 v[52:53], v9 offset:32768
    v_mfma_f32_16x16x32_bf16 v[216:219], v[76:79], v[120:123], v[216:219]
    ds_read_b64_tr_b16 v[54:55], v9 offset:36864
    buffer_load_dwordx4 v[120:123], v7, s[8:11], s31 offen offset:0 sc1
    v_mfma_f32_16x16x32_bf16 v[196:199], v[64:67], v[124:127], v[196:199]
    ds_read_b64_tr_b16 v[56:57], v10 offset:32768
    v_mfma_f32_16x16x32_bf16 v[204:207], v[68:71], v[124:127], v[204:207]
    ds_read_b64_tr_b16 v[58:59], v10 offset:36864
    v_mfma_f32_16x16x32_bf16 v[212:215], v[72:75], v[124:127], v[212:215]
    ds_read_b64_tr_b16 v[60:61], v11 offset:32768
    v_mfma_f32_16x16x32_bf16 v[220:223], v[76:79], v[124:127], v[220:223]
    ds_read_b64_tr_b16 v[62:63], v11 offset:36864
    buffer_load_dwordx4 v[124:127], v7, s[8:11], s31 offen offset:1024 sc1
    s_add_u32 s31, s31, 32768
    s_waitcnt lgkmcnt(8)
    s_waitcnt vmcnt(25)
    v_mfma_f32_16x16x32_bf16 v[224:227], v[32:35], v[80:83], v[224:227]
    ds_read_b64_tr_b16 v[64:65], v12 offset:40960
    v_mfma_f32_16x16x32_bf16 v[232:235], v[36:39], v[80:83], v[232:235]
    ds_read_b64_tr_b16 v[66:67], v12 offset:45056
    v_mfma_f32_16x16x32_bf16 v[240:243], v[40:43], v[80:83], v[240:243]
    ds_read_b64_tr_b16 v[68:69], v13 offset:40960
    v_mfma_f32_16x16x32_bf16 v[248:251], v[44:47], v[80:83], v[248:251]
    ds_read_b64_tr_b16 v[70:71], v13 offset:45056
    s_waitcnt vmcnt(24)
    v_mfma_f32_16x16x32_bf16 v[228:231], v[32:35], v[84:87], v[228:231]
    ds_read_b64_tr_b16 v[72:73], v14 offset:40960
    v_mfma_f32_16x16x32_bf16 v[236:239], v[36:39], v[84:87], v[236:239]
    ds_read_b64_tr_b16 v[74:75], v14 offset:45056
    v_mfma_f32_16x16x32_bf16 v[244:247], v[40:43], v[84:87], v[244:247]
    ds_read_b64_tr_b16 v[76:77], v15 offset:40960
    v_mfma_f32_16x16x32_bf16 v[252:255], v[44:47], v[84:87], v[252:255]
    ds_read_b64_tr_b16 v[78:79], v15 offset:45056
    s_waitcnt lgkmcnt(8)
    v_mfma_f32_16x16x32_bf16 v[192:195], v[48:51], v[80:83], v[192:195]
    ds_read_b64_tr_b16 v[32:33], v8 offset:40960
    v_mfma_f32_16x16x32_bf16 v[200:203], v[52:55], v[80:83], v[200:203]
    ds_read_b64_tr_b16 v[34:35], v8 offset:45056
    v_mfma_f32_16x16x32_bf16 v[208:211], v[56:59], v[80:83], v[208:211]
    ds_read_b64_tr_b16 v[36:37], v9 offset:40960
    v_mfma_f32_16x16x32_bf16 v[216:219], v[60:63], v[80:83], v[216:219]
    ds_read_b64_tr_b16 v[38:39], v9 offset:45056
    buffer_load_dwordx4 v[80:83], v6, s[8:11], s31 offen offset:0 sc1
    v_mfma_f32_16x16x32_bf16 v[196:199], v[48:51], v[84:87], v[196:199]
    ds_read_b64_tr_b16 v[40:41], v10 offset:40960
    v_mfma_f32_16x16x32_bf16 v[204:207], v[52:55], v[84:87], v[204:207]
    ds_read_b64_tr_b16 v[42:43], v10 offset:45056
    v_mfma_f32_16x16x32_bf16 v[212:215], v[56:59], v[84:87], v[212:215]
    ds_read_b64_tr_b16 v[44:45], v11 offset:40960
    v_mfma_f32_16x16x32_bf16 v[220:223], v[60:63], v[84:87], v[220:223]
    ds_read_b64_tr_b16 v[46:47], v11 offset:45056
    buffer_load_dwordx4 v[84:87], v6, s[8:11], s31 offen offset:1024 sc1
    s_waitcnt lgkmcnt(8) vmcnt(12)
    s_barrier
    v_xor_b32 v8, 0x10000, v8
    v_xor_b32 v9, 0x10000, v9
    v_xor_b32 v10, 0x10000, v10
    v_xor_b32 v11, 0x10000, v11
    v_xor_b32 v12, 0x10000, v12
    v_xor_b32 v13, 0x10000, v13
    v_xor_b32 v14, 0x10000, v14
    v_xor_b32 v15, 0x10000, v15
    s_cmp_lg_u32 s30, 7
    s_cbranch_scc1 L_fl_ss
    s_lshr_b32 s3, s2, 5
    s_lshl_b32 s3, s3, 9
    s_and_b32 s4, s2, 31
    s_lshl_b32 s4, s4, 2
    s_add_u32 s3, s3, s4
    s_add_u32 s3, s3, 16384
    v_mov_b32 v2, s98
    v_lshlrev_b32 v3, 7, v1
    s_mov_b64 exec, 0xf
    buffer_store_dword v2, v3, s[32:35], s3 offen sc1
    s_mov_b64 exec, -1
L_fl_ss:
    s_waitcnt vmcnt(21)
    v_mfma_f32_16x16x32_bf16 v[224:227], v[64:67], v[88:91], v[224:227]
    ds_read_b64_tr_b16 v[48:49], v12 offset:0
    v_mfma_f32_16x16x32_bf16 v[232:235], v[68:71], v[88:91], v[232:235]
    ds_read_b64_tr_b16 v[50:51], v12 offset:4096
    s_add_u32 m0, s97, 0
    s_nop 0
    buffer_load_dwordx4 v24, s[92:95], s96 offen lds
    v_mfma_f32_16x16x32_bf16 v[240:243], v[72:75], v[88:91], v[240:243]
    ds_read_b64_tr_b16 v[52:53], v13 offset:0
    v_mfma_f32_16x16x32_bf16 v[248:251], v[76:79], v[88:91], v[248:251]
    ds_read_b64_tr_b16 v[54:55], v13 offset:4096
    buffer_load_dwordx4 v25, s[92:95], s96 offen offset:1024 lds
    s_waitcnt vmcnt(22)
    v_mfma_f32_16x16x32_bf16 v[228:231], v[64:67], v[92:95], v[228:231]
    ds_read_b64_tr_b16 v[56:57], v14 offset:0
    v_mfma_f32_16x16x32_bf16 v[236:239], v[68:71], v[92:95], v[236:239]
    ds_read_b64_tr_b16 v[58:59], v14 offset:4096
    buffer_load_dwordx4 v26, s[92:95], s96 offen offset:2048 lds
    v_mfma_f32_16x16x32_bf16 v[244:247], v[72:75], v[92:95], v[244:247]
    ds_read_b64_tr_b16 v[60:61], v15 offset:0
    v_mfma_f32_16x16x32_bf16 v[252:255], v[76:79], v[92:95], v[252:255]
    ds_read_b64_tr_b16 v[62:63], v15 offset:4096
    buffer_load_dwordx4 v27, s[92:95], s96 offen offset:3072 lds
    s_add_u32 s96, s96, 262144
    s_waitcnt lgkmcnt(8)
    v_mfma_f32_16x16x32_bf16 v[192:195], v[32:35], v[88:91], v[192:195]
    ds_read_b64_tr_b16 v[64:65], v8 offset:0
    v_mfma_f32_16x16x32_bf16 v[200:203], v[36:39], v[88:91], v[200:203]
    ds_read_b64_tr_b16 v[66:67], v8 offset:4096
    v_mfma_f32_16x16x32_bf16 v[208:211], v[40:43], v[88:91], v[208:211]
    ds_read_b64_tr_b16 v[68:69], v9 offset:0
    v_mfma_f32_16x16x32_bf16 v[216:219], v[44:47], v[88:91], v[216:219]
    ds_read_b64_tr_b16 v[70:71], v9 offset:4096
    buffer_load_dwordx4 v[88:91], v7, s[8:11], s31 offen offset:0 sc1
    v_mfma_f32_16x16x32_bf16 v[196:199], v[32:35], v[92:95], v[196:199]
    ds_read_b64_tr_b16 v[72:73], v10 offset:0
    v_mfma_f32_16x16x32_bf16 v[204:207], v[36:39], v[92:95], v[204:207]
    ds_read_b64_tr_b16 v[74:75], v10 offset:4096
    v_mfma_f32_16x16x32_bf16 v[212:215], v[40:43], v[92:95], v[212:215]
    ds_read_b64_tr_b16 v[76:77], v11 offset:0
    v_mfma_f32_16x16x32_bf16 v[220:223], v[44:47], v[92:95], v[220:223]
    ds_read_b64_tr_b16 v[78:79], v11 offset:4096
    buffer_load_dwordx4 v[92:95], v7, s[8:11], s31 offen offset:1024 sc1
    s_add_u32 s31, s31, 32768
    s_waitcnt lgkmcnt(8)
    s_waitcnt vmcnt(25)
    v_mfma_f32_16x16x32_bf16 v[224:227], v[48:51], v[96:99], v[224:227]
    ds_read_b64_tr_b16 v[32:33], v12 offset:8192
    v_mfma_f32_16x16x32_bf16 v[232:235], v[52:55], v[96:99], v[232:235]
    ds_read_b64_tr_b16 v[34:35], v12 offset:12288
    v_mfma_f32_16x16x32_bf16 v[240:243], v[56:59], v[96:99], v[240:243]
    ds_read_b64_tr_b16 v[36:37], v13 offset:8192
    v_mfma_f32_16x16x32_bf16 v[248:251], v[60:63], v[96:99], v[248:251]
    ds_read_b64_tr_b16 v[38:39], v13 offset:12288
    s_waitcnt vmcnt(24)
    v_mfma_f32_16x16x32_bf16 v[228:231], v[48:51], v[100:103], v[228:231]
    ds_read_b64_tr_b16 v[40:41], v14 offset:8192
    v_mfma_f32_16x16x32_bf16 v[236:239], v[52:55], v[100:103], v[236:239]
    ds_read_b64_tr_b16 v[42:43], v14 offset:12288
    v_mfma_f32_16x16x32_bf16 v[244:247], v[56:59], v[100:103], v[244:247]
    ds_read_b64_tr_b16 v[44:45], v15 offset:8192
    v_mfma_f32_16x16x32_bf16 v[252:255], v[60:63], v[100:103], v[252:255]
    ds_read_b64_tr_b16 v[46:47], v15 offset:12288
    s_waitcnt lgkmcnt(8)
    v_mfma_f32_16x16x32_bf16 v[192:195], v[64:67], v[96:99], v[192:195]
    ds_read_b64_tr_b16 v[48:49], v8 offset:8192
    v_mfma_f32_16x16x32_bf16 v[200:203], v[68:71], v[96:99], v[200:203]
    ds_read_b64_tr_b16 v[50:51], v8 offset:12288
    v_mfma_f32_16x16x32_bf16 v[208:211], v[72:75], v[96:99], v[208:211]
    ds_read_b64_tr_b16 v[52:53], v9 offset:8192
    v_mfma_f32_16x16x32_bf16 v[216:219], v[76:79], v[96:99], v[216:219]
    ds_read_b64_tr_b16 v[54:55], v9 offset:12288
    buffer_load_dwordx4 v[96:99], v6, s[8:11], s31 offen offset:0 sc1
    v_mfma_f32_16x16x32_bf16 v[196:199], v[64:67], v[100:103], v[196:199]
    ds_read_b64_tr_b16 v[56:57], v10 offset:8192
    v_mfma_f32_16x16x32_bf16 v[204:207], v[68:71], v[100:103], v[204:207]
    ds_read_b64_tr_b16 v[58:59], v10 offset:12288
    v_mfma_f32_16x16x32_bf16 v[212:215], v[72:75], v[100:103], v[212:215]
    ds_read_b64_tr_b16 v[60:61], v11 offset:8192
    v_mfma_f32_16x16x32_bf16 v[220:223], v[76:79], v[100:103], v[220:223]
    ds_read_b64_tr_b16 v[62:63], v11 offset:12288
    buffer_load_dwordx4 v[100:103], v6, s[8:11], s31 offen offset:1024 sc1
    s_waitcnt lgkmcnt(8) vmcnt(12)
    s_barrier
    s_waitcnt vmcnt(19)
    v_mfma_f32_16x16x32_bf16 v[224:227], v[32:35], v[104:107], v[224:227]
    ds_read_b64_tr_b16 v[64:65], v12 offset:32768
    v_mfma_f32_16x16x32_bf16 v[232:235], v[36:39], v[104:107], v[232:235]
    ds_read_b64_tr_b16 v[66:67], v12 offset:36864
    s_add_u32 m0, s97, 32768
    s_nop 0
    buffer_load_dwordx4 v24, s[92:95], s96 offen lds
    v_mfma_f32_16x16x32_bf16 v[240:243], v[40:43], v[104:107], v[240:243]
    ds_read_b64_tr_b16 v[68:69], v13 offset:32768
    v_mfma_f32_16x16x32_bf16 v[248:251], v[44:47], v[104:107], v[248:251]
    ds_read_b64_tr_b16 v[70:71], v13 offset:36864
    buffer_load_dwordx4 v25, s[92:95], s96 offen offset:1024 lds
    s_waitcnt vmcnt(20)
    v_mfma_f32_16x16x32_bf16 v[228:231], v[32:35], v[108:111], v[228:231]
    ds_read_b64_tr_b16 v[72:73], v14 offset:32768
    v_mfma_f32_16x16x32_bf16 v[236:239], v[36:39], v[108:111], v[236:239]
    ds_read_b64_tr_b16 v[74:75], v14 offset:36864
    buffer_load_dwordx4 v26, s[92:95], s96 offen offset:2048 lds
    v_mfma_f32_16x16x32_bf16 v[244:247], v[40:43], v[108:111], v[244:247]
    ds_read_b64_tr_b16 v[76:77], v15 offset:32768
    v_mfma_f32_16x16x32_bf16 v[252:255], v[44:47], v[108:111], v[252:255]
    ds_read_b64_tr_b16 v[78:79], v15 offset:36864
    buffer_load_dwordx4 v27, s[92:95], s96 offen offset:3072 lds
    s_add_u32 s96, s96, 262144
    s_waitcnt lgkmcnt(8)
    v_mfma_f32_16x16x32_bf16 v[192:195], v[48:51], v[104:107], v[192:195]
    ds_read_b64_tr_b16 v[32:33], v8 offset:32768
    v_mfma_f32_16x16x32_bf16 v[200:203], v[52:55], v[104:107], v[200:203]
    ds_read_b64_tr_b16 v[34:35], v8 offset:36864
    v_mfma_f32_16x16x32_bf16 v[208:211], v[56:59], v[104:107], v[208:211]
    ds_read_b64_tr_b16 v[36:37], v9 offset:32768
    v_mfma_f32_16x16x32_bf16 v[216:219], v[60:63], v[104:107], v[216:219]
    ds_read_b64_tr_b16 v[38:39], v9 offset:36864
    buffer_load_dwordx4 v[104:107], v7, s[8:11], s31 offen offset:0 sc1
    v_mfma_f32_16x16x32_bf16 v[196:199], v[48:51], v[108:111], v[196:199]
    ds_read_b64_tr_b16 v[40:41], v10 offset:32768
    v_mfma_f32_16x16x32_bf16 v[204:207], v[52:55], v[108:111], v[204:207]
    ds_read_b64_tr_b16 v[42:43], v10 offset:36864
    v_mfma_f32_16x16x32_bf16 v[212:215], v[56:59], v[108:111], v[212:215]
    ds_read_b64_tr_b16 v[44:45], v11 offset:32768
    v_mfma_f32_16x16x32_bf16 v[220:223], v[60:63], v[108:111], v[220:223]
    ds_read_b64_tr_b16 v[46:47], v11 offset:36864
    buffer_load_dwordx4 v[108:111], v7, s[8:11], s31 offen offset:1024 sc1
    s_add_u32 s31, s31, 32768
    s_waitcnt lgkmcnt(8)
    s_waitcnt vmcnt(23)
    v_mfma_f32_16x16x32_bf16 v[224:227], v[64:67], v[112:115], v[224:227]
    ds_read_b64_tr_b16 v[48:49], v12 offset:40960
    v_mfma_f32_16x16x32_bf16 v[232:235], v[68:71], v[112:115], v[232:235]
    ds_read_b64_tr_b16 v[50:51], v12 offset:45056
    v_mfma_f32_16x16x32_bf16 v[240:243], v[72:75], v[112:115], v[240:243]
    ds_read_b64_tr_b16 v[52:53], v13 offset:40960
    v_mfma_f32_16x16x32_bf16 v[248:251], v[76:79], v[112:115], v[248:251]
    ds_read_b64_tr_b16 v[54:55], v13 offset:45056
    s_waitcnt vmcnt(22)
    v_mfma_f32_16x16x32_bf16 v[228:231], v[64:67], v[116:119], v[228:231]
    ds_read_b64_tr_b16 v[56:57], v14 offset:40960
    v_mfma_f32_16x16x32_bf16 v[236:239], v[68:71], v[116:119], v[236:239]
    ds_read_b64_tr_b16 v[58:59], v14 offset:45056
    v_mfma_f32_16x16x32_bf16 v[244:247], v[72:75], v[116:119], v[244:247]
    ds_read_b64_tr_b16 v[60:61], v15 offset:40960
    v_mfma_f32_16x16x32_bf16 v[252:255], v[76:79], v[116:119], v[252:255]
    ds_read_b64_tr_b16 v[62:63], v15 offset:45056
    s_waitcnt lgkmcnt(8)
    v_mfma_f32_16x16x32_bf16 v[192:195], v[32:35], v[112:115], v[192:195]
    ds_read_b64_tr_b16 v[64:65], v8 offset:40960
    v_mfma_f32_16x16x32_bf16 v[200:203], v[36:39], v[112:115], v[200:203]
    ds_read_b64_tr_b16 v[66:67], v8 offset:45056
    v_mfma_f32_16x16x32_bf16 v[208:211], v[40:43], v[112:115], v[208:211]
    ds_read_b64_tr_b16 v[68:69], v9 offset:40960
    v_mfma_f32_16x16x32_bf16 v[216:219], v[44:47], v[112:115], v[216:219]
    ds_read_b64_tr_b16 v[70:71], v9 offset:45056
    v_mfma_f32_16x16x32_bf16 v[196:199], v[32:35], v[116:119], v[196:199]
    ds_read_b64_tr_b16 v[72:73], v10 offset:40960
    v_mfma_f32_16x16x32_bf16 v[204:207], v[36:39], v[116:119], v[204:207]
    ds_read_b64_tr_b16 v[74:75], v10 offset:45056
    v_mfma_f32_16x16x32_bf16 v[212:215], v[40:43], v[116:119], v[212:215]
    ds_read_b64_tr_b16 v[76:77], v11 offset:40960
    v_mfma_f32_16x16x32_bf16 v[220:223], v[44:47], v[116:119], v[220:223]
    ds_read_b64_tr_b16 v[78:79], v11 offset:45056
    s_add_u32 s84, s54, 0x2800000
    s_addc_u32 s85, s55, 0
    s_mov_b32 s86, 0x1000000
    s_mov_b32 s87, 0x20000
    v_lshrrev_b32 v2, 3, v1
    v_lshlrev_b32 v2, 11, v2
    v_and_b32 v3, 7, v1
    v_lshl_add_u32 v2, v3, 4, v2
    s_lshl_b32 s5, s28, 18
    s_lshr_b32 s6, s2, 5
    s_lshl_b32 s6, s6, 8
    s_add_u32 s5, s5, s6
    s_and_b32 s6, s2, 1
    s_lshl_b32 s6, s6, 7
    s_add_u32 s5, s5, s6
    s_lshl_b32 s6, s30, 15
    s_add_u32 s5, s5, s6
    v_add_u32 v16, s5, v2
    s_mov_b32 s5, 16384
    buffer_load_dwordx4 v[128:131], v16, s[12:15], 0 offen
    buffer_load_dwordx4 v[132:135], v16, s[12:15], s5 offen
    s_lshl_b32 s48, s2, 15
    s_lshl_b32 s6, s30, 12
    s_add_u32 s48, s48, s6
    s_xor_b32 s50, s48, 0x8000
    s_add_u32 s32, s54, 0x2300000
    s_addc_u32 s33, s55, 0
    s_mov_b32 s34, 0x28000
    s_mov_b32 s35, 0x20000
    s_lshl_b32 s88, s2, 7
    s_lshl_b32 s6, s30, 4
    s_add_u32 s88, s88, s6
    s_add_u32 s88, s88, 98304
    s_xor_b32 s89, s88, 128
    v_and_b32 v22, 15, v1
    v_mul_u32_u24 v22, 272, v22
    v_lshl_add_u32 v22, v5, 4, v22
    s_mul_i32 s6, s30, 8704
    s_add_u32 s6, s6, 65536
    v_add_u32 v22, s6, v22
    v_lshrrev_b32 v23, 3, v1
    v_mul_u32_u24 v23, 272, v23
    v_and_b32 v2, 7, v1
    v_lshl_add_u32 v23, v2, 5, v23
    s_mul_i32 s6, s30, 4352
    s_add_u32 s6, s6, 65536
    v_add_u32 v23, s6, v23
    s_waitcnt lgkmcnt(8) vmcnt(12)
    s_barrier
    v_xor_b32 v8, 0x10000, v8
    v_xor_b32 v9, 0x10000, v9
    v_xor_b32 v10, 0x10000, v10
    v_xor_b32 v11, 0x10000, v11
    v_xor_b32 v12, 0x10000, v12
    v_xor_b32 v13, 0x10000, v13
    v_xor_b32 v14, 0x10000, v14
    v_xor_b32 v15, 0x10000, v15
    s_waitcnt vmcnt(19)
    v_mfma_f32_16x16x32_bf16 v[224:227], v[48:51], v[120:123], v[224:227]
    ds_read_b64_tr_b16 v[32:33], v12 offset:0
    v_mfma_f32_16x16x32_bf16 v[232:235], v[52:55], v[120:123], v[232:235]
    ds_read_b64_tr_b16 v[34:35], v12 offset:4096
    v_mfma_f32_16x16x32_bf16 v[240:243], v[56:59], v[120:123], v[240:243]
    ds_read_b64_tr_b16 v[36:37], v13 offset:0
    v_mfma_f32_16x16x32_bf16 v[248:251], v[60:63], v[120:123], v[248:251]
    ds_read_b64_tr_b16 v[38:39], v13 offset:4096
    s_waitcnt vmcnt(18)
    v_mfma_f32_16x16x32_bf16 v[228:231], v[48:51], v[124:127], v[228:231]
    ds_read_b64_tr_b16 v[40:41], v14 offset:0
    v_mfma_f32_16x16x32_bf16 v[236:239], v[52:55], v[124:127], v[236:239]
    ds_read_b64_tr_b16 v[42:43], v14 offset:4096
    v_mfma_f32_16x16x32_bf16 v[244:247], v[56:59], v[124:127], v[244:247]
    ds_read_b64_tr_b16 v[44:45], v15 offset:0
    v_mfma_f32_16x16x32_bf16 v[252:255], v[60:63], v[124:127], v[252:255]
    ds_read_b64_tr_b16 v[46:47], v15 offset:4096
    s_waitcnt lgkmcnt(8)
    v_mfma_f32_16x16x32_bf16 v[192:195], v[64:67], v[120:123], v[192:195]
    ds_read_b64_tr_b16 v[48:49], v12 offset:8192
    v_mfma_f32_16x16x32_bf16 v[200:203], v[68:71], v[120:123], v[200:203]
    ds_read_b64_tr_b16 v[50:51], v12 offset:12288
    v_mfma_f32_16x16x32_bf16 v[208:211], v[72:75], v[120:123], v[208:211]
    ds_read_b64_tr_b16 v[52:53], v13 offset:8192
    v_mfma_f32_16x16x32_bf16 v[216:219], v[76:79], v[120:123], v[216:219]
    ds_read_b64_tr_b16 v[54:55], v13 offset:12288
    v_mfma_f32_16x16x32_bf16 v[196:199], v[64:67], v[124:127], v[196:199]
    ds_read_b64_tr_b16 v[56:57], v14 offset:8192
    v_mfma_f32_16x16x32_bf16 v[204:207], v[68:71], v[124:127], v[204:207]
    ds_read_b64_tr_b16 v[58:59], v14 offset:12288
    v_mfma_f32_16x16x32_bf16 v[212:215], v[72:75], v[124:127], v[212:215]
    ds_read_b64_tr_b16 v[60:61], v15 offset:8192
    v_mfma_f32_16x16x32_bf16 v[220:223], v[76:79], v[124:127], v[220:223]
    ds_read_b64_tr_b16 v[62:63], v15 offset:12288
    s_waitcnt lgkmcnt(8) vmcnt(4)
    s_barrier
    s_waitcnt vmcnt(17)
    v_mfma_f32_16x16x32_bf16 v[224:227], v[32:35], v[80:83], v[224:227]
    ds_read_b64_tr_b16 v[64:65], v12 offset:32768
    v_mfma_f32_16x16x32_bf16 v[232:235], v[36:39], v[80:83], v[232:235]
    ds_read_b64_tr_b16 v[66:67], v12 offset:36864
    v_mfma_f32_16x16x32_bf16 v[240:243], v[40:43], v[80:83], v[240:243]
    ds_read_b64_tr_b16 v[68:69], v13 offset:32768
    v_mfma_f32_16x16x32_bf16 v[248:251], v[44:47], v[80:83], v[248:251]
    ds_read_b64_tr_b16 v[70:71], v13 offset:36864
    s_waitcnt vmcnt(16)
    v_mfma_f32_16x16x32_bf16 v[228:231], v[32:35], v[84:87], v[228:231]
    ds_read_b64_tr_b16 v[72:73], v14 offset:32768
    v_mfma_f32_16x16x32_bf16 v[236:239], v[36:39], v[84:87], v[236:239]
    ds_read_b64_tr_b16 v[74:75], v14 offset:36864
    v_mfma_f32_16x16x32_bf16 v[244:247], v[40:43], v[84:87], v[244:247]
    ds_read_b64_tr_b16 v[76:77], v15 offset:32768
    v_mfma_f32_16x16x32_bf16 v[252:255], v[44:47], v[84:87], v[252:255]
    ds_read_b64_tr_b16 v[78:79], v15 offset:36864
    s_waitcnt lgkmcnt(8)
    s_waitcnt vmcnt(11)
    v_mfma_f32_16x16x32_bf16 v[224:227], v[48:51], v[88:91], v[224:227]
    ds_read_b64_tr_b16 v[32:33], v12 offset:40960
    v_mfma_f32_16x16x32_bf16 v[232:235], v[52:55], v[88:91], v[232:235]
    ds_read_b64_tr_b16 v[34:35], v12 offset:45056
    v_mfma_f32_16x16x32_bf16 v[240:243], v[56:59], v[88:91], v[240:243]
    ds_read_b64_tr_b16 v[36:37], v13 offset:40960
    v_mfma_f32_16x16x32_bf16 v[248:251], v[60:63], v[88:91], v[248:251]
    ds_read_b64_tr_b16 v[38:39], v13 offset:45056
    s_waitcnt vmcnt(10)
    v_mfma_f32_16x16x32_bf16 v[228:231], v[48:51], v[92:95], v[228:231]
    ds_read_b64_tr_b16 v[40:41], v14 offset:40960
    v_mfma_f32_16x16x32_bf16 v[236:239], v[52:55], v[92:95], v[236:239]
    ds_read_b64_tr_b16 v[42:43], v14 offset:45056
    v_mfma_f32_16x16x32_bf16 v[244:247], v[56:59], v[92:95], v[244:247]
    ds_read_b64_tr_b16 v[44:45], v15 offset:40960
    v_mfma_f32_16x16x32_bf16 v[252:255], v[60:63], v[92:95], v[252:255]
    ds_read_b64_tr_b16 v[46:47], v15 offset:45056
    s_lshr_b32 s42, s28, 2
    s_lshl_b32 s42, s42, 1
    s_and_b32 s6, s28, 1
    s_add_u32 s42, s42, s6
    s_lshl_b32 s42, s42, 9
    s_and_b32 s6, s2, 1
    s_lshl_b32 s6, s6, 8
    s_add_u32 s42, s42, s6
    s_and_b32 s6, s2, 128
    s_add_u32 s42, s42, s6
    s_add_u32 s42, s42, 16384
    v_and_b32 v3, 31, v1
    v_lshlrev_b32 v3, 2, v3
    buffer_load_dword v2, v3, s[32:35], s42 offen sc1
    s_waitcnt lgkmcnt(8)
    s_waitcnt vmcnt(10)
    v_mfma_f32_16x16x32_bf16 v[224:227], v[64:67], v[96:99], v[224:227]
    ds_read_b64_tr_b16 v[48:49], v8 offset:0
    v_mfma_f32_16x16x32_bf16 v[232:235], v[68:71], v[96:99], v[232:235]
    ds_read_b64_tr_b16 v[50:51], v8 offset:4096
    v_mfma_f32_16x16x32_bf16 v[240:243], v[72:75], v[96:99], v[240:243]
    ds_read_b64_tr_b16 v[52:53], v9 offset:0
    v_mfma_f32_16x16x32_bf16 v[248:251], v[76:79], v[96:99], v[248:251]
    ds_read_b64_tr_b16 v[54:55], v9 offset:4096
    s_waitcnt vmcnt(9)
    v_mfma_f32_16x16x32_bf16 v[228:231], v[64:67], v[100:103], v[228:231]
    ds_read_b64_tr_b16 v[56:57], v10 offset:0
    v_mfma_f32_16x16x32_bf16 v[236:239], v[68:71], v[100:103], v[236:239]
    ds_read_b64_tr_b16 v[58:59], v10 offset:4096
    v_mfma_f32_16x16x32_bf16 v[244:247], v[72:75], v[100:103], v[244:247]
    ds_read_b64_tr_b16 v[60:61], v11 offset:0
    v_mfma_f32_16x16x32_bf16 v[252:255], v[76:79], v[100:103], v[252:255]
    ds_read_b64_tr_b16 v[62:63], v11 offset:4096
    s_waitcnt lgkmcnt(8)
    s_waitcnt vmcnt(4)
    v_mfma_f32_16x16x32_bf16 v[224:227], v[32:35], v[104:107], v[224:227]
    ds_read_b64_tr_b16 v[64:65], v8 offset:8192
    v_mfma_f32_16x16x32_bf16 v[232:235], v[36:39], v[104:107], v[232:235]
    ds_read_b64_tr_b16 v[66:67], v8 offset:12288
    v_mfma_f32_16x16x32_bf16 v[240:243], v[40:43], v[104:107], v[240:243]
    ds_read_b64_tr_b16 v[68:69], v9 offset:8192
    v_mfma_f32_16x16x32_bf16 v[248:251], v[44:47], v[104:107], v[248:251]
    ds_read_b64_tr_b16 v[70:71], v9 offset:12288
    s_waitcnt vmcnt(3)
    v_mfma_f32_16x16x32_bf16 v[228:231], v[32:35], v[108:111], v[228:231]
    ds_read_b64_tr_b16 v[72:73], v10 offset:8192
    v_mfma_f32_16x16x32_bf16 v[236:239], v[36:39], v[108:111], v[236:239]
    ds_read_b64_tr_b16 v[74:75], v10 offset:12288
    v_mfma_f32_16x16x32_bf16 v[244:247], v[40:43], v[108:111], v[244:247]
    ds_read_b64_tr_b16 v[76:77], v11 offset:8192
    v_mfma_f32_16x16x32_bf16 v[252:255], v[44:47], v[108:111], v[252:255]
    ds_read_b64_tr_b16 v[78:79], v11 offset:12288
    s_waitcnt lgkmcnt(8)
    v_mfma_f32_16x16x32_bf16 v[192:195], v[48:51], v[80:83], v[192:195]
    ds_read_b64_tr_b16 v[32:33], v8 offset:32768
    v_mfma_f32_16x16x32_bf16 v[200:203], v[52:55], v[80:83], v[200:203]
    ds_read_b64_tr_b16 v[34:35], v8 offset:36864
    v_mfma_f32_16x16x32_bf16 v[208:211], v[56:59], v[80:83], v[208:211]
    ds_read_b64_tr_b16 v[36:37], v9 offset:32768
    v_mfma_f32_16x16x32_bf16 v[216:219], v[60:63], v[80:83], v[216:219]
    ds_read_b64_tr_b16 v[38:39], v9 offset:36864
    v_mfma_f32_16x16x32_bf16 v[196:199], v[48:51], v[84:87], v[196:199]
    ds_read_b64_tr_b16 v[40:41], v10 offset:32768
    v_mfma_f32_16x16x32_bf16 v[204:207], v[52:55], v[84:87], v[204:207]
    ds_read_b64_tr_b16 v[42:43], v10 offset:36864
    v_mfma_f32_16x16x32_bf16 v[212:215], v[56:59], v[84:87], v[212:215]
    ds_read_b64_tr_b16 v[44:45], v11 offset:32768
    v_mfma_f32_16x16x32_bf16 v[220:223], v[60:63], v[84:87], v[220:223]
    ds_read_b64_tr_b16 v[46:47], v11 offset:36864
    ds_write_b128 v22, v[224:227] offset:0
    ds_write_b128 v22, v[228:231] offset:4352
    ds_write_b128 v22, v[232:235] offset:64
    ds_write_b128 v22, v[236:239] offset:4416
    ds_write_b128 v22, v[240:243] offset:128
    ds_write_b128 v22, v[244:247] offset:4480
    ds_write_b128 v22, v[248:251] offset:192
    ds_write_b128 v22, v[252:255] offset:4544
    s_waitcnt lgkmcnt(0)
    s_barrier
    ds_read_b128 v[144:147], v23 offset:0
    ds_read_b128 v[148:151], v23 offset:16
    ds_read_b128 v[152:155], v23 offset:34816
    ds_read_b128 v[156:159], v23 offset:34832
    ds_read_b128 v[160:163], v23 offset:2176
    ds_read_b128 v[164:167], v23 offset:2192
    ds_read_b128 v[168:171], v23 offset:36992
    ds_read_b128 v[172:175], v23 offset:37008
    v_mfma_f32_16x16x32_bf16 v[192:195], v[64:67], v[88:91], v[192:195]
    ds_read_b64_tr_b16 v[48:49], v8 offset:40960
    v_mfma_f32_16x16x32_bf16 v[200:203], v[68:71], v[88:91], v[200:203]
    ds_read_b64_tr_b16 v[50:51], v8 offset:45056
    v_mfma_f32_16x16x32_bf16 v[208:211], v[72:75], v[88:91], v[208:211]
    ds_read_b64_tr_b16 v[52:53], v9 offset:40960
    v_mfma_f32_16x16x32_bf16 v[216:219], v[76:79], v[88:91], v[216:219]
    ds_read_b64_tr_b16 v[54:55], v9 offset:45056
    v_mfma_f32_16x16x32_bf16 v[196:199], v[64:67], v[92:95], v[196:199]
    ds_read_b64_tr_b16 v[56:57], v10 offset:40960
    v_mfma_f32_16x16x32_bf16 v[204:207], v[68:71], v[92:95], v[204:207]
    ds_read_b64_tr_b16 v[58:59], v10 offset:45056
    v_mfma_f32_16x16x32_bf16 v[212:215], v[72:75], v[92:95], v[212:215]
    ds_read_b64_tr_b16 v[60:61], v11 offset:40960
    v_mfma_f32_16x16x32_bf16 v[220:223], v[76:79], v[92:95], v[220:223]
    ds_read_b64_tr_b16 v[62:63], v11 offset:45056
    s_waitcnt vmcnt(0)
    s_mov_b32 s7, 0
L_g2_s:
    v_cmp_ne_u32 vcc, s98, v2
    s_cmp_eq_u32 vcc_lo, 0
    s_cbranch_scc1 L_g2_s_done
    s_add_u32 s7, s7, 1
    s_cmp_ge_u32 s7, 0x40000
    s_cbranch_scc1 L_g2_s_done
    s_sleep 4
    buffer_load_dword v2, v3, s[32:35], s42 offen sc1
    s_waitcnt vmcnt(0)
    s_branch L_g2_s
L_g2_s_done:
    s_mov_b32 s5, 16384
    buffer_load_dwordx4 v[136:139], v16, s[16:19], 0 offen sc1
    buffer_load_dwordx4 v[140:143], v16, s[16:19], s5 offen sc1
    s_waitcnt lgkmcnt(0)
    v_add_f32 v144, v144, v152
    v_add_f32 v145, v145, v153
    v_add_f32 v146, v146, v154
    v_add_f32 v147, v147, v155
    v_add_f32 v148, v148, v156
    v_add_f32 v149, v149, v157
    v_add_f32 v150, v150, v158
    v_add_f32 v151, v151, v159
    v_cvt_pk_bf16_f32 v152, v144, v145
    v_cvt_pk_bf16_f32 v153, v146, v147
    v_cvt_pk_bf16_f32 v154, v148, v149
    v_cvt_pk_bf16_f32 v155, v150, v151
    buffer_store_dwordx4 v[152:155], v20, s[84:87], s50 offen offset:0 sc1
    v_add_f32 v160, v160, v168
    v_add_f32 v161, v161, v169
    v_add_f32 v162, v162, v170
    v_add_f32 v163, v163, v171
    v_add_f32 v164, v164, v172
    v_add_f32 v165, v165, v173
    v_add_f32 v166, v166, v174
    v_add_f32 v167, v167, v175
    v_cvt_pk_bf16_f32 v168, v160, v161
    v_cvt_pk_bf16_f32 v169, v162, v163
    v_cvt_pk_bf16_f32 v170, v164, v165
    v_cvt_pk_bf16_f32 v171, v166, v167
    buffer_store_dwordx4 v[168:171], v20, s[84:87], s50 offen offset:1024 sc1
    v_mfma_f32_16x16x32_bf16 v[192:195], v[32:35], v[96:99], v[192:195]
    v_mfma_f32_16x16x32_bf16 v[200:203], v[36:39], v[96:99], v[200:203]
    v_mfma_f32_16x16x32_bf16 v[208:211], v[40:43], v[96:99], v[208:211]
    v_mfma_f32_16x16x32_bf16 v[216:219], v[44:47], v[96:99], v[216:219]
    v_mfma_f32_16x16x32_bf16 v[196:199], v[32:35], v[100:103], v[196:199]
    v_mfma_f32_16x16x32_bf16 v[204:207], v[36:39], v[100:103], v[204:207]
    v_mfma_f32_16x16x32_bf16 v[212:215], v[40:43], v[100:103], v[212:215]
    v_mfma_f32_16x16x32_bf16 v[220:223], v[44:47], v[100:103], v[220:223]
    s_waitcnt lgkmcnt(0)
    v_mfma_f32_16x16x32_bf16 v[192:195], v[48:51], v[104:107], v[192:195]
    v_mfma_f32_16x16x32_bf16 v[200:203], v[52:55], v[104:107], v[200:203]
    v_mfma_f32_16x16x32_bf16 v[208:211], v[56:59], v[104:107], v[208:211]
    v_mfma_f32_16x16x32_bf16 v[216:219], v[60:63], v[104:107], v[216:219]
    v_mfma_f32_16x16x32_bf16 v[196:199], v[48:51], v[108:111], v[196:199]
    v_mfma_f32_16x16x32_bf16 v[204:207], v[52:55], v[108:111], v[204:207]
    v_mfma_f32_16x16x32_bf16 v[212:215], v[56:59], v[108:111], v[212:215]
    v_mfma_f32_16x16x32_bf16 v[220:223], v[60:63], v[108:111], v[220:223]
    s_barrier
    ds_write_b128 v22, v[192:195] offset:0
    s_nop 2
    ds_write_b128 v22, v[196:199] offset:4352
    ds_write_b128 v22, v[200:203] offset:64
    ds_write_b128 v22, v[204:207] offset:4416
    ds_write_b128 v22, v[208:211] offset:128
    ds_write_b128 v22, v[212:215] offset:4480
    ds_write_b128 v22, v[216:219] offset:192
    ds_write_b128 v22, v[220:223] offset:4544
    v_mov_b32 v2, s98
    s_waitcnt vmcnt(0)
    s_mov_b64 exec, 1
    buffer_store_dword v2, off, s[32:35], s89 sc1
    s_mov_b64 exec, -1
    s_mov_b32 s40, 0xbfb8aa3b
    s_mov_b32 s41, s40
    s_mov_b32 s42, 1.0
    s_mov_b32 s43, 1.0
    s_mov_b32 s44, 0xffff0000
    s_mov_b32 s5, 16384
    v_lshlrev_b32 v144, 16, v136
    v_and_b32 v145, s44, v136
    v_lshlrev_b32 v160, 16, v128
    v_and_b32 v161, s44, v128
    v_lshlrev_b32 v146, 16, v137
    v_and_b32 v147, s44, v137
    v_lshlrev_b32 v162, 16, v129
    v_and_b32 v163, s44, v129
    v_lshlrev_b32 v148, 16, v138
    v_and_b32 v149, s44, v138
    v_lshlrev_b32 v164, 16, v130
    v_and_b32 v165, s44, v130
    v_lshlrev_b32 v150, 16, v139
    v_and_b32 v151, s44, v139
    v_lshlrev_b32 v166, 16, v131
    v_and_b32 v167, s44, v131
    v_lshlrev_b32 v152, 16, v140
    v_and_b32 v153, s44, v140
    v_lshlrev_b32 v168, 16, v132
    v_and_b32 v169, s44, v132
    v_lshlrev_b32 v154, 16, v141
    v_and_b32 v155, s44, v141
    v_lshlrev_b32 v170, 16, v133
    v_and_b32 v171, s44, v133
    v_lshlrev_b32 v156, 16, v142
    v_and_b32 v157, s44, v142
    v_lshlrev_b32 v172, 16, v134
    v_and_b32 v173, s44, v134
    v_lshlrev_b32 v158, 16, v143
    v_and_b32 v159, s44, v143
    v_lshlrev_b32 v174, 16, v135
    v_and_b32 v175, s44, v135
    s_waitcnt lgkmcnt(0)
    s_barrier
    ds_read_b128 v[64:67], v23 offset:0
    ds_read_b128 v[68:71], v23 offset:16
    ds_read_b128 v[72:75], v23 offset:34816
    ds_read_b128 v[76:79], v23 offset:34832
    ds_read_b128 v[80:83], v23 offset:2176
    ds_read_b128 v[84:87], v23 offset:2192
    ds_read_b128 v[88:91], v23 offset:36992
    ds_read_b128 v[92:95], v23 offset:37008
    s_mov_b32 s7, 0
L_g2_x:
    buffer_load_dword v2, off, s[32:35], s88 sc1
    s_add_u32 s7, s7, 1
    s_waitcnt vmcnt(0)
    v_readfirstlane_b32 s6, v2
    s_cmp_eq_u32 s6, s98
    s_cbranch_scc1 L_g2_x_done
    s_cmp_ge_u32 s7, 0x40000
    s_cbranch_scc1 L_g2_x_done
    s_sleep 1
    s_branch L_g2_x
L_g2_x_done:
    buffer_load_dwordx4 v[112:115], v20, s[84:87], s48 offen offset:0 sc1
    buffer_load_dwordx4 v[116:119], v20, s[84:87], s48 offen offset:1024 sc1
    s_waitcnt lgkmcnt(0)
    v_pk_add_f32 v[64:65], v[64:65], v[72:73]
    v_pk_add_f32 v[66:67], v[66:67], v[74:75]
    v_pk_add_f32 v[68:69], v[68:69], v[76:77]
    v_pk_add_f32 v[70:71], v[70:71], v[78:79]
    v_pk_add_f32 v[80:81], v[80:81], v[88:89]
    v_pk_add_f32 v[82:83], v[82:83], v[90:91]
    v_pk_add_f32 v[84:85], v[84:85], v[92:93]
    v_pk_add_f32 v[86:87], v[86:87], v[94:95]
    s_waitcnt vmcnt(1)
    v_lshlrev_b32 v72, 16, v112
    v_and_b32 v73, s44, v112
    v_lshlrev_b32 v74, 16, v113
    v_and_b32 v75, s44, v113
    v_lshlrev_b32 v76, 16, v114
    v_and_b32 v77, s44, v114
    v_lshlrev_b32 v78, 16, v115
    v_and_b32 v79, s44, v115
    v_pk_add_f32 v[64:65], v[64:65], v[72:73]
    v_pk_add_f32 v[66:67], v[66:67], v[74:75]
    v_pk_add_f32 v[68:69], v[68:69], v[76:77]
    v_pk_add_f32 v[70:71], v[70:71], v[78:79]
    v_pk_mul_f32 v[72:73], v[64:65], s[40:41]
    v_pk_mul_f32 v[74:75], v[66:67], s[40:41]
    v_pk_mul_f32 v[76:77], v[68:69], s[40:41]
    v_pk_mul_f32 v[78:79], v[70:71], s[40:41]
    v_exp_f32 v72, v72
    v_exp_f32 v73, v73
    v_exp_f32 v74, v74
    v_exp_f32 v75, v75
    v_exp_f32 v76, v76
    v_exp_f32 v77, v77
    v_exp_f32 v78, v78
    v_exp_f32 v79, v79
    v_pk_mul_f32 v[64:65], v[64:65], v[144:145]
    v_pk_mul_f32 v[66:67], v[66:67], v[146:147]
    v_pk_mul_f32 v[68:69], v[68:69], v[148:149]
    v_pk_mul_f32 v[70:71], v[70:71], v[150:151]
    v_pk_add_f32 v[72:73], v[72:73], s[42:43]
    v_pk_add_f32 v[74:75], v[74:75], s[42:43]
    v_pk_add_f32 v[76:77], v[76:77], s[42:43]
    v_pk_add_f32 v[78:79], v[78:79], s[42:43]
    v_rcp_f32 v72, v72
    v_rcp_f32 v73, v73
    v_rcp_f32 v74, v74
    v_rcp_f32 v75, v75
    v_rcp_f32 v76, v76
    v_rcp_f32 v77, v77
    v_rcp_f32 v78, v78
    v_rcp_f32 v79, v79
    v_pk_fma_f32 v[64:65], v[64:65], v[72:73], v[160:161]
    v_pk_fma_f32 v[66:67], v[66:67], v[74:75], v[162:163]
    v_pk_fma_f32 v[68:69], v[68:69], v[76:77], v[164:165]
    v_pk_fma_f32 v[70:71], v[70:71], v[78:79], v[166:167]
    v_cvt_pk_bf16_f32 v72, v64, v65
    v_cvt_pk_bf16_f32 v73, v66, v67
    v_cvt_pk_bf16_f32 v74, v68, v69
    v_cvt_pk_bf16_f32 v75, v70, v71
    buffer_store_dwordx4 v[72:75], v16, s[20:23], 0 offen
    s_waitcnt vmcnt(1)
    v_lshlrev_b32 v88, 16, v116
    v_and_b32 v89, s44, v116
    v_lshlrev_b32 v90, 16, v117
    v_and_b32 v91, s44, v117
    v_lshlrev_b32 v92, 16, v118
    v_and_b32 v93, s44, v118
    v_lshlrev_b32 v94, 16, v119
    v_and_b32 v95, s44, v119
    v_pk_add_f32 v[80:81], v[80:81], v[88:89]
    v_pk_add_f32 v[82:83], v[82:83], v[90:91]
    v_pk_add_f32 v[84:85], v[84:85], v[92:93]
    v_pk_add_f32 v[86:87], v[86:87], v[94:95]
    v_pk_mul_f32 v[88:89], v[80:81], s[40:41]
    v_pk_mul_f32 v[90:91], v[82:83], s[40:41]
    v_pk_mul_f32 v[92:93], v[84:85], s[40:41]
    v_pk_mul_f32 v[94:95], v[86:87], s[40:41]
    v_exp_f32 v88, v88
    v_exp_f32 v89, v89
    v_exp_f32 v90, v90
    v_exp_f32 v91, v91
    v_exp_f32 v92, v92
    v_exp_f32 v93, v93
    v_exp_f32 v94, v94
    v_exp_f32 v95, v95
    v_pk_mul_f32 v[80:81], v[80:81], v[152:153]
    v_pk_mul_f32 v[82:83], v[82:83], v[154:155]
    v_pk_mul_f32 v[84:85], v[84:85], v[156:157]
    v_pk_mul_f32 v[86:87], v[86:87], v[158:159]
    v_pk_add_f32 v[88:89], v[88:89], s[42:43]
    v_pk_add_f32 v[90:91], v[90:91], s[42:43]
    v_pk_add_f32 v[92:93], v[92:93], s[42:43]
    v_pk_add_f32 v[94:95], v[94:95], s[42:43]
    v_rcp_f32 v88, v88
    v_rcp_f32 v89, v89
    v_rcp_f32 v90, v90
    v_rcp_f32 v91, v91
    v_rcp_f32 v92, v92
    v_rcp_f32 v93, v93
    v_rcp_f32 v94, v94
    v_rcp_f32 v95, v95
    v_pk_fma_f32 v[80:81], v[80:81], v[88:89], v[168:169]
    v_pk_fma_f32 v[82:83], v[82:83], v[90:91], v[170:171]
    v_pk_fma_f32 v[84:85], v[84:85], v[92:93], v[172:173]
    v_pk_fma_f32 v[86:87], v[86:87], v[94:95], v[174:175]
    v_cvt_pk_bf16_f32 v88, v80, v81
    v_cvt_pk_bf16_f32 v89, v82, v83
    v_cvt_pk_bf16_f32 v90, v84, v85
    v_cvt_pk_bf16_f32 v91, v86, v87
    buffer_store_dwordx4 v[88:91], v16, s[20:23], s5 offen
    s_mov_b32 s36, s54
    s_mov_b32 s37, s55
    s_endpgm
L_kb_spec:
    s_load_dwordx2 s[4:5], s[0:1], 0
    s_load_dwordx4 s[92:95], s[0:1], 8
    s_load_dwordx4 s[52:55], s[0:1], 64
    s_getpc_b64 s[6:7]
L_sp_pc:
    s_add_u32 s12, s6, spec_tables-L_sp_pc
    s_addc_u32 s13, s7, 0
    s_mov_b32 s14, 67584
    s_mov_b32 s15, 0x20000
    v_lshrrev_b32 v4, 6, v0
    v_and_b32 v1, 63, v0
    v_readfirstlane_b32 s44, v4
    v_lshrrev_b32 v2, 4, v1
    v_and_b32 v3, 15, v1
    v_lshlrev_b32 v8, 4, v1
    s_mov_b32 s24, s6
    s_mov_b32 s25, s7
    s_and_b32 s49, s44, 3
    s_lshr_b32 s48, s44, 2
    s_lshl_b32 s45, s49, 15
    s_and_b32 s46, s2, 15
    s_lshr_b32 s47, s2, 4
    s_lshl_b32 s47, s47, 3
    s_lshl_b32 s3, s49, 1
    s_add_u32 s47, s47, s3
    s_lshl_b32 s38, s47, 4
    s_add_u32 s38, s38, s46
    s_lshl_b32 s6, s48, 10
    s_add_u32 s84, s6, s45
    s_lshl_b32 s7, s38, 11
    s_add_u32 s85, s7, s6
    s_lshl_b32 s86, s48, 12
    s_lshl_b32 s87, s48, 11
    s_waitcnt lgkmcnt(0)
    s_mov_b32 s8, s4
    s_mov_b32 s9, s5
    s_mov_b32 s10, 0x400000
    s_mov_b32 s11, 0x20000
    s_mov_b32 s40, s52
    s_mov_b32 s41, s53
    s_mov_b32 s42, 0x100
    s_mov_b32 s43, 0x20000
    s_lshl_b32 s3, s2, 3
    s_or_b32 s3, s3, s44
    s_cmp_lg_u32 s3, 7
    s_cbranch_scc1 L_fl_np
    s_memrealtime s[98:99]
    s_waitcnt lgkmcnt(0)
    s_or_b32 s98, s98, 1
    v_mov_b32 v31, s98
    s_mov_b64 exec, 1
    buffer_store_dword v31, off, s[40:43], 0 offset:8 sc1
    s_mov_b64 exec, -1
    s_waitcnt vmcnt(0)
L_fl_np:
    s_add_u32 s3, s85, 0
    s_add_u32 m0, s84, 0
    s_nop 0
    buffer_load_dwordx4 v8, s[8:11], s3 offen lds
    s_add_u32 s3, s85, 524288
    s_add_u32 m0, s84, 2048
    s_nop 0
    buffer_load_dwordx4 v8, s[8:11], s3 offen lds
    s_add_u32 s3, s86, 0
    buffer_load_dwordx4 v[32:35], v8, s[12:15], s3 offen offset:0
    s_add_u32 s3, s86, 0
    buffer_load_dwordx4 v[36:39], v8, s[12:15], s3 offen offset:1024
    s_add_u32 s3, s86, 0
    buffer_load_dwordx4 v[40:43], v8, s[12:15], s3 offen offset:2048
    s_add_u32 s3, s86, 0
    buffer_load_dwordx4 v[44:47], v8, s[12:15], s3 offen offset:3072
    s_add_u32 s3, s87, 12288
    buffer_load_dwordx4 v[16:19], v8, s[12:15], s3 offen offset:0
    s_add_u32 s3, s87, 12288
    buffer_load_dwordx4 v[20:23], v8, s[12:15], s3 offen offset:1024
    s_mov_b32 s3, 8192
    buffer_load_dwordx4 v[48:51], v8, s[12:15], s3 offen offset:0
    s_mov_b32 s3, 8192
    buffer_load_dwordx4 v[52:55], v8, s[12:15], s3 offen offset:1024
    s_mov_b32 s3, 8192
    buffer_load_dwordx4 v[56:59], v8, s[12:15], s3 offen offset:2048
    s_mov_b32 s3, 8192
    buffer_load_dwordx4 v[60:63], v8, s[12:15], s3 offen offset:3072
    s_add_u32 s3, s85, 1048576
    s_add_u32 m0, s84, 4096
    s_nop 0
    buffer_load_dwordx4 v8, s[8:11], s3 offen lds
    s_add_u32 s3, s85, 1572864
    s_add_u32 m0, s84, 6144
    s_nop 0
    buffer_load_dwordx4 v8, s[8:11], s3 offen lds
    s_add_u32 s3, s85, 2097152
    s_add_u32 m0, s84, 8192
    s_nop 0
    buffer_load_dwordx4 v8, s[8:11], s3 offen lds
    s_add_u32 s3, s85, 2621440
    s_add_u32 m0, s84, 10240
    s_nop 0
    buffer_load_dwordx4 v8, s[8:11], s3 offen lds
    s_add_u32 s3, s85, 3145728
    s_add_u32 m0, s84, 12288
    s_nop 0
    buffer_load_dwordx4 v8, s[8:11], s3 offen lds
    s_add_u32 s3, s85, 3670016
    s_add_u32 m0, s84, 14336
    s_nop 0
    buffer_load_dwordx4 v8, s[8:11], s3 offen lds
    v_lshl_add_u32 v10, v1, 3, s45
    s_add_u32 s16, s54, 0x1400000
    s_addc_u32 s17, s55, 0
    s_mov_b32 s18, 0x400000
    s_mov_b32 s19, 0x20000
    s_add_u32 s20, s54, 0x1800000
    s_addc_u32 s21, s55, 0
    s_mov_b32 s22, 0x400000
    s_mov_b32 s23, 0x20000
    s_add_u32 s32, s54, 0x2100000
    s_addc_u32 s33, s55, 0
    s_mov_b32 s34, 0x8000
    s_mov_b32 s35, 0x20000
    s_mov_b32 s40, s52
    s_mov_b32 s41, s53
    s_mov_b32 s42, 0x100
    s_mov_b32 s43, 0x20000
    s_cmp_eq_u32 s48, 0
    s_cselect_b32 s28, s92, s94
    s_cselect_b32 s29, s93, s95
    s_mov_b32 s30, 2101248
    s_mov_b32 s31, 0x20000
    s_and_b32 s3, s2, 3
    s_lshl_b32 s3, s3, 1
    s_and_b32 s4, s44, 1
    s_add_u32 s50, s3, s4
    s_and_b32 s3, s2, 4
    s_lshr_b32 s4, s2, 3
    s_add_u32 s3, s3, s4
    s_sub_u32 s4, 15, s3
    s_cmp_lt_u32 s49, 2
    s_cselect_b32 s5, s3, s4
    s_lshl_b32 s89, s5, 1
    s_and_b32 s4, s44, 1
    s_add_u32 s89, s89, s4
    s_lshl_b32 s3, s5, 6
    s_sub_u32 s4, 993, s3
    s_sub_u32 s6, 992, s3
    s_cmp_lt_u32 s5, 8
    s_cselect_b32 s4, s3, s4
    s_cselect_b32 s6, s3, s6
    s_cselect_b32 s51, 0, 3
    s_cselect_b32 s86, 1, -1
    s_mov_b32 s87, 0x01000302
    s_cselect_b32 s39, 0x07060504, s87
    s_mov_b32 s87, 0x03020504
    s_cselect_b32 s87, 0x05040302, s87
    s_xor_b32 s88, s4, s50
    s_bitcmp1_b32 s88, 0
    s_cselect_b32 s39, s87, s39
    s_cselect_b32 s86, s86, 0
    s_add_u32 s4, s4, s86
    s_cmp_eq_u32 s5, 0
    s_cselect_b32 s6, 512, s6
    s_cselect_b32 s88, 1, s50
    s_lshl_b32 s7, s6, 1
    s_bitcmp1_b32 s88, 0
    s_cselect_b32 s7, s7, 0x7fff0000
    v_lshrrev_b32 v4, 2, v1
    v_and_b32 v5, 3, v1
    v_lshl_add_u32 v6, v4, 3, s50
    v_mul_u32_u24 v6, 1026, v6
    v_lshl_add_u32 v6, v5, 4, v6
    s_lshl_b32 s4, s4, 1
    v_add_u32 v12, s4, v6
    v_cmp_eq_u32 vcc, 0, v3
    s_nop 1
    v_cndmask_b32 v13, 0, 1.0, vcc
    s_mov_b64 s[36:37], vcc
    v_lshl_add_u32 v4, v2, 2, 0
    v_cmp_eq_u32 vcc, v4, v3
    s_nop 1
    v_cndmask_b32 v24, 0, 1.0, vcc
    v_lshl_add_u32 v4, v2, 2, 1
    v_cmp_eq_u32 vcc, v4, v3
    s_nop 1
    v_cndmask_b32 v25, 0, 1.0, vcc
    v_lshl_add_u32 v4, v2, 2, 2
    v_cmp_eq_u32 vcc, v4, v3
    s_nop 1
    v_cndmask_b32 v26, 0, 1.0, vcc
    v_lshl_add_u32 v4, v2, 2, 3
    v_cmp_eq_u32 vcc, v4, v3
    s_nop 1
    v_cndmask_b32 v27, 0, 1.0, vcc
    s_lshl_b32 s3, s44, 12
    s_add_u32 s3, s3, 131072
    v_lshl_add_u32 v30, v1, 2, s3
    s_cmp_lg_u32 s48, 0
    s_cbranch_scc1 L_sp_t1
    s_waitcnt vmcnt(6)
    s_barrier
    ds_read_b64_tr_b16 v[64:65], v10 offset:0
    ds_read_b64_tr_b16 v[66:67], v10 offset:512
    ds_read_b64_tr_b16 v[68:69], v10 offset:1024
    ds_read_b64_tr_b16 v[70:71], v10 offset:1536
    ds_read_b64_tr_b16 v[72:73], v10 offset:2048
    ds_read_b64_tr_b16 v[74:75], v10 offset:2560
    ds_read_b64_tr_b16 v[76:77], v10 offset:3072
    ds_read_b64_tr_b16 v[78:79], v10 offset:3584
    s_waitcnt lgkmcnt(4)
    v_mfma_f32_16x16x32_bf16 v[88:91], v[64:67], v[32:35], 0
    v_mfma_f32_16x16x32_bf16 v[92:95], v[64:67], v[40:43], 0
    v_mfma_f32_16x16x32_bf16 v[88:91], v[68:71], v[36:39], v[88:91]
    v_mfma_f32_16x16x32_bf16 v[92:95], v[68:71], v[44:47], v[92:95]
    s_waitcnt lgkmcnt(0)
    s_waitcnt vmcnt(4)
    s_barrier
    ds_read_b64_tr_b16 v[64:65], v10 offset:4096
    ds_read_b64_tr_b16 v[66:67], v10 offset:4608
    ds_read_b64_tr_b16 v[68:69], v10 offset:5120
    ds_read_b64_tr_b16 v[70:71], v10 offset:5632
    s_add_u32 s3, s85, 32768
    s_add_u32 m0, s84, 16384
    s_nop 0
    buffer_load_dwordx4 v8, s[8:11], s3 offen lds
    v_readlane_b32 s88, v88, 0
    v_add_f32 v28, v88, v89
    v_add_f32 v80, v90, v91
    v_add_f32 v28, v28, v80
    v_mfma_f32_16x16x32_bf16 v[96:99], v[72:75], v[32:35], 0
    v_mul_f32 v80, s88, v13
    ds_write_b32 v30, v28 offset:0
    v_sub_f32 v88, v88, v80
    v_sub_f32 v89, v89, v80
    v_sub_f32 v90, v90, v80
    v_sub_f32 v91, v91, v80
    v_mul_f32 v80, v92, v20
    v_mfma_f32_16x16x32_bf16 v[100:103], v[72:75], v[40:43], 0
    v_mul_f32 v84, v88, v20
    v_mul_f32 v81, v93, v21
    v_mul_f32 v85, v89, v21
    v_mul_f32 v82, v94, v22
    v_mul_f32 v86, v90, v22
    v_mul_f32 v83, v95, v23
    v_mul_f32 v87, v91, v23
    v_fma_f32 v88, v88, v16, -v80
    v_mfma_f32_16x16x32_bf16 v[96:99], v[76:79], v[36:39], v[96:99]
    v_fma_f32 v92, v92, v16, v84
    v_fma_f32 v89, v89, v17, -v81
    v_fma_f32 v93, v93, v17, v85
    v_fma_f32 v90, v90, v18, -v82
    v_fma_f32 v94, v94, v18, v86
    v_fma_f32 v91, v91, v19, -v83
    v_fma_f32 v95, v95, v19, v87
    v_mfma_f32_16x16x32_bf16 v[100:103], v[76:79], v[44:47], v[100:103]
    v_cvt_pk_bf16_f32 v120, v88, v92
    v_cvt_pk_bf16_f32 v121, v89, v93
    v_cvt_pk_bf16_f32 v122, v90, v94
    v_cvt_pk_bf16_f32 v123, v91, v95
    s_waitcnt lgkmcnt(0)
    ds_read_b64_tr_b16 v[72:73], v10 offset:6144
    ds_read_b64_tr_b16 v[74:75], v10 offset:6656
    ds_read_b64_tr_b16 v[76:77], v10 offset:7168
    ds_read_b64_tr_b16 v[78:79], v10 offset:7680
    s_add_u32 s3, s85, 557056
    s_add_u32 m0, s84, 18432
    s_nop 0
    buffer_load_dwordx4 v8, s[8:11], s3 offen lds
    v_readlane_b32 s88, v96, 0
    v_add_f32 v29, v96, v97
    v_mfma_f32_16x16x32_bf16 v[104:107], v[48:51], v[120:123], 0
    v_add_f32 v80, v98, v99
    v_add_f32 v29, v29, v80
    v_mul_f32 v80, s88, v13
    ds_write_b32 v30, v29 offset:256
    v_sub_f32 v96, v96, v80
    v_mfma_f32_16x16x32_bf16 v[108:111], v[52:55], v[120:123], 0
    v_sub_f32 v97, v97, v80
    v_sub_f32 v98, v98, v80
    v_sub_f32 v99, v99, v80
    v_mul_f32 v80, v100, v20
    v_mfma_f32_16x16x32_bf16 v[112:115], v[56:59], v[120:123], 0
    v_mul_f32 v84, v96, v20
    v_mul_f32 v81, v101, v21
    v_mul_f32 v85, v97, v21
    v_mul_f32 v82, v102, v22
    v_mfma_f32_16x16x32_bf16 v[116:119], v[60:63], v[120:123], 0
    v_mul_f32 v86, v98, v22
    v_mul_f32 v83, v103, v23
    v_mul_f32 v87, v99, v23
    v_fma_f32 v96, v96, v16, -v80
    v_fma_f32 v100, v100, v16, v84
    v_mfma_f32_16x16x32_bf16 v[88:91], v[64:67], v[32:35], 0
    v_fma_f32 v97, v97, v17, -v81
    v_fma_f32 v101, v101, v17, v85
    v_fma_f32 v98, v98, v18, -v82
    v_fma_f32 v102, v102, v18, v86
    v_mfma_f32_16x16x32_bf16 v[92:95], v[64:67], v[40:43], 0
    v_fma_f32 v99, v99, v19, -v83
    v_fma_f32 v103, v103, v19, v87
    v_cvt_pk_bf16_f32 v124, v96, v100
    v_cvt_pk_bf16_f32 v125, v97, v101
    v_mfma_f32_16x16x32_bf16 v[88:91], v[68:71], v[36:39], v[88:91]
    v_cvt_pk_bf16_f32 v126, v98, v102
    v_cvt_pk_bf16_f32 v127, v99, v103
    v_cvt_pk_bf16_f32 v128, v104, v108
    v_cvt_pk_bf16_f32 v132, v105, v109
    v_cvt_pk_bf16_f32 v136, v106, v110
    v_mfma_f32_16x16x32_bf16 v[92:95], v[68:71], v[44:47], v[92:95]
    v_cvt_pk_bf16_f32 v140, v107, v111
    s_mov_b64 exec, s[36:37]
    v_cvt_pk_bf16_f32 v128, v112, v116
    v_cvt_pk_bf16_f32 v132, v113, v117
    v_cvt_pk_bf16_f32 v136, v114, v118
    v_cvt_pk_bf16_f32 v140, v115, v119
    s_mov_b64 exec, -1
    s_waitcnt lgkmcnt(0)
    s_waitcnt vmcnt(4)
    s_barrier
    ds_read_b64_tr_b16 v[64:65], v10 offset:8192
    ds_read_b64_tr_b16 v[66:67], v10 offset:8704
    ds_read_b64_tr_b16 v[68:69], v10 offset:9216
    ds_read_b64_tr_b16 v[70:71], v10 offset:9728
    s_add_u32 s3, s85, 1081344
    s_add_u32 m0, s84, 20480
    s_nop 0
    buffer_load_dwordx4 v8, s[8:11], s3 offen lds
    v_readlane_b32 s88, v88, 0
    v_add_f32 v28, v88, v89
    v_mfma_f32_16x16x32_bf16 v[104:107], v[48:51], v[124:127], 0
    v_add_f32 v80, v90, v91
    v_add_f32 v28, v28, v80
    v_mul_f32 v80, s88, v13
    ds_write_b32 v30, v28 offset:512
    v_sub_f32 v88, v88, v80
    v_mfma_f32_16x16x32_bf16 v[108:111], v[52:55], v[124:127], 0
    v_sub_f32 v89, v89, v80
    v_sub_f32 v90, v90, v80
    v_sub_f32 v91, v91, v80
    v_mul_f32 v80, v92, v20
    v_mfma_f32_16x16x32_bf16 v[112:115], v[56:59], v[124:127], 0
    v_mul_f32 v84, v88, v20
    v_mul_f32 v81, v93, v21
    v_mul_f32 v85, v89, v21
    v_mul_f32 v82, v94, v22
    v_mfma_f32_16x16x32_bf16 v[116:119], v[60:63], v[124:127], 0
    v_mul_f32 v86, v90, v22
    v_mul_f32 v83, v95, v23
    v_mul_f32 v87, v91, v23
    v_fma_f32 v88, v88, v16, -v80
    v_fma_f32 v92, v92, v16, v84
    v_mfma_f32_16x16x32_bf16 v[96:99], v[72:75], v[32:35], 0
    v_fma_f32 v89, v89, v17, -v81
    v_fma_f32 v93, v93, v17, v85
    v_fma_f32 v90, v90, v18, -v82
    v_fma_f32 v94, v94, v18, v86
    v_mfma_f32_16x16x32_bf16 v[100:103], v[72:75], v[40:43], 0
    v_fma_f32 v91, v91, v19, -v83
    v_fma_f32 v95, v95, v19, v87
    v_cvt_pk_bf16_f32 v120, v88, v92
    v_cvt_pk_bf16_f32 v121, v89, v93
    v_mfma_f32_16x16x32_bf16 v[96:99], v[76:79], v[36:39], v[96:99]
    v_cvt_pk_bf16_f32 v122, v90, v94
    v_cvt_pk_bf16_f32 v123, v91, v95
    v_cvt_pk_bf16_f32 v129, v104, v108
    v_cvt_pk_bf16_f32 v133, v105, v109
    v_cvt_pk_bf16_f32 v137, v106, v110
    v_mfma_f32_16x16x32_bf16 v[100:103], v[76:79], v[44:47], v[100:103]
    v_cvt_pk_bf16_f32 v141, v107, v111
    s_mov_b64 exec, s[36:37]
    v_cvt_pk_bf16_f32 v129, v112, v116
    v_cvt_pk_bf16_f32 v133, v113, v117
    v_cvt_pk_bf16_f32 v137, v114, v118
    v_cvt_pk_bf16_f32 v141, v115, v119
    s_mov_b64 exec, -1
    s_waitcnt lgkmcnt(0)
    ds_read_b64_tr_b16 v[72:73], v10 offset:10240
    ds_read_b64_tr_b16 v[74:75], v10 offset:10752
    ds_read_b64_tr_b16 v[76:77], v10 offset:11264
    ds_read_b64_tr_b16 v[78:79], v10 offset:11776
    s_add_u32 s3, s85, 1605632
    s_add_u32 m0, s84, 22528
    s_nop 0
    buffer_load_dwordx4 v8, s[8:11], s3 offen lds
    v_readlane_b32 s88, v96, 0
    v_add_f32 v29, v96, v97
    v_mfma_f32_16x16x32_bf16 v[104:107], v[48:51], v[120:123], 0
    v_add_f32 v80, v98, v99
    v_add_f32 v29, v29, v80
    v_mul_f32 v80, s88, v13
    ds_write_b32 v30, v29 offset:768
    v_sub_f32 v96, v96, v80
    v_mfma_f32_16x16x32_bf16 v[108:111], v[52:55], v[120:123], 0
    v_sub_f32 v97, v97, v80
    v_sub_f32 v98, v98, v80
    v_sub_f32 v99, v99, v80
    v_mul_f32 v80, v100, v20
    v_mfma_f32_16x16x32_bf16 v[112:115], v[56:59], v[120:123], 0
    v_mul_f32 v84, v96, v20
    v_mul_f32 v81, v101, v21
    v_mul_f32 v85, v97, v21
    v_mul_f32 v82, v102, v22
    v_mfma_f32_16x16x32_bf16 v[116:119], v[60:63], v[120:123], 0
    v_mul_f32 v86, v98, v22
    v_mul_f32 v83, v103, v23
    v_mul_f32 v87, v99, v23
    v_fma_f32 v96, v96, v16, -v80
    v_fma_f32 v100, v100, v16, v84
    v_mfma_f32_16x16x32_bf16 v[88:91], v[64:67], v[32:35], 0
    v_fma_f32 v97, v97, v17, -v81
    v_fma_f32 v101, v101, v17, v85
    v_fma_f32 v98, v98, v18, -v82
    v_fma_f32 v102, v102, v18, v86
    v_mfma_f32_16x16x32_bf16 v[92:95], v[64:67], v[40:43], 0
    v_fma_f32 v99, v99, v19, -v83
    v_fma_f32 v103, v103, v19, v87
    v_cvt_pk_bf16_f32 v124, v96, v100
    v_cvt_pk_bf16_f32 v125, v97, v101
    v_mfma_f32_16x16x32_bf16 v[88:91], v[68:71], v[36:39], v[88:91]
    v_cvt_pk_bf16_f32 v126, v98, v102
    v_cvt_pk_bf16_f32 v127, v99, v103
    v_cvt_pk_bf16_f32 v130, v104, v108
    v_cvt_pk_bf16_f32 v134, v105, v109
    v_cvt_pk_bf16_f32 v138, v106, v110
    v_mfma_f32_16x16x32_bf16 v[92:95], v[68:71], v[44:47], v[92:95]
    v_cvt_pk_bf16_f32 v142, v107, v111
    s_mov_b64 exec, s[36:37]
    v_cvt_pk_bf16_f32 v130, v112, v116
    v_cvt_pk_bf16_f32 v134, v113, v117
    v_cvt_pk_bf16_f32 v138, v114, v118
    v_cvt_pk_bf16_f32 v142, v115, v119
    s_mov_b64 exec, -1
    s_waitcnt lgkmcnt(0)
    s_waitcnt vmcnt(4)
    s_barrier
    ds_read_b64_tr_b16 v[64:65], v10 offset:12288
    ds_read_b64_tr_b16 v[66:67], v10 offset:12800
    ds_read_b64_tr_b16 v[68:69], v10 offset:13312
    ds_read_b64_tr_b16 v[70:71], v10 offset:13824
    s_add_u32 s3, s85, 2129920
    s_add_u32 m0, s84, 24576
    s_nop 0
    buffer_load_dwordx4 v8, s[8:11], s3 offen lds
    v_readlane_b32 s88, v88, 0
    v_add_f32 v28, v88, v89
    v_mfma_f32_16x16x32_bf16 v[104:107], v[48:51], v[124:127], 0
    v_add_f32 v80, v90, v91
    v_add_f32 v28, v28, v80
    v_mul_f32 v80, s88, v13
    ds_write_b32 v30, v28 offset:1024
    v_sub_f32 v88, v88, v80
    v_mfma_f32_16x16x32_bf16 v[108:111], v[52:55], v[124:127], 0
    v_sub_f32 v89, v89, v80
    v_sub_f32 v90, v90, v80
    v_sub_f32 v91, v91, v80
    v_mul_f32 v80, v92, v20
    v_mfma_f32_16x16x32_bf16 v[112:115], v[56:59], v[124:127], 0
    v_mul_f32 v84, v88, v20
    v_mul_f32 v81, v93, v21
    v_mul_f32 v85, v89, v21
    v_mul_f32 v82, v94, v22
    v_mfma_f32_16x16x32_bf16 v[116:119], v[60:63], v[124:127], 0
    v_mul_f32 v86, v90, v22
    v_mul_f32 v83, v95, v23
    v_mul_f32 v87, v91, v23
    v_fma_f32 v88, v88, v16, -v80
    v_fma_f32 v92, v92, v16, v84
    v_mfma_f32_16x16x32_bf16 v[96:99], v[72:75], v[32:35], 0
    v_fma_f32 v89, v89, v17, -v81
    v_fma_f32 v93, v93, v17, v85
    v_fma_f32 v90, v90, v18, -v82
    v_fma_f32 v94, v94, v18, v86
    v_mfma_f32_16x16x32_bf16 v[100:103], v[72:75], v[40:43], 0
    v_fma_f32 v91, v91, v19, -v83
    v_fma_f32 v95, v95, v19, v87
    v_cvt_pk_bf16_f32 v120, v88, v92
    v_cvt_pk_bf16_f32 v121, v89, v93
    v_mfma_f32_16x16x32_bf16 v[96:99], v[76:79], v[36:39], v[96:99]
    v_cvt_pk_bf16_f32 v122, v90, v94
    v_cvt_pk_bf16_f32 v123, v91, v95
    v_cvt_pk_bf16_f32 v131, v104, v108
    v_cvt_pk_bf16_f32 v135, v105, v109
    v_cvt_pk_bf16_f32 v139, v106, v110
    v_mfma_f32_16x16x32_bf16 v[100:103], v[76:79], v[44:47], v[100:103]
    v_cvt_pk_bf16_f32 v143, v107, v111
    s_mov_b64 exec, s[36:37]
    v_cvt_pk_bf16_f32 v131, v112, v116
    v_cvt_pk_bf16_f32 v135, v113, v117
    v_cvt_pk_bf16_f32 v139, v114, v118
    v_cvt_pk_bf16_f32 v143, v115, v119
    s_mov_b64 exec, -1
    s_waitcnt lgkmcnt(0)
    ds_read_b64_tr_b16 v[72:73], v10 offset:14336
    ds_read_b64_tr_b16 v[74:75], v10 offset:14848
    ds_read_b64_tr_b16 v[76:77], v10 offset:15360
    ds_read_b64_tr_b16 v[78:79], v10 offset:15872
    s_add_u32 s3, s85, 2654208
    s_add_u32 m0, s84, 26624
    s_nop 0
    buffer_load_dwordx4 v8, s[8:11], s3 offen lds
    v_readlane_b32 s88, v96, 0
    v_add_f32 v29, v96, v97
    v_mfma_f32_16x16x32_bf16 v[104:107], v[48:51], v[120:123], 0
    v_add_f32 v80, v98, v99
    v_add_f32 v29, v29, v80
    v_mul_f32 v80, s88, v13
    ds_write_b32 v30, v29 offset:1280
    v_sub_f32 v96, v96, v80
    v_mfma_f32_16x16x32_bf16 v[108:111], v[52:55], v[120:123], 0
    v_sub_f32 v97, v97, v80
    v_sub_f32 v98, v98, v80
    v_sub_f32 v99, v99, v80
    v_mul_f32 v80, v100, v20
    v_mfma_f32_16x16x32_bf16 v[112:115], v[56:59], v[120:123], 0
    v_mul_f32 v84, v96, v20
    v_mul_f32 v81, v101, v21
    v_mul_f32 v85, v97, v21
    v_mul_f32 v82, v102, v22
    v_mfma_f32_16x16x32_bf16 v[116:119], v[60:63], v[120:123], 0
    v_mul_f32 v86, v98, v22
    v_mul_f32 v83, v103, v23
    v_mul_f32 v87, v99, v23
    v_fma_f32 v96, v96, v16, -v80
    v_fma_f32 v100, v100, v16, v84
    v_mfma_f32_16x16x32_bf16 v[88:91], v[64:67], v[32:35], 0
    v_fma_f32 v97, v97, v17, -v81
    v_fma_f32 v101, v101, v17, v85
    v_fma_f32 v98, v98, v18, -v82
    v_fma_f32 v102, v102, v18, v86
    v_mfma_f32_16x16x32_bf16 v[92:95], v[64:67], v[40:43], 0
    v_fma_f32 v99, v99, v19, -v83
    v_fma_f32 v103, v103, v19, v87
    v_cvt_pk_bf16_f32 v124, v96, v100
    v_cvt_pk_bf16_f32 v125, v97, v101
    v_mfma_f32_16x16x32_bf16 v[88:91], v[68:71], v[36:39], v[88:91]
    v_cvt_pk_bf16_f32 v126, v98, v102
    v_cvt_pk_bf16_f32 v127, v99, v103
    v_cvt_pk_bf16_f32 v144, v104, v108
    v_cvt_pk_bf16_f32 v148, v105, v109
    v_cvt_pk_bf16_f32 v152, v106, v110
    v_mfma_f32_16x16x32_bf16 v[92:95], v[68:71], v[44:47], v[92:95]
    v_cvt_pk_bf16_f32 v156, v107, v111
    s_mov_b64 exec, s[36:37]
    v_cvt_pk_bf16_f32 v144, v112, v116
    v_cvt_pk_bf16_f32 v148, v113, v117
    v_cvt_pk_bf16_f32 v152, v114, v118
    v_cvt_pk_bf16_f32 v156, v115, v119
    s_mov_b64 exec, -1
    s_waitcnt lgkmcnt(0)
    s_waitcnt vmcnt(4)
    s_barrier
    ds_read_b64_tr_b16 v[64:65], v10 offset:16384
    ds_read_b64_tr_b16 v[66:67], v10 offset:16896
    ds_read_b64_tr_b16 v[68:69], v10 offset:17408
    ds_read_b64_tr_b16 v[70:71], v10 offset:17920
    s_add_u32 s3, s85, 3178496
    s_add_u32 m0, s84, 28672
    s_nop 0
    buffer_load_dwordx4 v8, s[8:11], s3 offen lds
    v_readlane_b32 s88, v88, 0
    v_add_f32 v28, v88, v89
    v_mfma_f32_16x16x32_bf16 v[104:107], v[48:51], v[124:127], 0
    v_add_f32 v80, v90, v91
    v_add_f32 v28, v28, v80
    v_mul_f32 v80, s88, v13
    ds_write_b32 v30, v28 offset:1536
    v_sub_f32 v88, v88, v80
    v_mfma_f32_16x16x32_bf16 v[108:111], v[52:55], v[124:127], 0
    v_sub_f32 v89, v89, v80
    v_sub_f32 v90, v90, v80
    v_sub_f32 v91, v91, v80
    v_mul_f32 v80, v92, v20
    v_mfma_f32_16x16x32_bf16 v[112:115], v[56:59], v[124:127], 0
    v_mul_f32 v84, v88, v20
    v_mul_f32 v81, v93, v21
    v_mul_f32 v85, v89, v21
    v_mul_f32 v82, v94, v22
    v_mfma_f32_16x16x32_bf16 v[116:119], v[60:63], v[124:127], 0
    v_mul_f32 v86, v90, v22
    v_mul_f32 v83, v95, v23
    v_mul_f32 v87, v91, v23
    v_fma_f32 v88, v88, v16, -v80
    v_fma_f32 v92, v92, v16, v84
    v_mfma_f32_16x16x32_bf16 v[96:99], v[72:75], v[32:35], 0
    v_fma_f32 v89, v89, v17, -v81
    v_fma_f32 v93, v93, v17, v85
    v_fma_f32 v90, v90, v18, -v82
    v_fma_f32 v94, v94, v18, v86
    v_mfma_f32_16x16x32_bf16 v[100:103], v[72:75], v[40:43], 0
    v_fma_f32 v91, v91, v19, -v83
    v_fma_f32 v95, v95, v19, v87
    v_cvt_pk_bf16_f32 v120, v88, v92
    v_cvt_pk_bf16_f32 v121, v89, v93
    v_mfma_f32_16x16x32_bf16 v[96:99], v[76:79], v[36:39], v[96:99]
    v_cvt_pk_bf16_f32 v122, v90, v94
    v_cvt_pk_bf16_f32 v123, v91, v95
    v_cvt_pk_bf16_f32 v145, v104, v108
    v_cvt_pk_bf16_f32 v149, v105, v109
    v_cvt_pk_bf16_f32 v153, v106, v110
    v_mfma_f32_16x16x32_bf16 v[100:103], v[76:79], v[44:47], v[100:103]
    v_cvt_pk_bf16_f32 v157, v107, v111
    s_mov_b64 exec, s[36:37]
    v_cvt_pk_bf16_f32 v145, v112, v116
    v_cvt_pk_bf16_f32 v149, v113, v117
    v_cvt_pk_bf16_f32 v153, v114, v118
    v_cvt_pk_bf16_f32 v157, v115, v119
    s_mov_b64 exec, -1
    s_waitcnt lgkmcnt(0)
    ds_read_b64_tr_b16 v[72:73], v10 offset:18432
    ds_read_b64_tr_b16 v[74:75], v10 offset:18944
    ds_read_b64_tr_b16 v[76:77], v10 offset:19456
    ds_read_b64_tr_b16 v[78:79], v10 offset:19968
    s_add_u32 s3, s85, 3702784
    s_add_u32 m0, s84, 30720
    s_nop 0
    buffer_load_dwordx4 v8, s[8:11], s3 offen lds
    v_readlane_b32 s88, v96, 0
    v_add_f32 v29, v96, v97
    v_mfma_f32_16x16x32_bf16 v[104:107], v[48:51], v[120:123], 0
    v_add_f32 v80, v98, v99
    v_add_f32 v29, v29, v80
    v_mul_f32 v80, s88, v13
    ds_write_b32 v30, v29 offset:1792
    v_sub_f32 v96, v96, v80
    v_mfma_f32_16x16x32_bf16 v[108:111], v[52:55], v[120:123], 0
    v_sub_f32 v97, v97, v80
    v_sub_f32 v98, v98, v80
    v_sub_f32 v99, v99, v80
    v_mul_f32 v80, v100, v20
    v_mfma_f32_16x16x32_bf16 v[112:115], v[56:59], v[120:123], 0
    v_mul_f32 v84, v96, v20
    v_mul_f32 v81, v101, v21
    v_mul_f32 v85, v97, v21
    v_mul_f32 v82, v102, v22
    v_mfma_f32_16x16x32_bf16 v[116:119], v[60:63], v[120:123], 0
    v_mul_f32 v86, v98, v22
    v_mul_f32 v83, v103, v23
    v_mul_f32 v87, v99, v23
    v_fma_f32 v96, v96, v16, -v80
    v_fma_f32 v100, v100, v16, v84
    v_mfma_f32_16x16x32_bf16 v[88:91], v[64:67], v[32:35], 0
    v_fma_f32 v97, v97, v17, -v81
    v_fma_f32 v101, v101, v17, v85
    v_fma_f32 v98, v98, v18, -v82
    v_fma_f32 v102, v102, v18, v86
    v_mfma_f32_16x16x32_bf16 v[92:95], v[64:67], v[40:43], 0
    v_fma_f32 v99, v99, v19, -v83
    v_fma_f32 v103, v103, v19, v87
    v_cvt_pk_bf16_f32 v124, v96, v100
    v_cvt_pk_bf16_f32 v125, v97, v101
    v_mfma_f32_16x16x32_bf16 v[88:91], v[68:71], v[36:39], v[88:91]
    v_cvt_pk_bf16_f32 v126, v98, v102
    v_cvt_pk_bf16_f32 v127, v99, v103
    v_cvt_pk_bf16_f32 v146, v104, v108
    v_cvt_pk_bf16_f32 v150, v105, v109
    v_cvt_pk_bf16_f32 v154, v106, v110
    v_mfma_f32_16x16x32_bf16 v[92:95], v[68:71], v[44:47], v[92:95]
    v_cvt_pk_bf16_f32 v158, v107, v111
    s_mov_b64 exec, s[36:37]
    v_cvt_pk_bf16_f32 v146, v112, v116
    v_cvt_pk_bf16_f32 v150, v113, v117
    v_cvt_pk_bf16_f32 v154, v114, v118
    v_cvt_pk_bf16_f32 v158, v115, v119
    s_mov_b64 exec, -1
    s_waitcnt lgkmcnt(0)
    s_waitcnt vmcnt(4)
    s_barrier
    ds_read_b64_tr_b16 v[64:65], v10 offset:20480
    ds_read_b64_tr_b16 v[66:67], v10 offset:20992
    ds_read_b64_tr_b16 v[68:69], v10 offset:21504
    ds_read_b64_tr_b16 v[70:71], v10 offset:22016
    buffer_load_dword v31, off, s[40:43], 0 offset:8 sc1
    v_readlane_b32 s88, v88, 0
    v_add_f32 v28, v88, v89
    v_mfma_f32_16x16x32_bf16 v[104:107], v[48:51], v[124:127], 0
    v_add_f32 v80, v90, v91
    v_add_f32 v28, v28, v80
    v_mul_f32 v80, s88, v13
    ds_write_b32 v30, v28 offset:2048
    v_sub_f32 v88, v88, v80
    v_mfma_f32_16x16x32_bf16 v[108:111], v[52:55], v[124:127], 0
    v_sub_f32 v89, v89, v80
    v_sub_f32 v90, v90, v80
    v_sub_f32 v91, v91, v80
    v_mul_f32 v80, v92, v20
    v_mfma_f32_16x16x32_bf16 v[112:115], v[56:59], v[124:127], 0
    v_mul_f32 v84, v88, v20
    v_mul_f32 v81, v93, v21
    v_mul_f32 v85, v89, v21
    v_mul_f32 v82, v94, v22
    v_mfma_f32_16x16x32_bf16 v[116:119], v[60:63], v[124:127], 0
    v_mul_f32 v86, v90, v22
    v_mul_f32 v83, v95, v23
    v_mul_f32 v87, v91, v23
    v_fma_f32 v88, v88, v16, -v80
    v_fma_f32 v92, v92, v16, v84
    v_mfma_f32_16x16x32_bf16 v[96:99], v[72:75], v[32:35], 0
    v_fma_f32 v89, v89, v17, -v81
    v_fma_f32 v93, v93, v17, v85
    v_fma_f32 v90, v90, v18, -v82
    v_fma_f32 v94, v94, v18, v86
    v_mfma_f32_16x16x32_bf16 v[100:103], v[72:75], v[40:43], 0
    v_fma_f32 v91, v91, v19, -v83
    v_fma_f32 v95, v95, v19, v87
    v_cvt_pk_bf16_f32 v120, v88, v92
    v_cvt_pk_bf16_f32 v121, v89, v93
    v_mfma_f32_16x16x32_bf16 v[96:99], v[76:79], v[36:39], v[96:99]
    v_cvt_pk_bf16_f32 v122, v90, v94
    v_cvt_pk_bf16_f32 v123, v91, v95
    v_cvt_pk_bf16_f32 v147, v104, v108
    v_cvt_pk_bf16_f32 v151, v105, v109
    v_cvt_pk_bf16_f32 v155, v106, v110
    v_mfma_f32_16x16x32_bf16 v[100:103], v[76:79], v[44:47], v[100:103]
    v_cvt_pk_bf16_f32 v159, v107, v111
    s_mov_b64 exec, s[36:37]
    v_cvt_pk_bf16_f32 v147, v112, v116
    v_cvt_pk_bf16_f32 v151, v113, v117
    v_cvt_pk_bf16_f32 v155, v114, v118
    v_cvt_pk_bf16_f32 v159, v115, v119
    s_mov_b64 exec, -1
    s_waitcnt lgkmcnt(0)
    ds_read_b64_tr_b16 v[72:73], v10 offset:22528
    ds_read_b64_tr_b16 v[74:75], v10 offset:23040
    ds_read_b64_tr_b16 v[76:77], v10 offset:23552
    ds_read_b64_tr_b16 v[78:79], v10 offset:24064
    s_mov_b32 s3, 0
    buffer_load_dwordx4 v[192:195], v12, s[28:31], s3 offen
    s_mov_b32 s3, 131328
    buffer_load_dwordx4 v[196:199], v12, s[28:31], s3 offen
    v_readlane_b32 s88, v96, 0
    v_add_f32 v29, v96, v97
    v_mfma_f32_16x16x32_bf16 v[104:107], v[48:51], v[120:123], 0
    v_add_f32 v80, v98, v99
    v_add_f32 v29, v29, v80
    v_mul_f32 v80, s88, v13
    ds_write_b32 v30, v29 offset:2304
    v_sub_f32 v96, v96, v80
    v_mfma_f32_16x16x32_bf16 v[108:111], v[52:55], v[120:123], 0
    v_sub_f32 v97, v97, v80
    v_sub_f32 v98, v98, v80
    v_sub_f32 v99, v99, v80
    v_mul_f32 v80, v100, v20
    v_mfma_f32_16x16x32_bf16 v[112:115], v[56:59], v[120:123], 0
    v_mul_f32 v84, v96, v20
    v_mul_f32 v81, v101, v21
    v_mul_f32 v85, v97, v21
    v_mul_f32 v82, v102, v22
    v_mfma_f32_16x16x32_bf16 v[116:119], v[60:63], v[120:123], 0
    v_mul_f32 v86, v98, v22
    v_mul_f32 v83, v103, v23
    v_mul_f32 v87, v99, v23
    v_fma_f32 v96, v96, v16, -v80
    v_fma_f32 v100, v100, v16, v84
    v_mfma_f32_16x16x32_bf16 v[88:91], v[64:67], v[32:35], 0
    v_fma_f32 v97, v97, v17, -v81
    v_fma_f32 v101, v101, v17, v85
    v_fma_f32 v98, v98, v18, -v82
    v_fma_f32 v102, v102, v18, v86
    v_mfma_f32_16x16x32_bf16 v[92:95], v[64:67], v[40:43], 0
    v_fma_f32 v99, v99, v19, -v83
    v_fma_f32 v103, v103, v19, v87
    v_cvt_pk_bf16_f32 v124, v96, v100
    v_cvt_pk_bf16_f32 v125, v97, v101
    v_mfma_f32_16x16x32_bf16 v[88:91], v[68:71], v[36:39], v[88:91]
    v_cvt_pk_bf16_f32 v126, v98, v102
    v_cvt_pk_bf16_f32 v127, v99, v103
    v_cvt_pk_bf16_f32 v160, v104, v108
    v_cvt_pk_bf16_f32 v164, v105, v109
    v_cvt_pk_bf16_f32 v168, v106, v110
    v_mfma_f32_16x16x32_bf16 v[92:95], v[68:71], v[44:47], v[92:95]
    v_cvt_pk_bf16_f32 v172, v107, v111
    s_mov_b64 exec, s[36:37]
    v_cvt_pk_bf16_f32 v160, v112, v116
    v_cvt_pk_bf16_f32 v164, v113, v117
    v_cvt_pk_bf16_f32 v168, v114, v118
    v_cvt_pk_bf16_f32 v172, v115, v119
    s_mov_b64 exec, -1
    s_waitcnt lgkmcnt(0)
    s_waitcnt vmcnt(5)
    s_barrier
    ds_read_b64_tr_b16 v[64:65], v10 offset:24576
    ds_read_b64_tr_b16 v[66:67], v10 offset:25088
    ds_read_b64_tr_b16 v[68:69], v10 offset:25600
    ds_read_b64_tr_b16 v[70:71], v10 offset:26112
    s_mov_b32 s3, 262656
    buffer_load_dwordx4 v[200:203], v12, s[28:31], s3 offen
    s_mov_b32 s3, 393984
    buffer_load_dwordx4 v[204:207], v12, s[28:31], s3 offen
    v_readlane_b32 s88, v88, 0
    v_add_f32 v28, v88, v89
    v_mfma_f32_16x16x32_bf16 v[104:107], v[48:51], v[124:127], 0
    v_add_f32 v80, v90, v91
    v_add_f32 v28, v28, v80
    v_mul_f32 v80, s88, v13
    ds_write_b32 v30, v28 offset:2560
    v_sub_f32 v88, v88, v80
    v_mfma_f32_16x16x32_bf16 v[108:111], v[52:55], v[124:127], 0
    v_sub_f32 v89, v89, v80
    v_sub_f32 v90, v90, v80
    v_sub_f32 v91, v91, v80
    v_mul_f32 v80, v92, v20
    v_mfma_f32_16x16x32_bf16 v[112:115], v[56:59], v[124:127], 0
    v_mul_f32 v84, v88, v20
    v_mul_f32 v81, v93, v21
    v_mul_f32 v85, v89, v21
    v_mul_f32 v82, v94, v22
    v_mfma_f32_16x16x32_bf16 v[116:119], v[60:63], v[124:127], 0
    v_mul_f32 v86, v90, v22
    v_mul_f32 v83, v95, v23
    v_mul_f32 v87, v91, v23
    v_fma_f32 v88, v88, v16, -v80
    v_fma_f32 v92, v92, v16, v84
    v_mfma_f32_16x16x32_bf16 v[96:99], v[72:75], v[32:35], 0
    v_fma_f32 v89, v89, v17, -v81
    v_fma_f32 v93, v93, v17, v85
    v_fma_f32 v90, v90, v18, -v82
    v_fma_f32 v94, v94, v18, v86
    v_mfma_f32_16x16x32_bf16 v[100:103], v[72:75], v[40:43], 0
    v_fma_f32 v91, v91, v19, -v83
    v_fma_f32 v95, v95, v19, v87
    v_cvt_pk_bf16_f32 v120, v88, v92
    v_cvt_pk_bf16_f32 v121, v89, v93
    v_mfma_f32_16x16x32_bf16 v[96:99], v[76:79], v[36:39], v[96:99]
    v_cvt_pk_bf16_f32 v122, v90, v94
    v_cvt_pk_bf16_f32 v123, v91, v95
    v_cvt_pk_bf16_f32 v161, v104, v108
    v_cvt_pk_bf16_f32 v165, v105, v109
    v_cvt_pk_bf16_f32 v169, v106, v110
    v_mfma_f32_16x16x32_bf16 v[100:103], v[76:79], v[44:47], v[100:103]
    v_cvt_pk_bf16_f32 v173, v107, v111
    s_mov_b64 exec, s[36:37]
    v_cvt_pk_bf16_f32 v161, v112, v116
    v_cvt_pk_bf16_f32 v165, v113, v117
    v_cvt_pk_bf16_f32 v169, v114, v118
    v_cvt_pk_bf16_f32 v173, v115, v119
    s_mov_b64 exec, -1
    s_waitcnt lgkmcnt(0)
    ds_read_b64_tr_b16 v[72:73], v10 offset:26624
    ds_read_b64_tr_b16 v[74:75], v10 offset:27136
    ds_read_b64_tr_b16 v[76:77], v10 offset:27648
    ds_read_b64_tr_b16 v[78:79], v10 offset:28160
    s_mov_b32 s3, 525312
    buffer_load_dwordx4 v[208:211], v12, s[28:31], s3 offen
    s_mov_b32 s3, 656640
    buffer_load_dwordx4 v[212:215], v12, s[28:31], s3 offen
    v_readlane_b32 s88, v96, 0
    v_add_f32 v29, v96, v97
    v_mfma_f32_16x16x32_bf16 v[104:107], v[48:51], v[120:123], 0
    v_add_f32 v80, v98, v99
    v_add_f32 v29, v29, v80
    v_mul_f32 v80, s88, v13
    ds_write_b32 v30, v29 offset:2816
    v_sub_f32 v96, v96, v80
    v_mfma_f32_16x16x32_bf16 v[108:111], v[52:55], v[120:123], 0
    v_sub_f32 v97, v97, v80
    v_sub_f32 v98, v98, v80
    v_sub_f32 v99, v99, v80
    v_mul_f32 v80, v100, v20
    v_mfma_f32_16x16x32_bf16 v[112:115], v[56:59], v[120:123], 0
    v_mul_f32 v84, v96, v20
    v_mul_f32 v81, v101, v21
    v_mul_f32 v85, v97, v21
    v_mul_f32 v82, v102, v22
    v_mfma_f32_16x16x32_bf16 v[116:119], v[60:63], v[120:123], 0
    v_mul_f32 v86, v98, v22
    v_mul_f32 v83, v103, v23
    v_mul_f32 v87, v99, v23
    v_fma_f32 v96, v96, v16, -v80
    v_fma_f32 v100, v100, v16, v84
    v_mfma_f32_16x16x32_bf16 v[88:91], v[64:67], v[32:35], 0
    v_fma_f32 v97, v97, v17, -v81
    v_fma_f32 v101, v101, v17, v85
    v_fma_f32 v98, v98, v18, -v82
    v_fma_f32 v102, v102, v18, v86
    v_mfma_f32_16x16x32_bf16 v[92:95], v[64:67], v[40:43], 0
    v_fma_f32 v99, v99, v19, -v83
    v_fma_f32 v103, v103, v19, v87
    v_cvt_pk_bf16_f32 v124, v96, v100
    v_cvt_pk_bf16_f32 v125, v97, v101
    v_mfma_f32_16x16x32_bf16 v[88:91], v[68:71], v[36:39], v[88:91]
    v_cvt_pk_bf16_f32 v126, v98, v102
    v_cvt_pk_bf16_f32 v127, v99, v103
    v_cvt_pk_bf16_f32 v162, v104, v108
    v_cvt_pk_bf16_f32 v166, v105, v109
    v_cvt_pk_bf16_f32 v170, v106, v110
    v_mfma_f32_16x16x32_bf16 v[92:95], v[68:71], v[44:47], v[92:95]
    v_cvt_pk_bf16_f32 v174, v107, v111
    s_mov_b64 exec, s[36:37]
    v_cvt_pk_bf16_f32 v162, v112, v116
    v_cvt_pk_bf16_f32 v166, v113, v117
    v_cvt_pk_bf16_f32 v170, v114, v118
    v_cvt_pk_bf16_f32 v174, v115, v119
    s_mov_b64 exec, -1
    s_waitcnt lgkmcnt(0)
    s_waitcnt vmcnt(7)
    s_barrier
    ds_read_b64_tr_b16 v[64:65], v10 offset:28672
    ds_read_b64_tr_b16 v[66:67], v10 offset:29184
    ds_read_b64_tr_b16 v[68:69], v10 offset:29696
    ds_read_b64_tr_b16 v[70:71], v10 offset:30208
    s_mov_b32 s3, 787968
    buffer_load_dwordx4 v[216:219], v12, s[28:31], s3 offen
    s_mov_b32 s3, 919296
    buffer_load_dwordx4 v[220:223], v12, s[28:31], s3 offen
    v_readlane_b32 s88, v88, 0
    v_add_f32 v28, v88, v89
    v_mfma_f32_16x16x32_bf16 v[104:107], v[48:51], v[124:127], 0
    v_add_f32 v80, v90, v91
    v_add_f32 v28, v28, v80
    v_mul_f32 v80, s88, v13
    ds_write_b32 v30, v28 offset:3072
    v_sub_f32 v88, v88, v80
    v_mfma_f32_16x16x32_bf16 v[108:111], v[52:55], v[124:127], 0
    v_sub_f32 v89, v89, v80
    v_sub_f32 v90, v90, v80
    v_sub_f32 v91, v91, v80
    v_mul_f32 v80, v92, v20
    v_mfma_f32_16x16x32_bf16 v[112:115], v[56:59], v[124:127], 0
    v_mul_f32 v84, v88, v20
    v_mul_f32 v81, v93, v21
    v_mul_f32 v85, v89, v21
    v_mul_f32 v82, v94, v22
    v_mfma_f32_16x16x32_bf16 v[116:119], v[60:63], v[124:127], 0
    v_mul_f32 v86, v90, v22
    v_mul_f32 v83, v95, v23
    v_mul_f32 v87, v91, v23
    v_fma_f32 v88, v88, v16, -v80
    v_fma_f32 v92, v92, v16, v84
    v_mfma_f32_16x16x32_bf16 v[96:99], v[72:75], v[32:35], 0
    v_fma_f32 v89, v89, v17, -v81
    v_fma_f32 v93, v93, v17, v85
    v_fma_f32 v90, v90, v18, -v82
    v_fma_f32 v94, v94, v18, v86
    v_mfma_f32_16x16x32_bf16 v[100:103], v[72:75], v[40:43], 0
    v_fma_f32 v91, v91, v19, -v83
    v_fma_f32 v95, v95, v19, v87
    v_cvt_pk_bf16_f32 v120, v88, v92
    v_cvt_pk_bf16_f32 v121, v89, v93
    v_mfma_f32_16x16x32_bf16 v[96:99], v[76:79], v[36:39], v[96:99]
    v_cvt_pk_bf16_f32 v122, v90, v94
    v_cvt_pk_bf16_f32 v123, v91, v95
    v_cvt_pk_bf16_f32 v163, v104, v108
    v_cvt_pk_bf16_f32 v167, v105, v109
    v_cvt_pk_bf16_f32 v171, v106, v110
    v_mfma_f32_16x16x32_bf16 v[100:103], v[76:79], v[44:47], v[100:103]
    v_cvt_pk_bf16_f32 v175, v107, v111
    s_mov_b64 exec, s[36:37]
    v_cvt_pk_bf16_f32 v163, v112, v116
    v_cvt_pk_bf16_f32 v167, v113, v117
    v_cvt_pk_bf16_f32 v171, v114, v118
    v_cvt_pk_bf16_f32 v175, v115, v119
    s_mov_b64 exec, -1
    s_waitcnt lgkmcnt(0)
    ds_read_b64_tr_b16 v[72:73], v10 offset:30720
    ds_read_b64_tr_b16 v[74:75], v10 offset:31232
    ds_read_b64_tr_b16 v[76:77], v10 offset:31744
    ds_read_b64_tr_b16 v[78:79], v10 offset:32256
    s_mov_b32 s3, 1050624
    buffer_load_dwordx4 v[224:227], v12, s[28:31], s3 offen
    s_mov_b32 s3, 1181952
    buffer_load_dwordx4 v[228:231], v12, s[28:31], s3 offen
    v_readlane_b32 s88, v96, 0
    v_add_f32 v29, v96, v97
    v_mfma_f32_16x16x32_bf16 v[104:107], v[48:51], v[120:123], 0
    v_add_f32 v80, v98, v99
    v_add_f32 v29, v29, v80
    v_mul_f32 v80, s88, v13
    ds_write_b32 v30, v29 offset:3328
    v_sub_f32 v96, v96, v80
    v_mfma_f32_16x16x32_bf16 v[108:111], v[52:55], v[120:123], 0
    v_sub_f32 v97, v97, v80
    v_sub_f32 v98, v98, v80
    v_sub_f32 v99, v99, v80
    v_mul_f32 v80, v100, v20
    v_mfma_f32_16x16x32_bf16 v[112:115], v[56:59], v[120:123], 0
    v_mul_f32 v84, v96, v20
    v_mul_f32 v81, v101, v21
    v_mul_f32 v85, v97, v21
    v_mul_f32 v82, v102, v22
    v_mfma_f32_16x16x32_bf16 v[116:119], v[60:63], v[120:123], 0
    v_mul_f32 v86, v98, v22
    v_mul_f32 v83, v103, v23
    v_mul_f32 v87, v99, v23
    v_fma_f32 v96, v96, v16, -v80
    v_fma_f32 v100, v100, v16, v84
    v_mfma_f32_16x16x32_bf16 v[88:91], v[64:67], v[32:35], 0
    v_fma_f32 v97, v97, v17, -v81
    v_fma_f32 v101, v101, v17, v85
    v_fma_f32 v98, v98, v18, -v82
    v_fma_f32 v102, v102, v18, v86
    v_mfma_f32_16x16x32_bf16 v[92:95], v[64:67], v[40:43], 0
    v_fma_f32 v99, v99, v19, -v83
    v_fma_f32 v103, v103, v19, v87
    v_cvt_pk_bf16_f32 v124, v96, v100
    v_cvt_pk_bf16_f32 v125, v97, v101
    v_mfma_f32_16x16x32_bf16 v[88:91], v[68:71], v[36:39], v[88:91]
    v_cvt_pk_bf16_f32 v126, v98, v102
    v_cvt_pk_bf16_f32 v127, v99, v103
    v_cvt_pk_bf16_f32 v176, v104, v108
    v_cvt_pk_bf16_f32 v180, v105, v109
    v_cvt_pk_bf16_f32 v184, v106, v110
    v_mfma_f32_16x16x32_bf16 v[92:95], v[68:71], v[44:47], v[92:95]
    v_cvt_pk_bf16_f32 v188, v107, v111
    s_mov_b64 exec, s[36:37]
    v_cvt_pk_bf16_f32 v176, v112, v116
    v_cvt_pk_bf16_f32 v180, v113, v117
    v_cvt_pk_bf16_f32 v184, v114, v118
    v_cvt_pk_bf16_f32 v188, v115, v119
    s_mov_b64 exec, -1
    s_waitcnt lgkmcnt(0)
    s_mov_b32 s3, 1313280
    buffer_load_dwordx4 v[232:235], v12, s[28:31], s3 offen
    s_mov_b32 s3, 1444608
    buffer_load_dwordx4 v[236:239], v12, s[28:31], s3 offen
    v_readlane_b32 s88, v88, 0
    v_add_f32 v28, v88, v89
    v_mfma_f32_16x16x32_bf16 v[104:107], v[48:51], v[124:127], 0
    v_add_f32 v80, v90, v91
    v_add_f32 v28, v28, v80
    v_mul_f32 v80, s88, v13
    ds_write_b32 v30, v28 offset:3584
    v_sub_f32 v88, v88, v80
    v_mfma_f32_16x16x32_bf16 v[108:111], v[52:55], v[124:127], 0
    v_sub_f32 v89, v89, v80
    v_sub_f32 v90, v90, v80
    v_sub_f32 v91, v91, v80
    v_mul_f32 v80, v92, v20
    v_mfma_f32_16x16x32_bf16 v[112:115], v[56:59], v[124:127], 0
    v_mul_f32 v84, v88, v20
    v_mul_f32 v81, v93, v21
    v_mul_f32 v85, v89, v21
    v_mul_f32 v82, v94, v22
    v_mfma_f32_16x16x32_bf16 v[116:119], v[60:63], v[124:127], 0
    v_mul_f32 v86, v90, v22
    v_mul_f32 v83, v95, v23
    v_mul_f32 v87, v91, v23
    v_fma_f32 v88, v88, v16, -v80
    v_fma_f32 v92, v92, v16, v84
    v_mfma_f32_16x16x32_bf16 v[96:99], v[72:75], v[32:35], 0
    v_fma_f32 v89, v89, v17, -v81
    v_fma_f32 v93, v93, v17, v85
    v_fma_f32 v90, v90, v18, -v82
    v_fma_f32 v94, v94, v18, v86
    v_mfma_f32_16x16x32_bf16 v[100:103], v[72:75], v[40:43], 0
    v_fma_f32 v91, v91, v19, -v83
    v_fma_f32 v95, v95, v19, v87
    v_cvt_pk_bf16_f32 v120, v88, v92
    v_cvt_pk_bf16_f32 v121, v89, v93
    v_mfma_f32_16x16x32_bf16 v[96:99], v[76:79], v[36:39], v[96:99]
    v_cvt_pk_bf16_f32 v122, v90, v94
    v_cvt_pk_bf16_f32 v123, v91, v95
    v_cvt_pk_bf16_f32 v177, v104, v108
    v_cvt_pk_bf16_f32 v181, v105, v109
    v_cvt_pk_bf16_f32 v185, v106, v110
    v_mfma_f32_16x16x32_bf16 v[100:103], v[76:79], v[44:47], v[100:103]
    v_cvt_pk_bf16_f32 v189, v107, v111
    s_mov_b64 exec, s[36:37]
    v_cvt_pk_bf16_f32 v177, v112, v116
    v_cvt_pk_bf16_f32 v181, v113, v117
    v_cvt_pk_bf16_f32 v185, v114, v118
    v_cvt_pk_bf16_f32 v189, v115, v119
    s_mov_b64 exec, -1
    s_waitcnt lgkmcnt(0)
    s_mov_b32 s3, 1575936
    buffer_load_dwordx4 v[240:243], v12, s[28:31], s3 offen
    s_mov_b32 s3, 1707264
    buffer_load_dwordx4 v[244:247], v12, s[28:31], s3 offen
    v_mfma_f32_16x16x32_bf16 v[104:107], v[48:51], v[120:123], 0
    v_mfma_f32_16x16x32_bf16 v[108:111], v[52:55], v[120:123], 0
    v_mfma_f32_16x16x32_bf16 v[112:115], v[56:59], v[120:123], 0
    v_mfma_f32_16x16x32_bf16 v[116:119], v[60:63], v[120:123], 0
    v_readlane_b32 s88, v96, 0
    v_add_f32 v29, v96, v97
    v_add_f32 v80, v98, v99
    v_add_f32 v29, v29, v80
    v_mul_f32 v80, s88, v13
    ds_write_b32 v30, v29 offset:3840
    v_sub_f32 v96, v96, v80
    v_sub_f32 v97, v97, v80
    v_sub_f32 v98, v98, v80
    v_sub_f32 v99, v99, v80
    v_mul_f32 v80, v100, v20
    v_mul_f32 v84, v96, v20
    v_mul_f32 v81, v101, v21
    v_mul_f32 v85, v97, v21
    v_mul_f32 v82, v102, v22
    v_mul_f32 v86, v98, v22
    v_mul_f32 v83, v103, v23
    v_mul_f32 v87, v99, v23
    v_fma_f32 v96, v96, v16, -v80
    v_fma_f32 v100, v100, v16, v84
    v_fma_f32 v97, v97, v17, -v81
    v_fma_f32 v101, v101, v17, v85
    v_fma_f32 v98, v98, v18, -v82
    v_fma_f32 v102, v102, v18, v86
    v_fma_f32 v99, v99, v19, -v83
    v_fma_f32 v103, v103, v19, v87
    v_cvt_pk_bf16_f32 v124, v96, v100
    v_cvt_pk_bf16_f32 v125, v97, v101
    v_cvt_pk_bf16_f32 v126, v98, v102
    v_cvt_pk_bf16_f32 v127, v99, v103
    v_cvt_pk_bf16_f32 v178, v104, v108
    v_cvt_pk_bf16_f32 v182, v105, v109
    v_cvt_pk_bf16_f32 v186, v106, v110
    v_cvt_pk_bf16_f32 v190, v107, v111
    s_mov_b64 exec, s[36:37]
    v_cvt_pk_bf16_f32 v178, v112, v116
    v_cvt_pk_bf16_f32 v182, v113, v117
    v_cvt_pk_bf16_f32 v186, v114, v118
    v_cvt_pk_bf16_f32 v190, v115, v119
    s_mov_b64 exec, -1
    s_waitcnt lgkmcnt(0)
    s_mov_b32 s3, 1838592
    buffer_load_dwordx4 v[248:251], v12, s[28:31], s3 offen
    s_mov_b32 s3, 1969920
    buffer_load_dwordx4 v[252:255], v12, s[28:31], s3 offen
    v_mfma_f32_16x16x32_bf16 v[104:107], v[48:51], v[124:127], 0
    v_mfma_f32_16x16x32_bf16 v[108:111], v[52:55], v[124:127], 0
    v_mfma_f32_16x16x32_bf16 v[112:115], v[56:59], v[124:127], 0
    v_mfma_f32_16x16x32_bf16 v[116:119], v[60:63], v[124:127], 0
    s_nop 5
    v_cvt_pk_bf16_f32 v179, v104, v108
    v_cvt_pk_bf16_f32 v183, v105, v109
    v_cvt_pk_bf16_f32 v187, v106, v110
    v_cvt_pk_bf16_f32 v191, v107, v111
    s_mov_b64 exec, s[36:37]
    v_cvt_pk_bf16_f32 v179, v112, v116
    v_cvt_pk_bf16_f32 v183, v113, v117
    v_cvt_pk_bf16_f32 v187, v114, v118
    v_cvt_pk_bf16_f32 v191, v115, v119
    s_mov_b64 exec, -1
    s_branch L_sp_tj
L_sp_t1:
    s_waitcnt vmcnt(6)
    s_barrier
    ds_read_b64_tr_b16 v[64:65], v10 offset:0
    ds_read_b64_tr_b16 v[66:67], v10 offset:512
    ds_read_b64_tr_b16 v[68:69], v10 offset:1024
    ds_read_b64_tr_b16 v[70:71], v10 offset:1536
    ds_read_b64_tr_b16 v[72:73], v10 offset:2048
    ds_read_b64_tr_b16 v[74:75], v10 offset:2560
    ds_read_b64_tr_b16 v[76:77], v10 offset:3072
    ds_read_b64_tr_b16 v[78:79], v10 offset:3584
    s_waitcnt lgkmcnt(4)
    v_mfma_f32_16x16x32_bf16 v[88:91], v[64:67], v[32:35], 0
    v_mfma_f32_16x16x32_bf16 v[92:95], v[64:67], v[40:43], 0
    v_mfma_f32_16x16x32_bf16 v[88:91], v[68:71], v[36:39], v[88:91]
    v_mfma_f32_16x16x32_bf16 v[92:95], v[68:71], v[44:47], v[92:95]
    v_mfma_f32_16x16x32_bf16 v[112:115], v[64:67], v[64:67], 0
    v_mfma_f32_16x16x32_bf16 v[112:115], v[68:71], v[68:71], v[112:115]
    s_waitcnt lgkmcnt(0)
    s_waitcnt vmcnt(4)
    s_barrier
    ds_read_b64_tr_b16 v[64:65], v10 offset:4096
    ds_read_b64_tr_b16 v[66:67], v10 offset:4608
    ds_read_b64_tr_b16 v[68:69], v10 offset:5120
    ds_read_b64_tr_b16 v[70:71], v10 offset:5632
    s_add_u32 s3, s85, 32768
    s_add_u32 m0, s84, 16384
    s_nop 0
    buffer_load_dwordx4 v8, s[8:11], s3 offen lds
    v_mul_f32 v80, v92, v20
    v_mul_f32 v84, v88, v20
    v_mfma_f32_16x16x32_bf16 v[96:99], v[72:75], v[32:35], 0
    v_mul_f32 v81, v93, v21
    v_mul_f32 v85, v89, v21
    v_mul_f32 v82, v94, v22
    v_mul_f32 v86, v90, v22
    v_mfma_f32_16x16x32_bf16 v[100:103], v[72:75], v[40:43], 0
    v_mul_f32 v83, v95, v23
    v_mul_f32 v87, v91, v23
    v_fma_f32 v88, v88, v16, -v80
    v_fma_f32 v92, v92, v16, v84
    v_mfma_f32_16x16x32_bf16 v[96:99], v[76:79], v[36:39], v[96:99]
    v_fma_f32 v89, v89, v17, -v81
    v_fma_f32 v93, v93, v17, v85
    v_fma_f32 v90, v90, v18, -v82
    v_fma_f32 v94, v94, v18, v86
    v_fma_f32 v91, v91, v19, -v83
    v_mfma_f32_16x16x32_bf16 v[100:103], v[76:79], v[44:47], v[100:103]
    v_fma_f32 v95, v95, v19, v87
    v_cvt_pk_bf16_f32 v120, v88, v92
    v_cvt_pk_bf16_f32 v121, v89, v93
    v_cvt_pk_bf16_f32 v122, v90, v94
    v_mfma_f32_16x16x32_bf16 v[116:119], v[72:75], v[72:75], 0
    v_cvt_pk_bf16_f32 v123, v91, v95
    v_mul_f32 v28, v24, v112
    v_fmac_f32 v28, v25, v113
    v_fmac_f32 v28, v26, v114
    v_mfma_f32_16x16x32_bf16 v[116:119], v[76:79], v[76:79], v[116:119]
    v_fmac_f32 v28, v27, v115
    ds_write_b32 v30, v28 offset:0
    s_waitcnt lgkmcnt(0)
    ds_read_b64_tr_b16 v[72:73], v10 offset:6144
    ds_read_b64_tr_b16 v[74:75], v10 offset:6656
    ds_read_b64_tr_b16 v[76:77], v10 offset:7168
    ds_read_b64_tr_b16 v[78:79], v10 offset:7680
    s_add_u32 s3, s85, 557056
    s_add_u32 m0, s84, 18432
    s_nop 0
    buffer_load_dwordx4 v8, s[8:11], s3 offen lds
    v_mul_f32 v80, v100, v20
    v_mul_f32 v84, v96, v20
    v_mfma_f32_16x16x32_bf16 v[104:107], v[48:51], v[120:123], 0
    v_mul_f32 v81, v101, v21
    v_mul_f32 v85, v97, v21
    v_mul_f32 v82, v102, v22
    v_mfma_f32_16x16x32_bf16 v[108:111], v[52:55], v[120:123], 0
    v_mul_f32 v86, v98, v22
    v_mul_f32 v83, v103, v23
    v_mul_f32 v87, v99, v23
    v_fma_f32 v96, v96, v16, -v80
    v_mfma_f32_16x16x32_bf16 v[88:91], v[64:67], v[32:35], 0
    v_fma_f32 v100, v100, v16, v84
    v_fma_f32 v97, v97, v17, -v81
    v_fma_f32 v101, v101, v17, v85
    v_fma_f32 v98, v98, v18, -v82
    v_mfma_f32_16x16x32_bf16 v[92:95], v[64:67], v[40:43], 0
    v_fma_f32 v102, v102, v18, v86
    v_fma_f32 v99, v99, v19, -v83
    v_fma_f32 v103, v103, v19, v87
    v_mfma_f32_16x16x32_bf16 v[88:91], v[68:71], v[36:39], v[88:91]
    v_cvt_pk_bf16_f32 v124, v96, v100
    v_cvt_pk_bf16_f32 v125, v97, v101
    v_cvt_pk_bf16_f32 v126, v98, v102
    v_cvt_pk_bf16_f32 v127, v99, v103
    v_mfma_f32_16x16x32_bf16 v[92:95], v[68:71], v[44:47], v[92:95]
    v_mul_f32 v29, v24, v116
    v_fmac_f32 v29, v25, v117
    v_fmac_f32 v29, v26, v118
    v_fmac_f32 v29, v27, v119
    v_mfma_f32_16x16x32_bf16 v[112:115], v[64:67], v[64:67], 0
    ds_write_b32 v30, v29 offset:256
    v_cvt_pk_bf16_f32 v128, v104, v108
    v_cvt_pk_bf16_f32 v132, v105, v109
    v_mfma_f32_16x16x32_bf16 v[112:115], v[68:71], v[68:71], v[112:115]
    v_cvt_pk_bf16_f32 v136, v106, v110
    v_cvt_pk_bf16_f32 v140, v107, v111
    s_waitcnt lgkmcnt(0)
    s_waitcnt vmcnt(4)
    s_barrier
    ds_read_b64_tr_b16 v[64:65], v10 offset:8192
    ds_read_b64_tr_b16 v[66:67], v10 offset:8704
    ds_read_b64_tr_b16 v[68:69], v10 offset:9216
    ds_read_b64_tr_b16 v[70:71], v10 offset:9728
    s_add_u32 s3, s85, 1081344
    s_add_u32 m0, s84, 20480
    s_nop 0
    buffer_load_dwordx4 v8, s[8:11], s3 offen lds
    v_mul_f32 v80, v92, v20
    v_mul_f32 v84, v88, v20
    v_mfma_f32_16x16x32_bf16 v[104:107], v[48:51], v[124:127], 0
    v_mul_f32 v81, v93, v21
    v_mul_f32 v85, v89, v21
    v_mul_f32 v82, v94, v22
    v_mfma_f32_16x16x32_bf16 v[108:111], v[52:55], v[124:127], 0
    v_mul_f32 v86, v90, v22
    v_mul_f32 v83, v95, v23
    v_mul_f32 v87, v91, v23
    v_fma_f32 v88, v88, v16, -v80
    v_mfma_f32_16x16x32_bf16 v[96:99], v[72:75], v[32:35], 0
    v_fma_f32 v92, v92, v16, v84
    v_fma_f32 v89, v89, v17, -v81
    v_fma_f32 v93, v93, v17, v85
    v_fma_f32 v90, v90, v18, -v82
    v_mfma_f32_16x16x32_bf16 v[100:103], v[72:75], v[40:43], 0
    v_fma_f32 v94, v94, v18, v86
    v_fma_f32 v91, v91, v19, -v83
    v_fma_f32 v95, v95, v19, v87
    v_mfma_f32_16x16x32_bf16 v[96:99], v[76:79], v[36:39], v[96:99]
    v_cvt_pk_bf16_f32 v120, v88, v92
    v_cvt_pk_bf16_f32 v121, v89, v93
    v_cvt_pk_bf16_f32 v122, v90, v94
    v_cvt_pk_bf16_f32 v123, v91, v95
    v_mfma_f32_16x16x32_bf16 v[100:103], v[76:79], v[44:47], v[100:103]
    v_mul_f32 v28, v24, v112
    v_fmac_f32 v28, v25, v113
    v_fmac_f32 v28, v26, v114
    v_fmac_f32 v28, v27, v115
    v_mfma_f32_16x16x32_bf16 v[116:119], v[72:75], v[72:75], 0
    ds_write_b32 v30, v28 offset:512
    v_cvt_pk_bf16_f32 v129, v104, v108
    v_cvt_pk_bf16_f32 v133, v105, v109
    v_mfma_f32_16x16x32_bf16 v[116:119], v[76:79], v[76:79], v[116:119]
    v_cvt_pk_bf16_f32 v137, v106, v110
    v_cvt_pk_bf16_f32 v141, v107, v111
    s_waitcnt lgkmcnt(0)
    ds_read_b64_tr_b16 v[72:73], v10 offset:10240
    ds_read_b64_tr_b16 v[74:75], v10 offset:10752
    ds_read_b64_tr_b16 v[76:77], v10 offset:11264
    ds_read_b64_tr_b16 v[78:79], v10 offset:11776
    s_add_u32 s3, s85, 1605632
    s_add_u32 m0, s84, 22528
    s_nop 0
    buffer_load_dwordx4 v8, s[8:11], s3 offen lds
    v_mul_f32 v80, v100, v20
    v_mul_f32 v84, v96, v20
    v_mfma_f32_16x16x32_bf16 v[104:107], v[48:51], v[120:123], 0
    v_mul_f32 v81, v101, v21
    v_mul_f32 v85, v97, v21
    v_mul_f32 v82, v102, v22
    v_mfma_f32_16x16x32_bf16 v[108:111], v[52:55], v[120:123], 0
    v_mul_f32 v86, v98, v22
    v_mul_f32 v83, v103, v23
    v_mul_f32 v87, v99, v23
    v_fma_f32 v96, v96, v16, -v80
    v_mfma_f32_16x16x32_bf16 v[88:91], v[64:67], v[32:35], 0
    v_fma_f32 v100, v100, v16, v84
    v_fma_f32 v97, v97, v17, -v81
    v_fma_f32 v101, v101, v17, v85
    v_fma_f32 v98, v98, v18, -v82
    v_mfma_f32_16x16x32_bf16 v[92:95], v[64:67], v[40:43], 0
    v_fma_f32 v102, v102, v18, v86
    v_fma_f32 v99, v99, v19, -v83
    v_fma_f32 v103, v103, v19, v87
    v_mfma_f32_16x16x32_bf16 v[88:91], v[68:71], v[36:39], v[88:91]
    v_cvt_pk_bf16_f32 v124, v96, v100
    v_cvt_pk_bf16_f32 v125, v97, v101
    v_cvt_pk_bf16_f32 v126, v98, v102
    v_cvt_pk_bf16_f32 v127, v99, v103
    v_mfma_f32_16x16x32_bf16 v[92:95], v[68:71], v[44:47], v[92:95]
    v_mul_f32 v29, v24, v116
    v_fmac_f32 v29, v25, v117
    v_fmac_f32 v29, v26, v118
    v_fmac_f32 v29, v27, v119
    v_mfma_f32_16x16x32_bf16 v[112:115], v[64:67], v[64:67], 0
    ds_write_b32 v30, v29 offset:768
    v_cvt_pk_bf16_f32 v130, v104, v108
    v_cvt_pk_bf16_f32 v134, v105, v109
    v_mfma_f32_16x16x32_bf16 v[112:115], v[68:71], v[68:71], v[112:115]
    v_cvt_pk_bf16_f32 v138, v106, v110
    v_cvt_pk_bf16_f32 v142, v107, v111
    s_waitcnt lgkmcnt(0)
    s_waitcnt vmcnt(4)
    s_barrier
    ds_read_b64_tr_b16 v[64:65], v10 offset:12288
    ds_read_b64_tr_b16 v[66:67], v10 offset:12800
    ds_read_b64_tr_b16 v[68:69], v10 offset:13312
    ds_read_b64_tr_b16 v[70:71], v10 offset:13824
    s_add_u32 s3, s85, 2129920
    s_add_u32 m0, s84, 24576
    s_nop 0
    buffer_load_dwordx4 v8, s[8:11], s3 offen lds
    v_mul_f32 v80, v92, v20
    v_mul_f32 v84, v88, v20
    v_mfma_f32_16x16x32_bf16 v[104:107], v[48:51], v[124:127], 0
    v_mul_f32 v81, v93, v21
    v_mul_f32 v85, v89, v21
    v_mul_f32 v82, v94, v22
    v_mfma_f32_16x16x32_bf16 v[108:111], v[52:55], v[124:127], 0
    v_mul_f32 v86, v90, v22
    v_mul_f32 v83, v95, v23
    v_mul_f32 v87, v91, v23
    v_fma_f32 v88, v88, v16, -v80
    v_mfma_f32_16x16x32_bf16 v[96:99], v[72:75], v[32:35], 0
    v_fma_f32 v92, v92, v16, v84
    v_fma_f32 v89, v89, v17, -v81
    v_fma_f32 v93, v93, v17, v85
    v_fma_f32 v90, v90, v18, -v82
    v_mfma_f32_16x16x32_bf16 v[100:103], v[72:75], v[40:43], 0
    v_fma_f32 v94, v94, v18, v86
    v_fma_f32 v91, v91, v19, -v83
    v_fma_f32 v95, v95, v19, v87
    v_mfma_f32_16x16x32_bf16 v[96:99], v[76:79], v[36:39], v[96:99]
    v_cvt_pk_bf16_f32 v120, v88, v92
    v_cvt_pk_bf16_f32 v121, v89, v93
    v_cvt_pk_bf16_f32 v122, v90, v94
    v_cvt_pk_bf16_f32 v123, v91, v95
    v_mfma_f32_16x16x32_bf16 v[100:103], v[76:79], v[44:47], v[100:103]
    v_mul_f32 v28, v24, v112
    v_fmac_f32 v28, v25, v113
    v_fmac_f32 v28, v26, v114
    v_fmac_f32 v28, v27, v115
    v_mfma_f32_16x16x32_bf16 v[116:119], v[72:75], v[72:75], 0
    ds_write_b32 v30, v28 offset:1024
    v_cvt_pk_bf16_f32 v131, v104, v108
    v_cvt_pk_bf16_f32 v135, v105, v109
    v_mfma_f32_16x16x32_bf16 v[116:119], v[76:79], v[76:79], v[116:119]
    v_cvt_pk_bf16_f32 v139, v106, v110
    v_cvt_pk_bf16_f32 v143, v107, v111
    s_waitcnt lgkmcnt(0)
    ds_read_b64_tr_b16 v[72:73], v10 offset:14336
    ds_read_b64_tr_b16 v[74:75], v10 offset:14848
    ds_read_b64_tr_b16 v[76:77], v10 offset:15360
    ds_read_b64_tr_b16 v[78:79], v10 offset:15872
    s_add_u32 s3, s85, 2654208
    s_add_u32 m0, s84, 26624
    s_nop 0
    buffer_load_dwordx4 v8, s[8:11], s3 offen lds
    v_mul_f32 v80, v100, v20
    v_mul_f32 v84, v96, v20
    v_mfma_f32_16x16x32_bf16 v[104:107], v[48:51], v[120:123], 0
    v_mul_f32 v81, v101, v21
    v_mul_f32 v85, v97, v21
    v_mul_f32 v82, v102, v22
    v_mfma_f32_16x16x32_bf16 v[108:111], v[52:55], v[120:123], 0
    v_mul_f32 v86, v98, v22
    v_mul_f32 v83, v103, v23
    v_mul_f32 v87, v99, v23
    v_fma_f32 v96, v96, v16, -v80
    v_mfma_f32_16x16x32_bf16 v[88:91], v[64:67], v[32:35], 0
    v_fma_f32 v100, v100, v16, v84
    v_fma_f32 v97, v97, v17, -v81
    v_fma_f32 v101, v101, v17, v85
    v_fma_f32 v98, v98, v18, -v82
    v_mfma_f32_16x16x32_bf16 v[92:95], v[64:67], v[40:43], 0
    v_fma_f32 v102, v102, v18, v86
    v_fma_f32 v99, v99, v19, -v83
    v_fma_f32 v103, v103, v19, v87
    v_mfma_f32_16x16x32_bf16 v[88:91], v[68:71], v[36:39], v[88:91]
    v_cvt_pk_bf16_f32 v124, v96, v100
    v_cvt_pk_bf16_f32 v125, v97, v101
    v_cvt_pk_bf16_f32 v126, v98, v102
    v_cvt_pk_bf16_f32 v127, v99, v103
    v_mfma_f32_16x16x32_bf16 v[92:95], v[68:71], v[44:47], v[92:95]
    v_mul_f32 v29, v24, v116
    v_fmac_f32 v29, v25, v117
    v_fmac_f32 v29, v26, v118
    v_fmac_f32 v29, v27, v119
    v_mfma_f32_16x16x32_bf16 v[112:115], v[64:67], v[64:67], 0
    ds_write_b32 v30, v29 offset:1280
    v_cvt_pk_bf16_f32 v144, v104, v108
    v_cvt_pk_bf16_f32 v148, v105, v109
    v_mfma_f32_16x16x32_bf16 v[112:115], v[68:71], v[68:71], v[112:115]
    v_cvt_pk_bf16_f32 v152, v106, v110
    v_cvt_pk_bf16_f32 v156, v107, v111
    s_waitcnt lgkmcnt(0)
    s_waitcnt vmcnt(4)
    s_barrier
    ds_read_b64_tr_b16 v[64:65], v10 offset:16384
    ds_read_b64_tr_b16 v[66:67], v10 offset:16896
    ds_read_b64_tr_b16 v[68:69], v10 offset:17408
    ds_read_b64_tr_b16 v[70:71], v10 offset:17920
    s_add_u32 s3, s85, 3178496
    s_add_u32 m0, s84, 28672
    s_nop 0
    buffer_load_dwordx4 v8, s[8:11], s3 offen lds
    v_mul_f32 v80, v92, v20
    v_mul_f32 v84, v88, v20
    v_mfma_f32_16x16x32_bf16 v[104:107], v[48:51], v[124:127], 0
    v_mul_f32 v81, v93, v21
    v_mul_f32 v85, v89, v21
    v_mul_f32 v82, v94, v22
    v_mfma_f32_16x16x32_bf16 v[108:111], v[52:55], v[124:127], 0
    v_mul_f32 v86, v90, v22
    v_mul_f32 v83, v95, v23
    v_mul_f32 v87, v91, v23
    v_fma_f32 v88, v88, v16, -v80
    v_mfma_f32_16x16x32_bf16 v[96:99], v[72:75], v[32:35], 0
    v_fma_f32 v92, v92, v16, v84
    v_fma_f32 v89, v89, v17, -v81
    v_fma_f32 v93, v93, v17, v85
    v_fma_f32 v90, v90, v18, -v82
    v_mfma_f32_16x16x32_bf16 v[100:103], v[72:75], v[40:43], 0
    v_fma_f32 v94, v94, v18, v86
    v_fma_f32 v91, v91, v19, -v83
    v_fma_f32 v95, v95, v19, v87
    v_mfma_f32_16x16x32_bf16 v[96:99], v[76:79], v[36:39], v[96:99]
    v_cvt_pk_bf16_f32 v120, v88, v92
    v_cvt_pk_bf16_f32 v121, v89, v93
    v_cvt_pk_bf16_f32 v122, v90, v94
    v_cvt_pk_bf16_f32 v123, v91, v95
    v_mfma_f32_16x16x32_bf16 v[100:103], v[76:79], v[44:47], v[100:103]
    v_mul_f32 v28, v24, v112
    v_fmac_f32 v28, v25, v113
    v_fmac_f32 v28, v26, v114
    v_fmac_f32 v28, v27, v115
    v_mfma_f32_16x16x32_bf16 v[116:119], v[72:75], v[72:75], 0
    ds_write_b32 v30, v28 offset:1536
    v_cvt_pk_bf16_f32 v145, v104, v108
    v_cvt_pk_bf16_f32 v149, v105, v109
    v_mfma_f32_16x16x32_bf16 v[116:119], v[76:79], v[76:79], v[116:119]
    v_cvt_pk_bf16_f32 v153, v106, v110
    v_cvt_pk_bf16_f32 v157, v107, v111
    s_waitcnt lgkmcnt(0)
    ds_read_b64_tr_b16 v[72:73], v10 offset:18432
    ds_read_b64_tr_b16 v[74:75], v10 offset:18944
    ds_read_b64_tr_b16 v[76:77], v10 offset:19456
    ds_read_b64_tr_b16 v[78:79], v10 offset:19968
    s_add_u32 s3, s85, 3702784
    s_add_u32 m0, s84, 30720
    s_nop 0
    buffer_load_dwordx4 v8, s[8:11], s3 offen lds
    v_mul_f32 v80, v100, v20
    v_mul_f32 v84, v96, v20
    v_mfma_f32_16x16x32_bf16 v[104:107], v[48:51], v[120:123], 0
    v_mul_f32 v81, v101, v21
    v_mul_f32 v85, v97, v21
    v_mul_f32 v82, v102, v22
    v_mfma_f32_16x16x32_bf16 v[108:111], v[52:55], v[120:123], 0
    v_mul_f32 v86, v98, v22
    v_mul_f32 v83, v103, v23
    v_mul_f32 v87, v99, v23
    v_fma_f32 v96, v96, v16, -v80
    v_mfma_f32_16x16x32_bf16 v[88:91], v[64:67], v[32:35], 0
    v_fma_f32 v100, v100, v16, v84
    v_fma_f32 v97, v97, v17, -v81
    v_fma_f32 v101, v101, v17, v85
    v_fma_f32 v98, v98, v18, -v82
    v_mfma_f32_16x16x32_bf16 v[92:95], v[64:67], v[40:43], 0
    v_fma_f32 v102, v102, v18, v86
    v_fma_f32 v99, v99, v19, -v83
    v_fma_f32 v103, v103, v19, v87
    v_mfma_f32_16x16x32_bf16 v[88:91], v[68:71], v[36:39], v[88:91]
    v_cvt_pk_bf16_f32 v124, v96, v100
    v_cvt_pk_bf16_f32 v125, v97, v101
    v_cvt_pk_bf16_f32 v126, v98, v102
    v_cvt_pk_bf16_f32 v127, v99, v103
    v_mfma_f32_16x16x32_bf16 v[92:95], v[68:71], v[44:47], v[92:95]
    v_mul_f32 v29, v24, v116
    v_fmac_f32 v29, v25, v117
    v_fmac_f32 v29, v26, v118
    v_fmac_f32 v29, v27, v119
    v_mfma_f32_16x16x32_bf16 v[112:115], v[64:67], v[64:67], 0
    ds_write_b32 v30, v29 offset:1792
    v_cvt_pk_bf16_f32 v146, v104, v108
    v_cvt_pk_bf16_f32 v150, v105, v109
    v_mfma_f32_16x16x32_bf16 v[112:115], v[68:71], v[68:71], v[112:115]
    v_cvt_pk_bf16_f32 v154, v106, v110
    v_cvt_pk_bf16_f32 v158, v107, v111
    s_waitcnt lgkmcnt(0)
    s_waitcnt vmcnt(4)
    s_barrier
    ds_read_b64_tr_b16 v[64:65], v10 offset:20480
    ds_read_b64_tr_b16 v[66:67], v10 offset:20992
    ds_read_b64_tr_b16 v[68:69], v10 offset:21504
    ds_read_b64_tr_b16 v[70:71], v10 offset:22016
    buffer_load_dword v31, off, s[40:43], 0 offset:8 sc1
    v_mul_f32 v80, v92, v20
    v_mul_f32 v84, v88, v20
    v_mfma_f32_16x16x32_bf16 v[104:107], v[48:51], v[124:127], 0
    v_mul_f32 v81, v93, v21
    v_mul_f32 v85, v89, v21
    v_mul_f32 v82, v94, v22
    v_mfma_f32_16x16x32_bf16 v[108:111], v[52:55], v[124:127], 0
    v_mul_f32 v86, v90, v22
    v_mul_f32 v83, v95, v23
    v_mul_f32 v87, v91, v23
    v_fma_f32 v88, v88, v16, -v80
    v_mfma_f32_16x16x32_bf16 v[96:99], v[72:75], v[32:35], 0
    v_fma_f32 v92, v92, v16, v84
    v_fma_f32 v89, v89, v17, -v81
    v_fma_f32 v93, v93, v17, v85
    v_fma_f32 v90, v90, v18, -v82
    v_mfma_f32_16x16x32_bf16 v[100:103], v[72:75], v[40:43], 0
    v_fma_f32 v94, v94, v18, v86
    v_fma_f32 v91, v91, v19, -v83
    v_fma_f32 v95, v95, v19, v87
    v_mfma_f32_16x16x32_bf16 v[96:99], v[76:79], v[36:39], v[96:99]
    v_cvt_pk_bf16_f32 v120, v88, v92
    v_cvt_pk_bf16_f32 v121, v89, v93
    v_cvt_pk_bf16_f32 v122, v90, v94
    v_cvt_pk_bf16_f32 v123, v91, v95
    v_mfma_f32_16x16x32_bf16 v[100:103], v[76:79], v[44:47], v[100:103]
    v_mul_f32 v28, v24, v112
    v_fmac_f32 v28, v25, v113
    v_fmac_f32 v28, v26, v114
    v_fmac_f32 v28, v27, v115
    v_mfma_f32_16x16x32_bf16 v[116:119], v[72:75], v[72:75], 0
    ds_write_b32 v30, v28 offset:2048
    v_cvt_pk_bf16_f32 v147, v104, v108
    v_cvt_pk_bf16_f32 v151, v105, v109
    v_mfma_f32_16x16x32_bf16 v[116:119], v[76:79], v[76:79], v[116:119]
    v_cvt_pk_bf16_f32 v155, v106, v110
    v_cvt_pk_bf16_f32 v159, v107, v111
    s_waitcnt lgkmcnt(0)
    ds_read_b64_tr_b16 v[72:73], v10 offset:22528
    ds_read_b64_tr_b16 v[74:75], v10 offset:23040
    ds_read_b64_tr_b16 v[76:77], v10 offset:23552
    ds_read_b64_tr_b16 v[78:79], v10 offset:24064
    s_mov_b32 s3, 0
    buffer_load_dwordx4 v[192:195], v12, s[28:31], s3 offen
    s_mov_b32 s3, 131328
    buffer_load_dwordx4 v[196:199], v12, s[28:31], s3 offen
    v_mul_f32 v80, v100, v20
    v_mul_f32 v84, v96, v20
    v_mfma_f32_16x16x32_bf16 v[104:107], v[48:51], v[120:123], 0
    v_mul_f32 v81, v101, v21
    v_mul_f32 v85, v97, v21
    v_mul_f32 v82, v102, v22
    v_mfma_f32_16x16x32_bf16 v[108:111], v[52:55], v[120:123], 0
    v_mul_f32 v86, v98, v22
    v_mul_f32 v83, v103, v23
    v_mul_f32 v87, v99, v23
    v_fma_f32 v96, v96, v16, -v80
    v_mfma_f32_16x16x32_bf16 v[88:91], v[64:67], v[32:35], 0
    v_fma_f32 v100, v100, v16, v84
    v_fma_f32 v97, v97, v17, -v81
    v_fma_f32 v101, v101, v17, v85
    v_fma_f32 v98, v98, v18, -v82
    v_mfma_f32_16x16x32_bf16 v[92:95], v[64:67], v[40:43], 0
    v_fma_f32 v102, v102, v18, v86
    v_fma_f32 v99, v99, v19, -v83
    v_fma_f32 v103, v103, v19, v87
    v_mfma_f32_16x16x32_bf16 v[88:91], v[68:71], v[36:39], v[88:91]
    v_cvt_pk_bf16_f32 v124, v96, v100
    v_cvt_pk_bf16_f32 v125, v97, v101
    v_cvt_pk_bf16_f32 v126, v98, v102
    v_cvt_pk_bf16_f32 v127, v99, v103
    v_mfma_f32_16x16x32_bf16 v[92:95], v[68:71], v[44:47], v[92:95]
    v_mul_f32 v29, v24, v116
    v_fmac_f32 v29, v25, v117
    v_fmac_f32 v29, v26, v118
    v_fmac_f32 v29, v27, v119
    v_mfma_f32_16x16x32_bf16 v[112:115], v[64:67], v[64:67], 0
    ds_write_b32 v30, v29 offset:2304
    v_cvt_pk_bf16_f32 v160, v104, v108
    v_cvt_pk_bf16_f32 v164, v105, v109
    v_mfma_f32_16x16x32_bf16 v[112:115], v[68:71], v[68:71], v[112:115]
    v_cvt_pk_bf16_f32 v168, v106, v110
    v_cvt_pk_bf16_f32 v172, v107, v111
    s_waitcnt lgkmcnt(0)
    s_waitcnt vmcnt(5)
    s_barrier
    ds_read_b64_tr_b16 v[64:65], v10 offset:24576
    ds_read_b64_tr_b16 v[66:67], v10 offset:25088
    ds_read_b64_tr_b16 v[68:69], v10 offset:25600
    ds_read_b64_tr_b16 v[70:71], v10 offset:26112
    s_mov_b32 s3, 262656
    buffer_load_dwordx4 v[200:203], v12, s[28:31], s3 offen
    s_mov_b32 s3, 393984
    buffer_load_dwordx4 v[204:207], v12, s[28:31], s3 offen
    v_mul_f32 v80, v92, v20
    v_mul_f32 v84, v88, v20
    v_mfma_f32_16x16x32_bf16 v[104:107], v[48:51], v[124:127], 0
    v_mul_f32 v81, v93, v21
    v_mul_f32 v85, v89, v21
    v_mul_f32 v82, v94, v22
    v_mfma_f32_16x16x32_bf16 v[108:111], v[52:55], v[124:127], 0
    v_mul_f32 v86, v90, v22
    v_mul_f32 v83, v95, v23
    v_mul_f32 v87, v91, v23
    v_fma_f32 v88, v88, v16, -v80
    v_mfma_f32_16x16x32_bf16 v[96:99], v[72:75], v[32:35], 0
    v_fma_f32 v92, v92, v16, v84
    v_fma_f32 v89, v89, v17, -v81
    v_fma_f32 v93, v93, v17, v85
    v_fma_f32 v90, v90, v18, -v82
    v_mfma_f32_16x16x32_bf16 v[100:103], v[72:75], v[40:43], 0
    v_fma_f32 v94, v94, v18, v86
    v_fma_f32 v91, v91, v19, -v83
    v_fma_f32 v95, v95, v19, v87
    v_mfma_f32_16x16x32_bf16 v[96:99], v[76:79], v[36:39], v[96:99]
    v_cvt_pk_bf16_f32 v120, v88, v92
    v_cvt_pk_bf16_f32 v121, v89, v93
    v_cvt_pk_bf16_f32 v122, v90, v94
    v_cvt_pk_bf16_f32 v123, v91, v95
    v_mfma_f32_16x16x32_bf16 v[100:103], v[76:79], v[44:47], v[100:103]
    v_mul_f32 v28, v24, v112
    v_fmac_f32 v28, v25, v113
    v_fmac_f32 v28, v26, v114
    v_fmac_f32 v28, v27, v115
    v_mfma_f32_16x16x32_bf16 v[116:119], v[72:75], v[72:75], 0
    ds_write_b32 v30, v28 offset:2560
    v_cvt_pk_bf16_f32 v161, v104, v108
    v_cvt_pk_bf16_f32 v165, v105, v109
    v_mfma_f32_16x16x32_bf16 v[116:119], v[76:79], v[76:79], v[116:119]
    v_cvt_pk_bf16_f32 v169, v106, v110
    v_cvt_pk_bf16_f32 v173, v107, v111
    s_waitcnt lgkmcnt(0)
    ds_read_b64_tr_b16 v[72:73], v10 offset:26624
    ds_read_b64_tr_b16 v[74:75], v10 offset:27136
    ds_read_b64_tr_b16 v[76:77], v10 offset:27648
    ds_read_b64_tr_b16 v[78:79], v10 offset:28160
    s_mov_b32 s3, 525312
    buffer_load_dwordx4 v[208:211], v12, s[28:31], s3 offen
    s_mov_b32 s3, 656640
    buffer_load_dwordx4 v[212:215], v12, s[28:31], s3 offen
    v_mul_f32 v80, v100, v20
    v_mul_f32 v84, v96, v20
    v_mfma_f32_16x16x32_bf16 v[104:107], v[48:51], v[120:123], 0
    v_mul_f32 v81, v101, v21
    v_mul_f32 v85, v97, v21
    v_mul_f32 v82, v102, v22
    v_mfma_f32_16x16x32_bf16 v[108:111], v[52:55], v[120:123], 0
    v_mul_f32 v86, v98, v22
    v_mul_f32 v83, v103, v23
    v_mul_f32 v87, v99, v23
    v_fma_f32 v96, v96, v16, -v80
    v_mfma_f32_16x16x32_bf16 v[88:91], v[64:67], v[32:35], 0
    v_fma_f32 v100, v100, v16, v84
    v_fma_f32 v97, v97, v17, -v81
    v_fma_f32 v101, v101, v17, v85
    v_fma_f32 v98, v98, v18, -v82
    v_mfma_f32_16x16x32_bf16 v[92:95], v[64:67], v[40:43], 0
    v_fma_f32 v102, v102, v18, v86
    v_fma_f32 v99, v99, v19, -v83
    v_fma_f32 v103, v103, v19, v87
    v_mfma_f32_16x16x32_bf16 v[88:91], v[68:71], v[36:39], v[88:91]
    v_cvt_pk_bf16_f32 v124, v96, v100
    v_cvt_pk_bf16_f32 v125, v97, v101
    v_cvt_pk_bf16_f32 v126, v98, v102
    v_cvt_pk_bf16_f32 v127, v99, v103
    v_mfma_f32_16x16x32_bf16 v[92:95], v[68:71], v[44:47], v[92:95]
    v_mul_f32 v29, v24, v116
    v_fmac_f32 v29, v25, v117
    v_fmac_f32 v29, v26, v118
    v_fmac_f32 v29, v27, v119
    v_mfma_f32_16x16x32_bf16 v[112:115], v[64:67], v[64:67], 0
    ds_write_b32 v30, v29 offset:2816
    v_cvt_pk_bf16_f32 v162, v104, v108
    v_cvt_pk_bf16_f32 v166, v105, v109
    v_mfma_f32_16x16x32_bf16 v[112:115], v[68:71], v[68:71], v[112:115]
    v_cvt_pk_bf16_f32 v170, v106, v110
    v_cvt_pk_bf16_f32 v174, v107, v111
    s_waitcnt lgkmcnt(0)
    s_waitcnt vmcnt(7)
    s_barrier
    ds_read_b64_tr_b16 v[64:65], v10 offset:28672
    ds_read_b64_tr_b16 v[66:67], v10 offset:29184
    ds_read_b64_tr_b16 v[68:69], v10 offset:29696
    ds_read_b64_tr_b16 v[70:71], v10 offset:30208
    s_mov_b32 s3, 787968
    buffer_load_dwordx4 v[216:219], v12, s[28:31], s3 offen
    s_mov_b32 s3, 919296
    buffer_load_dwordx4 v[220:223], v12, s[28:31], s3 offen
    v_mul_f32 v80, v92, v20
    v_mul_f32 v84, v88, v20
    v_mfma_f32_16x16x32_bf16 v[104:107], v[48:51], v[124:127], 0
    v_mul_f32 v81, v93, v21
    v_mul_f32 v85, v89, v21
    v_mul_f32 v82, v94, v22
    v_mfma_f32_16x16x32_bf16 v[108:111], v[52:55], v[124:127], 0
    v_mul_f32 v86, v90, v22
    v_mul_f32 v83, v95, v23
    v_mul_f32 v87, v91, v23
    v_fma_f32 v88, v88, v16, -v80
    v_mfma_f32_16x16x32_bf16 v[96:99], v[72:75], v[32:35], 0
    v_fma_f32 v92, v92, v16, v84
    v_fma_f32 v89, v89, v17, -v81
    v_fma_f32 v93, v93, v17, v85
    v_fma_f32 v90, v90, v18, -v82
    v_mfma_f32_16x16x32_bf16 v[100:103], v[72:75], v[40:43], 0
    v_fma_f32 v94, v94, v18, v86
    v_fma_f32 v91, v91, v19, -v83
    v_fma_f32 v95, v95, v19, v87
    v_mfma_f32_16x16x32_bf16 v[96:99], v[76:79], v[36:39], v[96:99]
    v_cvt_pk_bf16_f32 v120, v88, v92
    v_cvt_pk_bf16_f32 v121, v89, v93
    v_cvt_pk_bf16_f32 v122, v90, v94
    v_cvt_pk_bf16_f32 v123, v91, v95
    v_mfma_f32_16x16x32_bf16 v[100:103], v[76:79], v[44:47], v[100:103]
    v_mul_f32 v28, v24, v112
    v_fmac_f32 v28, v25, v113
    v_fmac_f32 v28, v26, v114
    v_fmac_f32 v28, v27, v115
    v_mfma_f32_16x16x32_bf16 v[116:119], v[72:75], v[72:75], 0
    ds_write_b32 v30, v28 offset:3072
    v_cvt_pk_bf16_f32 v163, v104, v108
    v_cvt_pk_bf16_f32 v167, v105, v109
    v_mfma_f32_16x16x32_bf16 v[116:119], v[76:79], v[76:79], v[116:119]
    v_cvt_pk_bf16_f32 v171, v106, v110
    v_cvt_pk_bf16_f32 v175, v107, v111
    s_waitcnt lgkmcnt(0)
    ds_read_b64_tr_b16 v[72:73], v10 offset:30720
    ds_read_b64_tr_b16 v[74:75], v10 offset:31232
    ds_read_b64_tr_b16 v[76:77], v10 offset:31744
    ds_read_b64_tr_b16 v[78:79], v10 offset:32256
    s_mov_b32 s3, 1050624
    buffer_load_dwordx4 v[224:227], v12, s[28:31], s3 offen
    s_mov_b32 s3, 1181952
    buffer_load_dwordx4 v[228:231], v12, s[28:31], s3 offen
    v_mul_f32 v80, v100, v20
    v_mul_f32 v84, v96, v20
    v_mfma_f32_16x16x32_bf16 v[104:107], v[48:51], v[120:123], 0
    v_mul_f32 v81, v101, v21
    v_mul_f32 v85, v97, v21
    v_mul_f32 v82, v102, v22
    v_mfma_f32_16x16x32_bf16 v[108:111], v[52:55], v[120:123], 0
    v_mul_f32 v86, v98, v22
    v_mul_f32 v83, v103, v23
    v_mul_f32 v87, v99, v23
    v_fma_f32 v96, v96, v16, -v80
    v_mfma_f32_16x16x32_bf16 v[88:91], v[64:67], v[32:35], 0
    v_fma_f32 v100, v100, v16, v84
    v_fma_f32 v97, v97, v17, -v81
    v_fma_f32 v101, v101, v17, v85
    v_fma_f32 v98, v98, v18, -v82
    v_mfma_f32_16x16x32_bf16 v[92:95], v[64:67], v[40:43], 0
    v_fma_f32 v102, v102, v18, v86
    v_fma_f32 v99, v99, v19, -v83
    v_fma_f32 v103, v103, v19, v87
    v_mfma_f32_16x16x32_bf16 v[88:91], v[68:71], v[36:39], v[88:91]
    v_cvt_pk_bf16_f32 v124, v96, v100
    v_cvt_pk_bf16_f32 v125, v97, v101
    v_cvt_pk_bf16_f32 v126, v98, v102
    v_cvt_pk_bf16_f32 v127, v99, v103
    v_mfma_f32_16x16x32_bf16 v[92:95], v[68:71], v[44:47], v[92:95]
    v_mul_f32 v29, v24, v116
    v_fmac_f32 v29, v25, v117
    v_fmac_f32 v29, v26, v118
    v_fmac_f32 v29, v27, v119
    v_mfma_f32_16x16x32_bf16 v[112:115], v[64:67], v[64:67], 0
    ds_write_b32 v30, v29 offset:3328
    v_cvt_pk_bf16_f32 v176, v104, v108
    v_cvt_pk_bf16_f32 v180, v105, v109
    v_mfma_f32_16x16x32_bf16 v[112:115], v[68:71], v[68:71], v[112:115]
    v_cvt_pk_bf16_f32 v184, v106, v110
    v_cvt_pk_bf16_f32 v188, v107, v111
    s_waitcnt lgkmcnt(0)
    s_mov_b32 s3, 1313280
    buffer_load_dwordx4 v[232:235], v12, s[28:31], s3 offen
    s_mov_b32 s3, 1444608
    buffer_load_dwordx4 v[236:239], v12, s[28:31], s3 offen
    v_mul_f32 v80, v92, v20
    v_mul_f32 v84, v88, v20
    v_mfma_f32_16x16x32_bf16 v[104:107], v[48:51], v[124:127], 0
    v_mul_f32 v81, v93, v21
    v_mul_f32 v85, v89, v21
    v_mul_f32 v82, v94, v22
    v_mfma_f32_16x16x32_bf16 v[108:111], v[52:55], v[124:127], 0
    v_mul_f32 v86, v90, v22
    v_mul_f32 v83, v95, v23
    v_mul_f32 v87, v91, v23
    v_fma_f32 v88, v88, v16, -v80
    v_mfma_f32_16x16x32_bf16 v[96:99], v[72:75], v[32:35], 0
    v_fma_f32 v92, v92, v16, v84
    v_fma_f32 v89, v89, v17, -v81
    v_fma_f32 v93, v93, v17, v85
    v_fma_f32 v90, v90, v18, -v82
    v_mfma_f32_16x16x32_bf16 v[100:103], v[72:75], v[40:43], 0
    v_fma_f32 v94, v94, v18, v86
    v_fma_f32 v91, v91, v19, -v83
    v_fma_f32 v95, v95, v19, v87
    v_mfma_f32_16x16x32_bf16 v[96:99], v[76:79], v[36:39], v[96:99]
    v_cvt_pk_bf16_f32 v120, v88, v92
    v_cvt_pk_bf16_f32 v121, v89, v93
    v_cvt_pk_bf16_f32 v122, v90, v94
    v_cvt_pk_bf16_f32 v123, v91, v95
    v_mfma_f32_16x16x32_bf16 v[100:103], v[76:79], v[44:47], v[100:103]
    v_mul_f32 v28, v24, v112
    v_fmac_f32 v28, v25, v113
    v_fmac_f32 v28, v26, v114
    v_fmac_f32 v28, v27, v115
    v_mfma_f32_16x16x32_bf16 v[116:119], v[72:75], v[72:75], 0
    ds_write_b32 v30, v28 offset:3584
    v_cvt_pk_bf16_f32 v177, v104, v108
    v_cvt_pk_bf16_f32 v181, v105, v109
    v_mfma_f32_16x16x32_bf16 v[116:119], v[76:79], v[76:79], v[116:119]
    v_cvt_pk_bf16_f32 v185, v106, v110
    v_cvt_pk_bf16_f32 v189, v107, v111
    s_waitcnt lgkmcnt(0)
    s_mov_b32 s3, 1575936
    buffer_load_dwordx4 v[240:243], v12, s[28:31], s3 offen
    s_mov_b32 s3, 1707264
    buffer_load_dwordx4 v[244:247], v12, s[28:31], s3 offen
    v_mfma_f32_16x16x32_bf16 v[104:107], v[48:51], v[120:123], 0
    v_mfma_f32_16x16x32_bf16 v[108:111], v[52:55], v[120:123], 0
    v_mul_f32 v80, v100, v20
    v_mul_f32 v84, v96, v20
    v_mul_f32 v81, v101, v21
    v_mul_f32 v85, v97, v21
    v_mul_f32 v82, v102, v22
    v_mul_f32 v86, v98, v22
    v_mul_f32 v83, v103, v23
    v_mul_f32 v87, v99, v23
    v_fma_f32 v96, v96, v16, -v80
    v_fma_f32 v100, v100, v16, v84
    v_fma_f32 v97, v97, v17, -v81
    v_fma_f32 v101, v101, v17, v85
    v_fma_f32 v98, v98, v18, -v82
    v_fma_f32 v102, v102, v18, v86
    v_fma_f32 v99, v99, v19, -v83
    v_fma_f32 v103, v103, v19, v87
    v_cvt_pk_bf16_f32 v124, v96, v100
    v_cvt_pk_bf16_f32 v125, v97, v101
    v_cvt_pk_bf16_f32 v126, v98, v102
    v_cvt_pk_bf16_f32 v127, v99, v103
    v_mul_f32 v29, v24, v116
    v_fmac_f32 v29, v25, v117
    v_fmac_f32 v29, v26, v118
    v_fmac_f32 v29, v27, v119
    ds_write_b32 v30, v29 offset:3840
    v_cvt_pk_bf16_f32 v178, v104, v108
    v_cvt_pk_bf16_f32 v182, v105, v109
    v_cvt_pk_bf16_f32 v186, v106, v110
    v_cvt_pk_bf16_f32 v190, v107, v111
    s_waitcnt lgkmcnt(0)
    s_mov_b32 s3, 1838592
    buffer_load_dwordx4 v[248:251], v12, s[28:31], s3 offen
    s_mov_b32 s3, 1969920
    buffer_load_dwordx4 v[252:255], v12, s[28:31], s3 offen
    v_mfma_f32_16x16x32_bf16 v[104:107], v[48:51], v[124:127], 0
    v_mfma_f32_16x16x32_bf16 v[108:111], v[52:55], v[124:127], 0
    s_nop 7
    v_cvt_pk_bf16_f32 v179, v104, v108
    v_cvt_pk_bf16_f32 v183, v105, v109
    v_cvt_pk_bf16_f32 v187, v106, v110
    v_cvt_pk_bf16_f32 v191, v107, v111
L_sp_tj:
    s_waitcnt vmcnt(16) lgkmcnt(0)
    s_mov_b32 s99, 0
L_fl_lnsp:
    v_readfirstlane_b32 s98, v31
    s_cmp_lg_u32 s98, 0
    s_cbranch_scc1 L_fl_ldsp
    s_add_u32 s99, s99, 1
    s_cmp_ge_u32 s99, 0x40000
    s_cbranch_scc1 L_fl_ldsp
    s_sleep 8
    buffer_load_dword v31, off, s[40:43], 0 offset:8 sc1
    s_waitcnt vmcnt(0)
    s_branch L_fl_lnsp
L_fl_ldsp:
    s_barrier
    s_lshl_b32 s3, s49, 12
    s_add_u32 s3, s3, 131072
    v_lshl_add_u32 v5, v2, 10, s3
    v_and_b32 v4, 3, v3
    v_lshl_add_u32 v4, v4, 6, v5
    v_lshrrev_b32 v6, 2, v3
    v_lshl_add_u32 v6, v6, 4, v3
    v_lshl_add_u32 v5, v6, 2, v5
    ds_read_b32 v96, v4 offset:0
    ds_read_b32 v100, v5 offset:16384
    ds_read_b32 v97, v4 offset:256
    ds_read_b32 v101, v5 offset:16640
    ds_read_b32 v98, v4 offset:512
    ds_read_b32 v102, v5 offset:16896
    ds_read_b32 v99, v4 offset:768
    ds_read_b32 v103, v5 offset:17152
    v_lshrrev_b32 v4, 1, v2
    v_lshlrev_b32 v9, 4, v4
    v_and_b32 v6, 1, v2
    v_lshl_add_u32 v9, v6, 10, v9
    v_add_u32 v9, s38, v9
    v_lshrrev_b32 v6, 1, v3
    s_mov_b32 s3, 0x3a000000
    v_add_u32 v7, 0, v9
    v_mul_u32_u24 v7, v7, v6
    v_and_b32 v7, 0x7ff, v7
    v_cvt_f32_u32 v7, v7
    v_mul_f32 v7, s3, v7
    v_cos_f32 v88, v7
    v_sin_f32 v92, v7
    v_add_u32 v7, 256, v9
    v_mul_u32_u24 v7, v7, v6
    v_and_b32 v7, 0x7ff, v7
    v_cvt_f32_u32 v7, v7
    v_mul_f32 v7, s3, v7
    v_cos_f32 v89, v7
    v_sin_f32 v93, v7
    v_add_u32 v7, 512, v9
    v_mul_u32_u24 v7, v7, v6
    v_and_b32 v7, 0x7ff, v7
    v_cvt_f32_u32 v7, v7
    v_mul_f32 v7, s3, v7
    v_cos_f32 v90, v7
    v_sin_f32 v94, v7
    v_add_u32 v7, 768, v9
    v_mul_u32_u24 v7, v7, v6
    v_and_b32 v7, 0x7ff, v7
    v_cvt_f32_u32 v7, v7
    v_mul_f32 v7, s3, v7
    v_cos_f32 v91, v7
    v_sin_f32 v95, v7
    v_and_b32 v7, 1, v3
    v_cmp_eq_u32 vcc, v4, v7
    s_nop 1
    v_cndmask_b32 v14, 0, 1.0, vcc
    s_waitcnt lgkmcnt(0)
    s_barrier
    v_add_f32_dpp v96, v96, v96 quad_perm:[1,0,3,2] row_mask:0xf bank_mask:0xf
    v_add_f32_dpp v97, v97, v97 quad_perm:[1,0,3,2] row_mask:0xf bank_mask:0xf
    v_add_f32_dpp v98, v98, v98 quad_perm:[1,0,3,2] row_mask:0xf bank_mask:0xf
    v_add_f32_dpp v99, v99, v99 quad_perm:[1,0,3,2] row_mask:0xf bank_mask:0xf
    v_add_f32_dpp v100, v100, v100 quad_perm:[1,0,3,2] row_mask:0xf bank_mask:0xf
    v_add_f32_dpp v101, v101, v101 quad_perm:[1,0,3,2] row_mask:0xf bank_mask:0xf
    v_add_f32_dpp v102, v102, v102 quad_perm:[1,0,3,2] row_mask:0xf bank_mask:0xf
    v_add_f32_dpp v103, v103, v103 quad_perm:[1,0,3,2] row_mask:0xf bank_mask:0xf
    v_add_f32_dpp v96, v96, v96 quad_perm:[2,3,0,1] row_mask:0xf bank_mask:0xf
    v_add_f32_dpp v97, v97, v97 quad_perm:[2,3,0,1] row_mask:0xf bank_mask:0xf
    v_add_f32_dpp v98, v98, v98 quad_perm:[2,3,0,1] row_mask:0xf bank_mask:0xf
    v_add_f32_dpp v99, v99, v99 quad_perm:[2,3,0,1] row_mask:0xf bank_mask:0xf
    v_add_f32_dpp v100, v100, v100 quad_perm:[2,3,0,1] row_mask:0xf bank_mask:0xf
    v_add_f32_dpp v101, v101, v101 quad_perm:[2,3,0,1] row_mask:0xf bank_mask:0xf
    v_add_f32_dpp v102, v102, v102 quad_perm:[2,3,0,1] row_mask:0xf bank_mask:0xf
    v_add_f32_dpp v103, v103, v103 quad_perm:[2,3,0,1] row_mask:0xf bank_mask:0xf
    v_add_f32_dpp v100, v100, v100 row_ror:4 row_mask:0xf bank_mask:0xf
    v_add_f32_dpp v101, v101, v101 row_ror:4 row_mask:0xf bank_mask:0xf
    v_add_f32_dpp v102, v102, v102 row_ror:4 row_mask:0xf bank_mask:0xf
    v_add_f32_dpp v103, v103, v103 row_ror:4 row_mask:0xf bank_mask:0xf
    v_add_f32_dpp v100, v100, v100 row_ror:8 row_mask:0xf bank_mask:0xf
    v_add_f32_dpp v101, v101, v101 row_ror:8 row_mask:0xf bank_mask:0xf
    v_add_f32_dpp v102, v102, v102 row_ror:8 row_mask:0xf bank_mask:0xf
    v_add_f32_dpp v103, v103, v103 row_ror:8 row_mask:0xf bank_mask:0xf
    v_permlane32_swap_b32 v128, v160
    v_permlane32_swap_b32 v144, v176
    v_permlane32_swap_b32 v129, v161
    v_permlane32_swap_b32 v145, v177
    v_permlane32_swap_b32 v130, v162
    v_permlane32_swap_b32 v146, v178
    v_permlane32_swap_b32 v131, v163
    v_permlane32_swap_b32 v147, v179
    v_permlane32_swap_b32 v132, v164
    v_permlane32_swap_b32 v148, v180
    v_permlane32_swap_b32 v133, v165
    v_permlane32_swap_b32 v149, v181
    v_permlane32_swap_b32 v134, v166
    v_permlane32_swap_b32 v150, v182
    v_permlane32_swap_b32 v135, v167
    v_permlane32_swap_b32 v151, v183
    v_permlane32_swap_b32 v136, v168
    v_permlane32_swap_b32 v152, v184
    v_permlane32_swap_b32 v137, v169
    v_permlane32_swap_b32 v153, v185
    v_permlane32_swap_b32 v138, v170
    v_permlane32_swap_b32 v154, v186
    v_permlane32_swap_b32 v139, v171
    v_permlane32_swap_b32 v155, v187
    v_permlane32_swap_b32 v140, v172
    v_permlane32_swap_b32 v156, v188
    v_permlane32_swap_b32 v141, v173
    v_permlane32_swap_b32 v157, v189
    v_permlane32_swap_b32 v142, v174
    v_permlane32_swap_b32 v158, v190
    v_permlane32_swap_b32 v143, v175
    v_permlane32_swap_b32 v159, v191
    s_lshl_b32 s4, s44, 12
    s_add_u32 s3, s4, 16384
    s_add_u32 m0, s4, 131072
    s_nop 0
    buffer_load_dwordx4 v8, s[12:15], s3 offen offset:0 lds
    buffer_load_dwordx4 v8, s[12:15], s3 offen offset:1024 lds
    buffer_load_dwordx4 v8, s[12:15], s3 offen offset:2048 lds
    buffer_load_dwordx4 v8, s[12:15], s3 offen offset:3072 lds
    s_cmp_eq_u32 s7, 0x7fff0000
    s_cbranch_scc1 L_sp_nopl
    v_lshl_add_u32 v6, v1, 3, s50
    v_mul_u32_u24 v6, 1026, v6
    v_add_u32 v6, s7, v6
    s_mov_b32 s3, 0
    buffer_load_ushort v120, v6, s[28:31], s3 offen
    s_mov_b32 s3, 525312
    buffer_load_ushort v121, v6, s[28:31], s3 offen
    s_mov_b32 s3, 1050624
    buffer_load_ushort v122, v6, s[28:31], s3 offen
    s_mov_b32 s3, 1575936
    buffer_load_ushort v123, v6, s[28:31], s3 offen
L_sp_nopl:
    s_mov_b32 s3, 0x3a800000
    s_mov_b32 s4, 0x3727c5ac
    v_mul_f32 v104, s3, v96
    v_mul_f32 v106, s3, v100
    v_mov_b32 v105, s98
    v_mov_b32 v107, s98
    v_mul_f32 v108, s3, v97
    v_mul_f32 v110, s3, v101
    v_mov_b32 v109, s98
    v_mov_b32 v111, s98
    v_mul_f32 v112, s3, v98
    v_mul_f32 v114, s3, v102
    v_mov_b32 v113, s98
    v_mov_b32 v115, s98
    v_mul_f32 v116, s3, v99
    v_mul_f32 v118, s3, v103
    v_mov_b32 v117, s98
    v_mov_b32 v119, s98
    v_fma_f32 v106, -v104, v104, v106
    v_fma_f32 v110, -v108, v108, v110
    v_fma_f32 v114, -v112, v112, v114
    v_fma_f32 v118, -v116, v116, v118
    v_max_f32 v106, 0, v106
    v_max_f32 v110, 0, v110
    v_max_f32 v114, 0, v114
    v_max_f32 v118, 0, v118
    v_add_f32 v106, s4, v106
    v_add_f32 v110, s4, v110
    v_add_f32 v114, s4, v114
    v_add_f32 v118, s4, v118
    v_rsq_f32 v106, v106
    v_rsq_f32 v110, v110
    v_rsq_f32 v114, v114
    v_rsq_f32 v118, v118
    v_lshlrev_b32 v9, 4, v9
    s_cmp_lg_u32 s48, 0
    s_cselect_b64 exec, 0, s[36:37]
    s_cbranch_execz L_sp_nostat
    s_mov_b32 s3, 0
    buffer_store_dwordx4 v[104:107], v9, s[32:35], s3 offen sc1
    s_mov_b32 s3, 4096
    buffer_store_dwordx4 v[108:111], v9, s[32:35], s3 offen sc1
    s_mov_b32 s3, 8192
    buffer_store_dwordx4 v[112:115], v9, s[32:35], s3 offen sc1
    s_mov_b32 s3, 12288
    buffer_store_dwordx4 v[116:119], v9, s[32:35], s3 offen sc1
L_sp_nostat:
    s_mov_b64 exec, -1
    v_mul_f32 v96, v14, v106
    v_mul_f32 v97, v14, v110
    v_mul_f32 v98, v14, v114
    v_mul_f32 v99, v14, v118
    v_mul_f32 v88, v88, v96
    v_mul_f32 v92, v92, v96
    v_mul_f32 v89, v89, v97
    v_mul_f32 v93, v93, v97
    v_mul_f32 v90, v90, v98
    v_mul_f32 v94, v94, v98
    v_mul_f32 v91, v91, v99
    v_mul_f32 v95, v95, v99
    v_cvt_pk_bf16_f32 v24, v88, v92
    v_cvt_pk_bf16_f32 v28, -v92, v88
    v_cvt_pk_bf16_f32 v25, v89, v93
    v_cvt_pk_bf16_f32 v29, -v93, v89
    v_cvt_pk_bf16_f32 v26, v90, v94
    v_cvt_pk_bf16_f32 v30, -v94, v90
    v_cvt_pk_bf16_f32 v27, v91, v95
    v_cvt_pk_bf16_f32 v31, -v95, v91
    v_permlane16_swap_b32 v128, v144
    v_permlane16_swap_b32 v160, v176
    v_permlane16_swap_b32 v129, v145
    v_permlane16_swap_b32 v161, v177
    v_permlane16_swap_b32 v130, v146
    v_permlane16_swap_b32 v162, v178
    v_permlane16_swap_b32 v131, v147
    v_permlane16_swap_b32 v163, v179
    v_permlane16_swap_b32 v132, v148
    v_permlane16_swap_b32 v164, v180
    v_permlane16_swap_b32 v133, v149
    v_permlane16_swap_b32 v165, v181
    v_permlane16_swap_b32 v134, v150
    v_permlane16_swap_b32 v166, v182
    v_permlane16_swap_b32 v135, v151
    v_permlane16_swap_b32 v167, v183
    v_permlane16_swap_b32 v136, v152
    v_permlane16_swap_b32 v168, v184
    v_permlane16_swap_b32 v137, v153
    v_permlane16_swap_b32 v169, v185
    v_permlane16_swap_b32 v138, v154
    v_permlane16_swap_b32 v170, v186
    v_permlane16_swap_b32 v139, v155
    v_permlane16_swap_b32 v171, v187
    v_permlane16_swap_b32 v140, v156
    v_permlane16_swap_b32 v172, v188
    v_permlane16_swap_b32 v141, v157
    v_permlane16_swap_b32 v173, v189
    v_permlane16_swap_b32 v142, v158
    v_permlane16_swap_b32 v174, v190
    v_permlane16_swap_b32 v143, v159
    v_permlane16_swap_b32 v175, v191
    v_lshlrev_b32 v11, 20, v2
    v_lshl_add_u32 v11, v3, 4, v11
    s_lshl_b32 s3, s46, 11
    s_lshl_b32 s4, s47, 7
    s_add_u32 s3, s3, s4
    s_lshl_b32 s4, s48, 15
    s_add_u32 s3, s3, s4
    v_add_u32 v11, s3, v11
    v_mfma_f32_16x16x32_bf16 v[64:67], v[24:27], v[128:131], 0
    v_mfma_f32_16x16x32_bf16 v[68:71], v[28:31], v[128:131], 0
    v_mfma_f32_16x16x32_bf16 v[72:75], v[24:27], v[132:135], 0
    v_mfma_f32_16x16x32_bf16 v[76:79], v[28:31], v[132:135], 0
    s_nop 5
    v_cvt_pk_bf16_f32 v96, v64, v68
    v_mfma_f32_16x16x32_bf16 v[80:83], v[24:27], v[136:139], 0
    v_cvt_pk_bf16_f32 v97, v65, v69
    v_cvt_pk_bf16_f32 v98, v66, v70
    v_cvt_pk_bf16_f32 v99, v67, v71
    v_mfma_f32_16x16x32_bf16 v[84:87], v[28:31], v[136:139], 0
    s_mov_b32 s3, 0
    buffer_store_dwordx4 v[96:99], v11, s[16:19], s3 offen sc1
    v_cvt_pk_bf16_f32 v100, v72, v76
    v_mfma_f32_16x16x32_bf16 v[88:91], v[24:27], v[140:143], 0
    v_cvt_pk_bf16_f32 v101, v73, v77
    v_cvt_pk_bf16_f32 v102, v74, v78
    v_cvt_pk_bf16_f32 v103, v75, v79
    v_mfma_f32_16x16x32_bf16 v[92:95], v[28:31], v[140:143], 0
    s_mov_b32 s3, 65536
    buffer_store_dwordx4 v[100:103], v11, s[16:19], s3 offen sc1
    v_cvt_pk_bf16_f32 v104, v80, v84
    v_mfma_f32_16x16x32_bf16 v[64:67], v[24:27], v[144:147], 0
    v_cvt_pk_bf16_f32 v105, v81, v85
    v_cvt_pk_bf16_f32 v106, v82, v86
    v_cvt_pk_bf16_f32 v107, v83, v87
    v_mfma_f32_16x16x32_bf16 v[68:71], v[28:31], v[144:147], 0
    s_mov_b32 s3, 131072
    buffer_store_dwordx4 v[104:107], v11, s[16:19], s3 offen sc1
    v_cvt_pk_bf16_f32 v108, v88, v92
    v_mfma_f32_16x16x32_bf16 v[72:75], v[24:27], v[148:151], 0
    v_cvt_pk_bf16_f32 v109, v89, v93
    v_cvt_pk_bf16_f32 v110, v90, v94
    v_cvt_pk_bf16_f32 v111, v91, v95
    v_mfma_f32_16x16x32_bf16 v[76:79], v[28:31], v[148:151], 0
    s_mov_b32 s3, 196608
    buffer_store_dwordx4 v[108:111], v11, s[16:19], s3 offen sc1
    v_cvt_pk_bf16_f32 v96, v64, v68
    v_mfma_f32_16x16x32_bf16 v[80:83], v[24:27], v[152:155], 0
    v_cvt_pk_bf16_f32 v97, v65, v69
    v_cvt_pk_bf16_f32 v98, v66, v70
    v_cvt_pk_bf16_f32 v99, v67, v71
    v_mfma_f32_16x16x32_bf16 v[84:87], v[28:31], v[152:155], 0
    s_mov_b32 s3, 262144
    buffer_store_dwordx4 v[96:99], v11, s[16:19], s3 offen sc1
    v_cvt_pk_bf16_f32 v100, v72, v76
    v_mfma_f32_16x16x32_bf16 v[88:91], v[24:27], v[156:159], 0
    v_cvt_pk_bf16_f32 v101, v73, v77
    v_cvt_pk_bf16_f32 v102, v74, v78
    v_cvt_pk_bf16_f32 v103, v75, v79
    v_mfma_f32_16x16x32_bf16 v[92:95], v[28:31], v[156:159], 0
    s_mov_b32 s3, 327680
    buffer_store_dwordx4 v[100:103], v11, s[16:19], s3 offen sc1
    v_cvt_pk_bf16_f32 v104, v80, v84
    v_mfma_f32_16x16x32_bf16 v[64:67], v[24:27], v[160:163], 0
    v_cvt_pk_bf16_f32 v105, v81, v85
    v_cvt_pk_bf16_f32 v106, v82, v86
    v_cvt_pk_bf16_f32 v107, v83, v87
    v_mfma_f32_16x16x32_bf16 v[68:71], v[28:31], v[160:163], 0
    s_mov_b32 s3, 393216
    buffer_store_dwordx4 v[104:107], v11, s[16:19], s3 offen sc1
    v_cvt_pk_bf16_f32 v108, v88, v92
    v_mfma_f32_16x16x32_bf16 v[72:75], v[24:27], v[164:167], 0
    v_cvt_pk_bf16_f32 v109, v89, v93
    v_cvt_pk_bf16_f32 v110, v90, v94
    v_cvt_pk_bf16_f32 v111, v91, v95
    v_mfma_f32_16x16x32_bf16 v[76:79], v[28:31], v[164:167], 0
    s_mov_b32 s3, 458752
    buffer_store_dwordx4 v[108:111], v11, s[16:19], s3 offen sc1
    v_cvt_pk_bf16_f32 v96, v64, v68
    v_mfma_f32_16x16x32_bf16 v[80:83], v[24:27], v[168:171], 0
    v_cvt_pk_bf16_f32 v97, v65, v69
    v_cvt_pk_bf16_f32 v98, v66, v70
    v_cvt_pk_bf16_f32 v99, v67, v71
    v_mfma_f32_16x16x32_bf16 v[84:87], v[28:31], v[168:171], 0
    s_mov_b32 s3, 524288
    buffer_store_dwordx4 v[96:99], v11, s[16:19], s3 offen sc1
    v_cvt_pk_bf16_f32 v100, v72, v76
    v_mfma_f32_16x16x32_bf16 v[88:91], v[24:27], v[172:175], 0
    v_cvt_pk_bf16_f32 v101, v73, v77
    v_cvt_pk_bf16_f32 v102, v74, v78
    v_cvt_pk_bf16_f32 v103, v75, v79
    v_mfma_f32_16x16x32_bf16 v[92:95], v[28:31], v[172:175], 0
    s_mov_b32 s3, 589824
    buffer_store_dwordx4 v[100:103], v11, s[16:19], s3 offen sc1
    v_cvt_pk_bf16_f32 v104, v80, v84
    v_mfma_f32_16x16x32_bf16 v[64:67], v[24:27], v[176:179], 0
    v_cvt_pk_bf16_f32 v105, v81, v85
    v_cvt_pk_bf16_f32 v106, v82, v86
    v_cvt_pk_bf16_f32 v107, v83, v87
    v_mfma_f32_16x16x32_bf16 v[68:71], v[28:31], v[176:179], 0
    s_mov_b32 s3, 655360
    buffer_store_dwordx4 v[104:107], v11, s[16:19], s3 offen sc1
    v_cvt_pk_bf16_f32 v108, v88, v92
    v_mfma_f32_16x16x32_bf16 v[72:75], v[24:27], v[180:183], 0
    v_cvt_pk_bf16_f32 v109, v89, v93
    v_cvt_pk_bf16_f32 v110, v90, v94
    v_cvt_pk_bf16_f32 v111, v91, v95
    v_mfma_f32_16x16x32_bf16 v[76:79], v[28:31], v[180:183], 0
    s_mov_b32 s3, 720896
    buffer_store_dwordx4 v[108:111], v11, s[16:19], s3 offen sc1
    v_cvt_pk_bf16_f32 v96, v64, v68
    v_mfma_f32_16x16x32_bf16 v[80:83], v[24:27], v[184:187], 0
    v_cvt_pk_bf16_f32 v97, v65, v69
    v_cvt_pk_bf16_f32 v98, v66, v70
    v_cvt_pk_bf16_f32 v99, v67, v71
    v_mfma_f32_16x16x32_bf16 v[84:87], v[28:31], v[184:187], 0
    s_mov_b32 s3, 786432
    buffer_store_dwordx4 v[96:99], v11, s[16:19], s3 offen sc1
    v_cvt_pk_bf16_f32 v100, v72, v76
    v_mfma_f32_16x16x32_bf16 v[88:91], v[24:27], v[188:191], 0
    v_cvt_pk_bf16_f32 v101, v73, v77
    v_cvt_pk_bf16_f32 v102, v74, v78
    v_cvt_pk_bf16_f32 v103, v75, v79
    v_mfma_f32_16x16x32_bf16 v[92:95], v[28:31], v[188:191], 0
    s_mov_b32 s3, 851968
    buffer_store_dwordx4 v[100:103], v11, s[16:19], s3 offen sc1
    v_cvt_pk_bf16_f32 v104, v80, v84
    v_cvt_pk_bf16_f32 v105, v81, v85
    v_cvt_pk_bf16_f32 v106, v82, v86
    v_cvt_pk_bf16_f32 v107, v83, v87
    s_mov_b32 s3, 917504
    buffer_store_dwordx4 v[104:107], v11, s[16:19], s3 offen sc1
    v_cvt_pk_bf16_f32 v108, v88, v92
    v_cvt_pk_bf16_f32 v109, v89, v93
    v_cvt_pk_bf16_f32 v110, v90, v94
    v_cvt_pk_bf16_f32 v111, v91, v95
    s_mov_b32 s3, 983040
    buffer_store_dwordx4 v[108:111], v11, s[16:19], s3 offen sc1
    s_waitcnt vmcnt(0)
    s_barrier
    s_cmp_lg_u32 s44, 7
    s_cbranch_scc1 L_fl_s1
    s_add_u32 s32, s54, 0x2300000
    s_addc_u32 s33, s55, 0
    s_mov_b32 s34, 0x28000
    s_mov_b32 s35, 0x20000
    s_lshl_b32 s3, s2, 2
    s_add_u32 s3, s3, 12288
    v_mov_b32 v4, s98
    v_lshlrev_b32 v5, 7, v1
    s_mov_b64 exec, 0xff
    buffer_store_dword v4, v5, s[32:35], s3 offen sc1
    s_mov_b64 exec, -1
L_fl_s1:
    s_lshl_b32 s4, s48, 14
    s_add_u32 s4, s4, s45
    v_lshrrev_b32 v4, 2, v1
    v_and_b32 v5, 3, v1
    v_xor_b32 v5, s51, v5
    v_lshlrev_b32 v5, 4, v5
    v_lshl_add_u32 v5, v4, 10, v5
    v_add_u32 v5, s4, v5
    v_lshlrev_b32 v6, 10, v3
    v_lshl_add_u32 v6, v2, 6, v6
    v_add_u32 v6, s4, v6
    s_cmp_lg_u32 s51, 0
    s_cbranch_scc1 L_sp_wmir
    s_waitcnt vmcnt(0)
    v_mov_b32_dpp v80, v195 row_shr:1 row_mask:0xf bank_mask:0xf
    v_perm_b32 v65, v193, v192, s39
    v_perm_b32 v66, v194, v193, s39
    v_perm_b32 v67, v195, v194, s39
    v_perm_b32 v64, v192, v80, s39
    ds_write_b128 v5, v[64:67] offset:0
    s_waitcnt vmcnt(0)
    v_mov_b32_dpp v81, v199 row_shr:1 row_mask:0xf bank_mask:0xf
    v_perm_b32 v69, v197, v196, s39
    v_perm_b32 v70, v198, v197, s39
    v_perm_b32 v71, v199, v198, s39
    v_perm_b32 v68, v196, v81, s39
    ds_write_b128 v5, v[68:71] offset:64
    s_waitcnt vmcnt(0)
    v_mov_b32_dpp v82, v203 row_shr:1 row_mask:0xf bank_mask:0xf
    v_perm_b32 v73, v201, v200, s39
    v_perm_b32 v74, v202, v201, s39
    v_perm_b32 v75, v203, v202, s39
    v_perm_b32 v72, v200, v82, s39
    ds_write_b128 v5, v[72:75] offset:128
    s_waitcnt vmcnt(0)
    v_mov_b32_dpp v83, v207 row_shr:1 row_mask:0xf bank_mask:0xf
    v_perm_b32 v77, v205, v204, s39
    v_perm_b32 v78, v206, v205, s39
    v_perm_b32 v79, v207, v206, s39
    v_perm_b32 v76, v204, v83, s39
    ds_write_b128 v5, v[76:79] offset:192
    s_waitcnt vmcnt(0)
    v_mov_b32_dpp v80, v211 row_shr:1 row_mask:0xf bank_mask:0xf
    v_perm_b32 v65, v209, v208, s39
    v_perm_b32 v66, v210, v209, s39
    v_perm_b32 v67, v211, v210, s39
    v_perm_b32 v64, v208, v80, s39
    ds_write_b128 v5, v[64:67] offset:256
    s_waitcnt vmcnt(0)
    v_mov_b32_dpp v81, v215 row_shr:1 row_mask:0xf bank_mask:0xf
    v_perm_b32 v69, v213, v212, s39
    v_perm_b32 v70, v214, v213, s39
    v_perm_b32 v71, v215, v214, s39
    v_perm_b32 v68, v212, v81, s39
    ds_write_b128 v5, v[68:71] offset:320
    s_waitcnt vmcnt(0)
    v_mov_b32_dpp v82, v219 row_shr:1 row_mask:0xf bank_mask:0xf
    v_perm_b32 v73, v217, v216, s39
    v_perm_b32 v74, v218, v217, s39
    v_perm_b32 v75, v219, v218, s39
    v_perm_b32 v72, v216, v82, s39
    ds_write_b128 v5, v[72:75] offset:384
    s_waitcnt vmcnt(0)
    v_mov_b32_dpp v83, v223 row_shr:1 row_mask:0xf bank_mask:0xf
    v_perm_b32 v77, v221, v220, s39
    v_perm_b32 v78, v222, v221, s39
    v_perm_b32 v79, v223, v222, s39
    v_perm_b32 v76, v220, v83, s39
    ds_write_b128 v5, v[76:79] offset:448
    s_waitcnt vmcnt(0)
    v_mov_b32_dpp v80, v227 row_shr:1 row_mask:0xf bank_mask:0xf
    v_perm_b32 v65, v225, v224, s39
    v_perm_b32 v66, v226, v225, s39
    v_perm_b32 v67, v227, v226, s39
    v_perm_b32 v64, v224, v80, s39
    ds_write_b128 v5, v[64:67] offset:512
    s_waitcnt vmcnt(0)
    v_mov_b32_dpp v81, v231 row_shr:1 row_mask:0xf bank_mask:0xf
    v_perm_b32 v69, v229, v228, s39
    v_perm_b32 v70, v230, v229, s39
    v_perm_b32 v71, v231, v230, s39
    v_perm_b32 v68, v228, v81, s39
    ds_write_b128 v5, v[68:71] offset:576
    s_waitcnt vmcnt(0)
    v_mov_b32_dpp v82, v235 row_shr:1 row_mask:0xf bank_mask:0xf
    v_perm_b32 v73, v233, v232, s39
    v_perm_b32 v74, v234, v233, s39
    v_perm_b32 v75, v235, v234, s39
    v_perm_b32 v72, v232, v82, s39
    ds_write_b128 v5, v[72:75] offset:640
    s_waitcnt vmcnt(0)
    v_mov_b32_dpp v83, v239 row_shr:1 row_mask:0xf bank_mask:0xf
    v_perm_b32 v77, v237, v236, s39
    v_perm_b32 v78, v238, v237, s39
    v_perm_b32 v79, v239, v238, s39
    v_perm_b32 v76, v236, v83, s39
    ds_write_b128 v5, v[76:79] offset:704
    s_waitcnt vmcnt(0)
    v_mov_b32_dpp v80, v243 row_shr:1 row_mask:0xf bank_mask:0xf
    v_perm_b32 v65, v241, v240, s39
    v_perm_b32 v66, v242, v241, s39
    v_perm_b32 v67, v243, v242, s39
    v_perm_b32 v64, v240, v80, s39
    ds_write_b128 v5, v[64:67] offset:768
    s_waitcnt vmcnt(0)
    v_mov_b32_dpp v81, v247 row_shr:1 row_mask:0xf bank_mask:0xf
    v_perm_b32 v69, v245, v244, s39
    v_perm_b32 v70, v246, v245, s39
    v_perm_b32 v71, v247, v246, s39
    v_perm_b32 v68, v244, v81, s39
    ds_write_b128 v5, v[68:71] offset:832
    s_waitcnt vmcnt(0)
    v_mov_b32_dpp v82, v251 row_shr:1 row_mask:0xf bank_mask:0xf
    v_perm_b32 v73, v249, v248, s39
    v_perm_b32 v74, v250, v249, s39
    v_perm_b32 v75, v251, v250, s39
    v_perm_b32 v72, v248, v82, s39
    ds_write_b128 v5, v[72:75] offset:896
    s_waitcnt vmcnt(0)
    v_mov_b32_dpp v83, v255 row_shr:1 row_mask:0xf bank_mask:0xf
    v_perm_b32 v77, v253, v252, s39
    v_perm_b32 v78, v254, v253, s39
    v_perm_b32 v79, v255, v254, s39
    v_perm_b32 v76, v252, v83, s39
    ds_write_b128 v5, v[76:79] offset:960
    s_branch L_sp_wj
L_sp_wmir:
    s_waitcnt vmcnt(0)
    v_mov_b32_dpp v80, v192 quad_perm:[1,2,3,0] row_mask:0xf bank_mask:0xf
    v_perm_b32 v65, v195, v194, s39
    v_perm_b32 v66, v194, v193, s39
    v_perm_b32 v67, v193, v192, s39
    v_perm_b32 v64, v80, v195, s39
    ds_write_b128 v5, v[64:67] offset:0
    s_waitcnt vmcnt(0)
    v_mov_b32_dpp v81, v196 quad_perm:[1,2,3,0] row_mask:0xf bank_mask:0xf
    v_perm_b32 v69, v199, v198, s39
    v_perm_b32 v70, v198, v197, s39
    v_perm_b32 v71, v197, v196, s39
    v_perm_b32 v68, v81, v199, s39
    ds_write_b128 v5, v[68:71] offset:64
    s_waitcnt vmcnt(0)
    v_mov_b32_dpp v82, v200 quad_perm:[1,2,3,0] row_mask:0xf bank_mask:0xf
    v_perm_b32 v73, v203, v202, s39
    v_perm_b32 v74, v202, v201, s39
    v_perm_b32 v75, v201, v200, s39
    v_perm_b32 v72, v82, v203, s39
    ds_write_b128 v5, v[72:75] offset:128
    s_waitcnt vmcnt(0)
    v_mov_b32_dpp v83, v204 quad_perm:[1,2,3,0] row_mask:0xf bank_mask:0xf
    v_perm_b32 v77, v207, v206, s39
    v_perm_b32 v78, v206, v205, s39
    v_perm_b32 v79, v205, v204, s39
    v_perm_b32 v76, v83, v207, s39
    ds_write_b128 v5, v[76:79] offset:192
    s_waitcnt vmcnt(0)
    v_mov_b32_dpp v80, v208 quad_perm:[1,2,3,0] row_mask:0xf bank_mask:0xf
    v_perm_b32 v65, v211, v210, s39
    v_perm_b32 v66, v210, v209, s39
    v_perm_b32 v67, v209, v208, s39
    v_perm_b32 v64, v80, v211, s39
    ds_write_b128 v5, v[64:67] offset:256
    s_waitcnt vmcnt(0)
    v_mov_b32_dpp v81, v212 quad_perm:[1,2,3,0] row_mask:0xf bank_mask:0xf
    v_perm_b32 v69, v215, v214, s39
    v_perm_b32 v70, v214, v213, s39
    v_perm_b32 v71, v213, v212, s39
    v_perm_b32 v68, v81, v215, s39
    ds_write_b128 v5, v[68:71] offset:320
    s_waitcnt vmcnt(0)
    v_mov_b32_dpp v82, v216 quad_perm:[1,2,3,0] row_mask:0xf bank_mask:0xf
    v_perm_b32 v73, v219, v218, s39
    v_perm_b32 v74, v218, v217, s39
    v_perm_b32 v75, v217, v216, s39
    v_perm_b32 v72, v82, v219, s39
    ds_write_b128 v5, v[72:75] offset:384
    s_waitcnt vmcnt(0)
    v_mov_b32_dpp v83, v220 quad_perm:[1,2,3,0] row_mask:0xf bank_mask:0xf
    v_perm_b32 v77, v223, v222, s39
    v_perm_b32 v78, v222, v221, s39
    v_perm_b32 v79, v221, v220, s39
    v_perm_b32 v76, v83, v223, s39
    ds_write_b128 v5, v[76:79] offset:448
    s_waitcnt vmcnt(0)
    v_mov_b32_dpp v80, v224 quad_perm:[1,2,3,0] row_mask:0xf bank_mask:0xf
    v_perm_b32 v65, v227, v226, s39
    v_perm_b32 v66, v226, v225, s39
    v_perm_b32 v67, v225, v224, s39
    v_perm_b32 v64, v80, v227, s39
    ds_write_b128 v5, v[64:67] offset:512
    s_waitcnt vmcnt(0)
    v_mov_b32_dpp v81, v228 quad_perm:[1,2,3,0] row_mask:0xf bank_mask:0xf
    v_perm_b32 v69, v231, v230, s39
    v_perm_b32 v70, v230, v229, s39
    v_perm_b32 v71, v229, v228, s39
    v_perm_b32 v68, v81, v231, s39
    ds_write_b128 v5, v[68:71] offset:576
    s_waitcnt vmcnt(0)
    v_mov_b32_dpp v82, v232 quad_perm:[1,2,3,0] row_mask:0xf bank_mask:0xf
    v_perm_b32 v73, v235, v234, s39
    v_perm_b32 v74, v234, v233, s39
    v_perm_b32 v75, v233, v232, s39
    v_perm_b32 v72, v82, v235, s39
    ds_write_b128 v5, v[72:75] offset:640
    s_waitcnt vmcnt(0)
    v_mov_b32_dpp v83, v236 quad_perm:[1,2,3,0] row_mask:0xf bank_mask:0xf
    v_perm_b32 v77, v239, v238, s39
    v_perm_b32 v78, v238, v237, s39
    v_perm_b32 v79, v237, v236, s39
    v_perm_b32 v76, v83, v239, s39
    ds_write_b128 v5, v[76:79] offset:704
    s_waitcnt vmcnt(0)
    v_mov_b32_dpp v80, v240 quad_perm:[1,2,3,0] row_mask:0xf bank_mask:0xf
    v_perm_b32 v65, v243, v242, s39
    v_perm_b32 v66, v242, v241, s39
    v_perm_b32 v67, v241, v240, s39
    v_perm_b32 v64, v80, v243, s39
    ds_write_b128 v5, v[64:67] offset:768
    s_waitcnt vmcnt(0)
    v_mov_b32_dpp v81, v244 quad_perm:[1,2,3,0] row_mask:0xf bank_mask:0xf
    v_perm_b32 v69, v247, v246, s39
    v_perm_b32 v70, v246, v245, s39
    v_perm_b32 v71, v245, v244, s39
    v_perm_b32 v68, v81, v247, s39
    ds_write_b128 v5, v[68:71] offset:832
    s_waitcnt vmcnt(0)
    v_mov_b32_dpp v82, v248 quad_perm:[1,2,3,0] row_mask:0xf bank_mask:0xf
    v_perm_b32 v73, v251, v250, s39
    v_perm_b32 v74, v250, v249, s39
    v_perm_b32 v75, v249, v248, s39
    v_perm_b32 v72, v82, v251, s39
    ds_write_b128 v5, v[72:75] offset:896
    s_waitcnt vmcnt(0)
    v_mov_b32_dpp v83, v252 quad_perm:[1,2,3,0] row_mask:0xf bank_mask:0xf
    v_perm_b32 v77, v255, v254, s39
    v_perm_b32 v78, v254, v253, s39
    v_perm_b32 v79, v253, v252, s39
    v_perm_b32 v76, v83, v255, s39
    ds_write_b128 v5, v[76:79] offset:960
L_sp_wj:
    s_cmp_eq_u32 s7, 0x7fff0000
    s_cbranch_scc1 L_sp_nopw
    ds_write_b16 v6, v120 offset:0
    ds_write_b16 v6, v121 offset:256
    ds_write_b16 v6, v122 offset:512
    ds_write_b16 v6, v123 offset:768
L_sp_nopw:
    s_mov_b32 s3, 49152
    buffer_load_dwordx4 v[16:19], v8, s[12:15], s3 offen offset:0
    s_mov_b32 s3, 49152
    buffer_load_dwordx4 v[20:23], v8, s[12:15], s3 offen offset:1024
    v_lshrrev_b32 v6, 2, v1
    v_lshlrev_b32 v6, 6, v6
    v_and_b32 v7, 3, v1
    v_lshl_add_u32 v6, v7, 3, v6
    s_and_b32 s5, s44, 2
    s_or_b32 s5, s5, s48
    s_lshl_b32 s5, s5, 15
    s_and_b32 s6, s44, 1
    s_lshl_b32 s6, s6, 5
    s_add_u32 s5, s5, s6
    v_add_u32 v12, s5, v6
    v_add_u32 v13, 131072, v8
    s_and_b32 s5, s2, 3
    s_mov_b32 s6, s89
    v_lshlrev_b32 v10, 9, v2
    v_lshl_add_u32 v10, v3, 4, v10
    s_lshl_b32 s92, s5, 20
    s_lshl_b32 s93, s6, 15
    s_add_u32 s92, s92, s93
    s_lshl_b32 s93, s48, 3
    s_add_u32 s92, s92, s93
    v_add_u32 v9, s92, v10
    v_lshlrev_b32 v11, 16, v2
    v_lshl_add_u32 v11, v3, 4, v11
    s_lshl_b32 s92, s5, 9
    s_lshl_b32 s93, s48, 8
    s_add_u32 s92, s92, s93
    s_lshl_b32 s93, s6, 11
    s_add_u32 s92, s92, s93
    v_add_u32 v11, s92, v11
    s_mov_b32 s6, 0xffff0000
    s_cmp_lg_u32 s44, 7
    s_cbranch_scc1 L_fl_w1_done
    s_add_u32 s32, s54, 0x2300000
    s_addc_u32 s33, s55, 0
    s_mov_b32 s34, 0x28000
    s_mov_b32 s35, 0x20000
    s_and_b32 s3, s2, 7
    s_lshl_b32 s3, s3, 7
    s_add_u32 s3, s3, 12288
    v_and_b32 v5, 31, v1
    v_lshlrev_b32 v5, 2, v5
    s_mov_b32 s7, 0
L_fl_w1:
    buffer_load_dword v4, v5, s[32:35], s3 offen sc1
    s_add_u32 s7, s7, 1
    s_waitcnt vmcnt(0)
    v_cmp_ne_u32 vcc, s98, v4
    s_and_b32 s4, vcc_lo, 0xffffffff
    s_cbranch_scc0 L_fl_w1_done
    s_cmp_ge_u32 s7, 0x40000
    s_cbranch_scc1 L_fl_w1_done
    s_sleep 2
    s_branch L_fl_w1
L_fl_w1_done:
    s_waitcnt lgkmcnt(0)
    s_barrier
    s_mov_b32 s3, 0
    buffer_load_dwordx2 v[128:129], v9, s[16:19], s3 offen sc1
    buffer_load_dwordx2 v[130:131], v9, s[16:19], s3 offen offset:256 sc1
    s_mov_b32 s3, 2048
    buffer_load_dwordx2 v[132:133], v9, s[16:19], s3 offen sc1
    buffer_load_dwordx2 v[134:135], v9, s[16:19], s3 offen offset:256 sc1
    s_mov_b32 s3, 4096
    buffer_load_dwordx2 v[136:137], v9, s[16:19], s3 offen sc1
    buffer_load_dwordx2 v[138:139], v9, s[16:19], s3 offen offset:256 sc1
    s_mov_b32 s3, 6144
    buffer_load_dwordx2 v[140:141], v9, s[16:19], s3 offen sc1
    buffer_load_dwordx2 v[142:143], v9, s[16:19], s3 offen offset:256 sc1
    s_mov_b32 s3, 8192
    buffer_load_dwordx2 v[144:145], v9, s[16:19], s3 offen sc1
    buffer_load_dwordx2 v[146:147], v9, s[16:19], s3 offen offset:256 sc1
    s_mov_b32 s3, 10240
    buffer_load_dwordx2 v[148:149], v9, s[16:19], s3 offen sc1
    buffer_load_dwordx2 v[150:151], v9, s[16:19], s3 offen offset:256 sc1
    s_mov_b32 s3, 12288
    buffer_load_dwordx2 v[152:153], v9, s[16:19], s3 offen sc1
    buffer_load_dwordx2 v[154:155], v9, s[16:19], s3 offen offset:256 sc1
    s_mov_b32 s3, 14336
    buffer_load_dwordx2 v[156:157], v9, s[16:19], s3 offen sc1
    buffer_load_dwordx2 v[158:159], v9, s[16:19], s3 offen offset:256 sc1
    s_mov_b32 s3, 16384
    buffer_load_dwordx2 v[160:161], v9, s[16:19], s3 offen sc1
    buffer_load_dwordx2 v[162:163], v9, s[16:19], s3 offen offset:256 sc1
    s_mov_b32 s3, 18432
    buffer_load_dwordx2 v[164:165], v9, s[16:19], s3 offen sc1
    buffer_load_dwordx2 v[166:167], v9, s[16:19], s3 offen offset:256 sc1
    s_mov_b32 s3, 20480
    buffer_load_dwordx2 v[168:169], v9, s[16:19], s3 offen sc1
    buffer_load_dwordx2 v[170:171], v9, s[16:19], s3 offen offset:256 sc1
    s_mov_b32 s3, 22528
    buffer_load_dwordx2 v[172:173], v9, s[16:19], s3 offen sc1
    buffer_load_dwordx2 v[174:175], v9, s[16:19], s3 offen offset:256 sc1
    s_mov_b32 s3, 24576
    buffer_load_dwordx2 v[176:177], v9, s[16:19], s3 offen sc1
    buffer_load_dwordx2 v[178:179], v9, s[16:19], s3 offen offset:256 sc1
    s_mov_b32 s3, 26624
    buffer_load_dwordx2 v[180:181], v9, s[16:19], s3 offen sc1
    buffer_load_dwordx2 v[182:183], v9, s[16:19], s3 offen offset:256 sc1
    s_mov_b32 s3, 28672
    buffer_load_dwordx2 v[184:185], v9, s[16:19], s3 offen sc1
    buffer_load_dwordx2 v[186:187], v9, s[16:19], s3 offen offset:256 sc1
    s_mov_b32 s3, 30720
    buffer_load_dwordx2 v[188:189], v9, s[16:19], s3 offen sc1
    buffer_load_dwordx2 v[190:191], v9, s[16:19], s3 offen offset:256 sc1
    ds_read_b128 v[24:27], v13 offset:0
    ds_read_b128 v[28:31], v13 offset:1024
    ds_read_b128 v[32:35], v13 offset:2048
    ds_read_b128 v[36:39], v13 offset:3072
    ds_read_b128 v[40:43], v13 offset:4096
    ds_read_b128 v[44:47], v13 offset:5120
    s_waitcnt vmcnt(30) lgkmcnt(4)
    v_mfma_f32_16x16x32_bf16 v[64:67], v[24:27], v[128:131], 0
    v_mfma_f32_16x16x32_bf16 v[68:71], v[28:31], v[128:131], 0
    ds_read_b128 v[24:27], v13 offset:6144
    ds_read_b128 v[28:31], v13 offset:7168
    s_waitcnt vmcnt(28) lgkmcnt(4)
    v_mfma_f32_16x16x32_bf16 v[72:75], v[32:35], v[132:135], 0
    v_mfma_f32_16x16x32_bf16 v[76:79], v[36:39], v[132:135], 0
    s_nop 2
    v_cvt_pk_bf16_f32 v192, v64, v68
    ds_read_b128 v[32:35], v13 offset:8192
    ds_read_b128 v[36:39], v13 offset:9216
    s_waitcnt vmcnt(26) lgkmcnt(4)
    v_cvt_pk_bf16_f32 v196, v65, v69
    v_mfma_f32_16x16x32_bf16 v[80:83], v[40:43], v[136:139], 0
    v_cvt_pk_bf16_f32 v200, v66, v70
    v_mfma_f32_16x16x32_bf16 v[84:87], v[44:47], v[136:139], 0
    v_cvt_pk_bf16_f32 v204, v67, v71
    v_cvt_pk_bf16_f32 v193, v72, v76
    ds_read_b128 v[40:43], v13 offset:10240
    ds_read_b128 v[44:47], v13 offset:11264
    s_waitcnt vmcnt(24) lgkmcnt(4)
    v_cvt_pk_bf16_f32 v197, v73, v77
    v_mfma_f32_16x16x32_bf16 v[88:91], v[24:27], v[140:143], 0
    v_cvt_pk_bf16_f32 v201, v74, v78
    v_mfma_f32_16x16x32_bf16 v[92:95], v[28:31], v[140:143], 0
    v_cvt_pk_bf16_f32 v205, v75, v79
    v_cvt_pk_bf16_f32 v194, v80, v84
    ds_read_b128 v[24:27], v13 offset:12288
    ds_read_b128 v[28:31], v13 offset:13312
    s_waitcnt vmcnt(22) lgkmcnt(4)
    v_cvt_pk_bf16_f32 v198, v81, v85
    v_mfma_f32_16x16x32_bf16 v[64:67], v[32:35], v[144:147], 0
    v_cvt_pk_bf16_f32 v202, v82, v86
    v_mfma_f32_16x16x32_bf16 v[68:71], v[36:39], v[144:147], 0
    v_cvt_pk_bf16_f32 v206, v83, v87
    v_cvt_pk_bf16_f32 v195, v88, v92
    ds_read_b128 v[32:35], v13 offset:14336
    ds_read_b128 v[36:39], v13 offset:15360
    s_waitcnt vmcnt(20) lgkmcnt(4)
    v_cvt_pk_bf16_f32 v199, v89, v93
    v_mfma_f32_16x16x32_bf16 v[72:75], v[40:43], v[148:151], 0
    v_cvt_pk_bf16_f32 v203, v90, v94
    v_mfma_f32_16x16x32_bf16 v[76:79], v[44:47], v[148:151], 0
    v_cvt_pk_bf16_f32 v207, v91, v95
    v_cvt_pk_bf16_f32 v208, v64, v68
    ds_read_b128 v[40:43], v13 offset:16384
    ds_read_b128 v[44:47], v13 offset:17408
    s_waitcnt vmcnt(18) lgkmcnt(4)
    v_cvt_pk_bf16_f32 v212, v65, v69
    v_mfma_f32_16x16x32_bf16 v[80:83], v[24:27], v[152:155], 0
    v_cvt_pk_bf16_f32 v216, v66, v70
    v_mfma_f32_16x16x32_bf16 v[84:87], v[28:31], v[152:155], 0
    v_cvt_pk_bf16_f32 v220, v67, v71
    v_cvt_pk_bf16_f32 v209, v72, v76
    ds_read_b128 v[24:27], v13 offset:18432
    ds_read_b128 v[28:31], v13 offset:19456
    s_waitcnt vmcnt(16) lgkmcnt(4)
    v_cvt_pk_bf16_f32 v213, v73, v77
    v_mfma_f32_16x16x32_bf16 v[88:91], v[32:35], v[156:159], 0
    v_cvt_pk_bf16_f32 v217, v74, v78
    v_mfma_f32_16x16x32_bf16 v[92:95], v[36:39], v[156:159], 0
    v_cvt_pk_bf16_f32 v221, v75, v79
    v_cvt_pk_bf16_f32 v210, v80, v84
    ds_read_b128 v[32:35], v13 offset:20480
    ds_read_b128 v[36:39], v13 offset:21504
    s_waitcnt vmcnt(14) lgkmcnt(4)
    v_cvt_pk_bf16_f32 v214, v81, v85
    v_mfma_f32_16x16x32_bf16 v[64:67], v[40:43], v[160:163], 0
    v_cvt_pk_bf16_f32 v218, v82, v86
    v_mfma_f32_16x16x32_bf16 v[68:71], v[44:47], v[160:163], 0
    v_cvt_pk_bf16_f32 v222, v83, v87
    v_cvt_pk_bf16_f32 v211, v88, v92
    ds_read_b128 v[40:43], v13 offset:22528
    ds_read_b128 v[44:47], v13 offset:23552
    s_waitcnt vmcnt(12) lgkmcnt(4)
    v_cvt_pk_bf16_f32 v215, v89, v93
    v_mfma_f32_16x16x32_bf16 v[72:75], v[24:27], v[164:167], 0
    v_cvt_pk_bf16_f32 v219, v90, v94
    v_mfma_f32_16x16x32_bf16 v[76:79], v[28:31], v[164:167], 0
    v_cvt_pk_bf16_f32 v223, v91, v95
    v_cvt_pk_bf16_f32 v224, v64, v68
    ds_read_b128 v[24:27], v13 offset:24576
    ds_read_b128 v[28:31], v13 offset:25600
    s_waitcnt vmcnt(10) lgkmcnt(4)
    v_cvt_pk_bf16_f32 v228, v65, v69
    v_mfma_f32_16x16x32_bf16 v[80:83], v[32:35], v[168:171], 0
    v_cvt_pk_bf16_f32 v232, v66, v70
    v_mfma_f32_16x16x32_bf16 v[84:87], v[36:39], v[168:171], 0
    v_cvt_pk_bf16_f32 v236, v67, v71
    v_cvt_pk_bf16_f32 v225, v72, v76
    ds_read_b128 v[32:35], v13 offset:26624
    ds_read_b128 v[36:39], v13 offset:27648
    s_waitcnt vmcnt(8) lgkmcnt(4)
    v_cvt_pk_bf16_f32 v229, v73, v77
    v_mfma_f32_16x16x32_bf16 v[88:91], v[40:43], v[172:175], 0
    v_cvt_pk_bf16_f32 v233, v74, v78
    v_mfma_f32_16x16x32_bf16 v[92:95], v[44:47], v[172:175], 0
    v_cvt_pk_bf16_f32 v237, v75, v79
    v_cvt_pk_bf16_f32 v226, v80, v84
    ds_read_b128 v[40:43], v13 offset:28672
    ds_read_b128 v[44:47], v13 offset:29696
    s_waitcnt vmcnt(6) lgkmcnt(4)
    v_cvt_pk_bf16_f32 v230, v81, v85
    v_mfma_f32_16x16x32_bf16 v[64:67], v[24:27], v[176:179], 0
    v_cvt_pk_bf16_f32 v234, v82, v86
    v_mfma_f32_16x16x32_bf16 v[68:71], v[28:31], v[176:179], 0
    v_cvt_pk_bf16_f32 v238, v83, v87
    v_cvt_pk_bf16_f32 v227, v88, v92
    ds_read_b128 v[24:27], v13 offset:30720
    ds_read_b128 v[28:31], v13 offset:31744
    s_waitcnt vmcnt(4) lgkmcnt(4)
    v_cvt_pk_bf16_f32 v231, v89, v93
    v_mfma_f32_16x16x32_bf16 v[72:75], v[32:35], v[180:183], 0
    v_cvt_pk_bf16_f32 v235, v90, v94
    v_mfma_f32_16x16x32_bf16 v[76:79], v[36:39], v[180:183], 0
    v_cvt_pk_bf16_f32 v239, v91, v95
    v_cvt_pk_bf16_f32 v240, v64, v68
    s_waitcnt vmcnt(2) lgkmcnt(2)
    v_cvt_pk_bf16_f32 v244, v65, v69
    v_mfma_f32_16x16x32_bf16 v[80:83], v[40:43], v[184:187], 0
    v_cvt_pk_bf16_f32 v248, v66, v70
    v_mfma_f32_16x16x32_bf16 v[84:87], v[44:47], v[184:187], 0
    v_cvt_pk_bf16_f32 v252, v67, v71
    v_cvt_pk_bf16_f32 v241, v72, v76
    s_waitcnt vmcnt(0) lgkmcnt(0)
    v_cvt_pk_bf16_f32 v245, v73, v77
    v_mfma_f32_16x16x32_bf16 v[88:91], v[24:27], v[188:191], 0
    v_cvt_pk_bf16_f32 v249, v74, v78
    v_mfma_f32_16x16x32_bf16 v[92:95], v[28:31], v[188:191], 0
    v_cvt_pk_bf16_f32 v253, v75, v79
    v_cvt_pk_bf16_f32 v242, v80, v84
    v_cvt_pk_bf16_f32 v246, v81, v85
    v_cvt_pk_bf16_f32 v250, v82, v86
    v_cvt_pk_bf16_f32 v254, v83, v87
    s_nop 2
    v_cvt_pk_bf16_f32 v243, v88, v92
    v_cvt_pk_bf16_f32 v247, v89, v93
    v_cvt_pk_bf16_f32 v251, v90, v94
    v_cvt_pk_bf16_f32 v255, v91, v95
    ds_read_b64_tr_b16 v[48:49], v12 offset:0
    ds_read_b64_tr_b16 v[50:51], v12 offset:16384
    v_permlane32_swap_b32 v192, v224
    v_permlane32_swap_b32 v208, v240
    v_permlane32_swap_b32 v193, v225
    v_permlane32_swap_b32 v209, v241
    v_permlane32_swap_b32 v194, v226
    v_permlane32_swap_b32 v210, v242
    v_permlane32_swap_b32 v195, v227
    v_permlane32_swap_b32 v211, v243
    v_permlane32_swap_b32 v196, v228
    v_permlane32_swap_b32 v212, v244
    v_permlane32_swap_b32 v197, v229
    v_permlane32_swap_b32 v213, v245
    v_permlane32_swap_b32 v198, v230
    v_permlane32_swap_b32 v214, v246
    v_permlane32_swap_b32 v199, v231
    v_permlane32_swap_b32 v215, v247
    v_permlane32_swap_b32 v200, v232
    v_permlane32_swap_b32 v216, v248
    v_permlane32_swap_b32 v201, v233
    v_permlane32_swap_b32 v217, v249
    v_permlane32_swap_b32 v202, v234
    v_permlane32_swap_b32 v218, v250
    v_permlane32_swap_b32 v203, v235
    v_permlane32_swap_b32 v219, v251
    v_permlane32_swap_b32 v204, v236
    v_permlane32_swap_b32 v220, v252
    v_permlane32_swap_b32 v205, v237
    v_permlane32_swap_b32 v221, v253
    v_permlane32_swap_b32 v206, v238
    v_permlane32_swap_b32 v222, v254
    v_permlane32_swap_b32 v207, v239
    v_permlane32_swap_b32 v223, v255
    v_permlane16_swap_b32 v192, v208
    v_permlane16_swap_b32 v224, v240
    v_permlane16_swap_b32 v193, v209
    v_permlane16_swap_b32 v225, v241
    v_permlane16_swap_b32 v194, v210
    v_permlane16_swap_b32 v226, v242
    v_permlane16_swap_b32 v195, v211
    v_permlane16_swap_b32 v227, v243
    v_permlane16_swap_b32 v196, v212
    v_permlane16_swap_b32 v228, v244
    v_permlane16_swap_b32 v197, v213
    v_permlane16_swap_b32 v229, v245
    v_permlane16_swap_b32 v198, v214
    v_permlane16_swap_b32 v230, v246
    v_permlane16_swap_b32 v199, v215
    v_permlane16_swap_b32 v231, v247
    v_permlane16_swap_b32 v200, v216
    v_permlane16_swap_b32 v232, v248
    v_permlane16_swap_b32 v201, v217
    v_permlane16_swap_b32 v233, v249
    v_permlane16_swap_b32 v202, v218
    v_permlane16_swap_b32 v234, v250
    v_permlane16_swap_b32 v203, v219
    v_permlane16_swap_b32 v235, v251
    v_permlane16_swap_b32 v204, v220
    v_permlane16_swap_b32 v236, v252
    v_permlane16_swap_b32 v205, v221
    v_permlane16_swap_b32 v237, v253
    v_permlane16_swap_b32 v206, v222
    v_permlane16_swap_b32 v238, v254
    v_permlane16_swap_b32 v207, v223
    v_permlane16_swap_b32 v239, v255
    v_mfma_f32_16x16x32_bf16 v[64:67], v[16:19], v[192:195], 0
    v_mfma_f32_16x16x32_bf16 v[68:71], v[20:23], v[192:195], 0
    s_waitcnt lgkmcnt(0)
    ds_read_b64_tr_b16 v[52:53], v12 offset:1024
    ds_read_b64_tr_b16 v[54:55], v12 offset:17408
    ds_read_b128 v[24:27], v13 offset:0
    ds_read_b128 v[28:31], v13 offset:1024
    v_lshlrev_b32 v56, 16, v48
    v_and_b32 v57, s6, v48
    v_mfma_f32_16x16x32_bf16 v[72:75], v[16:19], v[196:199], 0
    v_lshlrev_b32 v58, 16, v49
    v_and_b32 v59, s6, v49
    v_lshlrev_b32 v60, 16, v50
    v_and_b32 v61, s6, v50
    v_lshlrev_b32 v62, 16, v51
    v_mfma_f32_16x16x32_bf16 v[76:79], v[20:23], v[196:199], 0
    v_and_b32 v63, s6, v51
    v_mul_f32 v104, v68, v60
    v_mul_f32 v108, v64, v60
    v_mul_f32 v105, v69, v61
    v_mul_f32 v109, v65, v61
    v_mul_f32 v106, v70, v62
    v_mul_f32 v110, v66, v62
    v_mul_f32 v107, v71, v63
    v_mul_f32 v111, v67, v63
    v_fma_f32 v64, v64, v56, -v104
    v_fma_f32 v68, -v68, v56, -v108
    v_fma_f32 v65, v65, v57, -v105
    v_fma_f32 v69, -v69, v57, -v109
    v_fma_f32 v66, v66, v58, -v106
    v_fma_f32 v70, -v70, v58, -v110
    v_fma_f32 v67, v67, v59, -v107
    v_fma_f32 v71, -v71, v59, -v111
    v_cvt_pk_bf16_f32 v96, v64, v68
    v_cvt_pk_bf16_f32 v97, v65, v69
    v_cvt_pk_bf16_f32 v98, v66, v70
    v_cvt_pk_bf16_f32 v99, v67, v71
    s_waitcnt lgkmcnt(0)
    ds_read_b64_tr_b16 v[48:49], v12 offset:2048
    ds_read_b64_tr_b16 v[50:51], v12 offset:18432
    ds_read_b128 v[32:35], v13 offset:2048
    ds_read_b128 v[36:39], v13 offset:3072
    v_lshlrev_b32 v56, 16, v52
    v_and_b32 v57, s6, v52
    v_mfma_f32_16x16x32_bf16 v[80:83], v[24:27], v[96:99], 0
    v_lshlrev_b32 v58, 16, v53
    v_and_b32 v59, s6, v53
    v_lshlrev_b32 v60, 16, v54
    v_and_b32 v61, s6, v54
    v_mfma_f32_16x16x32_bf16 v[84:87], v[28:31], v[96:99], 0
    v_lshlrev_b32 v62, 16, v55
    v_and_b32 v63, s6, v55
    v_mul_f32 v104, v76, v60
    v_mul_f32 v108, v72, v60
    v_mfma_f32_16x16x32_bf16 v[64:67], v[16:19], v[200:203], 0
    v_mul_f32 v105, v77, v61
    v_mul_f32 v109, v73, v61
    v_mul_f32 v106, v78, v62
    v_mul_f32 v110, v74, v62
    v_mfma_f32_16x16x32_bf16 v[68:71], v[20:23], v[200:203], 0
    v_mul_f32 v107, v79, v63
    v_mul_f32 v111, v75, v63
    v_fma_f32 v72, v72, v56, -v104
    v_fma_f32 v76, -v76, v56, -v108
    v_fma_f32 v73, v73, v57, -v105
    v_fma_f32 v77, -v77, v57, -v109
    v_fma_f32 v74, v74, v58, -v106
    v_fma_f32 v78, -v78, v58, -v110
    v_fma_f32 v75, v75, v59, -v107
    v_fma_f32 v79, -v79, v59, -v111
    v_cvt_pk_bf16_f32 v100, v72, v76
    v_cvt_pk_bf16_f32 v101, v73, v77
    v_cvt_pk_bf16_f32 v102, v74, v78
    v_cvt_pk_bf16_f32 v103, v75, v79
    v_cvt_pk_bf16_f32 v128, v80, v84
    v_cvt_pk_bf16_f32 v132, v81, v85
    v_cvt_pk_bf16_f32 v136, v82, v86
    v_cvt_pk_bf16_f32 v140, v83, v87
    s_waitcnt lgkmcnt(0)
    ds_read_b64_tr_b16 v[52:53], v12 offset:3072
    ds_read_b64_tr_b16 v[54:55], v12 offset:19456
    ds_read_b128 v[40:43], v13 offset:4096
    ds_read_b128 v[44:47], v13 offset:5120
    v_lshlrev_b32 v56, 16, v48
    v_and_b32 v57, s6, v48
    v_mfma_f32_16x16x32_bf16 v[88:91], v[32:35], v[100:103], 0
    v_lshlrev_b32 v58, 16, v49
    v_and_b32 v59, s6, v49
    v_lshlrev_b32 v60, 16, v50
    v_and_b32 v61, s6, v50
    v_mfma_f32_16x16x32_bf16 v[92:95], v[36:39], v[100:103], 0
    v_lshlrev_b32 v62, 16, v51
    v_and_b32 v63, s6, v51
    v_mul_f32 v104, v68, v60
    v_mul_f32 v108, v64, v60
    v_mfma_f32_16x16x32_bf16 v[72:75], v[16:19], v[204:207], 0
    v_mul_f32 v105, v69, v61
    v_mul_f32 v109, v65, v61
    v_mul_f32 v106, v70, v62
    v_mul_f32 v110, v66, v62
    v_mfma_f32_16x16x32_bf16 v[76:79], v[20:23], v[204:207], 0
    v_mul_f32 v107, v71, v63
    v_mul_f32 v111, v67, v63
    v_fma_f32 v64, v64, v56, -v104
    v_fma_f32 v68, -v68, v56, -v108
    v_fma_f32 v65, v65, v57, -v105
    v_fma_f32 v69, -v69, v57, -v109
    v_fma_f32 v66, v66, v58, -v106
    v_fma_f32 v70, -v70, v58, -v110
    v_fma_f32 v67, v67, v59, -v107
    v_fma_f32 v71, -v71, v59, -v111
    v_cvt_pk_bf16_f32 v96, v64, v68
    v_cvt_pk_bf16_f32 v97, v65, v69
    v_cvt_pk_bf16_f32 v98, v66, v70
    v_cvt_pk_bf16_f32 v99, v67, v71
    v_cvt_pk_bf16_f32 v129, v88, v92
    v_cvt_pk_bf16_f32 v133, v89, v93
    v_cvt_pk_bf16_f32 v137, v90, v94
    v_cvt_pk_bf16_f32 v141, v91, v95
    s_waitcnt lgkmcnt(0)
    ds_read_b64_tr_b16 v[48:49], v12 offset:4096
    ds_read_b64_tr_b16 v[50:51], v12 offset:20480
    ds_read_b128 v[24:27], v13 offset:6144
    ds_read_b128 v[28:31], v13 offset:7168
    v_lshlrev_b32 v56, 16, v52
    v_and_b32 v57, s6, v52
    v_mfma_f32_16x16x32_bf16 v[80:83], v[40:43], v[96:99], 0
    v_lshlrev_b32 v58, 16, v53
    v_and_b32 v59, s6, v53
    v_lshlrev_b32 v60, 16, v54
    v_and_b32 v61, s6, v54
    v_mfma_f32_16x16x32_bf16 v[84:87], v[44:47], v[96:99], 0
    v_lshlrev_b32 v62, 16, v55
    v_and_b32 v63, s6, v55
    v_mul_f32 v104, v76, v60
    v_mul_f32 v108, v72, v60
    v_mfma_f32_16x16x32_bf16 v[64:67], v[16:19], v[208:211], 0
    v_mul_f32 v105, v77, v61
    v_mul_f32 v109, v73, v61
    v_mul_f32 v106, v78, v62
    v_mul_f32 v110, v74, v62
    v_mfma_f32_16x16x32_bf16 v[68:71], v[20:23], v[208:211], 0
    v_mul_f32 v107, v79, v63
    v_mul_f32 v111, v75, v63
    v_fma_f32 v72, v72, v56, -v104
    v_fma_f32 v76, -v76, v56, -v108
    v_fma_f32 v73, v73, v57, -v105
    v_fma_f32 v77, -v77, v57, -v109
    v_fma_f32 v74, v74, v58, -v106
    v_fma_f32 v78, -v78, v58, -v110
    v_fma_f32 v75, v75, v59, -v107
    v_fma_f32 v79, -v79, v59, -v111
    v_cvt_pk_bf16_f32 v100, v72, v76
    v_cvt_pk_bf16_f32 v101, v73, v77
    v_cvt_pk_bf16_f32 v102, v74, v78
    v_cvt_pk_bf16_f32 v103, v75, v79
    v_cvt_pk_bf16_f32 v130, v80, v84
    v_cvt_pk_bf16_f32 v134, v81, v85
    v_cvt_pk_bf16_f32 v138, v82, v86
    v_cvt_pk_bf16_f32 v142, v83, v87
    s_waitcnt lgkmcnt(0)
    ds_read_b64_tr_b16 v[52:53], v12 offset:5120
    ds_read_b64_tr_b16 v[54:55], v12 offset:21504
    ds_read_b128 v[32:35], v13 offset:8192
    ds_read_b128 v[36:39], v13 offset:9216
    v_lshlrev_b32 v56, 16, v48
    v_and_b32 v57, s6, v48
    v_mfma_f32_16x16x32_bf16 v[88:91], v[24:27], v[100:103], 0
    v_lshlrev_b32 v58, 16, v49
    v_and_b32 v59, s6, v49
    v_lshlrev_b32 v60, 16, v50
    v_and_b32 v61, s6, v50
    v_mfma_f32_16x16x32_bf16 v[92:95], v[28:31], v[100:103], 0
    v_lshlrev_b32 v62, 16, v51
    v_and_b32 v63, s6, v51
    v_mul_f32 v104, v68, v60
    v_mul_f32 v108, v64, v60
    v_mfma_f32_16x16x32_bf16 v[72:75], v[16:19], v[212:215], 0
    v_mul_f32 v105, v69, v61
    v_mul_f32 v109, v65, v61
    v_mul_f32 v106, v70, v62
    v_mul_f32 v110, v66, v62
    v_mfma_f32_16x16x32_bf16 v[76:79], v[20:23], v[212:215], 0
    v_mul_f32 v107, v71, v63
    v_mul_f32 v111, v67, v63
    v_fma_f32 v64, v64, v56, -v104
    v_fma_f32 v68, -v68, v56, -v108
    v_fma_f32 v65, v65, v57, -v105
    v_fma_f32 v69, -v69, v57, -v109
    v_fma_f32 v66, v66, v58, -v106
    v_fma_f32 v70, -v70, v58, -v110
    v_fma_f32 v67, v67, v59, -v107
    v_fma_f32 v71, -v71, v59, -v111
    v_cvt_pk_bf16_f32 v96, v64, v68
    v_cvt_pk_bf16_f32 v97, v65, v69
    v_cvt_pk_bf16_f32 v98, v66, v70
    v_cvt_pk_bf16_f32 v99, v67, v71
    v_cvt_pk_bf16_f32 v131, v88, v92
    v_cvt_pk_bf16_f32 v135, v89, v93
    v_cvt_pk_bf16_f32 v139, v90, v94
    v_cvt_pk_bf16_f32 v143, v91, v95
    s_waitcnt lgkmcnt(0)
    ds_read_b64_tr_b16 v[48:49], v12 offset:6144
    ds_read_b64_tr_b16 v[50:51], v12 offset:22528
    ds_read_b128 v[40:43], v13 offset:10240
    ds_read_b128 v[44:47], v13 offset:11264
    v_lshlrev_b32 v56, 16, v52
    v_and_b32 v57, s6, v52
    v_mfma_f32_16x16x32_bf16 v[80:83], v[32:35], v[96:99], 0
    v_lshlrev_b32 v58, 16, v53
    v_and_b32 v59, s6, v53
    v_lshlrev_b32 v60, 16, v54
    v_and_b32 v61, s6, v54
    v_mfma_f32_16x16x32_bf16 v[84:87], v[36:39], v[96:99], 0
    v_lshlrev_b32 v62, 16, v55
    v_and_b32 v63, s6, v55
    v_mul_f32 v104, v76, v60
    v_mul_f32 v108, v72, v60
    v_mfma_f32_16x16x32_bf16 v[64:67], v[16:19], v[216:219], 0
    v_mul_f32 v105, v77, v61
    v_mul_f32 v109, v73, v61
    v_mul_f32 v106, v78, v62
    v_mul_f32 v110, v74, v62
    v_mfma_f32_16x16x32_bf16 v[68:71], v[20:23], v[216:219], 0
    v_mul_f32 v107, v79, v63
    v_mul_f32 v111, v75, v63
    v_fma_f32 v72, v72, v56, -v104
    v_fma_f32 v76, -v76, v56, -v108
    v_fma_f32 v73, v73, v57, -v105
    v_fma_f32 v77, -v77, v57, -v109
    v_fma_f32 v74, v74, v58, -v106
    v_fma_f32 v78, -v78, v58, -v110
    v_fma_f32 v75, v75, v59, -v107
    v_fma_f32 v79, -v79, v59, -v111
    v_cvt_pk_bf16_f32 v100, v72, v76
    v_cvt_pk_bf16_f32 v101, v73, v77
    v_cvt_pk_bf16_f32 v102, v74, v78
    v_cvt_pk_bf16_f32 v103, v75, v79
    v_cvt_pk_bf16_f32 v144, v80, v84
    v_cvt_pk_bf16_f32 v148, v81, v85
    v_cvt_pk_bf16_f32 v152, v82, v86
    v_cvt_pk_bf16_f32 v156, v83, v87
    s_waitcnt lgkmcnt(0)
    ds_read_b64_tr_b16 v[52:53], v12 offset:7168
    ds_read_b64_tr_b16 v[54:55], v12 offset:23552
    ds_read_b128 v[24:27], v13 offset:12288
    ds_read_b128 v[28:31], v13 offset:13312
    v_lshlrev_b32 v56, 16, v48
    v_and_b32 v57, s6, v48
    v_mfma_f32_16x16x32_bf16 v[88:91], v[40:43], v[100:103], 0
    v_lshlrev_b32 v58, 16, v49
    v_and_b32 v59, s6, v49
    v_lshlrev_b32 v60, 16, v50
    v_and_b32 v61, s6, v50
    v_mfma_f32_16x16x32_bf16 v[92:95], v[44:47], v[100:103], 0
    v_lshlrev_b32 v62, 16, v51
    v_and_b32 v63, s6, v51
    v_mul_f32 v104, v68, v60
    v_mul_f32 v108, v64, v60
    v_mfma_f32_16x16x32_bf16 v[72:75], v[16:19], v[220:223], 0
    v_mul_f32 v105, v69, v61
    v_mul_f32 v109, v65, v61
    v_mul_f32 v106, v70, v62
    v_mul_f32 v110, v66, v62
    v_mfma_f32_16x16x32_bf16 v[76:79], v[20:23], v[220:223], 0
    v_mul_f32 v107, v71, v63
    v_mul_f32 v111, v67, v63
    v_fma_f32 v64, v64, v56, -v104
    v_fma_f32 v68, -v68, v56, -v108
    v_fma_f32 v65, v65, v57, -v105
    v_fma_f32 v69, -v69, v57, -v109
    v_fma_f32 v66, v66, v58, -v106
    v_fma_f32 v70, -v70, v58, -v110
    v_fma_f32 v67, v67, v59, -v107
    v_fma_f32 v71, -v71, v59, -v111
    v_cvt_pk_bf16_f32 v96, v64, v68
    v_cvt_pk_bf16_f32 v97, v65, v69
    v_cvt_pk_bf16_f32 v98, v66, v70
    v_cvt_pk_bf16_f32 v99, v67, v71
    v_cvt_pk_bf16_f32 v145, v88, v92
    v_cvt_pk_bf16_f32 v149, v89, v93
    v_cvt_pk_bf16_f32 v153, v90, v94
    v_cvt_pk_bf16_f32 v157, v91, v95
    s_waitcnt lgkmcnt(0)
    ds_read_b64_tr_b16 v[48:49], v12 offset:8192
    ds_read_b64_tr_b16 v[50:51], v12 offset:24576
    ds_read_b128 v[32:35], v13 offset:14336
    ds_read_b128 v[36:39], v13 offset:15360
    v_lshlrev_b32 v56, 16, v52
    v_and_b32 v57, s6, v52
    v_mfma_f32_16x16x32_bf16 v[80:83], v[24:27], v[96:99], 0
    v_lshlrev_b32 v58, 16, v53
    v_and_b32 v59, s6, v53
    v_lshlrev_b32 v60, 16, v54
    v_and_b32 v61, s6, v54
    v_mfma_f32_16x16x32_bf16 v[84:87], v[28:31], v[96:99], 0
    v_lshlrev_b32 v62, 16, v55
    v_and_b32 v63, s6, v55
    v_mul_f32 v104, v76, v60
    v_mul_f32 v108, v72, v60
    v_mfma_f32_16x16x32_bf16 v[64:67], v[16:19], v[224:227], 0
    v_mul_f32 v105, v77, v61
    v_mul_f32 v109, v73, v61
    v_mul_f32 v106, v78, v62
    v_mul_f32 v110, v74, v62
    v_mfma_f32_16x16x32_bf16 v[68:71], v[20:23], v[224:227], 0
    v_mul_f32 v107, v79, v63
    v_mul_f32 v111, v75, v63
    v_fma_f32 v72, v72, v56, -v104
    v_fma_f32 v76, -v76, v56, -v108
    v_fma_f32 v73, v73, v57, -v105
    v_fma_f32 v77, -v77, v57, -v109
    v_fma_f32 v74, v74, v58, -v106
    v_fma_f32 v78, -v78, v58, -v110
    v_fma_f32 v75, v75, v59, -v107
    v_fma_f32 v79, -v79, v59, -v111
    v_cvt_pk_bf16_f32 v100, v72, v76
    v_cvt_pk_bf16_f32 v101, v73, v77
    v_cvt_pk_bf16_f32 v102, v74, v78
    v_cvt_pk_bf16_f32 v103, v75, v79
    v_cvt_pk_bf16_f32 v146, v80, v84
    v_cvt_pk_bf16_f32 v150, v81, v85
    v_cvt_pk_bf16_f32 v154, v82, v86
    v_cvt_pk_bf16_f32 v158, v83, v87
    s_waitcnt lgkmcnt(0)
    ds_read_b64_tr_b16 v[52:53], v12 offset:9216
    ds_read_b64_tr_b16 v[54:55], v12 offset:25600
    ds_read_b128 v[40:43], v13 offset:16384
    ds_read_b128 v[44:47], v13 offset:17408
    v_lshlrev_b32 v56, 16, v48
    v_and_b32 v57, s6, v48
    v_mfma_f32_16x16x32_bf16 v[88:91], v[32:35], v[100:103], 0
    v_lshlrev_b32 v58, 16, v49
    v_and_b32 v59, s6, v49
    v_lshlrev_b32 v60, 16, v50
    v_and_b32 v61, s6, v50
    v_mfma_f32_16x16x32_bf16 v[92:95], v[36:39], v[100:103], 0
    v_lshlrev_b32 v62, 16, v51
    v_and_b32 v63, s6, v51
    v_mul_f32 v104, v68, v60
    v_mul_f32 v108, v64, v60
    v_mfma_f32_16x16x32_bf16 v[72:75], v[16:19], v[228:231], 0
    v_mul_f32 v105, v69, v61
    v_mul_f32 v109, v65, v61
    v_mul_f32 v106, v70, v62
    v_mul_f32 v110, v66, v62
    v_mfma_f32_16x16x32_bf16 v[76:79], v[20:23], v[228:231], 0
    v_mul_f32 v107, v71, v63
    v_mul_f32 v111, v67, v63
    v_fma_f32 v64, v64, v56, -v104
    v_fma_f32 v68, -v68, v56, -v108
    v_fma_f32 v65, v65, v57, -v105
    v_fma_f32 v69, -v69, v57, -v109
    v_fma_f32 v66, v66, v58, -v106
    v_fma_f32 v70, -v70, v58, -v110
    v_fma_f32 v67, v67, v59, -v107
    v_fma_f32 v71, -v71, v59, -v111
    v_cvt_pk_bf16_f32 v96, v64, v68
    v_cvt_pk_bf16_f32 v97, v65, v69
    v_cvt_pk_bf16_f32 v98, v66, v70
    v_cvt_pk_bf16_f32 v99, v67, v71
    v_cvt_pk_bf16_f32 v147, v88, v92
    v_cvt_pk_bf16_f32 v151, v89, v93
    v_cvt_pk_bf16_f32 v155, v90, v94
    v_cvt_pk_bf16_f32 v159, v91, v95
    s_waitcnt lgkmcnt(0)
    ds_read_b64_tr_b16 v[48:49], v12 offset:10240
    ds_read_b64_tr_b16 v[50:51], v12 offset:26624
    ds_read_b128 v[24:27], v13 offset:18432
    ds_read_b128 v[28:31], v13 offset:19456
    v_lshlrev_b32 v56, 16, v52
    v_and_b32 v57, s6, v52
    v_mfma_f32_16x16x32_bf16 v[80:83], v[40:43], v[96:99], 0
    v_lshlrev_b32 v58, 16, v53
    v_and_b32 v59, s6, v53
    v_lshlrev_b32 v60, 16, v54
    v_and_b32 v61, s6, v54
    v_mfma_f32_16x16x32_bf16 v[84:87], v[44:47], v[96:99], 0
    v_lshlrev_b32 v62, 16, v55
    v_and_b32 v63, s6, v55
    v_mul_f32 v104, v76, v60
    v_mul_f32 v108, v72, v60
    v_mfma_f32_16x16x32_bf16 v[64:67], v[16:19], v[232:235], 0
    v_mul_f32 v105, v77, v61
    v_mul_f32 v109, v73, v61
    v_mul_f32 v106, v78, v62
    v_mul_f32 v110, v74, v62
    v_mfma_f32_16x16x32_bf16 v[68:71], v[20:23], v[232:235], 0
    v_mul_f32 v107, v79, v63
    v_mul_f32 v111, v75, v63
    v_fma_f32 v72, v72, v56, -v104
    v_fma_f32 v76, -v76, v56, -v108
    v_fma_f32 v73, v73, v57, -v105
    v_fma_f32 v77, -v77, v57, -v109
    v_fma_f32 v74, v74, v58, -v106
    v_fma_f32 v78, -v78, v58, -v110
    v_fma_f32 v75, v75, v59, -v107
    v_fma_f32 v79, -v79, v59, -v111
    v_cvt_pk_bf16_f32 v100, v72, v76
    v_cvt_pk_bf16_f32 v101, v73, v77
    v_cvt_pk_bf16_f32 v102, v74, v78
    v_cvt_pk_bf16_f32 v103, v75, v79
    v_cvt_pk_bf16_f32 v160, v80, v84
    v_cvt_pk_bf16_f32 v164, v81, v85
    v_cvt_pk_bf16_f32 v168, v82, v86
    v_cvt_pk_bf16_f32 v172, v83, v87
    s_waitcnt lgkmcnt(0)
    ds_read_b64_tr_b16 v[52:53], v12 offset:11264
    ds_read_b64_tr_b16 v[54:55], v12 offset:27648
    ds_read_b128 v[32:35], v13 offset:20480
    ds_read_b128 v[36:39], v13 offset:21504
    v_lshlrev_b32 v56, 16, v48
    v_and_b32 v57, s6, v48
    v_mfma_f32_16x16x32_bf16 v[88:91], v[24:27], v[100:103], 0
    v_lshlrev_b32 v58, 16, v49
    v_and_b32 v59, s6, v49
    v_lshlrev_b32 v60, 16, v50
    v_and_b32 v61, s6, v50
    v_mfma_f32_16x16x32_bf16 v[92:95], v[28:31], v[100:103], 0
    v_lshlrev_b32 v62, 16, v51
    v_and_b32 v63, s6, v51
    v_mul_f32 v104, v68, v60
    v_mul_f32 v108, v64, v60
    v_mfma_f32_16x16x32_bf16 v[72:75], v[16:19], v[236:239], 0
    v_mul_f32 v105, v69, v61
    v_mul_f32 v109, v65, v61
    v_mul_f32 v106, v70, v62
    v_mul_f32 v110, v66, v62
    v_mfma_f32_16x16x32_bf16 v[76:79], v[20:23], v[236:239], 0
    v_mul_f32 v107, v71, v63
    v_mul_f32 v111, v67, v63
    v_fma_f32 v64, v64, v56, -v104
    v_fma_f32 v68, -v68, v56, -v108
    v_fma_f32 v65, v65, v57, -v105
    v_fma_f32 v69, -v69, v57, -v109
    v_fma_f32 v66, v66, v58, -v106
    v_fma_f32 v70, -v70, v58, -v110
    v_fma_f32 v67, v67, v59, -v107
    v_fma_f32 v71, -v71, v59, -v111
    v_cvt_pk_bf16_f32 v96, v64, v68
    v_cvt_pk_bf16_f32 v97, v65, v69
    v_cvt_pk_bf16_f32 v98, v66, v70
    v_cvt_pk_bf16_f32 v99, v67, v71
    v_cvt_pk_bf16_f32 v161, v88, v92
    v_cvt_pk_bf16_f32 v165, v89, v93
    v_cvt_pk_bf16_f32 v169, v90, v94
    v_cvt_pk_bf16_f32 v173, v91, v95
    s_waitcnt lgkmcnt(0)
    ds_read_b64_tr_b16 v[48:49], v12 offset:12288
    ds_read_b64_tr_b16 v[50:51], v12 offset:28672
    ds_read_b128 v[40:43], v13 offset:22528
    ds_read_b128 v[44:47], v13 offset:23552
    v_lshlrev_b32 v56, 16, v52
    v_and_b32 v57, s6, v52
    v_mfma_f32_16x16x32_bf16 v[80:83], v[32:35], v[96:99], 0
    v_lshlrev_b32 v58, 16, v53
    v_and_b32 v59, s6, v53
    v_lshlrev_b32 v60, 16, v54
    v_and_b32 v61, s6, v54
    v_mfma_f32_16x16x32_bf16 v[84:87], v[36:39], v[96:99], 0
    v_lshlrev_b32 v62, 16, v55
    v_and_b32 v63, s6, v55
    v_mul_f32 v104, v76, v60
    v_mul_f32 v108, v72, v60
    v_mfma_f32_16x16x32_bf16 v[64:67], v[16:19], v[240:243], 0
    v_mul_f32 v105, v77, v61
    v_mul_f32 v109, v73, v61
    v_mul_f32 v106, v78, v62
    v_mul_f32 v110, v74, v62
    v_mfma_f32_16x16x32_bf16 v[68:71], v[20:23], v[240:243], 0
    v_mul_f32 v107, v79, v63
    v_mul_f32 v111, v75, v63
    v_fma_f32 v72, v72, v56, -v104
    v_fma_f32 v76, -v76, v56, -v108
    v_fma_f32 v73, v73, v57, -v105
    v_fma_f32 v77, -v77, v57, -v109
    v_fma_f32 v74, v74, v58, -v106
    v_fma_f32 v78, -v78, v58, -v110
    v_fma_f32 v75, v75, v59, -v107
    v_fma_f32 v79, -v79, v59, -v111
    v_cvt_pk_bf16_f32 v100, v72, v76
    v_cvt_pk_bf16_f32 v101, v73, v77
    v_cvt_pk_bf16_f32 v102, v74, v78
    v_cvt_pk_bf16_f32 v103, v75, v79
    v_cvt_pk_bf16_f32 v162, v80, v84
    v_cvt_pk_bf16_f32 v166, v81, v85
    v_cvt_pk_bf16_f32 v170, v82, v86
    v_cvt_pk_bf16_f32 v174, v83, v87
    s_waitcnt lgkmcnt(0)
    ds_read_b64_tr_b16 v[52:53], v12 offset:13312
    ds_read_b64_tr_b16 v[54:55], v12 offset:29696
    ds_read_b128 v[24:27], v13 offset:24576
    ds_read_b128 v[28:31], v13 offset:25600
    v_lshlrev_b32 v56, 16, v48
    v_and_b32 v57, s6, v48
    v_mfma_f32_16x16x32_bf16 v[88:91], v[40:43], v[100:103], 0
    v_lshlrev_b32 v58, 16, v49
    v_and_b32 v59, s6, v49
    v_lshlrev_b32 v60, 16, v50
    v_and_b32 v61, s6, v50
    v_mfma_f32_16x16x32_bf16 v[92:95], v[44:47], v[100:103], 0
    v_lshlrev_b32 v62, 16, v51
    v_and_b32 v63, s6, v51
    v_mul_f32 v104, v68, v60
    v_mul_f32 v108, v64, v60
    v_mfma_f32_16x16x32_bf16 v[72:75], v[16:19], v[244:247], 0
    v_mul_f32 v105, v69, v61
    v_mul_f32 v109, v65, v61
    v_mul_f32 v106, v70, v62
    v_mul_f32 v110, v66, v62
    v_mfma_f32_16x16x32_bf16 v[76:79], v[20:23], v[244:247], 0
    v_mul_f32 v107, v71, v63
    v_mul_f32 v111, v67, v63
    v_fma_f32 v64, v64, v56, -v104
    v_fma_f32 v68, -v68, v56, -v108
    v_fma_f32 v65, v65, v57, -v105
    v_fma_f32 v69, -v69, v57, -v109
    v_fma_f32 v66, v66, v58, -v106
    v_fma_f32 v70, -v70, v58, -v110
    v_fma_f32 v67, v67, v59, -v107
    v_fma_f32 v71, -v71, v59, -v111
    v_cvt_pk_bf16_f32 v96, v64, v68
    v_cvt_pk_bf16_f32 v97, v65, v69
    v_cvt_pk_bf16_f32 v98, v66, v70
    v_cvt_pk_bf16_f32 v99, v67, v71
    v_cvt_pk_bf16_f32 v163, v88, v92
    v_cvt_pk_bf16_f32 v167, v89, v93
    v_cvt_pk_bf16_f32 v171, v90, v94
    v_cvt_pk_bf16_f32 v175, v91, v95
    s_waitcnt lgkmcnt(0)
    ds_read_b64_tr_b16 v[48:49], v12 offset:14336
    ds_read_b64_tr_b16 v[50:51], v12 offset:30720
    ds_read_b128 v[32:35], v13 offset:26624
    ds_read_b128 v[36:39], v13 offset:27648
    v_lshlrev_b32 v56, 16, v52
    v_and_b32 v57, s6, v52
    v_mfma_f32_16x16x32_bf16 v[80:83], v[24:27], v[96:99], 0
    v_lshlrev_b32 v58, 16, v53
    v_and_b32 v59, s6, v53
    v_lshlrev_b32 v60, 16, v54
    v_and_b32 v61, s6, v54
    v_mfma_f32_16x16x32_bf16 v[84:87], v[28:31], v[96:99], 0
    v_lshlrev_b32 v62, 16, v55
    v_and_b32 v63, s6, v55
    v_mul_f32 v104, v76, v60
    v_mul_f32 v108, v72, v60
    v_mfma_f32_16x16x32_bf16 v[64:67], v[16:19], v[248:251], 0
    v_mul_f32 v105, v77, v61
    v_mul_f32 v109, v73, v61
    v_mul_f32 v106, v78, v62
    v_mul_f32 v110, v74, v62
    v_mfma_f32_16x16x32_bf16 v[68:71], v[20:23], v[248:251], 0
    v_mul_f32 v107, v79, v63
    v_mul_f32 v111, v75, v63
    v_fma_f32 v72, v72, v56, -v104
    v_fma_f32 v76, -v76, v56, -v108
    v_fma_f32 v73, v73, v57, -v105
    v_fma_f32 v77, -v77, v57, -v109
    v_fma_f32 v74, v74, v58, -v106
    v_fma_f32 v78, -v78, v58, -v110
    v_fma_f32 v75, v75, v59, -v107
    v_fma_f32 v79, -v79, v59, -v111
    v_cvt_pk_bf16_f32 v100, v72, v76
    v_cvt_pk_bf16_f32 v101, v73, v77
    v_cvt_pk_bf16_f32 v102, v74, v78
    v_cvt_pk_bf16_f32 v103, v75, v79
    v_cvt_pk_bf16_f32 v176, v80, v84
    v_cvt_pk_bf16_f32 v180, v81, v85
    v_cvt_pk_bf16_f32 v184, v82, v86
    v_cvt_pk_bf16_f32 v188, v83, v87
    s_waitcnt lgkmcnt(0)
    ds_read_b64_tr_b16 v[52:53], v12 offset:15360
    ds_read_b64_tr_b16 v[54:55], v12 offset:31744
    ds_read_b128 v[40:43], v13 offset:28672
    ds_read_b128 v[44:47], v13 offset:29696
    v_lshlrev_b32 v56, 16, v48
    v_and_b32 v57, s6, v48
    v_mfma_f32_16x16x32_bf16 v[88:91], v[32:35], v[100:103], 0
    v_lshlrev_b32 v58, 16, v49
    v_and_b32 v59, s6, v49
    v_lshlrev_b32 v60, 16, v50
    v_and_b32 v61, s6, v50
    v_mfma_f32_16x16x32_bf16 v[92:95], v[36:39], v[100:103], 0
    v_lshlrev_b32 v62, 16, v51
    v_and_b32 v63, s6, v51
    v_mul_f32 v104, v68, v60
    v_mul_f32 v108, v64, v60
    v_mfma_f32_16x16x32_bf16 v[72:75], v[16:19], v[252:255], 0
    v_mul_f32 v105, v69, v61
    v_mul_f32 v109, v65, v61
    v_mul_f32 v106, v70, v62
    v_mul_f32 v110, v66, v62
    v_mfma_f32_16x16x32_bf16 v[76:79], v[20:23], v[252:255], 0
    v_mul_f32 v107, v71, v63
    v_mul_f32 v111, v67, v63
    v_fma_f32 v64, v64, v56, -v104
    v_fma_f32 v68, -v68, v56, -v108
    v_fma_f32 v65, v65, v57, -v105
    v_fma_f32 v69, -v69, v57, -v109
    v_fma_f32 v66, v66, v58, -v106
    v_fma_f32 v70, -v70, v58, -v110
    v_fma_f32 v67, v67, v59, -v107
    v_fma_f32 v71, -v71, v59, -v111
    v_cvt_pk_bf16_f32 v96, v64, v68
    v_cvt_pk_bf16_f32 v97, v65, v69
    v_cvt_pk_bf16_f32 v98, v66, v70
    v_cvt_pk_bf16_f32 v99, v67, v71
    v_cvt_pk_bf16_f32 v177, v88, v92
    v_cvt_pk_bf16_f32 v181, v89, v93
    v_cvt_pk_bf16_f32 v185, v90, v94
    v_cvt_pk_bf16_f32 v189, v91, v95
    s_waitcnt lgkmcnt(0)
    ds_read_b128 v[24:27], v13 offset:30720
    ds_read_b128 v[28:31], v13 offset:31744
    v_lshlrev_b32 v56, 16, v52
    v_and_b32 v57, s6, v52
    v_lshlrev_b32 v58, 16, v53
    v_mfma_f32_16x16x32_bf16 v[80:83], v[40:43], v[96:99], 0
    v_and_b32 v59, s6, v53
    v_lshlrev_b32 v60, 16, v54
    v_and_b32 v61, s6, v54
    v_lshlrev_b32 v62, 16, v55
    v_and_b32 v63, s6, v55
    v_mfma_f32_16x16x32_bf16 v[84:87], v[44:47], v[96:99], 0
    v_mul_f32 v104, v76, v60
    v_mul_f32 v108, v72, v60
    v_mul_f32 v105, v77, v61
    v_mul_f32 v109, v73, v61
    v_mul_f32 v106, v78, v62
    v_mul_f32 v110, v74, v62
    v_mul_f32 v107, v79, v63
    v_mul_f32 v111, v75, v63
    v_fma_f32 v72, v72, v56, -v104
    v_fma_f32 v76, -v76, v56, -v108
    v_fma_f32 v73, v73, v57, -v105
    v_fma_f32 v77, -v77, v57, -v109
    v_fma_f32 v74, v74, v58, -v106
    v_fma_f32 v78, -v78, v58, -v110
    v_fma_f32 v75, v75, v59, -v107
    v_fma_f32 v79, -v79, v59, -v111
    v_cvt_pk_bf16_f32 v100, v72, v76
    v_cvt_pk_bf16_f32 v101, v73, v77
    v_cvt_pk_bf16_f32 v102, v74, v78
    v_cvt_pk_bf16_f32 v103, v75, v79
    v_cvt_pk_bf16_f32 v178, v80, v84
    v_cvt_pk_bf16_f32 v182, v81, v85
    v_cvt_pk_bf16_f32 v186, v82, v86
    v_cvt_pk_bf16_f32 v190, v83, v87
    s_waitcnt lgkmcnt(0)
    v_mfma_f32_16x16x32_bf16 v[88:91], v[24:27], v[100:103], 0
    v_mfma_f32_16x16x32_bf16 v[92:95], v[28:31], v[100:103], 0
    s_nop 7
    v_cvt_pk_bf16_f32 v179, v88, v92
    v_cvt_pk_bf16_f32 v183, v89, v93
    v_cvt_pk_bf16_f32 v187, v90, v94
    v_cvt_pk_bf16_f32 v191, v91, v95
    v_permlane32_swap_b32 v128, v160
    v_permlane32_swap_b32 v144, v176
    v_permlane32_swap_b32 v129, v161
    v_permlane32_swap_b32 v145, v177
    v_permlane32_swap_b32 v130, v162
    v_permlane32_swap_b32 v146, v178
    v_permlane32_swap_b32 v131, v163
    v_permlane32_swap_b32 v147, v179
    v_permlane32_swap_b32 v132, v164
    v_permlane32_swap_b32 v148, v180
    v_permlane32_swap_b32 v133, v165
    v_permlane32_swap_b32 v149, v181
    v_permlane32_swap_b32 v134, v166
    v_permlane32_swap_b32 v150, v182
    v_permlane32_swap_b32 v135, v167
    v_permlane32_swap_b32 v151, v183
    v_permlane32_swap_b32 v136, v168
    v_permlane32_swap_b32 v152, v184
    v_permlane32_swap_b32 v137, v169
    v_permlane32_swap_b32 v153, v185
    v_permlane32_swap_b32 v138, v170
    v_permlane32_swap_b32 v154, v186
    v_permlane32_swap_b32 v139, v171
    v_permlane32_swap_b32 v155, v187
    v_permlane32_swap_b32 v140, v172
    v_permlane32_swap_b32 v156, v188
    v_permlane32_swap_b32 v141, v173
    v_permlane32_swap_b32 v157, v189
    v_permlane32_swap_b32 v142, v174
    v_permlane32_swap_b32 v158, v190
    v_permlane32_swap_b32 v143, v175
    v_permlane32_swap_b32 v159, v191
    v_permlane16_swap_b32 v128, v144
    v_permlane16_swap_b32 v160, v176
    v_permlane16_swap_b32 v129, v145
    v_permlane16_swap_b32 v161, v177
    v_permlane16_swap_b32 v130, v146
    v_permlane16_swap_b32 v162, v178
    v_permlane16_swap_b32 v131, v147
    v_permlane16_swap_b32 v163, v179
    v_permlane16_swap_b32 v132, v148
    v_permlane16_swap_b32 v164, v180
    v_permlane16_swap_b32 v133, v149
    v_permlane16_swap_b32 v165, v181
    v_permlane16_swap_b32 v134, v150
    v_permlane16_swap_b32 v166, v182
    v_permlane16_swap_b32 v135, v151
    v_permlane16_swap_b32 v167, v183
    v_permlane16_swap_b32 v136, v152
    v_permlane16_swap_b32 v168, v184
    v_permlane16_swap_b32 v137, v153
    v_permlane16_swap_b32 v169, v185
    v_permlane16_swap_b32 v138, v154
    v_permlane16_swap_b32 v170, v186
    v_permlane16_swap_b32 v139, v155
    v_permlane16_swap_b32 v171, v187
    v_permlane16_swap_b32 v140, v156
    v_permlane16_swap_b32 v172, v188
    v_permlane16_swap_b32 v141, v157
    v_permlane16_swap_b32 v173, v189
    v_permlane16_swap_b32 v142, v158
    v_permlane16_swap_b32 v174, v190
    v_permlane16_swap_b32 v143, v159
    v_permlane16_swap_b32 v175, v191
    v_mfma_f32_16x16x32_bf16 v[64:67], v[16:19], v[128:131], 0
    v_mfma_f32_16x16x32_bf16 v[68:71], v[20:23], v[128:131], 0
    v_mfma_f32_16x16x32_bf16 v[72:75], v[16:19], v[132:135], 0
    v_mfma_f32_16x16x32_bf16 v[76:79], v[20:23], v[132:135], 0
    s_nop 5
    v_cvt_pk_bf16_f32 v112, v64, v68
    v_mfma_f32_16x16x32_bf16 v[80:83], v[16:19], v[136:139], 0
    v_cvt_pk_bf16_f32 v113, v65, v69
    v_cvt_pk_bf16_f32 v114, v66, v70
    v_cvt_pk_bf16_f32 v115, v67, v71
    v_mfma_f32_16x16x32_bf16 v[84:87], v[20:23], v[136:139], 0
    s_mov_b32 s3, 0
    buffer_store_dwordx4 v[112:115], v11, s[20:23], s3 offen sc1
    v_cvt_pk_bf16_f32 v116, v72, v76
    v_mfma_f32_16x16x32_bf16 v[88:91], v[16:19], v[140:143], 0
    v_cvt_pk_bf16_f32 v117, v73, v77
    v_cvt_pk_bf16_f32 v118, v74, v78
    v_cvt_pk_bf16_f32 v119, v75, v79
    v_mfma_f32_16x16x32_bf16 v[92:95], v[20:23], v[140:143], 0
    s_mov_b32 s3, 262144
    buffer_store_dwordx4 v[116:119], v11, s[20:23], s3 offen sc1
    v_cvt_pk_bf16_f32 v120, v80, v84
    v_mfma_f32_16x16x32_bf16 v[64:67], v[16:19], v[144:147], 0
    v_cvt_pk_bf16_f32 v121, v81, v85
    v_cvt_pk_bf16_f32 v122, v82, v86
    v_cvt_pk_bf16_f32 v123, v83, v87
    v_mfma_f32_16x16x32_bf16 v[68:71], v[20:23], v[144:147], 0
    s_mov_b32 s3, 524288
    buffer_store_dwordx4 v[120:123], v11, s[20:23], s3 offen sc1
    v_cvt_pk_bf16_f32 v124, v88, v92
    v_mfma_f32_16x16x32_bf16 v[72:75], v[16:19], v[148:151], 0
    v_cvt_pk_bf16_f32 v125, v89, v93
    v_cvt_pk_bf16_f32 v126, v90, v94
    v_cvt_pk_bf16_f32 v127, v91, v95
    v_mfma_f32_16x16x32_bf16 v[76:79], v[20:23], v[148:151], 0
    s_mov_b32 s3, 786432
    buffer_store_dwordx4 v[124:127], v11, s[20:23], s3 offen sc1
    v_cvt_pk_bf16_f32 v112, v64, v68
    v_mfma_f32_16x16x32_bf16 v[80:83], v[16:19], v[152:155], 0
    v_cvt_pk_bf16_f32 v113, v65, v69
    v_cvt_pk_bf16_f32 v114, v66, v70
    v_cvt_pk_bf16_f32 v115, v67, v71
    v_mfma_f32_16x16x32_bf16 v[84:87], v[20:23], v[152:155], 0
    s_mov_b32 s3, 1048576
    buffer_store_dwordx4 v[112:115], v11, s[20:23], s3 offen sc1
    v_cvt_pk_bf16_f32 v116, v72, v76
    v_mfma_f32_16x16x32_bf16 v[88:91], v[16:19], v[156:159], 0
    v_cvt_pk_bf16_f32 v117, v73, v77
    v_cvt_pk_bf16_f32 v118, v74, v78
    v_cvt_pk_bf16_f32 v119, v75, v79
    v_mfma_f32_16x16x32_bf16 v[92:95], v[20:23], v[156:159], 0
    s_mov_b32 s3, 1310720
    buffer_store_dwordx4 v[116:119], v11, s[20:23], s3 offen sc1
    v_cvt_pk_bf16_f32 v120, v80, v84
    v_mfma_f32_16x16x32_bf16 v[64:67], v[16:19], v[160:163], 0
    v_cvt_pk_bf16_f32 v121, v81, v85
    v_cvt_pk_bf16_f32 v122, v82, v86
    v_cvt_pk_bf16_f32 v123, v83, v87
    v_mfma_f32_16x16x32_bf16 v[68:71], v[20:23], v[160:163], 0
    s_mov_b32 s3, 1572864
    buffer_store_dwordx4 v[120:123], v11, s[20:23], s3 offen sc1
    v_cvt_pk_bf16_f32 v124, v88, v92
    v_mfma_f32_16x16x32_bf16 v[72:75], v[16:19], v[164:167], 0
    v_cvt_pk_bf16_f32 v125, v89, v93
    v_cvt_pk_bf16_f32 v126, v90, v94
    v_cvt_pk_bf16_f32 v127, v91, v95
    v_mfma_f32_16x16x32_bf16 v[76:79], v[20:23], v[164:167], 0
    s_mov_b32 s3, 1835008
    buffer_store_dwordx4 v[124:127], v11, s[20:23], s3 offen sc1
    v_cvt_pk_bf16_f32 v112, v64, v68
    v_mfma_f32_16x16x32_bf16 v[80:83], v[16:19], v[168:171], 0
    v_cvt_pk_bf16_f32 v113, v65, v69
    v_cvt_pk_bf16_f32 v114, v66, v70
    v_cvt_pk_bf16_f32 v115, v67, v71
    v_mfma_f32_16x16x32_bf16 v[84:87], v[20:23], v[168:171], 0
    s_mov_b32 s3, 2097152
    buffer_store_dwordx4 v[112:115], v11, s[20:23], s3 offen sc1
    v_cvt_pk_bf16_f32 v116, v72, v76
    v_mfma_f32_16x16x32_bf16 v[88:91], v[16:19], v[172:175], 0
    v_cvt_pk_bf16_f32 v117, v73, v77
    v_cvt_pk_bf16_f32 v118, v74, v78
    v_cvt_pk_bf16_f32 v119, v75, v79
    v_mfma_f32_16x16x32_bf16 v[92:95], v[20:23], v[172:175], 0
    s_mov_b32 s3, 2359296
    buffer_store_dwordx4 v[116:119], v11, s[20:23], s3 offen sc1
    v_cvt_pk_bf16_f32 v120, v80, v84
    v_mfma_f32_16x16x32_bf16 v[64:67], v[16:19], v[176:179], 0
    v_cvt_pk_bf16_f32 v121, v81, v85
    v_cvt_pk_bf16_f32 v122, v82, v86
    v_cvt_pk_bf16_f32 v123, v83, v87
    v_mfma_f32_16x16x32_bf16 v[68:71], v[20:23], v[176:179], 0
    s_mov_b32 s3, 2621440
    buffer_store_dwordx4 v[120:123], v11, s[20:23], s3 offen sc1
    v_cvt_pk_bf16_f32 v124, v88, v92
    v_mfma_f32_16x16x32_bf16 v[72:75], v[16:19], v[180:183], 0
    v_cvt_pk_bf16_f32 v125, v89, v93
    v_cvt_pk_bf16_f32 v126, v90, v94
    v_cvt_pk_bf16_f32 v127, v91, v95
    v_mfma_f32_16x16x32_bf16 v[76:79], v[20:23], v[180:183], 0
    s_mov_b32 s3, 2883584
    buffer_store_dwordx4 v[124:127], v11, s[20:23], s3 offen sc1
    v_cvt_pk_bf16_f32 v112, v64, v68
    v_mfma_f32_16x16x32_bf16 v[80:83], v[16:19], v[184:187], 0
    v_cvt_pk_bf16_f32 v113, v65, v69
    v_cvt_pk_bf16_f32 v114, v66, v70
    v_cvt_pk_bf16_f32 v115, v67, v71
    v_mfma_f32_16x16x32_bf16 v[84:87], v[20:23], v[184:187], 0
    s_mov_b32 s3, 3145728
    buffer_store_dwordx4 v[112:115], v11, s[20:23], s3 offen sc1
    v_cvt_pk_bf16_f32 v116, v72, v76
    v_mfma_f32_16x16x32_bf16 v[88:91], v[16:19], v[188:191], 0
    v_cvt_pk_bf16_f32 v117, v73, v77
    v_cvt_pk_bf16_f32 v118, v74, v78
    v_cvt_pk_bf16_f32 v119, v75, v79
    v_mfma_f32_16x16x32_bf16 v[92:95], v[20:23], v[188:191], 0
    s_mov_b32 s3, 3407872
    buffer_store_dwordx4 v[116:119], v11, s[20:23], s3 offen sc1
    v_cvt_pk_bf16_f32 v120, v80, v84
    v_cvt_pk_bf16_f32 v121, v81, v85
    v_cvt_pk_bf16_f32 v122, v82, v86
    v_cvt_pk_bf16_f32 v123, v83, v87
    s_mov_b32 s3, 3670016
    buffer_store_dwordx4 v[120:123], v11, s[20:23], s3 offen sc1
    v_cvt_pk_bf16_f32 v124, v88, v92
    v_cvt_pk_bf16_f32 v125, v89, v93
    v_cvt_pk_bf16_f32 v126, v90, v94
    v_cvt_pk_bf16_f32 v127, v91, v95
    s_mov_b32 s3, 3932160
    buffer_store_dwordx4 v[124:127], v11, s[20:23], s3 offen sc1
    s_load_dwordx2 s[92:93], s[0:1], 48
    s_lshr_b32 s5, s2, 5
    s_lshl_b32 s5, s5, 8
    v_lshrrev_b32 v28, 4, v1
    v_lshlrev_b32 v29, 1, v28
    v_xor_b32 v29, v29, v1
    v_and_b32 v29, 15, v29
    v_lshlrev_b32 v28, 11, v28
    v_lshl_add_u32 v28, v29, 4, v28
    v_add_u32 v24, s5, v28
    v_xor_b32 v25, 128, v24
    v_add_u32 v25, 7168, v25
    v_add_u32 v26, 14336, v24
    v_add_u32 v27, 14336, v25
    s_and_b32 s5, s2, 1
    s_mul_i32 s5, s5, 3670016
    s_lshl_b32 s6, s44, 15
    s_add_u32 s96, s5, s6
    s_lshl_b32 s97, s44, 12
    s_mov_b32 s94, 7340032
    s_mov_b32 s95, 0x20000
    s_lshl_b32 s43, s2, 2
    s_add_u32 s43, s43, 8192
    s_mov_b32 s44, 0xffff
    s_branch L_post
L_kb_exit:
    s_endpgm
.p2align 6
.type touch_tab,@object
touch_tab:
.long 20,28,1279,1050,276,284,1279,1051,9,17,1279,1052,265,273,1279,1053,21,29,1279,1054,277,285,1279,1055,10,18,1024,1279,266,274,1025,1279,22,30,1026,1279,278,286,1027,1279,11,19,1028,1279,267,275,1029,1279,23,31,1030,1279,279,287,1031,1279,12,1279,1032,1279,268,1279,1033,1279,24,1279,1034,1279,280,1279,1035,1279,13,1279,1036,1279,269,1279,1037,1279,25,1279,1038,1279,281,1279,1039,1279,14,1279,1040,1279,270,1279,1041,1279,26,1279,1042,1279,282,1279,1043,1279,15,1279,1044,1279,271,1279,1045,1279,27,1279,1046,1279,283,1279,1047,1279,16,1279,1048,1279,272,1279,1049,1279
.size touch_tab, 512
.p2align 8
.type spec_tables,@object
spec_tables:
.long 0x3f803f80,0x3f803f80,0x3f803f80,0x3f803f80,0x3f7f3f80,0x3f753f7b,0xbdc90000,0xbe95be48,0x3f7b3f80,0x3f553f6d,0xbf7bbf80,0xbf55bf6d,0x3f753f80,0x3f223f55,0x3e950000,0x3f463f0e
.long 0x3f6d3f80,0x3ec43f35,0x3f6d3f80,0x3ec43f35,0x3f623f80,0x3dc93f0e,0xbef10000,0xbf7fbf55,0x3f553f80,0xbe483ec4,0xbf55bf80,0x3e48bec4,0x3f463f80,0xbef13e48,0x3f220000,0x3f623f7b
.long 0x3f353f80,0xbf350000,0x3f353f80,0xbf350000,0x3f223f80,0xbf62be48,0xbf460000,0xbef1bf7b,0x3f0e3f80,0xbf7bbec4,0xbf0ebf80,0x3f7b3ec4,0x3ef13f80,0xbf7fbf0e,0x3f620000,0xbdc93f55
.long 0x3ec43f80,0xbf6dbf35,0x3ec43f80,0xbf6dbf35,0x3e953f80,0xbf46bf55,0xbf750000,0x3f22bf0e,0x3e483f80,0xbf0ebf6d,0xbe48bf80,0x3f0e3f6d,0x3dc93f80,0xbe95bf7b,0x3f7f0000,0xbf753e48
.long 0x3f803f80,0x3f803f80,0x3f803f80,0x3f803f80,0x3f623f6d,0x3f463f55,0xbef1bec4,0xbf22bf0e,0x3f0e3f35,0x3e483ec4,0xbf0ebf35,0xbe48bec4,0x3dc93ec4,0xbef1be48,0x3f7f3f6d,0x3f623f7b
.long 0xbec40000,0xbf6dbf35,0xbec40000,0xbf6dbf35,0xbf46bec4,0xbf75bf7b,0xbf22bf6d,0x3e95be48,0xbf7bbf35,0xbf0ebf6d,0x3f7b3f35,0x3f0e3f6d,0xbf75bf6d,0x3dc9bf0e,0xbe953ec4,0xbf7fbf55
.long 0xbf35bf80,0x3f350000,0xbf35bf80,0x3f350000,0xbe95bf6d,0x3f7f3f0e,0x3f753ec4,0x3dc93f55,0x3e48bf35,0x3f553f6d,0xbe483f35,0xbf55bf6d,0x3f22bec4,0x3e953f7b,0xbf46bf6d,0x3f753e48
.long 0x3f6d0000,0xbec43f35,0x3f6d0000,0xbec43f35,0x3f7f3ec4,0xbf623e48,0xbdc93f6d,0xbef1bf7b,0x3f553f35,0xbf7bbec4,0xbf55bf35,0x3f7b3ec4,0x3ef13f6d,0xbf22bf55,0x3f62bec4,0xbf463f0e
.long 0x3f803f80,0x3f803f80,0x3f803f80,0x3f803f80,0x3f223f35,0x3ef13f0e,0xbf46bf35,0xbf62bf55,0xbe480000,0xbf0ebec4,0x3e480000,0x3f0e3ec4,0xbf62bf35,0xbf7fbf7b,0x3ef13f35,0xbdc93e48
.long 0xbf6dbf80,0xbec4bf35,0xbf6dbf80,0xbec4bf35,0xbe95bf35,0x3f223e48,0x3f753f35,0x3f463f7b,0x3f0e0000,0x3f7b3f6d,0xbf0e0000,0xbf7bbf6d,0x3f7f3f35,0x3e953f55,0xbdc9bf35,0x3f753f0e
.long 0x3f353f80,0xbf350000,0x3f353f80,0xbf350000,0xbdc93f35,0xbf75bf55,0xbf7fbf35,0x3e95bf0e,0xbf550000,0xbe48bf6d,0x3f550000,0x3e483f6d,0xbf75bf35,0x3f46be48,0xbe953f35,0xbf22bf7b
.long 0xbec4bf80,0x3f6d3f35,0xbec4bf80,0x3f6d3f35,0x3ef1bf35,0x3dc93f7b,0x3f623f35,0xbf7fbe48,0x3f7b0000,0xbf553ec4,0xbf7b0000,0x3f55bec4,0x3f463f35,0xbf62bf0e,0x3f22bf35,0xbef13f55
.long 0x3f803f80,0x3f803f80,0x3f803f80,0x3f803f80,0x3e953ec4,0x3dc93e48,0xbf75bf6d,0xbf7fbf7b,0xbf55bf35,0xbf7bbf6d,0x3f553f35,0x3f7b3f6d,0xbf46bf6d,0xbe95bf0e,0xbf22bec4,0xbf75bf55
.long 0x3ec40000,0x3f6d3f35,0x3ec40000,0x3f6d3f35,0x3f7f3f6d,0x3ef13f55,0xbdc93ec4,0xbf62bf0e,0x3e483f35,0xbf55bec4,0xbe48bf35,0x3f553ec4,0xbf62bec4,0xbf22bf7b,0x3ef13f6d,0xbf46be48
.long 0xbf35bf80,0x3f350000,0xbf35bf80,0x3f350000,0x3ef1bec4,0x3f463f7b,0x3f623f6d,0xbf223e48,0x3f7b3f35,0xbf0e3ec4,0xbf7bbf35,0x3f0ebec4,0x3dc93f6d,0xbf62bf55,0x3f7f3ec4,0xbef13f0e
.long 0xbf6d0000,0x3ec4bf35,0xbf6d0000,0x3ec4bf35,0xbf22bf6d,0x3f753f0e,0x3f46bec4,0xbe953f55,0x3f0ebf35,0xbe483f6d,0xbf0e3f35,0x3e48bf6d,0x3f753ec4,0xbf7fbe48,0x3e95bf6d,0xbdc93f7b
.long 0x3f803f80,0x3f803f80,0x3f803f80,0x3f803f80,0xbf7fbf80,0xbf75bf7b,0x3dc90000,0x3e953e48,0x3f7b3f80,0x3f553f6d,0xbf7bbf80,0xbf55bf6d,0xbf75bf80,0xbf22bf55,0xbe950000,0xbf46bf0e
.long 0x3f6d3f80,0x3ec43f35,0x3f6d3f80,0x3ec43f35,0xbf62bf80,0xbdc9bf0e,0x3ef10000,0x3f7f3f55,0x3f553f80,0xbe483ec4,0xbf55bf80,0x3e48bec4,0xbf46bf80,0x3ef1be48,0xbf220000,0xbf62bf7b
.long 0x3f353f80,0xbf350000,0x3f353f80,0xbf350000,0xbf22bf80,0x3f623e48,0x3f460000,0x3ef13f7b,0x3f0e3f80,0xbf7bbec4,0xbf0ebf80,0x3f7b3ec4,0xbef1bf80,0x3f7f3f0e,0xbf620000,0x3dc9bf55
.long 0x3ec43f80,0xbf6dbf35,0x3ec43f80,0xbf6dbf35,0xbe95bf80,0x3f463f55,0x3f750000,0xbf223f0e,0x3e483f80,0xbf0ebf6d,0xbe48bf80,0x3f0e3f6d,0xbdc9bf80,0x3e953f7b,0xbf7f0000,0x3f75be48
.long 0x3f803f80,0x3f803f80,0x3f803f80,0x3f803f80,0xbf62bf6d,0xbf46bf55,0x3ef13ec4,0x3f223f0e,0x3f0e3f35,0x3e483ec4,0xbf0ebf35,0xbe48bec4,0xbdc9bec4,0x3ef13e48,0xbf7fbf6d,0xbf62bf7b
.long 0xbec40000,0xbf6dbf35,0xbec40000,0xbf6dbf35,0x3f463ec4,0x3f753f7b,0x3f223f6d,0xbe953e48,0xbf7bbf35,0xbf0ebf6d,0x3f7b3f35,0x3f0e3f6d,0x3f753f6d,0xbdc93f0e,0x3e95bec4,0x3f7f3f55
.long 0xbf35bf80,0x3f350000,0xbf35bf80,0x3f350000,0x3e953f6d,0xbf7fbf0e,0xbf75bec4,0xbdc9bf55,0x3e48bf35,0x3f553f6d,0xbe483f35,0xbf55bf6d,0xbf223ec4,0xbe95bf7b,0x3f463f6d,0xbf75be48
.long 0x3f6d0000,0xbec43f35,0x3f6d0000,0xbec43f35,0xbf7fbec4,0x3f62be48,0x3dc9bf6d,0x3ef13f7b,0x3f553f35,0xbf7bbec4,0xbf55bf35,0x3f7b3ec4,0xbef1bf6d,0x3f223f55,0xbf623ec4,0x3f46bf0e
.long 0x3f803f80,0x3f803f80,0x3f803f80,0x3f803f80,0xbf22bf35,0xbef1bf0e,0x3f463f35,0x3f623f55,0xbe480000,0xbf0ebec4,0x3e480000,0x3f0e3ec4,0x3f623f35,0x3f7f3f7b,0xbef1bf35,0x3dc9be48
.long 0xbf6dbf80,0xbec4bf35,0xbf6dbf80,0xbec4bf35,0x3e953f35,0xbf22be48,0xbf75bf35,0xbf46bf7b,0x3f0e0000,0x3f7b3f6d,0xbf0e0000,0xbf7bbf6d,0xbf7fbf35,0xbe95bf55,0x3dc93f35,0xbf75bf0e
.long 0x3f353f80,0xbf350000,0x3f353f80,0xbf350000,0x3dc9bf35,0x3f753f55,0x3f7f3f35,0xbe953f0e,0xbf550000,0xbe48bf6d,0x3f550000,0x3e483f6d,0x3f753f35,0xbf463e48,0x3e95bf35,0x3f223f7b
.long 0xbec4bf80,0x3f6d3f35,0xbec4bf80,0x3f6d3f35,0xbef13f35,0xbdc9bf7b,0xbf62bf35,0x3f7f3e48,0x3f7b0000,0xbf553ec4,0xbf7b0000,0x3f55bec4,0xbf46bf35,0x3f623f0e,0xbf223f35,0x3ef1bf55
.long 0x3f803f80,0x3f803f80,0x3f803f80,0x3f803f80,0xbe95bec4,0xbdc9be48,0x3f753f6d,0x3f7f3f7b,0xbf55bf35,0xbf7bbf6d,0x3f553f35,0x3f7b3f6d,0x3f463f6d,0x3e953f0e,0x3f223ec4,0x3f753f55
.long 0x3ec40000,0x3f6d3f35,0x3ec40000,0x3f6d3f35,0xbf7fbf6d,0xbef1bf55,0x3dc9bec4,0x3f623f0e,0x3e483f35,0xbf55bec4,0xbe48bf35,0x3f553ec4,0x3f623ec4,0x3f223f7b,0xbef1bf6d,0x3f463e48
.long 0xbf35bf80,0x3f350000,0xbf35bf80,0x3f350000,0xbef13ec4,0xbf46bf7b,0xbf62bf6d,0x3f22be48,0x3f7b3f35,0xbf0e3ec4,0xbf7bbf35,0x3f0ebec4,0xbdc9bf6d,0x3f623f55,0xbf7fbec4,0x3ef1bf0e
.long 0xbf6d0000,0x3ec4bf35,0xbf6d0000,0x3ec4bf35,0x3f223f6d,0xbf75bf0e,0xbf463ec4,0x3e95bf55,0x3f0ebf35,0xbe483f6d,0xbf0e3f35,0x3e48bf6d,0xbf75bec4,0x3f7f3e48,0xbe953f6d,0x3dc9bf7b
.long 0xbf803f80,0xbf803f80,0xbf803f80,0xbf803f80,0xbdc98000,0xbe95be48,0xbf7fbf80,0xbf75bf7b,0xbe488000,0xbf0ebec4,0x3e488000,0x3f0e3ec4,0xbe958000,0xbf46bf0e,0x3f753f80,0x3f223f55
.long 0xbec48000,0xbf6dbf35,0xbec48000,0xbf6dbf35,0xbef18000,0xbf7fbf55,0xbf62bf80,0xbdc9bf0e,0xbf0e8000,0xbf7bbf6d,0x3f0e8000,0x3f7b3f6d,0xbf228000,0xbf62bf7b,0x3f463f80,0xbef13e48
.long 0xbf358000,0xbf35bf80,0xbf358000,0xbf35bf80,0xbf468000,0xbef1bf7b,0xbf22bf80,0x3f623e48,0xbf558000,0xbe48bf6d,0x3f558000,0x3e483f6d,0xbf628000,0x3dc9bf55,0x3ef13f80,0xbf7fbf0e
.long 0xbf6d8000,0x3ec4bf35,0xbf6d8000,0x3ec4bf35,0xbf758000,0x3f22bf0e,0xbe95bf80,0x3f463f55,0xbf7b8000,0x3f55bec4,0x3f7b8000,0xbf553ec4,0xbf7f8000,0x3f75be48,0x3dc93f80,0xbe95bf7b
.long 0xbf803f80,0xbf803f80,0xbf803f80,0xbf803f80,0xbef1bec4,0xbf22bf0e,0xbf62bf6d,0xbf46bf55,0xbf55bf35,0xbf7bbf6d,0x3f553f35,0x3f7b3f6d,0xbf7fbf6d,0xbf62bf7b,0x3dc93ec4,0xbef1be48
.long 0xbf6dbf80,0xbec4bf35,0xbf6dbf80,0xbec4bf35,0xbf22bf6d,0x3e95be48,0x3f463ec4,0x3f753f7b,0xbe48bf35,0x3f553ec4,0x3e483f35,0xbf55bec4,0x3e95bec4,0x3f7f3f55,0xbf75bf6d,0x3dc9bf0e
.long 0x3f358000,0x3f353f80,0x3f358000,0x3f353f80,0x3f753ec4,0x3dc93f55,0x3e953f6d,0xbf7fbf0e,0x3f7b3f35,0xbf0e3ec4,0xbf7bbf35,0x3f0ebec4,0x3f463f6d,0xbf75be48,0x3f22bec4,0x3e953f7b
.long 0x3ec43f80,0xbf6dbf35,0x3ec43f80,0xbf6dbf35,0xbdc93f6d,0xbef1bf7b,0xbf7fbec4,0x3f62be48,0xbf0e3f35,0x3e48bf6d,0x3f0ebf35,0xbe483f6d,0xbf623ec4,0x3f46bf0e,0x3ef13f6d,0xbf22bf55
.long 0xbf803f80,0xbf803f80,0xbf803f80,0xbf803f80,0xbf46bf35,0xbf62bf55,0xbf22bf35,0xbef1bf0e,0xbf7bbf80,0xbf55bf6d,0x3f7b3f80,0x3f553f6d,0xbef1bf35,0x3dc9be48,0xbf62bf35,0xbf7fbf7b
.long 0x3ec48000,0x3f6d3f35,0x3ec48000,0x3f6d3f35,0x3f753f35,0x3f463f7b,0x3e953f35,0xbf22be48,0x3f553f80,0xbe483ec4,0xbf55bf80,0x3e48bec4,0x3dc93f35,0xbf75bf0e,0x3f7f3f35,0x3e953f55
.long 0xbf358000,0xbf35bf80,0xbf358000,0xbf35bf80,0xbf7fbf35,0x3e95bf0e,0x3dc9bf35,0x3f753f55,0xbf0ebf80,0x3f7b3ec4,0x3f0e3f80,0xbf7bbec4,0x3e95bf35,0x3f223f7b,0xbf75bf35,0x3f46be48
.long 0x3f6d8000,0xbec43f35,0x3f6d8000,0xbec43f35,0x3f623f35,0xbf7fbe48,0xbef13f35,0xbdc9bf7b,0x3e483f80,0xbf0ebf6d,0xbe48bf80,0x3f0e3f6d,0xbf223f35,0x3ef1bf55,0x3f463f35,0xbf62bf0e
.long 0xbf803f80,0xbf803f80,0xbf803f80,0xbf803f80,0xbf75bf6d,0xbf7fbf7b,0xbe95bec4,0xbdc9be48,0xbf0ebf35,0xbe48bec4,0x3f0e3f35,0x3e483ec4,0x3f223ec4,0x3f753f55,0xbf46bf6d,0xbe95bf0e
.long 0x3f6d3f80,0x3ec43f35,0x3f6d3f80,0x3ec43f35,0xbdc93ec4,0xbf62bf0e,0xbf7fbf6d,0xbef1bf55,0xbf7bbf35,0xbf0ebf6d,0x3f7b3f35,0x3f0e3f6d,0xbef1bf6d,0x3f463e48,0xbf62bec4,0xbf22bf7b
.long 0x3f358000,0x3f353f80,0x3f358000,0x3f353f80,0x3f623f6d,0xbf223e48,0xbef13ec4,0xbf46bf7b,0xbe483f35,0xbf55bf6d,0x3e48bf35,0x3f553f6d,0xbf7fbec4,0x3ef1bf0e,0x3dc93f6d,0xbf62bf55
.long 0xbec4bf80,0x3f6d3f35,0xbec4bf80,0x3f6d3f35,0x3f46bec4,0xbe953f55,0x3f223f6d,0xbf75bf0e,0x3f553f35,0xbf7bbec4,0xbf55bf35,0x3f7b3ec4,0xbe953f6d,0x3dc9bf7b,0x3f753ec4,0xbf7fbe48
.long 0xbf803f80,0xbf803f80,0xbf803f80,0xbf803f80,0x3dc98000,0x3e953e48,0x3f7f3f80,0x3f753f7b,0xbe488000,0xbf0ebec4,0x3e488000,0x3f0e3ec4,0x3e958000,0x3f463f0e,0xbf75bf80,0xbf22bf55
.long 0xbec48000,0xbf6dbf35,0xbec48000,0xbf6dbf35,0x3ef18000,0x3f7f3f55,0x3f623f80,0x3dc93f0e,0xbf0e8000,0xbf7bbf6d,0x3f0e8000,0x3f7b3f6d,0x3f228000,0x3f623f7b,0xbf46bf80,0x3ef1be48
.long 0xbf358000,0xbf35bf80,0xbf358000,0xbf35bf80,0x3f468000,0x3ef13f7b,0x3f223f80,0xbf62be48,0xbf558000,0xbe48bf6d,0x3f558000,0x3e483f6d,0x3f628000,0xbdc93f55,0xbef1bf80,0x3f7f3f0e
.long 0xbf6d8000,0x3ec4bf35,0xbf6d8000,0x3ec4bf35,0x3f758000,0xbf223f0e,0x3e953f80,0xbf46bf55,0xbf7b8000,0x3f55bec4,0x3f7b8000,0xbf553ec4,0x3f7f8000,0xbf753e48,0xbdc9bf80,0x3e953f7b
.long 0xbf803f80,0xbf803f80,0xbf803f80,0xbf803f80,0x3ef13ec4,0x3f223f0e,0x3f623f6d,0x3f463f55,0xbf55bf35,0xbf7bbf6d,0x3f553f35,0x3f7b3f6d,0x3f7f3f6d,0x3f623f7b,0xbdc9bec4,0x3ef13e48
.long 0xbf6dbf80,0xbec4bf35,0xbf6dbf80,0xbec4bf35,0x3f223f6d,0xbe953e48,0xbf46bec4,0xbf75bf7b,0xbe48bf35,0x3f553ec4,0x3e483f35,0xbf55bec4,0xbe953ec4,0xbf7fbf55,0x3f753f6d,0xbdc93f0e
.long 0x3f358000,0x3f353f80,0x3f358000,0x3f353f80,0xbf75bec4,0xbdc9bf55,0xbe95bf6d,0x3f7f3f0e,0x3f7b3f35,0xbf0e3ec4,0xbf7bbf35,0x3f0ebec4,0xbf46bf6d,0x3f753e48,0xbf223ec4,0xbe95bf7b
.long 0x3ec43f80,0xbf6dbf35,0x3ec43f80,0xbf6dbf35,0x3dc9bf6d,0x3ef13f7b,0x3f7f3ec4,0xbf623e48,0xbf0e3f35,0x3e48bf6d,0x3f0ebf35,0xbe483f6d,0x3f62bec4,0xbf463f0e,0xbef1bf6d,0x3f223f55
.long 0xbf803f80,0xbf803f80,0xbf803f80,0xbf803f80,0x3f463f35,0x3f623f55,0x3f223f35,0x3ef13f0e,0xbf7bbf80,0xbf55bf6d,0x3f7b3f80,0x3f553f6d,0x3ef13f35,0xbdc93e48,0x3f623f35,0x3f7f3f7b
.long 0x3ec48000,0x3f6d3f35,0x3ec48000,0x3f6d3f35,0xbf75bf35,0xbf46bf7b,0xbe95bf35,0x3f223e48,0x3f553f80,0xbe483ec4,0xbf55bf80,0x3e48bec4,0xbdc9bf35,0x3f753f0e,0xbf7fbf35,0xbe95bf55
.long 0xbf358000,0xbf35bf80,0xbf358000,0xbf35bf80,0x3f7f3f35,0xbe953f0e,0xbdc93f35,0xbf75bf55,0xbf0ebf80,0x3f7b3ec4,0x3f0e3f80,0xbf7bbec4,0xbe953f35,0xbf22bf7b,0x3f753f35,0xbf463e48
.long 0x3f6d8000,0xbec43f35,0x3f6d8000,0xbec43f35,0xbf62bf35,0x3f7f3e48,0x3ef1bf35,0x3dc93f7b,0x3e483f80,0xbf0ebf6d,0xbe48bf80,0x3f0e3f6d,0x3f22bf35,0xbef13f55,0xbf46bf35,0x3f623f0e
.long 0xbf803f80,0xbf803f80,0xbf803f80,0xbf803f80,0x3f753f6d,0x3f7f3f7b,0x3e953ec4,0x3dc93e48,0xbf0ebf35,0xbe48bec4,0x3f0e3f35,0x3e483ec4,0xbf22bec4,0xbf75bf55,0x3f463f6d,0x3e953f0e
.long 0x3f6d3f80,0x3ec43f35,0x3f6d3f80,0x3ec43f35,0x3dc9bec4,0x3f623f0e,0x3f7f3f6d,0x3ef13f55,0xbf7bbf35,0xbf0ebf6d,0x3f7b3f35,0x3f0e3f6d,0x3ef13f6d,0xbf46be48,0x3f623ec4,0x3f223f7b
.long 0x3f358000,0x3f353f80,0x3f358000,0x3f353f80,0xbf62bf6d,0x3f22be48,0x3ef1bec4,0x3f463f7b,0xbe483f35,0xbf55bf6d,0x3e48bf35,0x3f553f6d,0x3f7f3ec4,0xbef13f0e,0xbdc9bf6d,0x3f623f55
.long 0xbec4bf80,0x3f6d3f35,0xbec4bf80,0x3f6d3f35,0xbf463ec4,0x3e95bf55,0xbf22bf6d,0x3f753f0e,0x3f553f35,0xbf7bbec4,0xbf55bf35,0x3f7b3ec4,0x3e95bf6d,0xbdc93f7b,0xbf75bec4,0x3f7f3e48
.long 0x3f80,0xbf80,0x3f80,0xbf80,0xbdc93f80,0x3e95bf7b,0xbf7f0000,0x3f753e48,0xbe483f80,0x3f0ebf6d,0x3e48bf80,0xbf0e3f6d,0xbe953f80,0x3f46bf55,0x3f750000,0xbf22bf0e
.long 0xbec43f80,0x3f6dbf35,0xbec43f80,0x3f6dbf35,0xbef13f80,0x3f7fbf0e,0xbf620000,0x3dc93f55,0xbf0e3f80,0x3f7bbec4,0x3f0ebf80,0xbf7b3ec4,0xbf223f80,0x3f62be48,0x3f460000,0x3ef1bf7b
.long 0xbf353f80,0x3f350000,0xbf353f80,0x3f350000,0xbf463f80,0x3ef13e48,0xbf220000,0xbf623f7b,0xbf553f80,0x3e483ec4,0x3f55bf80,0xbe48bec4,0xbf623f80,0xbdc93f0e,0x3ef10000,0x3f7fbf55
.long 0xbf6d3f80,0xbec43f35,0xbf6d3f80,0xbec43f35,0xbf753f80,0xbf223f55,0xbe950000,0xbf463f0e,0xbf7b3f80,0xbf553f6d,0x3f7bbf80,0x3f55bf6d,0xbf7f3f80,0xbf753f7b,0x3dc90000,0x3e95be48
.long 0x3f80,0xbf80,0x3f80,0xbf80,0xbef13f6d,0x3f22bf55,0xbf62bec4,0x3f463f0e,0xbf553f35,0x3f7bbec4,0x3f55bf35,0xbf7b3ec4,0xbf7f3ec4,0x3f623e48,0x3dc93f6d,0x3ef1bf7b
.long 0xbf6d0000,0x3ec43f35,0xbf6d0000,0x3ec43f35,0xbf22bec4,0xbe953f7b,0x3f46bf6d,0xbf753e48,0xbe48bf35,0xbf553f6d,0x3e483f35,0x3f55bf6d,0x3e95bf6d,0xbf7f3f0e,0xbf753ec4,0xbdc93f55
.long 0x3f35bf80,0xbf350000,0x3f35bf80,0xbf350000,0x3f75bf6d,0xbdc9bf0e,0x3e953ec4,0x3f7fbf55,0x3f7bbf35,0x3f0ebf6d,0xbf7b3f35,0xbf0e3f6d,0x3f46bec4,0x3f75bf7b,0x3f22bf6d,0xbe95be48
.long 0x3ec40000,0x3f6dbf35,0x3ec40000,0x3f6dbf35,0xbdc93ec4,0x3ef1be48,0xbf7f3f6d,0xbf623f7b,0xbf0e3f35,0xbe483ec4,0x3f0ebf35,0x3e48bec4,0xbf623f6d,0xbf463f55,0x3ef1bec4,0x3f22bf0e
.long 0x3f80,0xbf80,0x3f80,0xbf80,0xbf463f35,0x3f62bf0e,0xbf22bf35,0x3ef13f55,0xbf7b0000,0x3f553ec4,0x3f7b0000,0xbf55bec4,0xbef1bf35,0xbdc93f7b,0xbf623f35,0x3f7fbe48
.long 0x3ec4bf80,0xbf6d3f35,0x3ec4bf80,0xbf6d3f35,0x3f75bf35,0xbf46be48,0x3e953f35,0x3f22bf7b,0x3f550000,0x3e48bf6d,0xbf550000,0xbe483f6d,0x3dc93f35,0x3f75bf55,0x3f7fbf35,0xbe95bf0e
.long 0xbf353f80,0x3f350000,0xbf353f80,0x3f350000,0xbf7f3f35,0xbe953f55,0x3dc9bf35,0xbf753f0e,0xbf0e0000,0xbf7b3f6d,0x3f0e0000,0x3f7bbf6d,0x3e95bf35,0xbf223e48,0xbf753f35,0xbf463f7b
.long 0x3f6dbf80,0x3ec4bf35,0x3f6dbf80,0x3ec4bf35,0x3f62bf35,0x3f7fbf7b,0xbef13f35,0x3dc93e48,0x3e480000,0x3f0ebec4,0xbe480000,0xbf0e3ec4,0xbf223f35,0xbef13f0e,0x3f46bf35,0x3f62bf55
.long 0x3f80,0xbf80,0x3f80,0xbf80,0xbf753ec4,0x3f7fbe48,0xbe95bf6d,0x3dc93f7b,0xbf0ebf35,0x3e483f6d,0x3f0e3f35,0xbe48bf6d,0x3f22bf6d,0xbf753f0e,0xbf46bec4,0x3e953f55
.long 0x3f6d0000,0xbec4bf35,0x3f6d0000,0xbec4bf35,0xbdc93f6d,0x3f62bf55,0xbf7f3ec4,0x3ef13f0e,0xbf7b3f35,0x3f0e3ec4,0x3f7bbf35,0xbf0ebec4,0xbef1bec4,0xbf463f7b,0xbf623f6d,0x3f223e48
.long 0x3f35bf80,0xbf350000,0x3f35bf80,0xbf350000,0x3f62bec4,0x3f22bf7b,0xbef13f6d,0x3f46be48,0xbe483f35,0x3f55bec4,0x3e48bf35,0xbf553ec4,0xbf7f3f6d,0xbef13f55,0x3dc93ec4,0x3f62bf0e
.long 0xbec40000,0xbf6d3f35,0xbec40000,0xbf6d3f35,0x3f46bf6d,0x3e95bf0e,0x3f22bec4,0x3f75bf55,0x3f55bf35,0x3f7bbf6d,0xbf553f35,0xbf7b3f6d,0xbe953ec4,0xbdc93e48,0x3f75bf6d,0x3f7fbf7b
.long 0x3f80,0xbf80,0x3f80,0xbf80,0x3dc9bf80,0xbe953f7b,0x3f7f0000,0xbf75be48,0xbe483f80,0x3f0ebf6d,0x3e48bf80,0xbf0e3f6d,0x3e95bf80,0xbf463f55,0xbf750000,0x3f223f0e
.long 0xbec43f80,0x3f6dbf35,0xbec43f80,0x3f6dbf35,0x3ef1bf80,0xbf7f3f0e,0x3f620000,0xbdc9bf55,0xbf0e3f80,0x3f7bbec4,0x3f0ebf80,0xbf7b3ec4,0x3f22bf80,0xbf623e48,0xbf460000,0xbef13f7b
.long 0xbf353f80,0x3f350000,0xbf353f80,0x3f350000,0x3f46bf80,0xbef1be48,0x3f220000,0x3f62bf7b,0xbf553f80,0x3e483ec4,0x3f55bf80,0xbe48bec4,0x3f62bf80,0x3dc9bf0e,0xbef10000,0xbf7f3f55
.long 0xbf6d3f80,0xbec43f35,0xbf6d3f80,0xbec43f35,0x3f75bf80,0x3f22bf55,0x3e950000,0x3f46bf0e,0xbf7b3f80,0xbf553f6d,0x3f7bbf80,0x3f55bf6d,0x3f7fbf80,0x3f75bf7b,0xbdc90000,0xbe953e48
.long 0x3f80,0xbf80,0x3f80,0xbf80,0x3ef1bf6d,0xbf223f55,0x3f623ec4,0xbf46bf0e,0xbf553f35,0x3f7bbec4,0x3f55bf35,0xbf7b3ec4,0x3f7fbec4,0xbf62be48,0xbdc9bf6d,0xbef13f7b
.long 0xbf6d0000,0x3ec43f35,0xbf6d0000,0x3ec43f35,0x3f223ec4,0x3e95bf7b,0xbf463f6d,0x3f75be48,0xbe48bf35,0xbf553f6d,0x3e483f35,0x3f55bf6d,0xbe953f6d,0x3f7fbf0e,0x3f75bec4,0x3dc9bf55
.long 0x3f35bf80,0xbf350000,0x3f35bf80,0xbf350000,0xbf753f6d,0x3dc93f0e,0xbe95bec4,0xbf7f3f55,0x3f7bbf35,0x3f0ebf6d,0xbf7b3f35,0xbf0e3f6d,0xbf463ec4,0xbf753f7b,0xbf223f6d,0x3e953e48
.long 0x3ec40000,0x3f6dbf35,0x3ec40000,0x3f6dbf35,0x3dc9bec4,0xbef13e48,0x3f7fbf6d,0x3f62bf7b,0xbf0e3f35,0xbe483ec4,0x3f0ebf35,0x3e48bec4,0x3f62bf6d,0x3f46bf55,0xbef13ec4,0xbf223f0e
.long 0x3f80,0xbf80,0x3f80,0xbf80,0x3f46bf35,0xbf623f0e,0x3f223f35,0xbef1bf55,0xbf7b0000,0x3f553ec4,0x3f7b0000,0xbf55bec4,0x3ef13f35,0x3dc9bf7b,0x3f62bf35,0xbf7f3e48
.long 0x3ec4bf80,0xbf6d3f35,0x3ec4bf80,0xbf6d3f35,0xbf753f35,0x3f463e48,0xbe95bf35,0xbf223f7b,0x3f550000,0x3e48bf6d,0xbf550000,0xbe483f6d,0xbdc9bf35,0xbf753f55,0xbf7f3f35,0x3e953f0e
.long 0xbf353f80,0x3f350000,0xbf353f80,0x3f350000,0x3f7fbf35,0x3e95bf55,0xbdc93f35,0x3f75bf0e,0xbf0e0000,0xbf7b3f6d,0x3f0e0000,0x3f7bbf6d,0xbe953f35,0x3f22be48,0x3f75bf35,0x3f46bf7b
.long 0x3f6dbf80,0x3ec4bf35,0x3f6dbf80,0x3ec4bf35,0xbf623f35,0xbf7f3f7b,0x3ef1bf35,0xbdc9be48,0x3e480000,0x3f0ebec4,0xbe480000,0xbf0e3ec4,0x3f22bf35,0x3ef1bf0e,0xbf463f35,0xbf623f55
.long 0x3f80,0xbf80,0x3f80,0xbf80,0x3f75bec4,0xbf7f3e48,0x3e953f6d,0xbdc9bf7b,0xbf0ebf35,0x3e483f6d,0x3f0e3f35,0xbe48bf6d,0xbf223f6d,0x3f75bf0e,0x3f463ec4,0xbe95bf55
.long 0x3f6d0000,0xbec4bf35,0x3f6d0000,0xbec4bf35,0x3dc9bf6d,0xbf623f55,0x3f7fbec4,0xbef1bf0e,0xbf7b3f35,0x3f0e3ec4,0x3f7bbf35,0xbf0ebec4,0x3ef13ec4,0x3f46bf7b,0x3f62bf6d,0xbf22be48
.long 0x3f35bf80,0xbf350000,0x3f35bf80,0xbf350000,0xbf623ec4,0xbf223f7b,0x3ef1bf6d,0xbf463e48,0xbe483f35,0x3f55bec4,0x3e48bf35,0xbf553ec4,0x3f7fbf6d,0x3ef1bf55,0xbdc9bec4,0xbf623f0e
.long 0xbec40000,0xbf6d3f35,0xbec40000,0xbf6d3f35,0xbf463f6d,0xbe953f0e,0xbf223ec4,0xbf753f55,0x3f55bf35,0x3f7bbf6d,0xbf553f35,0xbf7b3f6d,0x3e95bec4,0x3dc9be48,0xbf753f6d,0xbf7f3f7b
.long 0xbf808000,0x3f808000,0xbf808000,0x3f808000,0xbf7f8000,0x3f753e48,0x3dc9bf80,0xbe953f7b,0xbf7b8000,0x3f553ec4,0x3f7b8000,0xbf55bec4,0xbf758000,0x3f223f0e,0xbe953f80,0x3f46bf55
.long 0xbf6d8000,0x3ec43f35,0xbf6d8000,0x3ec43f35,0xbf628000,0x3dc93f55,0x3ef1bf80,0xbf7f3f0e,0xbf558000,0xbe483f6d,0x3f558000,0x3e48bf6d,0xbf468000,0xbef13f7b,0xbf223f80,0x3f62be48
.long 0xbf358000,0xbf353f80,0xbf358000,0xbf353f80,0xbf228000,0xbf623f7b,0x3f46bf80,0xbef1be48,0xbf0e8000,0xbf7b3f6d,0x3f0e8000,0x3f7bbf6d,0xbef18000,0xbf7f3f55,0xbf623f80,0xbdc93f0e
.long 0xbec48000,0xbf6d3f35,0xbec48000,0xbf6d3f35,0xbe958000,0xbf463f0e,0x3f75bf80,0x3f22bf55,0xbe488000,0xbf0e3ec4,0x3e488000,0x3f0ebec4,0xbdc98000,0xbe953e48,0xbf7f3f80,0xbf753f7b
.long 0xbf808000,0x3f808000,0xbf808000,0x3f808000,0xbf62bec4,0x3f463f0e,0x3ef1bf6d,0xbf223f55,0xbf0ebf35,0x3e483f6d,0x3f0e3f35,0xbe48bf6d,0xbdc9bf6d,0xbef13f7b,0xbf7f3ec4,0x3f623e48
.long 0x3ec4bf80,0xbf6d3f35,0x3ec4bf80,0xbf6d3f35,0x3f46bf6d,0xbf753e48,0x3f223ec4,0x3e95bf7b,0x3f7bbf35,0xbf0ebec4,0xbf7b3f35,0x3f0e3ec4,0x3f75bec4,0x3dc9bf55,0x3e95bf6d,0xbf7f3f0e
.long 0x3f358000,0x3f35bf80,0x3f358000,0x3f35bf80,0x3e953ec4,0x3f7fbf55,0xbf753f6d,0x3dc93f0e,0xbe483f35,0x3f55bec4,0x3e48bf35,0xbf553ec4,0xbf223f6d,0x3e953e48,0x3f46bec4,0x3f75bf7b
.long 0xbf6d3f80,0xbec43f35,0xbf6d3f80,0xbec43f35,0xbf7f3f6d,0xbf623f7b,0x3dc9bec4,0xbef13e48,0xbf553f35,0xbf7b3f6d,0x3f55bf35,0x3f7bbf6d,0xbef13ec4,0xbf223f0e,0xbf623f6d,0xbf463f55
.long 0xbf808000,0x3f808000,0xbf808000,0x3f808000,0xbf22bf35,0x3ef13f55,0x3f46bf35,0xbf623f0e,0x3e48bf80,0xbf0e3f6d,0xbe483f80,0x3f0ebf6d,0x3f62bf35,0xbf7f3e48,0xbef1bf35,0xbdc93f7b
.long 0x3f6d8000,0xbec4bf35,0x3f6d8000,0xbec4bf35,0x3e953f35,0x3f22bf7b,0xbf753f35,0x3f463e48,0xbf0e3f80,0x3f7bbec4,0x3f0ebf80,0xbf7b3ec4,0xbf7f3f35,0x3e953f0e,0x3dc93f35,0x3f75bf55
.long 0xbf358000,0xbf353f80,0xbf358000,0xbf353f80,0x3dc9bf35,0xbf753f0e,0x3f7fbf35,0x3e95bf55,0x3f55bf80,0xbe48bec4,0xbf553f80,0x3e483ec4,0x3f75bf35,0x3f46bf7b,0x3e95bf35,0xbf223e48
.long 0x3ec48000,0x3f6dbf35,0x3ec48000,0x3f6dbf35,0xbef13f35,0x3dc93e48,0xbf623f35,0xbf7f3f7b,0xbf7b3f80,0xbf553f6d,0x3f7bbf80,0x3f55bf6d,0xbf463f35,0xbf623f55,0xbf223f35,0xbef13f0e
.long 0xbf808000,0x3f808000,0xbf808000,0x3f808000,0xbe95bf6d,0x3dc93f7b,0x3f75bec4,0xbf7f3e48,0x3f55bf35,0xbf7b3ec4,0xbf553f35,0x3f7bbec4,0x3f463ec4,0xbe95bf55,0x3f22bf6d,0xbf753f0e
.long 0xbec43f80,0x3f6dbf35,0xbec43f80,0x3f6dbf35,0xbf7f3ec4,0x3ef13f0e,0x3dc9bf6d,0xbf623f55,0xbe48bf35,0xbf553f6d,0x3e483f35,0x3f55bf6d,0x3f62bf6d,0xbf22be48,0xbef1bec4,0xbf463f7b
.long 0x3f358000,0x3f35bf80,0x3f358000,0x3f35bf80,0xbef13f6d,0x3f46be48,0xbf623ec4,0xbf223f7b,0xbf7b3f35,0xbf0e3f6d,0x3f7bbf35,0x3f0ebf6d,0xbdc9bec4,0xbf623f0e,0xbf7f3f6d,0xbef13f55
.long 0x3f6dbf80,0x3ec4bf35,0x3f6dbf80,0x3ec4bf35,0x3f22bec4,0x3f75bf55,0xbf463f6d,0xbe953f0e,0xbf0e3f35,0xbe483ec4,0x3f0ebf35,0x3e48bec4,0xbf753f6d,0xbf7f3f7b,0xbe953ec4,0xbdc93e48
.long 0xbf808000,0x3f808000,0xbf808000,0x3f808000,0x3f7f8000,0xbf75be48,0xbdc93f80,0x3e95bf7b,0xbf7b8000,0x3f553ec4,0x3f7b8000,0xbf55bec4,0x3f758000,0xbf22bf0e,0x3e95bf80,0xbf463f55
.long 0xbf6d8000,0x3ec43f35,0xbf6d8000,0x3ec43f35,0x3f628000,0xbdc9bf55,0xbef13f80,0x3f7fbf0e,0xbf558000,0xbe483f6d,0x3f558000,0x3e48bf6d,0x3f468000,0x3ef1bf7b,0x3f22bf80,0xbf623e48
.long 0xbf358000,0xbf353f80,0xbf358000,0xbf353f80,0x3f228000,0x3f62bf7b,0xbf463f80,0x3ef13e48,0xbf0e8000,0xbf7b3f6d,0x3f0e8000,0x3f7bbf6d,0x3ef18000,0x3f7fbf55,0x3f62bf80,0x3dc9bf0e
.long 0xbec48000,0xbf6d3f35,0xbec48000,0xbf6d3f35,0x3e958000,0x3f46bf0e,0xbf753f80,0xbf223f55,0xbe488000,0xbf0e3ec4,0x3e488000,0x3f0ebec4,0x3dc98000,0x3e95be48,0x3f7fbf80,0x3f75bf7b
.long 0xbf808000,0x3f808000,0xbf808000,0x3f808000,0x3f623ec4,0xbf46bf0e,0xbef13f6d,0x3f22bf55,0xbf0ebf35,0x3e483f6d,0x3f0e3f35,0xbe48bf6d,0x3dc93f6d,0x3ef1bf7b,0x3f7fbec4,0xbf62be48
.long 0x3ec4bf80,0xbf6d3f35,0x3ec4bf80,0xbf6d3f35,0xbf463f6d,0x3f75be48,0xbf22bec4,0xbe953f7b,0x3f7bbf35,0xbf0ebec4,0xbf7b3f35,0x3f0e3ec4,0xbf753ec4,0xbdc93f55,0xbe953f6d,0x3f7fbf0e
.long 0x3f358000,0x3f35bf80,0x3f358000,0x3f35bf80,0xbe95bec4,0xbf7f3f55,0x3f75bf6d,0xbdc9bf0e,0xbe483f35,0x3f55bec4,0x3e48bf35,0xbf553ec4,0x3f22bf6d,0xbe95be48,0xbf463ec4,0xbf753f7b
.long 0xbf6d3f80,0xbec43f35,0xbf6d3f80,0xbec43f35,0x3f7fbf6d,0x3f62bf7b,0xbdc93ec4,0x3ef1be48,0xbf553f35,0xbf7b3f6d,0x3f55bf35,0x3f7bbf6d,0x3ef1bec4,0x3f22bf0e,0x3f62bf6d,0x3f46bf55
.long 0xbf808000,0x3f808000,0xbf808000,0x3f808000,0x3f223f35,0xbef1bf55,0xbf463f35,0x3f62bf0e,0x3e48bf80,0xbf0e3f6d,0xbe483f80,0x3f0ebf6d,0xbf623f35,0x3f7fbe48,0x3ef13f35,0x3dc9bf7b
.long 0x3f6d8000,0xbec4bf35,0x3f6d8000,0xbec4bf35,0xbe95bf35,0xbf223f7b,0x3f75bf35,0xbf46be48,0xbf0e3f80,0x3f7bbec4,0x3f0ebf80,0xbf7b3ec4,0x3f7fbf35,0xbe95bf0e,0xbdc9bf35,0xbf753f55
.long 0xbf358000,0xbf353f80,0xbf358000,0xbf353f80,0xbdc93f35,0x3f75bf0e,0xbf7f3f35,0xbe953f55,0x3f55bf80,0xbe48bec4,0xbf553f80,0x3e483ec4,0xbf753f35,0xbf463f7b,0xbe953f35,0x3f22be48
.long 0x3ec48000,0x3f6dbf35,0x3ec48000,0x3f6dbf35,0x3ef1bf35,0xbdc9be48,0x3f62bf35,0x3f7fbf7b,0xbf7b3f80,0xbf553f6d,0x3f7bbf80,0x3f55bf6d,0x3f46bf35,0x3f62bf55,0x3f22bf35,0x3ef1bf0e
.long 0xbf808000,0x3f808000,0xbf808000,0x3f808000,0x3e953f6d,0xbdc9bf7b,0xbf753ec4,0x3f7fbe48,0x3f55bf35,0xbf7b3ec4,0xbf553f35,0x3f7bbec4,0xbf46bec4,0x3e953f55,0xbf223f6d,0x3f75bf0e
.long 0xbec43f80,0x3f6dbf35,0xbec43f80,0x3f6dbf35,0x3f7fbec4,0xbef1bf0e,0xbdc93f6d,0x3f62bf55,0xbe48bf35,0xbf553f6d,0x3e483f35,0x3f55bf6d,0xbf623f6d,0x3f223e48,0x3ef13ec4,0x3f46bf7b
.long 0x3f358000,0x3f35bf80,0x3f358000,0x3f35bf80,0x3ef1bf6d,0xbf463e48,0x3f62bec4,0x3f22bf7b,0xbf7b3f35,0xbf0e3f6d,0x3f7bbf35,0x3f0ebf6d,0x3dc93ec4,0x3f62bf0e,0x3f7fbf6d,0x3ef1bf55
.long 0x3f6dbf80,0x3ec4bf35,0x3f6dbf80,0x3ec4bf35,0xbf223ec4,0xbf753f55,0x3f46bf6d,0x3e95bf0e,0xbf0e3f35,0xbe483ec4,0x3f0ebf35,0x3e48bec4,0x3f75bf6d,0x3f7fbf7b,0x3e95bec4,0x3dc9be48
.long 0x3f80,0x3f80,0x3f80,0x3f80,0x3f80,0x3ec43f6d,0x3f353f35,0x3f6d3ec4,0x3f80,0x3f353f35,0x3f800000,0x3f35bf35,0x3f80,0x3f6d3ec4,0x3f35bf35,0xbec4bf6d
.long 0x3f80,0x3f800000,0xbf80,0xbf800000,0x3f80,0x3f6dbec4,0xbf35bf35,0xbec43f6d,0x3f80,0x3f35bf35,0xbf800000,0x3f353f35,0x3f80,0x3ec4bf6d,0xbf353f35,0x3f6dbec4
.long 0x3f80,0xbf80,0x3f80,0xbf80,0x3f80,0xbec4bf6d,0x3f353f35,0xbf6dbec4,0x3f80,0xbf35bf35,0x3f800000,0xbf353f35,0x3f80,0xbf6dbec4,0x3f35bf35,0x3ec43f6d
.long 0x3f80,0xbf800000,0xbf80,0x3f800000,0x3f80,0xbf6d3ec4,0xbf35bf35,0x3ec4bf6d,0x3f80,0xbf353f35,0xbf800000,0xbf35bf35,0x3f80,0xbec43f6d,0xbf353f35,0xbf6d3ec4
.long 0x3f80,0x3f80,0x3f80,0x3f80,0x3f800000,0x3f6dbec4,0x3f35bf35,0x3ec4bf6d,0xbf80,0xbf35bf35,0xbf800000,0xbf353f35,0xbf800000,0xbec43f6d,0x3f353f35,0x3f6dbec4
.long 0x3f80,0x3f800000,0xbf80,0xbf800000,0x3f800000,0xbec4bf6d,0xbf353f35,0x3f6d3ec4,0xbf80,0xbf353f35,0x3f800000,0xbf35bf35,0xbf800000,0x3f6d3ec4,0xbf35bf35,0x3ec43f6d
.long 0x3f80,0xbf80,0x3f80,0xbf80,0x3f800000,0xbf6d3ec4,0x3f35bf35,0xbec43f6d,0xbf80,0x3f353f35,0xbf800000,0x3f35bf35,0xbf800000,0x3ec4bf6d,0x3f353f35,0xbf6d3ec4
.long 0x3f80,0xbf800000,0xbf80,0x3f800000,0x3f800000,0x3ec43f6d,0xbf353f35,0xbf6dbec4,0xbf80,0x3f35bf35,0x3f800000,0x3f353f35,0xbf800000,0xbf6dbec4,0xbf35bf35,0xbec4bf6d
.long 0x3f80,0x3f80,0x3f80,0x3f80,0xbf80,0xbec4bf6d,0xbf35bf35,0xbf6dbec4,0x3f80,0x3f353f35,0x3f800000,0x3f35bf35,0xbf80,0xbf6dbec4,0xbf353f35,0x3ec43f6d
.long 0x3f80,0x3f800000,0xbf80,0xbf800000,0xbf80,0xbf6d3ec4,0x3f353f35,0x3ec4bf6d,0x3f80,0x3f35bf35,0xbf800000,0x3f353f35,0xbf80,0xbec43f6d,0x3f35bf35,0xbf6d3ec4
.long 0x3f80,0xbf80,0x3f80,0xbf80,0xbf80,0x3ec43f6d,0xbf35bf35,0x3f6d3ec4,0x3f80,0xbf35bf35,0x3f800000,0xbf353f35,0xbf80,0x3f6d3ec4,0xbf353f35,0xbec4bf6d
.long 0x3f80,0xbf800000,0xbf80,0x3f800000,0xbf80,0x3f6dbec4,0x3f353f35,0xbec43f6d,0x3f80,0xbf353f35,0xbf800000,0xbf35bf35,0xbf80,0x3ec4bf6d,0x3f35bf35,0x3f6dbec4
.long 0x3f80,0x3f80,0x3f80,0x3f80,0xbf800000,0xbf6d3ec4,0xbf353f35,0xbec43f6d,0xbf80,0xbf35bf35,0xbf800000,0xbf353f35,0x3f800000,0x3ec4bf6d,0xbf35bf35,0xbf6d3ec4
.long 0x3f80,0x3f800000,0xbf80,0xbf800000,0xbf800000,0x3ec43f6d,0x3f35bf35,0xbf6dbec4,0xbf80,0xbf353f35,0x3f800000,0xbf35bf35,0x3f800000,0xbf6dbec4,0x3f353f35,0xbec4bf6d
.long 0x3f80,0xbf80,0x3f80,0xbf80,0xbf800000,0x3f6dbec4,0xbf353f35,0x3ec4bf6d,0xbf80,0x3f353f35,0xbf800000,0x3f35bf35,0x3f800000,0xbec43f6d,0xbf35bf35,0x3f6dbec4
.long 0x3f80,0xbf800000,0xbf80,0x3f800000,0xbf800000,0xbec4bf6d,0x3f35bf35,0x3f6d3ec4,0xbf80,0x3f35bf35,0x3f800000,0x3f353f35,0x3f800000,0x3f6d3ec4,0x3f353f35,0x3ec43f6d
.long 0x3f808000,0x3f808000,0x3f808000,0x3f808000,0x3f808000,0x3f6dbec4,0x3f35bf35,0x3ec4bf6d,0x3f808000,0x3f35bf35,0xbf80,0xbf35bf35,0x3f808000,0x3ec4bf6d,0xbf35bf35,0xbf6d3ec4
.long 0x3f808000,0xbf80,0xbf808000,0x3f80,0x3f808000,0xbec4bf6d,0xbf353f35,0x3f6d3ec4,0x3f808000,0xbf35bf35,0x3f80,0x3f35bf35,0x3f808000,0xbf6dbec4,0x3f353f35,0xbec4bf6d
.long 0xbf800000,0x3f800000,0xbf800000,0x3f800000,0xbf800000,0x3f6dbec4,0xbf353f35,0x3ec4bf6d,0xbf800000,0x3f35bf35,0x80003f80,0xbf35bf35,0xbf800000,0x3ec4bf6d,0x3f353f35,0xbf6d3ec4
.long 0xbf800000,0x8000bf80,0x3f800000,0x80003f80,0xbf800000,0xbec4bf6d,0x3f35bf35,0x3f6d3ec4,0xbf800000,0xbf35bf35,0x8000bf80,0x3f35bf35,0xbf800000,0xbf6dbec4,0xbf35bf35,0xbec4bf6d
.long 0x3f808000,0x3f808000,0x3f808000,0x3f808000,0xbf80,0xbec4bf6d,0xbf35bf35,0xbf6dbec4,0xbf808000,0xbf353f35,0x3f80,0x3f353f35,0x3f80,0x3f6d3ec4,0x3f35bf35,0xbec4bf6d
.long 0x3f808000,0xbf80,0xbf808000,0x3f80,0xbf80,0xbf6d3ec4,0x3f353f35,0x3ec4bf6d,0xbf808000,0x3f353f35,0xbf80,0xbf353f35,0x3f80,0x3ec4bf6d,0xbf353f35,0x3f6dbec4
.long 0xbf800000,0x3f800000,0xbf800000,0x3f800000,0x80003f80,0xbec4bf6d,0x3f353f35,0xbf6dbec4,0x3f800000,0xbf353f35,0x8000bf80,0x3f353f35,0x8000bf80,0x3f6d3ec4,0xbf353f35,0xbec4bf6d
.long 0xbf800000,0x8000bf80,0x3f800000,0x80003f80,0x80003f80,0xbf6d3ec4,0xbf35bf35,0x3ec4bf6d,0x3f800000,0x3f353f35,0x80003f80,0xbf353f35,0x8000bf80,0x3ec4bf6d,0x3f35bf35,0x3f6dbec4
.long 0x3f808000,0x3f808000,0x3f808000,0x3f808000,0xbf808000,0xbf6d3ec4,0xbf353f35,0xbec43f6d,0x3f808000,0x3f35bf35,0xbf80,0xbf35bf35,0xbf808000,0xbec43f6d,0x3f353f35,0x3f6dbec4
.long 0x3f808000,0xbf80,0xbf808000,0x3f80,0xbf808000,0x3ec43f6d,0x3f35bf35,0xbf6dbec4,0x3f808000,0xbf35bf35,0x3f80,0x3f35bf35,0xbf808000,0x3f6d3ec4,0xbf35bf35,0x3ec43f6d
.long 0xbf800000,0x3f800000,0xbf800000,0x3f800000,0x3f800000,0xbf6d3ec4,0x3f35bf35,0xbec43f6d,0xbf800000,0x3f35bf35,0x80003f80,0xbf35bf35,0x3f800000,0xbec43f6d,0xbf35bf35,0x3f6dbec4
.long 0xbf800000,0x8000bf80,0x3f800000,0x80003f80,0x3f800000,0x3ec43f6d,0xbf353f35,0xbf6dbec4,0xbf800000,0xbf35bf35,0x8000bf80,0x3f35bf35,0x3f800000,0x3f6d3ec4,0x3f353f35,0x3ec43f6d
.long 0x3f808000,0x3f808000,0x3f808000,0x3f808000,0x3f80,0x3ec43f6d,0x3f353f35,0x3f6d3ec4,0xbf808000,0xbf353f35,0x3f80,0x3f353f35,0xbf80,0xbf6dbec4,0xbf353f35,0x3ec43f6d
.long 0x3f808000,0xbf80,0xbf808000,0x3f80,0x3f80,0x3f6dbec4,0xbf35bf35,0xbec43f6d,0xbf808000,0x3f353f35,0xbf80,0xbf353f35,0xbf80,0xbec43f6d,0x3f35bf35,0xbf6d3ec4
.long 0xbf800000,0x3f800000,0xbf800000,0x3f800000,0x8000bf80,0x3ec43f6d,0xbf35bf35,0x3f6d3ec4,0x3f800000,0xbf353f35,0x8000bf80,0x3f353f35,0x80003f80,0xbf6dbec4,0x3f35bf35,0x3ec43f6d
.long 0xbf800000,0x8000bf80,0x3f800000,0x80003f80,0x8000bf80,0x3f6dbec4,0x3f353f35,0xbec43f6d,0x3f800000,0x3f353f35,0x80003f80,0xbf353f35,0x80003f80,0xbec43f6d,0xbf353f35,0xbf6d3ec4
.long 0x3f80,0xbf80,0x3f80,0xbf80,0x3f80,0x3f6d,0x3f35,0x3ec4,0x3f80,0x3f35,0x0,0xbf35,0x3f80,0x3ec4,0xbf35,0xbf6d
.long 0x3f80,0x0,0xbf80,0x0,0x3f80,0xbec4,0xbf35,0x3f6d,0x3f80,0xbf35,0x0,0x3f35,0x3f80,0xbf6d,0x3f35,0xbec4
.long 0x3f800000,0xbf7b0000,0x3f6d0000,0xbf550000,0x3f800000,0xbf550000,0x3ec40000,0x3e480000,0x3f800000,0xbf0e0000,0xbec40000,0x3f7b0000,0x3f800000,0xbe480000,0xbf6d0000,0x3f0e0000
.long 0x3f800000,0x3e480000,0xbf6d0000,0xbf0e0000,0x3f800000,0x3f0e0000,0xbec40000,0xbf7b0000,0x3f800000,0x3f550000,0x3ec40000,0xbe480000,0x3f800000,0x3f7b0000,0x3f6d0000,0x3f550000
.long 0x3f80,0xbf80,0x3f80,0xbf80,0x0,0xbec4,0xbf35,0xbf6d,0xbf80,0xbf35,0x0,0x3f35,0x0,0x3f6d,0x3f35,0xbec4
.long 0x3f80,0x0,0xbf80,0x0,0x0,0xbf6d,0x3f35,0x3ec4,0xbf80,0x3f35,0x0,0xbf35,0x0,0x3ec4,0xbf35,0x3f6d
.long 0x3f350000,0xbf0e0000,0x3ec40000,0xbe480000,0xbf350000,0x3f7b0000,0xbf6d0000,0x3f0e0000,0xbf350000,0xbe480000,0x3f6d0000,0xbf550000,0x3f350000,0xbf550000,0xbec40000,0x3f7b0000
.long 0x3f350000,0x3f550000,0xbec40000,0xbf7b0000,0xbf350000,0x3e480000,0x3f6d0000,0x3f550000,0xbf350000,0xbf7b0000,0xbf6d0000,0xbf0e0000,0x3f350000,0x3f0e0000,0x3ec40000,0x3e480000
.long 0x3f80,0xbf80,0x3f80,0xbf80,0xbf80,0xbf6d,0xbf35,0xbec4,0x3f80,0x3f35,0x0,0xbf35,0xbf80,0xbec4,0x3f35,0x3f6d
.long 0x3f80,0x0,0xbf80,0x0,0xbf80,0x3ec4,0x3f35,0xbf6d,0x3f80,0xbf35,0x0,0x3f35,0xbf80,0x3f6d,0xbf35,0x3ec4
.long 0x0,0x3e480000,0xbec40000,0x3f0e0000,0x0,0xbf0e0000,0x3f6d0000,0xbf7b0000,0x0,0x3f550000,0xbf6d0000,0x3e480000,0x0,0xbf7b0000,0x3ec40000,0x3f550000
.long 0x0,0x3f7b0000,0x3ec40000,0xbf550000,0x0,0xbf550000,0xbf6d0000,0xbe480000,0x0,0x3f0e0000,0x3f6d0000,0x3f7b0000,0x0,0xbe480000,0xbec40000,0xbf0e0000
.long 0x3f80,0xbf80,0x3f80,0xbf80,0x0,0x3ec4,0x3f35,0x3f6d,0xbf80,0xbf35,0x0,0x3f35,0x0,0xbf6d,0xbf35,0x3ec4
.long 0x3f80,0x0,0xbf80,0x0,0x0,0x3f6d,0xbf35,0xbec4,0xbf80,0x3f35,0x0,0xbf35,0x0,0xbec4,0x3f35,0xbf6d
.long 0xbf350000,0x3f550000,0xbf6d0000,0x3f7b0000,0x3f350000,0xbe480000,0xbec40000,0x3f550000,0x3f350000,0xbf7b0000,0x3ec40000,0x3f0e0000,0xbf350000,0xbf0e0000,0x3f6d0000,0x3e480000
.long 0xbf350000,0x3f0e0000,0x3f6d0000,0xbe480000,0x3f350000,0x3f7b0000,0x3ec40000,0xbf0e0000,0x3f350000,0x3e480000,0xbec40000,0xbf550000,0xbf350000,0xbf550000,0xbf6d0000,0xbf7b0000
.long 0x0,0x0,0x0,0x0,0x8000,0xbec4,0xbf35,0xbf6d,0x8000,0xbf35,0xbf80,0xbf35,0x8000,0xbf6d,0xbf35,0x3ec4
.long 0x8000,0xbf80,0x8000,0x3f80,0x8000,0xbf6d,0x3f35,0x3ec4,0x8000,0xbf35,0x3f80,0xbf35,0x8000,0xbec4,0x3f35,0xbf6d
.long 0x80000000,0xbe480000,0x3ec40000,0xbf0e0000,0x80000000,0xbf0e0000,0x3f6d0000,0xbf7b0000,0x80000000,0xbf550000,0x3f6d0000,0xbe480000,0x80000000,0xbf7b0000,0x3ec40000,0x3f550000
.long 0x80000000,0xbf7b0000,0xbec40000,0x3f550000,0x80000000,0xbf550000,0xbf6d0000,0xbe480000,0x80000000,0xbf0e0000,0xbf6d0000,0xbf7b0000,0x80000000,0xbe480000,0xbec40000,0xbf0e0000
.long 0x0,0x0,0x0,0x0,0xbf80,0xbf6d,0xbf35,0xbec4,0x8000,0x3f35,0x3f80,0x3f35,0x3f80,0x3ec4,0xbf35,0xbf6d
.long 0x8000,0xbf80,0x8000,0x3f80,0xbf80,0x3ec4,0x3f35,0xbf6d,0x8000,0x3f35,0xbf80,0x3f35,0x3f80,0xbf6d,0x3f35,0xbec4
.long 0x3f350000,0xbf550000,0x3f6d0000,0xbf7b0000,0x3f350000,0xbe480000,0xbec40000,0x3f550000,0xbf350000,0x3f7b0000,0xbec40000,0xbf0e0000,0xbf350000,0xbf0e0000,0x3f6d0000,0x3e480000
.long 0x3f350000,0xbf0e0000,0xbf6d0000,0x3e480000,0x3f350000,0x3f7b0000,0x3ec40000,0xbf0e0000,0xbf350000,0xbe480000,0x3ec40000,0x3f550000,0xbf350000,0xbf550000,0xbf6d0000,0xbf7b0000
.long 0x0,0x0,0x0,0x0,0x8000,0x3ec4,0x3f35,0x3f6d,0x8000,0xbf35,0xbf80,0xbf35,0x8000,0x3f6d,0x3f35,0xbec4
.long 0x8000,0xbf80,0x8000,0x3f80,0x8000,0x3f6d,0xbf35,0xbec4,0x8000,0xbf35,0x3f80,0xbf35,0x8000,0x3ec4,0xbf35,0x3f6d
.long 0x3f800000,0xbf7b0000,0x3f6d0000,0xbf550000,0xbf800000,0x3f550000,0xbec40000,0xbe480000,0x3f800000,0xbf0e0000,0xbec40000,0x3f7b0000,0xbf800000,0x3e480000,0x3f6d0000,0xbf0e0000
.long 0x3f800000,0x3e480000,0xbf6d0000,0xbf0e0000,0xbf800000,0xbf0e0000,0x3ec40000,0x3f7b0000,0x3f800000,0x3f550000,0x3ec40000,0xbe480000,0xbf800000,0xbf7b0000,0xbf6d0000,0xbf550000
.long 0x0,0x0,0x0,0x0,0x3f80,0x3f6d,0x3f35,0x3ec4,0x8000,0x3f35,0x3f80,0x3f35,0xbf80,0xbec4,0x3f35,0x3f6d
.long 0x8000,0xbf80,0x8000,0x3f80,0x3f80,0xbec4,0xbf35,0x3f6d,0x8000,0x3f35,0xbf80,0x3f35,0xbf80,0x3f6d,0xbf35,0x3ec4
.long 0x3f350000,0xbf0e0000,0x3ec40000,0xbe480000,0x3f350000,0xbf7b0000,0x3f6d0000,0xbf0e0000,0xbf350000,0xbe480000,0x3f6d0000,0xbf550000,0xbf350000,0x3f550000,0x3ec40000,0xbf7b0000
.long 0x3f350000,0x3f550000,0xbec40000,0xbf7b0000,0x3f350000,0xbe480000,0xbf6d0000,0xbf550000,0xbf350000,0xbf7b0000,0xbf6d0000,0xbf0e0000,0xbf350000,0xbf0e0000,0xbec40000,0xbe480000
.long 0x3f800000,0x3f800000,0x3f800000,0x3f800000,0x3f800000,0x3f7ffec4,0x3f7ffb11,0x3f7ff4e6,0x3f800000,0x3f7ffb11,0x3f7fec43,0x3f7fd397,0x3f800000,0x3f7ff4e6,0x3f7fd397,0x3f7f9c18
.long 0x3f800000,0x3f7fec43,0x3f7fb10f,0x3f7f4e6d,0x3f800000,0x3f7fe129,0x3f7f84ab,0x3f7eea9d,0x3f800000,0x3f7fd397,0x3f7f4e6d,0x3f7e70b0,0x3f800000,0x3f7fc38f,0x3f7f0e58,0x3f7de0b1
.long 0x3f800000,0x3f7fb10f,0x3f7ec46d,0x3f7d3aac,0x3f800000,0x3f7f9c18,0x3f7e70b0,0x3f7c7eb0,0x3f800000,0x3f7f84ab,0x3f7e1324,0x3f7baccd,0x3f800000,0x3f7f6ac7,0x3f7dabcc,0x3f7ac516
.long 0x3f800000,0x3f7f4e6d,0x3f7d3aac,0x3f79c79d,0x3f800000,0x3f7f2f9d,0x3f7cbfc9,0x3f78b47b,0x3f800000,0x3f7f0e58,0x3f7c3b28,0x3f778bc5,0x3f800000,0x3f7eea9d,0x3f7baccd,0x3f764d97
.long 0x3f800000,0x3f800000,0x3f800000,0x3f800000,0x3f7fec43,0x3f7fe129,0x3f7fd397,0x3f7fc38f,0x3f7fb10f,0x3f7f84ab,0x3f7f4e6d,0x3f7f0e58,0x3f7f4e6d,0x3f7eea9d,0x3f7e70b0,0x3f7de0b1
.long 0x3f7ec46d,0x3f7e1324,0x3f7d3aac,0x3f7c3b28,0x3f7e1324,0x3f7cfe73,0x3f7baccd,0x3f7a1e84,0x3f7d3aac,0x3f7baccd,0x3f79c79d,0x3f778bc5,0x3f7c3b28,0x3f7a1e84,0x3f778bc5,0x3f748422
.long 0x3f7b14be,0x3f7853f8,0x3f74fa0b,0x3f710908,0x3f79c79d,0x3f764d97,0x3f721352,0x3f6d1c1d,0x3f7853f8,0x3f740bdd,0x3f6ed89e,0x3f68bf3c,0x3f76ba07,0x3f718f57,0x3f6b4b0c,0x3f63f473
.long 0x3f74fa0b,0x3f6ed89e,0x3f676bd8,0x3f5ebe05,0x3f731447,0x3f6be858,0x3f633c5a,0x3f591e6a,0x3f710908,0x3f68bf3c,0x3f5ebe05,0x3f531849,0x3f6ed89e,0x3f655e0b,0x3f59f26a,0x3f4cae79
.long 0x3f800000,0x3f800000,0x3f800000,0x3f800000,0x3f7fb10f,0x3f7f9c18,0x3f7f84ab,0x3f7f6ac7,0x3f7ec46d,0x3f7e70b0,0x3f7e1324,0x3f7dabcc,0x3f7d3aac,0x3f7c7eb0,0x3f7baccd,0x3f7ac516
.long 0x3f7b14be,0x3f79c79d,0x3f7853f8,0x3f76ba07,0x3f7853f8,0x3f764d97,0x3f740bdd,0x3f718f57,0x3f74fa0b,0x3f721352,0x3f6ed89e,0x3f6b4b0c,0x3f710908,0x3f6d1c1d,0x3f68bf3c,0x3f63f473
.long 0x3f6c835e,0x3f676bd8,0x3f61c598,0x3f5b941a,0x3f676bd8,0x3f6106f2,0x3f59f26a,0x3f5233c6,0x3f61c598,0x3f59f26a,0x3f514d3d,0x3f47de65,0x3f5b941a,0x3f5233c6,0x3f47de65,0x3f3ca003
.long 0x3f54db31,0x3f49d112,0x3f3daef9,0x3f3085bb,0x3f4d9f02,0x3f40d0da,0x3f32c8c9,0x3f239da9,0x3f45e403,0x3f373a23,0x3f273656,0x3f15f6d9,0x3f3daef9,0x3f2d1469,0x3f1b02c6,0x3f07a136
.long 0x3f800000,0x3f800000,0x3f800000,0x3f800000,0x3f7f4e6d,0x3f7f2f9d,0x3f7f0e58,0x3f7eea9d,0x3f7d3aac,0x3f7cbfc9,0x3f7c3b28,0x3f7baccd,0x3f79c79d,0x3f78b47b,0x3f778bc5,0x3f764d97
.long 0x3f74fa0b,0x3f731447,0x3f710908,0x3f6ed89e,0x3f6ed89e,0x3f6be858,0x3f68bf3c,0x3f655e0b,0x3f676bd8,0x3f633c5a,0x3f5ebe05,0x3f59f26a,0x3f5ebe05,0x3f591e6a,0x3f531849,0x3f4cae79
.long 0x3f54db31,0x3f4d9f02,0x3f45e403,0x3f3daef9,0x3f49d112,0x3f40d0da,0x3f373a23,0x3f2d1469,0x3f3daef9,0x3f32c8c9,0x3f273656,0x3f1b02c6,0x3f3085bb,0x3f239da9,0x3f15f6d9,0x3f07a136
.long 0x3f226799,0x3f13682a,0x3f039c3d,0x3ee63375,0x3f13682a,0x3f0242b1,0x3ee0924f,0x3ebb31a0,0x3f039c3d,0x3ee0924f,0x3eb8442a,0x3e8e9a22,0x3ee63375,0x3ebb31a0,0x3e8e9a22,0x3e419b37
.long 0x80000000,0x80000000,0x80000000,0x80000000,0x80000000,0xbbc90f88,0xbc490e90,0xbc96c9b6,0x80000000,0xbc490e90,0xbcc90ab0,0xbd16c32c,0x80000000,0xbc96c9b6,0xbd16c32c,0xbd621469
.long 0x80000000,0xbcc90ab0,0xbd48fb30,0xbd96a905,0x80000000,0xbcfb49ba,0xbd7b2b74,0xbdbc3ac3,0x80000000,0xbd16c32c,0xbd96a905,0xbde1bc2e,0x80000000,0xbd2fe007,0xbdafb680,0xbe039502
.long 0x80000000,0xbd48fb30,0xbdc8bd36,0xbe164083,0x80000000,0xbd621469,0xbde1bc2e,0xbe28defc,0x80000000,0xbd7b2b74,0xbdfab273,0xbe3b6ecf,0x80000000,0xbd8a200a,0xbe09cf86,0xbe4dee60
.long 0x80000000,0xbd96a905,0xbe164083,0xbe605c13,0x80000000,0xbda3308c,0xbe22abb6,0xbe72b651,0x80000000,0xbdafb680,0xbe2f10a2,0xbe827dc0,0x80000000,0xbdbc3ac3,0xbe3b6ecf,0xbe8b9507
.long 0x80000000,0x80000000,0x80000000,0x80000000,0xbcc90ab0,0xbcfb49ba,0xbd16c32c,0xbd2fe007,0xbd48fb30,0xbd7b2b74,0xbd96a905,0xbdafb680,0xbd96a905,0xbdbc3ac3,0xbde1bc2e,0xbe039502
.long 0xbdc8bd36,0xbdfab273,0xbe164083,0xbe2f10a2,0xbdfab273,0xbe1c76de,0xbe3b6ecf,0xbe5a3997,0xbe164083,0xbe3b6ecf,0xbe605c13,0xbe827dc0,0xbe2f10a2,0xbe5a3997,0xbe827dc0,0xbe97a117
.long 0xbe47c5c2,0xbe78cfcc,0xbe94a031,0xbeac7cd4,0xbe605c13,0xbe8b9507,0xbea68f12,0xbec1071e,0xbe78cfcc,0xbe9aa086,0xbeb8442a,0xbed53641,0xbe888e93,0xbea986c4,0xbec9b953,0xbee900b7
.long 0xbe94a031,0xbeb8442a,0xbedae880,0xbefc5d27,0xbea09ae5,0xbec6d529,0xbeebcbbb,0xbf07a136,0xbeac7cd4,0xbed53641,0xbefc5d27,0xbf10d3cd,0xbeb8442a,0xbee363fa,0xbf064b82,0xbf19c200
.long 0x80000000,0x80000000,0x80000000,0x80000000,0xbd48fb30,0xbd621469,0xbd7b2b74,0xbd8a200a,0xbdc8bd36,0xbde1bc2e,0xbdfab273,0xbe09cf86,0xbe164083,0xbe28defc,0xbe3b6ecf,0xbe4dee60
.long 0xbe47c5c2,0xbe605c13,0xbe78cfcc,0xbe888e93,0xbe78cfcc,0xbe8b9507,0xbe9aa086,0xbea986c4,0xbe94a031,0xbea68f12,0xbeb8442a,0xbec9b953,0xbeac7cd4,0xbec1071e,0xbed53641,0xbee900b7
.long 0xbec3ef15,0xbedae880,0xbef15aea,0xbf039c3d,0xbedae880,0xbef41f07,0xbf064b82,0xbf121eb0,0xbef15aea,0xbf064b82,0xbf13682a,0xbf1ff6cb,0xbf039c3d,0xbf121eb0,0xbf1ff6cb,0xbf2d1469
.long 0xbf0e39da,0xbf1d7fd1,0xbf2beb4a,0xbf396842,0xbf187fc0,0xbf286605,0xbf373a23,0xbf44e3f5,0xbf226799,0xbf32c8c9,0xbf41d870,0xbf4f7a1f,0xbf2beb4a,0xbf3ca003,0xbf4bbbf8,0xbf591e6a
.long 0x80000000,0x80000000,0x80000000,0x80000000,0xbd96a905,0xbda3308c,0xbdafb680,0xbdbc3ac3,0xbe164083,0xbe22abb6,0xbe2f10a2,0xbe3b6ecf,0xbe605c13,0xbe72b651,0xbe827dc0,0xbe8b9507
.long 0xbe94a031,0xbea09ae5,0xbeac7cd4,0xbeb8442a,0xbeb8442a,0xbec6d529,0xbed53641,0xbee363fa,0xbedae880,0xbeebcbbb,0xbefc5d27,0xbf064b82,0xbefc5d27,0xbf07a136,0xbf10d3cd,0xbf19c200
.long 0xbf0e39da,0xbf187fc0,0xbf226799,0xbf2beb4a,0xbf1d7fd1,0xbf286605,0xbf32c8c9,0xbf3ca003,0xbf2beb4a,0xbf373a23,0xbf41d870,0xbf4bbbf8,0xbf396842,0xbf44e3f5,0xbf4f7a1f,0xbf591e6a
.long 0xbf45e403,0xbf514d3d,0xbf5b941a,0xbf64aa59,0xbf514d3d,0xbf5c61c7,0xbf660f88,0xbf6e46be,0xbf5b941a,0xbf660f88,0xbf6ed89e,0xbf75dec6,0xbf64aa59,0xbf6e46be,0xbf75dec6,0xbf7b61fc
.long 0x3f800000,0x3f7ec46d,0x3f7b14be,0x3f74fa0b,0x3f800000,0x3f7e9bc9,0x3f7a7302,0x3f73913f,0x3f800000,0x3f7e70b0,0x3f79c79d,0x3f721352,0x3f800000,0x3f7e4323,0x3f791298,0x3f708066
.long 0x3f800000,0x3f7e1324,0x3f7853f8,0x3f6ed89e,0x3f800000,0x3f7de0b1,0x3f778bc5,0x3f6d1c1d,0x3f800000,0x3f7dabcc,0x3f76ba07,0x3f6b4b0c,0x3f800000,0x3f7d7474,0x3f75dec6,0x3f696591
.long 0x3f800000,0x3f7d3aac,0x3f74fa0b,0x3f676bd8,0x3f800000,0x3f7cfe73,0x3f740bdd,0x3f655e0b,0x3f800000,0x3f7cbfc9,0x3f731447,0x3f633c5a,0x3f800000,0x3f7c7eb0,0x3f721352,0x3f6106f2
.long 0x3f800000,0x3f7c3b28,0x3f710908,0x3f5ebe05,0x3f800000,0x3f7bf531,0x3f6ff573,0x3f5c61c7,0x3f800000,0x3f7baccd,0x3f6ed89e,0x3f59f26a,0x3f800000,0x3f7b61fc,0x3f6db293,0x3f577026
.long 0x3f6c835e,0x3f61c598,0x3f54db31,0x3f45e403,0x3f6a09a7,0x3f5df6be,0x3f4f7a1f,0x3f3ebc1b,0x3f676bd8,0x3f59f26a,0x3f49d112,0x3f373a23,0x3f64aa59,0x3f55b993,0x3f43e200,0x3f2f61a5
.long 0x3f61c598,0x3f514d3d,0x3f3daef9,0x3f273656,0x3f5ebe05,0x3f4cae79,0x3f373a23,0x3f1ebc12,0x3f5b941a,0x3f47de65,0x3f3085bb,0x3f15f6d9,0x3f584853,0x3f42de29,0x3f299415,0x3f0cead0
.long 0x3f54db31,0x3f3daef9,0x3f226799,0x3f039c3d,0x3f514d3d,0x3f385216,0x3f1b02c6,0x3ef41f07,0x3f4d9f02,0x3f32c8c9,0x3f13682a,0x3ee0924f,0x3f49d112,0x3f2d1469,0x3f0b9a6b,0x3ecc9b8b
.long 0x3f45e403,0x3f273656,0x3f039c3d,0x3eb8442a,0x3f41d870,0x3f212ff9,0x3ef6e0cb,0x3ea395c5,0x3f3daef9,0x3f1b02c6,0x3ee63375,0x3e8e9a22,0x3f396842,0x3f14b039,0x3ed53641,0x3e72b651
.long 0x3f3504f3,0x3f226799,0x3f0e39da,0x3ef15aea,0x3f2beb4a,0x3f173c07,0x3f00e7e4,0x3ed25a09,0x3f226799,0x3f0b9a6b,0x3ee63375,0x3eb263ef,0x3f187fc0,0x3eff17b2,0x3ec9b953,0x3e919ddd
.long 0x3f0e39da,0x3ee63375,0x3eac7cd4,0x3e605c13,0x3f039c3d,0x3ecc9b8b,0x3e8e9a22,0x3e1c76de,0x3ef15aea,0x3eb263ef,0x3e605c13,0x3dafb680,0x3edae880,0x3e97a117,0x3e22abb6,0x3c96c9b6
.long 0x3ec3ef15,0x3e78cfcc,0x3dc8bd36,0xbd48fb30,0x3eac7cd4,0x3e419b37,0x3d16c32c,0xbdee3876,0x3e94a031,0x3e09cf86,0xbcc90ab0,0xbe3b6ecf,0x3e78cfcc,0x3da3308c,0xbdafb680,0xbe7ee6e1
.long 0x3e47c5c2,0x3cc90ab0,0xbe164083,0xbea09ae5,0x3e164083,0xbcfb49ba,0xbe541501,0xbec1071e,0x3dc8bd36,0xbdafb680,0xbe888e93,0xbee0924f,0x3d48fb30,0xbe1008b7,0xbea68f12,0xbeff17b2
.long 0x3ec3ef15,0x3e94a031,0x3e47c5c2,0x3dc8bd36,0x3ea09ae5,0x3e5a3997,0x3de1bc2e,0x3bc90f88,0x3e78cfcc,0x3e09cf86,0x3cc90ab0,0xbdafb680,0x3e2f10a2,0x3d621469,0xbd7b2b74,0xbe354098
.long 0x3dc8bd36,0xbcc90ab0,0xbe164083,0xbe888e93,0x3cc90ab0,0xbdd53db9,0xbe6c9a7f,0xbeb554ec,0xbd48fb30,0xbe3b6ecf,0xbea09ae5,0xbee0924f,0xbdfab273,0xbe8586ce,0xbec9b953,0xbf04f484
.long 0xbe47c5c2,0xbeac7cd4,0xbef15aea,0xbf187fc0,0xbe888e93,0xbed25a09,0xbf0b9a6b,0xbf2ac082,0xbeac7cd4,0xbef6e0cb,0xbf1d7fd1,0xbf3b8f3b,0xbecf7bca,0xbf0cead0,0xbf2e3bde,0xbf4ac77f
.long 0xbef15aea,0xbf1d7fd1,0xbf3daef9,0xbf584853,0xbf08f59b,0xbf2d1469,0xbf4bbbf8,0xbf63f473,0xbf187fc0,0xbf3b8f3b,0xbf584853,0xbf6db293,0xbf273656,0xbf48d8b3,0xbf633c5a,0xbf756d97
.long 0x80000000,0xbdc8bd36,0xbe47c5c2,0xbe94a031,0x80000000,0xbdd53db9,0xbe541501,0xbe9d9e78,0x80000000,0xbde1bc2e,0xbe605c13,0xbea68f12,0x80000000,0xbdee3876,0xbe6c9a7f,0xbeaf713a
.long 0x80000000,0xbdfab273,0xbe78cfcc,0xbeb8442a,0x80000000,0xbe039502,0xbe827dc0,0xbec1071e,0x80000000,0xbe09cf86,0xbe888e93,0xbec9b953,0x80000000,0xbe1008b7,0xbe8e9a22,0xbed25a09
.long 0x80000000,0xbe164083,0xbe94a031,0xbedae880,0x80000000,0xbe1c76de,0xbe9aa086,0xbee363fa,0x80000000,0xbe22abb6,0xbea09ae5,0xbeebcbbb,0x80000000,0xbe28defc,0xbea68f12,0xbef41f07
.long 0x80000000,0xbe2f10a2,0xbeac7cd4,0xbefc5d27,0x80000000,0xbe354098,0xbeb263ef,0xbf0242b1,0x80000000,0xbe3b6ecf,0xbeb8442a,0xbf064b82,0x80000000,0xbe419b37,0xbebe1d4a,0xbf0a48ad
.long 0xbec3ef15,0xbef15aea,0xbf0e39da,0xbf226799,0xbecf7bca,0xbeff17b2,0xbf15f6d9,0xbf2ac082,0xbedae880,0xbf064b82,0xbf1d7fd1,0xbf32c8c9,0xbee63375,0xbf0cead0,0xbf24d225,0xbf3a7ca4
.long 0xbef15aea,0xbf13682a,0xbf2beb4a,0xbf41d870,0xbefc5d27,0xbf19c200,0xbf32c8c9,0xbf48d8b3,0xbf039c3d,0xbf1ff6cb,0xbf396842,0xbf4f7a1f,0xbf08f59b,0xbf26050a,0xbf3fc767,0xbf55b993
.long 0xbf0e39da,0xbf2beb4a,0xbf45e403,0xbf5b941a,0xbf13682a,0xbf31a81d,0xbf4bbbf8,0xbf6106f2,0xbf187fc0,0xbf373a23,0xbf514d3d,0xbf660f88,0xbf1d7fd1,0xbf3ca003,0xbf5695e5,0xbf6aab7b
.long 0xbf226799,0xbf41d870,0xbf5b941a,0xbf6ed89e,0xbf273656,0xbf46e22a,0xbf604621,0xbf7294f8,0xbf2beb4a,0xbf4bbbf8,0xbf64aa59,0xbf75dec6,0xbf3085bb,0xbf5064af,0xbf68bf3c,0xbf78b47b
.long 0xbf3504f3,0xbf45e403,0xbf54db31,0xbf61c598,0xbf3daef9,0xbf4e8d90,0xbf5d2d53,0xbf696591,0xbf45e403,0xbf5695e5,0xbf64aa59,0xbf6ff573,0xbf4d9f02,0xbf5df6be,0xbf6b4b0c,0xbf756d97
.long 0xbf54db31,0xbf64aa59,0xbf710908,0xbf79c79d,0xbf5b941a,0xbf6aab7b,0xbf75dec6,0xbf7cfe73,0xbf61c598,0xbf6ff573,0xbf79c79d,0xbf7f0e58,0xbf676bd8,0xbf748422,0xbf7cbfc9,0xbf7ff4e6
.long 0xbf6c835e,0xbf7853f8,0xbf7ec46d,0xbf7fb10f,0xbf710908,0xbf7b61fc,0xbf7fd397,0xbf7e4323,0xbf74fa0b,0xbf7dabcc,0xbf7fec43,0xbf7baccd,0xbf7853f8,0xbf7f2f9d,0xbf7f0e58,0xbf77f110
.long 0xbf7b14be,0xbf7fec43,0xbf7d3aac,0xbf731447,0xbf7d3aac,0xbf7fe129,0xbf7a7302,0xbf6d1c1d,0xbf7ec46d,0xbf7f0e58,0xbf76ba07,0xbf660f88,0xbf7fb10f,0xbf7d7474,0xbf721352,0xbf5df6be
.long 0xbf6c835e,0xbf74fa0b,0xbf7b14be,0xbf7ec46d,0xbf731447,0xbf7a1e84,0xbf7e70b0,0xbf7ffec4,0xbf7853f8,0xbf7dabcc,0xbf7fec43,0xbf7f0e58,0xbf7c3b28,0xbf7f9c18,0xbf7f84ab,0xbf7bf531
.long 0xbf7ec46d,0xbf7fec43,0xbf7d3aac,0xbf76ba07,0xbf7fec43,0xbf7e9bc9,0xbf791298,0xbf6f6830,0xbf7fb10f,0xbf7baccd,0xbf731447,0xbf660f88,0xbf7e1324,0xbf772417,0xbf6b4b0c,0xbf5ac450
.long 0xbf7b14be,0xbf710908,0xbf61c598,0xbf4d9f02,0xbf76ba07,0xbf696591,0xbf5695e5,0xbf3ebc1b,0xbf710908,0xbf604621,0xbf49d112,0xbf2e3bde,0xbf6a09a7,0xbf55b993,0xbf3b8f3b,0xbf1c420c
.long 0xbf61c598,0xbf49d112,0xbf2beb4a,0xbf08f59b,0xbf584853,0xbf3ca003,0xbf1b02c6,0xbee900b7,0xbf4d9f02,0xbf2e3bde,0xbf08f59b,0xbebe1d4a,0xbf41d870,0xbf1ebc12,0xbeebcbbb,0xbe919ddd
.long 0x3f80,0x3f80,0x3f80,0x3f80,0x3f80,0x3ec43f6d,0x3f353f35,0x3f6d3ec4,0x3f80,0x3f353f35,0x3f800000,0x3f35bf35,0x3f80,0x3f6d3ec4,0x3f35bf35,0xbec4bf6d
.long 0x3f80,0x3f800000,0xbf80,0xbf800000,0x3f80,0x3f6dbec4,0xbf35bf35,0xbec43f6d,0x3f80,0x3f35bf35,0xbf800000,0x3f353f35,0x3f80,0x3ec4bf6d,0xbf353f35,0x3f6dbec4
.long 0x3f80,0xbf80,0x3f80,0xbf80,0x3f80,0xbec4bf6d,0x3f353f35,0xbf6dbec4,0x3f80,0xbf35bf35,0x3f800000,0xbf353f35,0x3f80,0xbf6dbec4,0x3f35bf35,0x3ec43f6d
.long 0x3f80,0xbf800000,0xbf80,0x3f800000,0x3f80,0xbf6d3ec4,0xbf35bf35,0x3ec4bf6d,0x3f80,0xbf353f35,0xbf800000,0xbf35bf35,0x3f80,0xbec43f6d,0xbf353f35,0xbf6d3ec4
.long 0x3f80,0x3f80,0x3f80,0x3f80,0x3f800000,0x3f6dbec4,0x3f35bf35,0x3ec4bf6d,0xbf80,0xbf35bf35,0xbf800000,0xbf353f35,0xbf800000,0xbec43f6d,0x3f353f35,0x3f6dbec4
.long 0x3f80,0x3f800000,0xbf80,0xbf800000,0x3f800000,0xbec4bf6d,0xbf353f35,0x3f6d3ec4,0xbf80,0xbf353f35,0x3f800000,0xbf35bf35,0xbf800000,0x3f6d3ec4,0xbf35bf35,0x3ec43f6d
.long 0x3f80,0xbf80,0x3f80,0xbf80,0x3f800000,0xbf6d3ec4,0x3f35bf35,0xbec43f6d,0xbf80,0x3f353f35,0xbf800000,0x3f35bf35,0xbf800000,0x3ec4bf6d,0x3f353f35,0xbf6d3ec4
.long 0x3f80,0xbf800000,0xbf80,0x3f800000,0x3f800000,0x3ec43f6d,0xbf353f35,0xbf6dbec4,0xbf80,0x3f35bf35,0x3f800000,0x3f353f35,0xbf800000,0xbf6dbec4,0xbf35bf35,0xbec4bf6d
.long 0x3f80,0x3f80,0x3f80,0x3f80,0xbf80,0xbec4bf6d,0xbf35bf35,0xbf6dbec4,0x3f80,0x3f353f35,0x3f800000,0x3f35bf35,0xbf80,0xbf6dbec4,0xbf353f35,0x3ec43f6d
.long 0x3f80,0x3f800000,0xbf80,0xbf800000,0xbf80,0xbf6d3ec4,0x3f353f35,0x3ec4bf6d,0x3f80,0x3f35bf35,0xbf800000,0x3f353f35,0xbf80,0xbec43f6d,0x3f35bf35,0xbf6d3ec4
.long 0x3f80,0xbf80,0x3f80,0xbf80,0xbf80,0x3ec43f6d,0xbf35bf35,0x3f6d3ec4,0x3f80,0xbf35bf35,0x3f800000,0xbf353f35,0xbf80,0x3f6d3ec4,0xbf353f35,0xbec4bf6d
.long 0x3f80,0xbf800000,0xbf80,0x3f800000,0xbf80,0x3f6dbec4,0x3f353f35,0xbec43f6d,0x3f80,0xbf353f35,0xbf800000,0xbf35bf35,0xbf80,0x3ec4bf6d,0x3f35bf35,0x3f6dbec4
.long 0x3f80,0x3f80,0x3f80,0x3f80,0xbf800000,0xbf6d3ec4,0xbf353f35,0xbec43f6d,0xbf80,0xbf35bf35,0xbf800000,0xbf353f35,0x3f800000,0x3ec4bf6d,0xbf35bf35,0xbf6d3ec4
.long 0x3f80,0x3f800000,0xbf80,0xbf800000,0xbf800000,0x3ec43f6d,0x3f35bf35,0xbf6dbec4,0xbf80,0xbf353f35,0x3f800000,0xbf35bf35,0x3f800000,0xbf6dbec4,0x3f353f35,0xbec4bf6d
.long 0x3f80,0xbf80,0x3f80,0xbf80,0xbf800000,0x3f6dbec4,0xbf353f35,0x3ec4bf6d,0xbf80,0x3f353f35,0xbf800000,0x3f35bf35,0x3f800000,0xbec43f6d,0xbf35bf35,0x3f6dbec4
.long 0x3f80,0xbf800000,0xbf80,0x3f800000,0xbf800000,0xbec4bf6d,0x3f35bf35,0x3f6d3ec4,0xbf80,0x3f35bf35,0x3f800000,0x3f353f35,0x3f800000,0x3f6d3ec4,0x3f353f35,0x3ec43f6d
.long 0x3f808000,0x3f808000,0x3f808000,0x3f808000,0x3f808000,0x3f6dbec4,0x3f35bf35,0x3ec4bf6d,0x3f808000,0x3f35bf35,0xbf80,0xbf35bf35,0x3f808000,0x3ec4bf6d,0xbf35bf35,0xbf6d3ec4
.long 0x3f808000,0xbf80,0xbf808000,0x3f80,0x3f808000,0xbec4bf6d,0xbf353f35,0x3f6d3ec4,0x3f808000,0xbf35bf35,0x3f80,0x3f35bf35,0x3f808000,0xbf6dbec4,0x3f353f35,0xbec4bf6d
.long 0x3f808000,0xbf808000,0x3f808000,0xbf808000,0x3f808000,0xbf6d3ec4,0x3f35bf35,0xbec43f6d,0x3f808000,0xbf353f35,0xbf80,0x3f353f35,0x3f808000,0xbec43f6d,0xbf35bf35,0x3f6dbec4
.long 0x3f808000,0x3f80,0xbf808000,0xbf80,0x3f808000,0x3ec43f6d,0xbf353f35,0xbf6dbec4,0x3f808000,0x3f353f35,0x3f80,0xbf353f35,0x3f808000,0x3f6d3ec4,0x3f353f35,0x3ec43f6d
.long 0x3f808000,0x3f808000,0x3f808000,0x3f808000,0xbf80,0xbec4bf6d,0xbf35bf35,0xbf6dbec4,0xbf808000,0xbf353f35,0x3f80,0x3f353f35,0x3f80,0x3f6d3ec4,0x3f35bf35,0xbec4bf6d
.long 0x3f808000,0xbf80,0xbf808000,0x3f80,0xbf80,0xbf6d3ec4,0x3f353f35,0x3ec4bf6d,0xbf808000,0x3f353f35,0xbf80,0xbf353f35,0x3f80,0x3ec4bf6d,0xbf353f35,0x3f6dbec4
.long 0x3f808000,0xbf808000,0x3f808000,0xbf808000,0xbf80,0x3ec43f6d,0xbf35bf35,0x3f6d3ec4,0xbf808000,0x3f35bf35,0x3f80,0xbf35bf35,0x3f80,0xbf6dbec4,0x3f35bf35,0x3ec43f6d
.long 0x3f808000,0x3f80,0xbf808000,0xbf80,0xbf80,0x3f6dbec4,0x3f353f35,0xbec43f6d,0xbf808000,0xbf35bf35,0xbf80,0x3f35bf35,0x3f80,0xbec43f6d,0xbf353f35,0xbf6d3ec4
.long 0x3f808000,0x3f808000,0x3f808000,0x3f808000,0xbf808000,0xbf6d3ec4,0xbf353f35,0xbec43f6d,0x3f808000,0x3f35bf35,0xbf80,0xbf35bf35,0xbf808000,0xbec43f6d,0x3f353f35,0x3f6dbec4
.long 0x3f808000,0xbf80,0xbf808000,0x3f80,0xbf808000,0x3ec43f6d,0x3f35bf35,0xbf6dbec4,0x3f808000,0xbf35bf35,0x3f80,0x3f35bf35,0xbf808000,0x3f6d3ec4,0xbf35bf35,0x3ec43f6d
.long 0x3f808000,0xbf808000,0x3f808000,0xbf808000,0xbf808000,0x3f6dbec4,0xbf353f35,0x3ec4bf6d,0x3f808000,0xbf353f35,0xbf80,0x3f353f35,0xbf808000,0x3ec4bf6d,0x3f353f35,0xbf6d3ec4
.long 0x3f808000,0x3f80,0xbf808000,0xbf80,0xbf808000,0xbec4bf6d,0x3f35bf35,0x3f6d3ec4,0x3f808000,0x3f353f35,0x3f80,0xbf353f35,0xbf808000,0xbf6dbec4,0xbf35bf35,0xbec4bf6d
.long 0x3f808000,0x3f808000,0x3f808000,0x3f808000,0x3f80,0x3ec43f6d,0x3f353f35,0x3f6d3ec4,0xbf808000,0xbf353f35,0x3f80,0x3f353f35,0xbf80,0xbf6dbec4,0xbf353f35,0x3ec43f6d
.long 0x3f808000,0xbf80,0xbf808000,0x3f80,0x3f80,0x3f6dbec4,0xbf35bf35,0xbec43f6d,0xbf808000,0x3f353f35,0xbf80,0xbf353f35,0xbf80,0xbec43f6d,0x3f35bf35,0xbf6d3ec4
.long 0x3f808000,0xbf808000,0x3f808000,0xbf808000,0x3f80,0xbec4bf6d,0x3f353f35,0xbf6dbec4,0xbf808000,0x3f35bf35,0x3f80,0xbf35bf35,0xbf80,0x3f6d3ec4,0xbf353f35,0xbec4bf6d
.long 0x3f808000,0x3f80,0xbf808000,0xbf80,0x3f80,0xbf6d3ec4,0xbf35bf35,0x3ec4bf6d,0xbf808000,0xbf35bf35,0xbf80,0x3f35bf35,0xbf80,0x3ec4bf6d,0x3f35bf35,0x3f6dbec4
.long 0x3f80,0x3f80,0x3f80,0x3f80,0x3cc93f80,0x3ecf3f6a,0x3f393f31,0x3f6f3eb8,0x3d493f80,0x3f3e3f2c,0x3f80bd49,0x3f2cbf3e,0x3d973f7f,0x3f733ea1,0x3f27bf42,0xbee6bf65
.long 0x3dc93f7f,0x3f7fbdc9,0xbdc9bf7f,0xbf7f3dc9,0x3dfb3f7e,0x3f5fbefc,0xbf4abf1d,0xbe893f77,0x3e163f7d,0x3f18bf4e,0xbf7d3e16,0x3f4e3f18,0x3e2f3f7c,0x3e60bf7a,0xbf133f51,0x3f58bf09
.long 0x3e483f7b,0xbe48bf7b,0x3e483f7b,0xbe48bf7b,0x3e603f7a,0xbf13bf51,0x3f583f09,0xbf7cbe2f,0x3e793f78,0xbf5cbf04,0x3f78be79,0xbf043f5c,0x3e893f77,0xbf7ebdfb,0x3efcbf5f,0x3f1d3f4a
.long 0x3e953f75,0xbf753e95,0xbe95bf75,0x3f75be95,0x3ea13f73,0xbf423f27,0xbf65bee6,0x3d97bf7f,0x3eac3f71,0xbedb3f67,0xbf713eac,0xbf67bedb,0x3eb83f6f,0xbcc93f80,0xbecf3f6a,0xbf393f31
.long 0x3f80,0x3f80,0x3f80,0x3f80,0x3f80bcc9,0x3f6abecf,0x3f31bf39,0x3eb8bf6f,0xbd49bf80,0xbf3ebf2c,0xbf803d49,0xbf2c3f3e,0xbf7f3d97,0xbea13f73,0x3f423f27,0x3f65bee6
.long 0x3dc93f7f,0x3f7fbdc9,0xbdc9bf7f,0xbf7f3dc9,0x3f7ebdfb,0xbefcbf5f,0xbf1d3f4a,0x3f773e89,0xbe16bf7d,0xbf183f4e,0x3f7dbe16,0xbf4ebf18,0xbf7c3e2f,0x3f7a3e60,0xbf51bf13,0x3f093f58
.long 0x3e483f7b,0xbe48bf7b,0x3e483f7b,0xbe48bf7b,0x3f7abe60,0xbf513f13,0x3f09bf58,0xbe2f3f7c,0xbe79bf78,0x3f5c3f04,0xbf783e79,0x3f04bf5c,0xbf773e89,0x3dfbbf7e,0x3f5f3efc,0xbf4a3f1d
.long 0x3e953f75,0xbf753e95,0xbe95bf75,0x3f75be95,0x3f73bea1,0x3f273f42,0xbee63f65,0xbf7fbd97,0xbeacbf71,0x3edbbf67,0x3f71beac,0x3f673edb,0xbf6f3eb8,0xbf80bcc9,0xbf6abecf,0xbf31bf39
.long 0x3f80,0x3f80,0x3f80,0x3f80,0xbcc9bf80,0xbecfbf6a,0xbf39bf31,0xbf6fbeb8,0x3d493f80,0x3f3e3f2c,0x3f80bd49,0x3f2cbf3e,0xbd97bf7f,0xbf73bea1,0xbf273f42,0x3ee63f65
.long 0x3dc93f7f,0x3f7fbdc9,0xbdc9bf7f,0xbf7f3dc9,0xbdfbbf7e,0xbf5f3efc,0x3f4a3f1d,0x3e89bf77,0x3e163f7d,0x3f18bf4e,0xbf7d3e16,0x3f4e3f18,0xbe2fbf7c,0xbe603f7a,0x3f13bf51,0xbf583f09
.long 0x3e483f7b,0xbe48bf7b,0x3e483f7b,0xbe48bf7b,0xbe60bf7a,0x3f133f51,0xbf58bf09,0x3f7c3e2f,0x3e793f78,0xbf5cbf04,0x3f78be79,0xbf043f5c,0xbe89bf77,0x3f7e3dfb,0xbefc3f5f,0xbf1dbf4a
.long 0x3e953f75,0xbf753e95,0xbe95bf75,0x3f75be95,0xbea1bf73,0x3f42bf27,0x3f653ee6,0xbd973f7f,0x3eac3f71,0xbedb3f67,0xbf713eac,0xbf67bedb,0xbeb8bf6f,0x3cc9bf80,0x3ecfbf6a,0x3f39bf31
.long 0x3f80,0x3f80,0x3f80,0x3f80,0xbf803cc9,0xbf6a3ecf,0xbf313f39,0xbeb83f6f,0xbd49bf80,0xbf3ebf2c,0xbf803d49,0xbf2c3f3e,0x3f7fbd97,0x3ea1bf73,0xbf42bf27,0xbf653ee6
.long 0x3dc93f7f,0x3f7fbdc9,0xbdc9bf7f,0xbf7f3dc9,0xbf7e3dfb,0x3efc3f5f,0x3f1dbf4a,0xbf77be89,0xbe16bf7d,0xbf183f4e,0x3f7dbe16,0xbf4ebf18,0x3f7cbe2f,0xbf7abe60,0x3f513f13,0xbf09bf58
.long 0x3e483f7b,0xbe48bf7b,0x3e483f7b,0xbe48bf7b,0xbf7a3e60,0x3f51bf13,0xbf093f58,0x3e2fbf7c,0xbe79bf78,0x3f5c3f04,0xbf783e79,0x3f04bf5c,0x3f77be89,0xbdfb3f7e,0xbf5fbefc,0x3f4abf1d
.long 0x3e953f75,0xbf753e95,0xbe95bf75,0x3f75be95,0xbf733ea1,0xbf27bf42,0x3ee6bf65,0x3f7f3d97,0xbeacbf71,0x3edbbf67,0x3f71beac,0x3f673edb,0x3f6fbeb8,0x3f803cc9,0x3f6a3ecf,0x3f313f39
.long 0x3f808000,0x3f808000,0x3f808000,0x3f808000,0x3f80bcc9,0x3f6abecf,0x3f31bf39,0x3eb8bf6f,0x3f80bd49,0x3f2cbf3e,0xbd49bf80,0xbf3ebf2c,0x3f7fbd97,0x3ea1bf73,0xbf42bf27,0xbf653ee6
.long 0x3f7fbdc9,0xbdc9bf7f,0xbf7f3dc9,0x3dc93f7f,0x3f7ebdfb,0xbefcbf5f,0xbf1d3f4a,0x3f773e89,0x3f7dbe16,0xbf4ebf18,0x3e163f7d,0x3f18bf4e,0x3f7cbe2f,0xbf7abe60,0x3f513f13,0xbf09bf58
.long 0x3f7bbe48,0xbf7b3e48,0x3f7bbe48,0xbf7b3e48,0x3f7abe60,0xbf513f13,0x3f09bf58,0xbe2f3f7c,0x3f78be79,0xbf043f5c,0xbe79bf78,0x3f5c3f04,0x3f77be89,0xbdfb3f7e,0xbf5fbefc,0x3f4abf1d
.long 0x3f75be95,0x3e953f75,0xbf753e95,0xbe95bf75,0x3f73bea1,0x3f273f42,0xbee63f65,0xbf7fbd97,0x3f71beac,0x3f673edb,0x3eac3f71,0xbedb3f67,0x3f6fbeb8,0x3f803cc9,0x3f6a3ecf,0x3f313f39
.long 0x3f808000,0x3f808000,0x3f808000,0x3f808000,0xbcc9bf80,0xbecfbf6a,0xbf39bf31,0xbf6fbeb8,0xbf803d49,0xbf2c3f3e,0x3d493f80,0x3f3e3f2c,0x3d973f7f,0x3f733ea1,0x3f27bf42,0xbee6bf65
.long 0x3f7fbdc9,0xbdc9bf7f,0xbf7f3dc9,0x3dc93f7f,0xbdfbbf7e,0xbf5f3efc,0x3f4a3f1d,0x3e89bf77,0xbf7d3e16,0x3f4e3f18,0xbe16bf7d,0xbf183f4e,0x3e2f3f7c,0x3e60bf7a,0xbf133f51,0x3f58bf09
.long 0x3f7bbe48,0xbf7b3e48,0x3f7bbe48,0xbf7b3e48,0xbe60bf7a,0x3f133f51,0xbf58bf09,0x3f7c3e2f,0xbf783e79,0x3f04bf5c,0x3e793f78,0xbf5cbf04,0x3e893f77,0xbf7ebdfb,0x3efcbf5f,0x3f1d3f4a
.long 0x3f75be95,0x3e953f75,0xbf753e95,0xbe95bf75,0xbea1bf73,0x3f42bf27,0x3f653ee6,0xbd973f7f,0xbf713eac,0xbf67bedb,0xbeacbf71,0x3edbbf67,0x3eb83f6f,0xbcc93f80,0xbecf3f6a,0xbf393f31
.long 0x3f808000,0x3f808000,0x3f808000,0x3f808000,0xbf803cc9,0xbf6a3ecf,0xbf313f39,0xbeb83f6f,0x3f80bd49,0x3f2cbf3e,0xbd49bf80,0xbf3ebf2c,0xbf7f3d97,0xbea13f73,0x3f423f27,0x3f65bee6
.long 0x3f7fbdc9,0xbdc9bf7f,0xbf7f3dc9,0x3dc93f7f,0xbf7e3dfb,0x3efc3f5f,0x3f1dbf4a,0xbf77be89,0x3f7dbe16,0xbf4ebf18,0x3e163f7d,0x3f18bf4e,0xbf7c3e2f,0x3f7a3e60,0xbf51bf13,0x3f093f58
.long 0x3f7bbe48,0xbf7b3e48,0x3f7bbe48,0xbf7b3e48,0xbf7a3e60,0x3f51bf13,0xbf093f58,0x3e2fbf7c,0x3f78be79,0xbf043f5c,0xbe79bf78,0x3f5c3f04,0xbf773e89,0x3dfbbf7e,0x3f5f3efc,0xbf4a3f1d
.long 0x3f75be95,0x3e953f75,0xbf753e95,0xbe95bf75,0xbf733ea1,0xbf27bf42,0x3ee6bf65,0x3f7f3d97,0x3f71beac,0x3f673edb,0x3eac3f71,0xbedb3f67,0xbf6f3eb8,0xbf80bcc9,0xbf6abecf,0xbf31bf39
.long 0x3f808000,0x3f808000,0x3f808000,0x3f808000,0x3cc93f80,0x3ecf3f6a,0x3f393f31,0x3f6f3eb8,0xbf803d49,0xbf2c3f3e,0x3d493f80,0x3f3e3f2c,0xbd97bf7f,0xbf73bea1,0xbf273f42,0x3ee63f65
.long 0x3f7fbdc9,0xbdc9bf7f,0xbf7f3dc9,0x3dc93f7f,0x3dfb3f7e,0x3f5fbefc,0xbf4abf1d,0xbe893f77,0xbf7d3e16,0x3f4e3f18,0xbe16bf7d,0xbf183f4e,0xbe2fbf7c,0xbe603f7a,0x3f13bf51,0xbf583f09
.long 0x3f7bbe48,0xbf7b3e48,0x3f7bbe48,0xbf7b3e48,0x3e603f7a,0xbf13bf51,0x3f583f09,0xbf7cbe2f,0xbf783e79,0x3f04bf5c,0x3e793f78,0xbf5cbf04,0xbe89bf77,0x3f7e3dfb,0xbefc3f5f,0xbf1dbf4a
.long 0x3f75be95,0x3e953f75,0xbf753e95,0xbe95bf75,0x3ea13f73,0xbf423f27,0xbf65bee6,0x3d97bf7f,0xbf713eac,0xbf67bedb,0xbeacbf71,0x3edbbf67,0xbeb8bf6f,0x3cc9bf80,0x3ecfbf6a,0x3f39bf31
.long 0x3f80,0x3f80,0x3f80,0x3f80,0x3d493f80,0x3edb3f67,0x3f3e3f2c,0x3f713eac,0x3dc93f7f,0x3f463f22,0x3f7fbdc9,0x3f22bf46,0x3e163f7d,0x3f783e79,0x3f18bf4e,0xbf04bf5c
.long 0x3e483f7b,0x3f7bbe48,0xbe48bf7b,0xbf7b3e48,0x3e793f78,0x3f4ebf18,0xbf5cbf04,0xbe163f7d,0x3e953f75,0x3ef1bf62,0xbf753e95,0x3f623ef1,0x3eac3f71,0x3d49bf80,0xbedb3f67,0x3f3ebf2c
.long 0x3ec43f6d,0xbec4bf6d,0x3ec43f6d,0xbec4bf6d,0x3edb3f67,0xbf3ebf2c,0x3f713eac,0xbf803d49,0x3ef13f62,0xbf75be95,0x3f62bef1,0xbe953f75,0x3f043f5c,0xbf7d3e16,0x3e79bf78,0x3f4e3f18
.long 0x3f0e3f55,0xbf553f0e,0xbf0ebf55,0x3f55bf0e,0x3f183f4e,0xbf043f5c,0xbf7dbe16,0xbe79bf78,0x3f223f46,0xbdc93f7f,0xbf463f22,0xbf7fbdc9,0x3f2c3f3e,0x3eac3f71,0xbd493f80,0xbedb3f67
.long 0x3f80,0x3f80,0x3f80,0x3f80,0x3f80bd49,0x3f67bedb,0x3f2cbf3e,0x3eacbf71,0xbdc9bf7f,0xbf46bf22,0xbf7f3dc9,0xbf223f46,0xbf7d3e16,0xbe793f78,0x3f4e3f18,0x3f5cbf04
.long 0x3e483f7b,0x3f7bbe48,0xbe48bf7b,0xbf7b3e48,0x3f78be79,0xbf18bf4e,0xbf043f5c,0x3f7d3e16,0xbe95bf75,0xbef13f62,0x3f75be95,0xbf62bef1,0xbf713eac,0x3f803d49,0xbf67bedb,0x3f2c3f3e
.long 0x3ec43f6d,0xbec4bf6d,0x3ec43f6d,0xbec4bf6d,0x3f67bedb,0xbf2c3f3e,0x3eacbf71,0x3d493f80,0xbef1bf62,0x3f753e95,0xbf623ef1,0x3e95bf75,0xbf5c3f04,0xbe16bf7d,0x3f783e79,0xbf183f4e
.long 0x3f0e3f55,0xbf553f0e,0xbf0ebf55,0x3f55bf0e,0x3f4ebf18,0x3f5c3f04,0xbe163f7d,0xbf783e79,0xbf22bf46,0x3dc9bf7f,0x3f46bf22,0x3f7f3dc9,0xbf3e3f2c,0xbf713eac,0xbf80bd49,0xbf67bedb
.long 0x3f80,0x3f80,0x3f80,0x3f80,0xbd49bf80,0xbedbbf67,0xbf3ebf2c,0xbf71beac,0x3dc93f7f,0x3f463f22,0x3f7fbdc9,0x3f22bf46,0xbe16bf7d,0xbf78be79,0xbf183f4e,0x3f043f5c
.long 0x3e483f7b,0x3f7bbe48,0xbe48bf7b,0xbf7b3e48,0xbe79bf78,0xbf4e3f18,0x3f5c3f04,0x3e16bf7d,0x3e953f75,0x3ef1bf62,0xbf753e95,0x3f623ef1,0xbeacbf71,0xbd493f80,0x3edbbf67,0xbf3e3f2c
.long 0x3ec43f6d,0xbec4bf6d,0x3ec43f6d,0xbec4bf6d,0xbedbbf67,0x3f3e3f2c,0xbf71beac,0x3f80bd49,0x3ef13f62,0xbf75be95,0x3f62bef1,0xbe953f75,0xbf04bf5c,0x3f7dbe16,0xbe793f78,0xbf4ebf18
.long 0x3f0e3f55,0xbf553f0e,0xbf0ebf55,0x3f55bf0e,0xbf18bf4e,0x3f04bf5c,0x3f7d3e16,0x3e793f78,0x3f223f46,0xbdc93f7f,0xbf463f22,0xbf7fbdc9,0xbf2cbf3e,0xbeacbf71,0x3d49bf80,0x3edbbf67
.long 0x3f80,0x3f80,0x3f80,0x3f80,0xbf803d49,0xbf673edb,0xbf2c3f3e,0xbeac3f71,0xbdc9bf7f,0xbf46bf22,0xbf7f3dc9,0xbf223f46,0x3f7dbe16,0x3e79bf78,0xbf4ebf18,0xbf5c3f04
.long 0x3e483f7b,0x3f7bbe48,0xbe48bf7b,0xbf7b3e48,0xbf783e79,0x3f183f4e,0x3f04bf5c,0xbf7dbe16,0xbe95bf75,0xbef13f62,0x3f75be95,0xbf62bef1,0x3f71beac,0xbf80bd49,0x3f673edb,0xbf2cbf3e
.long 0x3ec43f6d,0xbec4bf6d,0x3ec43f6d,0xbec4bf6d,0xbf673edb,0x3f2cbf3e,0xbeac3f71,0xbd49bf80,0xbef1bf62,0x3f753e95,0xbf623ef1,0x3e95bf75,0x3f5cbf04,0x3e163f7d,0xbf78be79,0x3f18bf4e
.long 0x3f0e3f55,0xbf553f0e,0xbf0ebf55,0x3f55bf0e,0xbf4e3f18,0xbf5cbf04,0x3e16bf7d,0x3f78be79,0xbf22bf46,0x3dc9bf7f,0x3f46bf22,0x3f7f3dc9,0x3f3ebf2c,0x3f71beac,0x3f803d49,0x3f673edb
.long 0x3f808000,0x3f808000,0x3f808000,0x3f808000,0x3f80bd49,0x3f67bedb,0x3f2cbf3e,0x3eacbf71,0x3f7fbdc9,0x3f22bf46,0xbdc9bf7f,0xbf46bf22,0x3f7dbe16,0x3e79bf78,0xbf4ebf18,0xbf5c3f04
.long 0x3f7bbe48,0xbe48bf7b,0xbf7b3e48,0x3e483f7b,0x3f78be79,0xbf18bf4e,0xbf043f5c,0x3f7d3e16,0x3f75be95,0xbf62bef1,0x3e953f75,0x3ef1bf62,0x3f71beac,0xbf80bd49,0x3f673edb,0xbf2cbf3e
.long 0x3f6dbec4,0xbf6d3ec4,0x3f6dbec4,0xbf6d3ec4,0x3f67bedb,0xbf2c3f3e,0x3eacbf71,0x3d493f80,0x3f62bef1,0xbe953f75,0xbef1bf62,0x3f753e95,0x3f5cbf04,0x3e163f7d,0xbf78be79,0x3f18bf4e
.long 0x3f55bf0e,0x3f0e3f55,0xbf553f0e,0xbf0ebf55,0x3f4ebf18,0x3f5c3f04,0xbe163f7d,0xbf783e79,0x3f46bf22,0x3f7f3dc9,0x3f223f46,0xbdc93f7f,0x3f3ebf2c,0x3f71beac,0x3f803d49,0x3f673edb
.long 0x3f808000,0x3f808000,0x3f808000,0x3f808000,0xbd49bf80,0xbedbbf67,0xbf3ebf2c,0xbf71beac,0xbf7f3dc9,0xbf223f46,0x3dc93f7f,0x3f463f22,0x3e163f7d,0x3f783e79,0x3f18bf4e,0xbf04bf5c
.long 0x3f7bbe48,0xbe48bf7b,0xbf7b3e48,0x3e483f7b,0xbe79bf78,0xbf4e3f18,0x3f5c3f04,0x3e16bf7d,0xbf753e95,0x3f623ef1,0xbe95bf75,0xbef13f62,0x3eac3f71,0x3d49bf80,0xbedb3f67,0x3f3ebf2c
.long 0x3f6dbec4,0xbf6d3ec4,0x3f6dbec4,0xbf6d3ec4,0xbedbbf67,0x3f3e3f2c,0xbf71beac,0x3f80bd49,0xbf623ef1,0x3e95bf75,0x3ef13f62,0xbf75be95,0x3f043f5c,0xbf7d3e16,0x3e79bf78,0x3f4e3f18
.long 0x3f55bf0e,0x3f0e3f55,0xbf553f0e,0xbf0ebf55,0xbf18bf4e,0x3f04bf5c,0x3f7d3e16,0x3e793f78,0xbf463f22,0xbf7fbdc9,0xbf22bf46,0x3dc9bf7f,0x3f2c3f3e,0x3eac3f71,0xbd493f80,0xbedb3f67
.long 0x3f808000,0x3f808000,0x3f808000,0x3f808000,0xbf803d49,0xbf673edb,0xbf2c3f3e,0xbeac3f71,0x3f7fbdc9,0x3f22bf46,0xbdc9bf7f,0xbf46bf22,0xbf7d3e16,0xbe793f78,0x3f4e3f18,0x3f5cbf04
.long 0x3f7bbe48,0xbe48bf7b,0xbf7b3e48,0x3e483f7b,0xbf783e79,0x3f183f4e,0x3f04bf5c,0xbf7dbe16,0x3f75be95,0xbf62bef1,0x3e953f75,0x3ef1bf62,0xbf713eac,0x3f803d49,0xbf67bedb,0x3f2c3f3e
.long 0x3f6dbec4,0xbf6d3ec4,0x3f6dbec4,0xbf6d3ec4,0xbf673edb,0x3f2cbf3e,0xbeac3f71,0xbd49bf80,0x3f62bef1,0xbe953f75,0xbef1bf62,0x3f753e95,0xbf5c3f04,0xbe16bf7d,0x3f783e79,0xbf183f4e
.long 0x3f55bf0e,0x3f0e3f55,0xbf553f0e,0xbf0ebf55,0xbf4e3f18,0xbf5cbf04,0x3e16bf7d,0x3f78be79,0x3f46bf22,0x3f7f3dc9,0x3f223f46,0xbdc93f7f,0xbf3e3f2c,0xbf713eac,0xbf80bd49,0xbf67bedb
.long 0x3f808000,0x3f808000,0x3f808000,0x3f808000,0x3d493f80,0x3edb3f67,0x3f3e3f2c,0x3f713eac,0xbf7f3dc9,0xbf223f46,0x3dc93f7f,0x3f463f22,0xbe16bf7d,0xbf78be79,0xbf183f4e,0x3f043f5c
.long 0x3f7bbe48,0xbe48bf7b,0xbf7b3e48,0x3e483f7b,0x3e793f78,0x3f4ebf18,0xbf5cbf04,0xbe163f7d,0xbf753e95,0x3f623ef1,0xbe95bf75,0xbef13f62,0xbeacbf71,0xbd493f80,0x3edbbf67,0xbf3e3f2c
.long 0x3f6dbec4,0xbf6d3ec4,0x3f6dbec4,0xbf6d3ec4,0x3edb3f67,0xbf3ebf2c,0x3f713eac,0xbf803d49,0xbf623ef1,0x3e95bf75,0x3ef13f62,0xbf75be95,0xbf04bf5c,0x3f7dbe16,0xbe793f78,0xbf4ebf18
.long 0x3f55bf0e,0x3f0e3f55,0xbf553f0e,0xbf0ebf55,0x3f183f4e,0xbf043f5c,0xbf7dbe16,0xbe79bf78,0xbf463f22,0xbf7fbdc9,0xbf22bf46,0x3dc9bf7f,0xbf2cbf3e,0xbeacbf71,0x3d49bf80,0x3edbbf67
.long 0x3f80,0x3f80,0x3f80,0x3f80,0x3d973f7f,0x3ee63f65,0x3f423f27,0x3f733ea1,0x3e163f7d,0x3f4e3f18,0x3f7dbe16,0x3f18bf4e,0x3e603f7a,0x3f7c3e2f,0x3f09bf58,0xbf13bf51
.long 0x3e953f75,0x3f75be95,0xbe95bf75,0xbf753e95,0x3eb83f6f,0x3f39bf31,0xbf6abecf,0xbcc93f80,0x3edb3f67,0x3eacbf71,0xbf673edb,0x3f713eac,0x3efc3f5f,0xbdfbbf7e,0xbe893f77,0x3f1dbf4a
.long 0x3f0e3f55,0xbf0ebf55,0x3f0e3f55,0xbf0ebf55,0x3f1d3f4a,0xbf5fbefc,0x3f7e3dfb,0xbf773e89,0x3f2c3f3e,0xbf80bd49,0x3f3ebf2c,0xbd493f80,0x3f393f31,0xbf6a3ecf,0xbcc9bf80,0x3f6f3eb8
.long 0x3f463f22,0xbf223f46,0xbf46bf22,0x3f22bf46,0x3f513f13,0xbe603f7a,0xbf7c3e2f,0xbf09bf58,0x3f5c3f04,0x3e793f78,0xbf043f5c,0xbf783e79,0x3f653ee6,0x3f273f42,0x3ea13f73,0xbd973f7f
.long 0x3f80,0x3f80,0x3f80,0x3f80,0x3f7fbd97,0x3f65bee6,0x3f27bf42,0x3ea1bf73,0xbe16bf7d,0xbf4ebf18,0xbf7d3e16,0xbf183f4e,0xbf7a3e60,0xbe2f3f7c,0x3f583f09,0x3f51bf13
.long 0x3e953f75,0x3f75be95,0xbe95bf75,0xbf753e95,0x3f6fbeb8,0xbf31bf39,0xbecf3f6a,0x3f803cc9,0xbedbbf67,0xbeac3f71,0x3f67bedb,0xbf71beac,0xbf5f3efc,0x3f7ebdfb,0xbf77be89,0x3f4a3f1d
.long 0x3f0e3f55,0xbf0ebf55,0x3f0e3f55,0xbf0ebf55,0x3f4abf1d,0xbefc3f5f,0x3dfbbf7e,0x3e893f77,0xbf2cbf3e,0x3f803d49,0xbf3e3f2c,0x3d49bf80,0xbf313f39,0xbecfbf6a,0x3f80bcc9,0xbeb83f6f
.long 0x3f463f22,0xbf223f46,0xbf46bf22,0x3f22bf46,0x3f13bf51,0x3f7a3e60,0x3e2f3f7c,0xbf583f09,0xbf5cbf04,0xbe79bf78,0x3f04bf5c,0x3f78be79,0xbee63f65,0xbf423f27,0xbf733ea1,0xbf7fbd97
.long 0x3f80,0x3f80,0x3f80,0x3f80,0xbd97bf7f,0xbee6bf65,0xbf42bf27,0xbf73bea1,0x3e163f7d,0x3f4e3f18,0x3f7dbe16,0x3f18bf4e,0xbe60bf7a,0xbf7cbe2f,0xbf093f58,0x3f133f51
.long 0x3e953f75,0x3f75be95,0xbe95bf75,0xbf753e95,0xbeb8bf6f,0xbf393f31,0x3f6a3ecf,0x3cc9bf80,0x3edb3f67,0x3eacbf71,0xbf673edb,0x3f713eac,0xbefcbf5f,0x3dfb3f7e,0x3e89bf77,0xbf1d3f4a
.long 0x3f0e3f55,0xbf0ebf55,0x3f0e3f55,0xbf0ebf55,0xbf1dbf4a,0x3f5f3efc,0xbf7ebdfb,0x3f77be89,0x3f2c3f3e,0xbf80bd49,0x3f3ebf2c,0xbd493f80,0xbf39bf31,0x3f6abecf,0x3cc93f80,0xbf6fbeb8
.long 0x3f463f22,0xbf223f46,0xbf46bf22,0x3f22bf46,0xbf51bf13,0x3e60bf7a,0x3f7cbe2f,0x3f093f58,0x3f5c3f04,0x3e793f78,0xbf043f5c,0xbf783e79,0xbf65bee6,0xbf27bf42,0xbea1bf73,0x3d97bf7f
.long 0x3f80,0x3f80,0x3f80,0x3f80,0xbf7f3d97,0xbf653ee6,0xbf273f42,0xbea13f73,0xbe16bf7d,0xbf4ebf18,0xbf7d3e16,0xbf183f4e,0x3f7abe60,0x3e2fbf7c,0xbf58bf09,0xbf513f13
.long 0x3e953f75,0x3f75be95,0xbe95bf75,0xbf753e95,0xbf6f3eb8,0x3f313f39,0x3ecfbf6a,0xbf80bcc9,0xbedbbf67,0xbeac3f71,0x3f67bedb,0xbf71beac,0x3f5fbefc,0xbf7e3dfb,0x3f773e89,0xbf4abf1d
.long 0x3f0e3f55,0xbf0ebf55,0x3f0e3f55,0xbf0ebf55,0xbf4a3f1d,0x3efcbf5f,0xbdfb3f7e,0xbe89bf77,0xbf2cbf3e,0x3f803d49,0xbf3e3f2c,0x3d49bf80,0x3f31bf39,0x3ecf3f6a,0xbf803cc9,0x3eb8bf6f
.long 0x3f463f22,0xbf223f46,0xbf46bf22,0x3f22bf46,0xbf133f51,0xbf7abe60,0xbe2fbf7c,0x3f58bf09,0xbf5cbf04,0xbe79bf78,0x3f04bf5c,0x3f78be79,0x3ee6bf65,0x3f42bf27,0x3f73bea1,0x3f7f3d97
.long 0x3f808000,0x3f808000,0x3f808000,0x3f808000,0x3f7fbd97,0x3f65bee6,0x3f27bf42,0x3ea1bf73,0x3f7dbe16,0x3f18bf4e,0xbe16bf7d,0xbf4ebf18,0x3f7abe60,0x3e2fbf7c,0xbf58bf09,0xbf513f13
.long 0x3f75be95,0xbe95bf75,0xbf753e95,0x3e953f75,0x3f6fbeb8,0xbf31bf39,0xbecf3f6a,0x3f803cc9,0x3f67bedb,0xbf71beac,0x3edb3f67,0x3eacbf71,0x3f5fbefc,0xbf7e3dfb,0x3f773e89,0xbf4abf1d
.long 0x3f55bf0e,0xbf553f0e,0x3f55bf0e,0xbf553f0e,0x3f4abf1d,0xbefc3f5f,0x3dfbbf7e,0x3e893f77,0x3f3ebf2c,0xbd493f80,0xbf2cbf3e,0x3f803d49,0x3f31bf39,0x3ecf3f6a,0xbf803cc9,0x3eb8bf6f
.long 0x3f22bf46,0x3f463f22,0xbf223f46,0xbf46bf22,0x3f13bf51,0x3f7a3e60,0x3e2f3f7c,0xbf583f09,0x3f04bf5c,0x3f78be79,0x3f5c3f04,0x3e793f78,0x3ee6bf65,0x3f42bf27,0x3f73bea1,0x3f7f3d97
.long 0x3f808000,0x3f808000,0x3f808000,0x3f808000,0xbd97bf7f,0xbee6bf65,0xbf42bf27,0xbf73bea1,0xbf7d3e16,0xbf183f4e,0x3e163f7d,0x3f4e3f18,0x3e603f7a,0x3f7c3e2f,0x3f09bf58,0xbf13bf51
.long 0x3f75be95,0xbe95bf75,0xbf753e95,0x3e953f75,0xbeb8bf6f,0xbf393f31,0x3f6a3ecf,0x3cc9bf80,0xbf673edb,0x3f713eac,0xbedbbf67,0xbeac3f71,0x3efc3f5f,0xbdfbbf7e,0xbe893f77,0x3f1dbf4a
.long 0x3f55bf0e,0xbf553f0e,0x3f55bf0e,0xbf553f0e,0xbf1dbf4a,0x3f5f3efc,0xbf7ebdfb,0x3f77be89,0xbf3e3f2c,0x3d49bf80,0x3f2c3f3e,0xbf80bd49,0x3f393f31,0xbf6a3ecf,0xbcc9bf80,0x3f6f3eb8
.long 0x3f22bf46,0x3f463f22,0xbf223f46,0xbf46bf22,0xbf51bf13,0x3e60bf7a,0x3f7cbe2f,0x3f093f58,0xbf043f5c,0xbf783e79,0xbf5cbf04,0xbe79bf78,0x3f653ee6,0x3f273f42,0x3ea13f73,0xbd973f7f
.long 0x3f808000,0x3f808000,0x3f808000,0x3f808000,0xbf7f3d97,0xbf653ee6,0xbf273f42,0xbea13f73,0x3f7dbe16,0x3f18bf4e,0xbe16bf7d,0xbf4ebf18,0xbf7a3e60,0xbe2f3f7c,0x3f583f09,0x3f51bf13
.long 0x3f75be95,0xbe95bf75,0xbf753e95,0x3e953f75,0xbf6f3eb8,0x3f313f39,0x3ecfbf6a,0xbf80bcc9,0x3f67bedb,0xbf71beac,0x3edb3f67,0x3eacbf71,0xbf5f3efc,0x3f7ebdfb,0xbf77be89,0x3f4a3f1d
.long 0x3f55bf0e,0xbf553f0e,0x3f55bf0e,0xbf553f0e,0xbf4a3f1d,0x3efcbf5f,0xbdfb3f7e,0xbe89bf77,0x3f3ebf2c,0xbd493f80,0xbf2cbf3e,0x3f803d49,0xbf313f39,0xbecfbf6a,0x3f80bcc9,0xbeb83f6f
.long 0x3f22bf46,0x3f463f22,0xbf223f46,0xbf46bf22,0xbf133f51,0xbf7abe60,0xbe2fbf7c,0x3f58bf09,0x3f04bf5c,0x3f78be79,0x3f5c3f04,0x3e793f78,0xbee63f65,0xbf423f27,0xbf733ea1,0xbf7fbd97
.long 0x3f808000,0x3f808000,0x3f808000,0x3f808000,0x3d973f7f,0x3ee63f65,0x3f423f27,0x3f733ea1,0xbf7d3e16,0xbf183f4e,0x3e163f7d,0x3f4e3f18,0xbe60bf7a,0xbf7cbe2f,0xbf093f58,0x3f133f51
.long 0x3f75be95,0xbe95bf75,0xbf753e95,0x3e953f75,0x3eb83f6f,0x3f39bf31,0xbf6abecf,0xbcc93f80,0xbf673edb,0x3f713eac,0xbedbbf67,0xbeac3f71,0xbefcbf5f,0x3dfb3f7e,0x3e89bf77,0xbf1d3f4a
.long 0x3f55bf0e,0xbf553f0e,0x3f55bf0e,0xbf553f0e,0x3f1d3f4a,0xbf5fbefc,0x3f7e3dfb,0xbf773e89,0xbf3e3f2c,0x3d49bf80,0x3f2c3f3e,0xbf80bd49,0xbf39bf31,0x3f6abecf,0x3cc93f80,0xbf6fbeb8
.long 0x3f22bf46,0x3f463f22,0xbf223f46,0xbf46bf22,0x3f513f13,0xbe603f7a,0xbf7c3e2f,0xbf09bf58,0xbf043f5c,0xbf783e79,0xbf5cbf04,0xbe79bf78,0xbf65bee6,0xbf27bf42,0xbea1bf73,0x3d97bf7f
.long 0x3f80,0x3f80,0x3f80,0x3f80,0x3dc93f7f,0x3ef13f62,0x3f463f22,0x3f753e95,0x3e483f7b,0x3f553f0e,0x3f7bbe48,0x3f0ebf55,0x3e953f75,0x3f7f3dc9,0x3ef1bf62,0xbf22bf46
.long 0x3ec43f6d,0x3f6dbec4,0xbec4bf6d,0xbf6d3ec4,0x3ef13f62,0x3f22bf46,0xbf75be95,0x3dc93f7f,0x3f0e3f55,0x3e48bf7b,0xbf553f0e,0x3f7b3e48,0x3f223f46,0xbe95bf75,0xbdc93f7f,0x3ef1bf62
.long 0x3f353f35,0xbf35bf35,0x3f353f35,0xbf35bf35,0x3f463f22,0xbf75be95,0x3f7fbdc9,0xbf623ef1,0x3f553f0e,0xbf7b3e48,0x3f0ebf55,0x3e483f7b,0x3f623ef1,0xbf463f22,0xbe95bf75,0x3f7f3dc9
.long 0x3f6d3ec4,0xbec43f6d,0xbf6dbec4,0x3ec4bf6d,0x3f753e95,0x3dc93f7f,0xbf623ef1,0xbf46bf22,0x3f7b3e48,0x3f0e3f55,0xbe483f7b,0xbf553f0e,0x3f7f3dc9,0x3f623ef1,0x3f223f46,0x3e953f75
.long 0x3f80,0x3f80,0x3f80,0x3f80,0x3f7fbdc9,0x3f62bef1,0x3f22bf46,0x3e95bf75,0xbe48bf7b,0xbf55bf0e,0xbf7b3e48,0xbf0e3f55,0xbf753e95,0xbdc93f7f,0x3f623ef1,0x3f46bf22
.long 0x3ec43f6d,0x3f6dbec4,0xbec4bf6d,0xbf6d3ec4,0x3f62bef1,0xbf46bf22,0xbe953f75,0x3f7fbdc9,0xbf0ebf55,0xbe483f7b,0x3f55bf0e,0xbf7bbe48,0xbf463f22,0x3f75be95,0xbf7fbdc9,0x3f623ef1
.long 0x3f353f35,0xbf35bf35,0x3f353f35,0xbf35bf35,0x3f22bf46,0xbe953f75,0xbdc9bf7f,0x3ef13f62,0xbf55bf0e,0x3f7bbe48,0xbf0e3f55,0xbe48bf7b,0xbef13f62,0xbf22bf46,0x3f75be95,0xbdc93f7f
.long 0x3f6d3ec4,0xbec43f6d,0xbf6dbec4,0x3ec4bf6d,0x3e95bf75,0x3f7fbdc9,0x3ef13f62,0xbf223f46,0xbf7bbe48,0xbf0ebf55,0x3e48bf7b,0x3f55bf0e,0xbdc93f7f,0xbef13f62,0xbf463f22,0xbf753e95
.long 0x3f80,0x3f80,0x3f80,0x3f80,0xbdc9bf7f,0xbef1bf62,0xbf46bf22,0xbf75be95,0x3e483f7b,0x3f553f0e,0x3f7bbe48,0x3f0ebf55,0xbe95bf75,0xbf7fbdc9,0xbef13f62,0x3f223f46
.long 0x3ec43f6d,0x3f6dbec4,0xbec4bf6d,0xbf6d3ec4,0xbef1bf62,0xbf223f46,0x3f753e95,0xbdc9bf7f,0x3f0e3f55,0x3e48bf7b,0xbf553f0e,0x3f7b3e48,0xbf22bf46,0x3e953f75,0x3dc9bf7f,0xbef13f62
.long 0x3f353f35,0xbf35bf35,0x3f353f35,0xbf35bf35,0xbf46bf22,0x3f753e95,0xbf7f3dc9,0x3f62bef1,0x3f553f0e,0xbf7b3e48,0x3f0ebf55,0x3e483f7b,0xbf62bef1,0x3f46bf22,0x3e953f75,0xbf7fbdc9
.long 0x3f6d3ec4,0xbec43f6d,0xbf6dbec4,0x3ec4bf6d,0xbf75be95,0xbdc9bf7f,0x3f62bef1,0x3f463f22,0x3f7b3e48,0x3f0e3f55,0xbe483f7b,0xbf553f0e,0xbf7fbdc9,0xbf62bef1,0xbf22bf46,0xbe95bf75
.long 0x3f80,0x3f80,0x3f80,0x3f80,0xbf7f3dc9,0xbf623ef1,0xbf223f46,0xbe953f75,0xbe48bf7b,0xbf55bf0e,0xbf7b3e48,0xbf0e3f55,0x3f75be95,0x3dc9bf7f,0xbf62bef1,0xbf463f22
.long 0x3ec43f6d,0x3f6dbec4,0xbec4bf6d,0xbf6d3ec4,0xbf623ef1,0x3f463f22,0x3e95bf75,0xbf7f3dc9,0xbf0ebf55,0xbe483f7b,0x3f55bf0e,0xbf7bbe48,0x3f46bf22,0xbf753e95,0x3f7f3dc9,0xbf62bef1
.long 0x3f353f35,0xbf35bf35,0x3f353f35,0xbf35bf35,0xbf223f46,0x3e95bf75,0x3dc93f7f,0xbef1bf62,0xbf55bf0e,0x3f7bbe48,0xbf0e3f55,0xbe48bf7b,0x3ef1bf62,0x3f223f46,0xbf753e95,0x3dc9bf7f
.long 0x3f6d3ec4,0xbec43f6d,0xbf6dbec4,0x3ec4bf6d,0xbe953f75,0xbf7f3dc9,0xbef1bf62,0x3f22bf46,0xbf7bbe48,0xbf0ebf55,0x3e48bf7b,0x3f55bf0e,0x3dc9bf7f,0x3ef1bf62,0x3f46bf22,0x3f75be95
.long 0x3f808000,0x3f808000,0x3f808000,0x3f808000,0x3f7fbdc9,0x3f62bef1,0x3f22bf46,0x3e95bf75,0x3f7bbe48,0x3f0ebf55,0xbe48bf7b,0xbf55bf0e,0x3f75be95,0x3dc9bf7f,0xbf62bef1,0xbf463f22
.long 0x3f6dbec4,0xbec4bf6d,0xbf6d3ec4,0x3ec43f6d,0x3f62bef1,0xbf46bf22,0xbe953f75,0x3f7fbdc9,0x3f55bf0e,0xbf7bbe48,0x3f0e3f55,0x3e48bf7b,0x3f46bf22,0xbf753e95,0x3f7f3dc9,0xbf62bef1
.long 0x3f35bf35,0xbf353f35,0x3f35bf35,0xbf353f35,0x3f22bf46,0xbe953f75,0xbdc9bf7f,0x3ef13f62,0x3f0ebf55,0x3e483f7b,0xbf55bf0e,0x3f7bbe48,0x3ef1bf62,0x3f223f46,0xbf753e95,0x3dc9bf7f
.long 0x3ec4bf6d,0x3f6d3ec4,0xbec43f6d,0xbf6dbec4,0x3e95bf75,0x3f7fbdc9,0x3ef13f62,0xbf223f46,0x3e48bf7b,0x3f55bf0e,0x3f7b3e48,0x3f0e3f55,0x3dc9bf7f,0x3ef1bf62,0x3f46bf22,0x3f75be95
.long 0x3f808000,0x3f808000,0x3f808000,0x3f808000,0xbdc9bf7f,0xbef1bf62,0xbf46bf22,0xbf75be95,0xbf7b3e48,0xbf0e3f55,0x3e483f7b,0x3f553f0e,0x3e953f75,0x3f7f3dc9,0x3ef1bf62,0xbf22bf46
.long 0x3f6dbec4,0xbec4bf6d,0xbf6d3ec4,0x3ec43f6d,0xbef1bf62,0xbf223f46,0x3f753e95,0xbdc9bf7f,0xbf553f0e,0x3f7b3e48,0xbf0ebf55,0xbe483f7b,0x3f223f46,0xbe95bf75,0xbdc93f7f,0x3ef1bf62
.long 0x3f35bf35,0xbf353f35,0x3f35bf35,0xbf353f35,0xbf46bf22,0x3f753e95,0xbf7f3dc9,0x3f62bef1,0xbf0e3f55,0xbe48bf7b,0x3f553f0e,0xbf7b3e48,0x3f623ef1,0xbf463f22,0xbe95bf75,0x3f7f3dc9
.long 0x3ec4bf6d,0x3f6d3ec4,0xbec43f6d,0xbf6dbec4,0xbf75be95,0xbdc9bf7f,0x3f62bef1,0x3f463f22,0xbe483f7b,0xbf553f0e,0xbf7bbe48,0xbf0ebf55,0x3f7f3dc9,0x3f623ef1,0x3f223f46,0x3e953f75
.long 0x3f808000,0x3f808000,0x3f808000,0x3f808000,0xbf7f3dc9,0xbf623ef1,0xbf223f46,0xbe953f75,0x3f7bbe48,0x3f0ebf55,0xbe48bf7b,0xbf55bf0e,0xbf753e95,0xbdc93f7f,0x3f623ef1,0x3f46bf22
.long 0x3f6dbec4,0xbec4bf6d,0xbf6d3ec4,0x3ec43f6d,0xbf623ef1,0x3f463f22,0x3e95bf75,0xbf7f3dc9,0x3f55bf0e,0xbf7bbe48,0x3f0e3f55,0x3e48bf7b,0xbf463f22,0x3f75be95,0xbf7fbdc9,0x3f623ef1
.long 0x3f35bf35,0xbf353f35,0x3f35bf35,0xbf353f35,0xbf223f46,0x3e95bf75,0x3dc93f7f,0xbef1bf62,0x3f0ebf55,0x3e483f7b,0xbf55bf0e,0x3f7bbe48,0xbef13f62,0xbf22bf46,0x3f75be95,0xbdc93f7f
.long 0x3ec4bf6d,0x3f6d3ec4,0xbec43f6d,0xbf6dbec4,0xbe953f75,0xbf7f3dc9,0xbef1bf62,0x3f22bf46,0x3e48bf7b,0x3f55bf0e,0x3f7b3e48,0x3f0e3f55,0xbdc93f7f,0xbef13f62,0xbf463f22,0xbf753e95
.long 0x3f808000,0x3f808000,0x3f808000,0x3f808000,0x3dc93f7f,0x3ef13f62,0x3f463f22,0x3f753e95,0xbf7b3e48,0xbf0e3f55,0x3e483f7b,0x3f553f0e,0xbe95bf75,0xbf7fbdc9,0xbef13f62,0x3f223f46
.long 0x3f6dbec4,0xbec4bf6d,0xbf6d3ec4,0x3ec43f6d,0x3ef13f62,0x3f22bf46,0xbf75be95,0x3dc93f7f,0xbf553f0e,0x3f7b3e48,0xbf0ebf55,0xbe483f7b,0xbf22bf46,0x3e953f75,0x3dc9bf7f,0xbef13f62
.long 0x3f35bf35,0xbf353f35,0x3f35bf35,0xbf353f35,0x3f463f22,0xbf75be95,0x3f7fbdc9,0xbf623ef1,0xbf0e3f55,0xbe48bf7b,0x3f553f0e,0xbf7b3e48,0xbf62bef1,0x3f46bf22,0x3e953f75,0xbf7fbdc9
.long 0x3ec4bf6d,0x3f6d3ec4,0xbec43f6d,0xbf6dbec4,0x3f753e95,0x3dc93f7f,0xbf623ef1,0xbf46bf22,0xbe483f7b,0xbf553f0e,0xbf7bbe48,0xbf0ebf55,0xbf7fbdc9,0xbf62bef1,0xbf22bf46,0xbe95bf75
.long 0x3f80,0x3f80,0x3f80,0x3f80,0x3dfb3f7e,0x3efc3f5f,0x3f4a3f1d,0x3f773e89,0x3e793f78,0x3f5c3f04,0x3f78be79,0x3f04bf5c,0x3eb83f6f,0x3f803cc9,0x3ecfbf6a,0xbf31bf39
.long 0x3ef13f62,0x3f62bef1,0xbef1bf62,0xbf623ef1,0x3f133f51,0x3f09bf58,0xbf7cbe2f,0x3e603f7a,0x3f2c3f3e,0x3d49bf80,0xbf3e3f2c,0x3f803d49,0x3f423f27,0xbee6bf65,0x3d973f7f,0x3ea1bf73
.long 0x3f553f0e,0xbf55bf0e,0x3f553f0e,0xbf55bf0e,0x3f653ee6,0xbf7fbd97,0x3f73bea1,0xbf423f27,0x3f713eac,0xbf673edb,0x3eacbf71,0x3edb3f67,0x3f7a3e60,0xbf133f51,0xbf09bf58,0x3f7cbe2f
.long 0x3f7f3dc9,0xbdc93f7f,0xbf7fbdc9,0x3dc9bf7f,0x3f80bcc9,0x3ecf3f6a,0xbf313f39,0xbf6fbeb8,0x3f7dbe16,0x3f4e3f18,0x3e163f7d,0xbf183f4e,0x3f77be89,0x3f7e3dfb,0x3f5f3efc,0x3f1d3f4a
.long 0x3f80,0x3f80,0x3f80,0x3f80,0x3f7ebdfb,0x3f5fbefc,0x3f1dbf4a,0x3e89bf77,0xbe79bf78,0xbf5cbf04,0xbf783e79,0xbf043f5c,0xbf6f3eb8,0xbcc93f80,0x3f6a3ecf,0x3f39bf31
.long 0x3ef13f62,0x3f62bef1,0xbef1bf62,0xbf623ef1,0x3f51bf13,0xbf58bf09,0xbe2f3f7c,0x3f7abe60,0xbf2cbf3e,0xbd493f80,0x3f3ebf2c,0xbf80bd49,0xbf273f42,0x3f65bee6,0xbf7f3d97,0x3f733ea1
.long 0x3f553f0e,0xbf55bf0e,0x3f553f0e,0xbf55bf0e,0x3ee6bf65,0xbd973f7f,0xbea1bf73,0x3f273f42,0xbf71beac,0x3f67bedb,0xbeac3f71,0xbedbbf67,0xbe603f7a,0xbf51bf13,0x3f58bf09,0x3e2f3f7c
.long 0x3f7f3dc9,0xbdc93f7f,0xbf7fbdc9,0x3dc9bf7f,0xbcc9bf80,0x3f6abecf,0x3f393f31,0xbeb83f6f,0xbf7d3e16,0xbf4ebf18,0xbe16bf7d,0x3f18bf4e,0x3e893f77,0xbdfb3f7e,0xbefc3f5f,0xbf4a3f1d
.long 0x3f80,0x3f80,0x3f80,0x3f80,0xbdfbbf7e,0xbefcbf5f,0xbf4abf1d,0xbf77be89,0x3e793f78,0x3f5c3f04,0x3f78be79,0x3f04bf5c,0xbeb8bf6f,0xbf80bcc9,0xbecf3f6a,0x3f313f39
.long 0x3ef13f62,0x3f62bef1,0xbef1bf62,0xbf623ef1,0xbf13bf51,0xbf093f58,0x3f7c3e2f,0xbe60bf7a,0x3f2c3f3e,0x3d49bf80,0xbf3e3f2c,0x3f803d49,0xbf42bf27,0x3ee63f65,0xbd97bf7f,0xbea13f73
.long 0x3f553f0e,0xbf55bf0e,0x3f553f0e,0xbf55bf0e,0xbf65bee6,0x3f7f3d97,0xbf733ea1,0x3f42bf27,0x3f713eac,0xbf673edb,0x3eacbf71,0x3edb3f67,0xbf7abe60,0x3f13bf51,0x3f093f58,0xbf7c3e2f
.long 0x3f7f3dc9,0xbdc93f7f,0xbf7fbdc9,0x3dc9bf7f,0xbf803cc9,0xbecfbf6a,0x3f31bf39,0x3f6f3eb8,0x3f7dbe16,0x3f4e3f18,0x3e163f7d,0xbf183f4e,0xbf773e89,0xbf7ebdfb,0xbf5fbefc,0xbf1dbf4a
.long 0x3f80,0x3f80,0x3f80,0x3f80,0xbf7e3dfb,0xbf5f3efc,0xbf1d3f4a,0xbe893f77,0xbe79bf78,0xbf5cbf04,0xbf783e79,0xbf043f5c,0x3f6fbeb8,0x3cc9bf80,0xbf6abecf,0xbf393f31
.long 0x3ef13f62,0x3f62bef1,0xbef1bf62,0xbf623ef1,0xbf513f13,0x3f583f09,0x3e2fbf7c,0xbf7a3e60,0xbf2cbf3e,0xbd493f80,0x3f3ebf2c,0xbf80bd49,0x3f27bf42,0xbf653ee6,0x3f7fbd97,0xbf73bea1
.long 0x3f553f0e,0xbf55bf0e,0x3f553f0e,0xbf55bf0e,0xbee63f65,0x3d97bf7f,0x3ea13f73,0xbf27bf42,0xbf71beac,0x3f67bedb,0xbeac3f71,0xbedbbf67,0x3e60bf7a,0x3f513f13,0xbf583f09,0xbe2fbf7c
.long 0x3f7f3dc9,0xbdc93f7f,0xbf7fbdc9,0x3dc9bf7f,0x3cc93f80,0xbf6a3ecf,0xbf39bf31,0x3eb8bf6f,0xbf7d3e16,0xbf4ebf18,0xbe16bf7d,0x3f18bf4e,0xbe89bf77,0x3dfbbf7e,0x3efcbf5f,0x3f4abf1d
.long 0x3f808000,0x3f808000,0x3f808000,0x3f808000,0x3f7ebdfb,0x3f5fbefc,0x3f1dbf4a,0x3e89bf77,0x3f78be79,0x3f04bf5c,0xbe79bf78,0xbf5cbf04,0x3f6fbeb8,0x3cc9bf80,0xbf6abecf,0xbf393f31
.long 0x3f62bef1,0xbef1bf62,0xbf623ef1,0x3ef13f62,0x3f51bf13,0xbf58bf09,0xbe2f3f7c,0x3f7abe60,0x3f3ebf2c,0xbf80bd49,0x3f2c3f3e,0x3d49bf80,0x3f27bf42,0xbf653ee6,0x3f7fbd97,0xbf73bea1
.long 0x3f0ebf55,0xbf0e3f55,0x3f0ebf55,0xbf0e3f55,0x3ee6bf65,0xbd973f7f,0xbea1bf73,0x3f273f42,0x3eacbf71,0x3edb3f67,0xbf71beac,0x3f67bedb,0x3e60bf7a,0x3f513f13,0xbf583f09,0xbe2fbf7c
.long 0x3dc9bf7f,0x3f7f3dc9,0xbdc93f7f,0xbf7fbdc9,0xbcc9bf80,0x3f6abecf,0x3f393f31,0xbeb83f6f,0xbe16bf7d,0x3f18bf4e,0x3f7dbe16,0x3f4e3f18,0xbe89bf77,0x3dfbbf7e,0x3efcbf5f,0x3f4abf1d
.long 0x3f808000,0x3f808000,0x3f808000,0x3f808000,0xbdfbbf7e,0xbefcbf5f,0xbf4abf1d,0xbf77be89,0xbf783e79,0xbf043f5c,0x3e793f78,0x3f5c3f04,0x3eb83f6f,0x3f803cc9,0x3ecfbf6a,0xbf31bf39
.long 0x3f62bef1,0xbef1bf62,0xbf623ef1,0x3ef13f62,0xbf13bf51,0xbf093f58,0x3f7c3e2f,0xbe60bf7a,0xbf3e3f2c,0x3f803d49,0xbf2cbf3e,0xbd493f80,0x3f423f27,0xbee6bf65,0x3d973f7f,0x3ea1bf73
.long 0x3f0ebf55,0xbf0e3f55,0x3f0ebf55,0xbf0e3f55,0xbf65bee6,0x3f7f3d97,0xbf733ea1,0x3f42bf27,0xbeac3f71,0xbedbbf67,0x3f713eac,0xbf673edb,0x3f7a3e60,0xbf133f51,0xbf09bf58,0x3f7cbe2f
.long 0x3dc9bf7f,0x3f7f3dc9,0xbdc93f7f,0xbf7fbdc9,0xbf803cc9,0xbecfbf6a,0x3f31bf39,0x3f6f3eb8,0x3e163f7d,0xbf183f4e,0xbf7d3e16,0xbf4ebf18,0x3f77be89,0x3f7e3dfb,0x3f5f3efc,0x3f1d3f4a
.long 0x3f808000,0x3f808000,0x3f808000,0x3f808000,0xbf7e3dfb,0xbf5f3efc,0xbf1d3f4a,0xbe893f77,0x3f78be79,0x3f04bf5c,0xbe79bf78,0xbf5cbf04,0xbf6f3eb8,0xbcc93f80,0x3f6a3ecf,0x3f39bf31
.long 0x3f62bef1,0xbef1bf62,0xbf623ef1,0x3ef13f62,0xbf513f13,0x3f583f09,0x3e2fbf7c,0xbf7a3e60,0x3f3ebf2c,0xbf80bd49,0x3f2c3f3e,0x3d49bf80,0xbf273f42,0x3f65bee6,0xbf7f3d97,0x3f733ea1
.long 0x3f0ebf55,0xbf0e3f55,0x3f0ebf55,0xbf0e3f55,0xbee63f65,0x3d97bf7f,0x3ea13f73,0xbf27bf42,0x3eacbf71,0x3edb3f67,0xbf71beac,0x3f67bedb,0xbe603f7a,0xbf51bf13,0x3f58bf09,0x3e2f3f7c
.long 0x3dc9bf7f,0x3f7f3dc9,0xbdc93f7f,0xbf7fbdc9,0x3cc93f80,0xbf6a3ecf,0xbf39bf31,0x3eb8bf6f,0xbe16bf7d,0x3f18bf4e,0x3f7dbe16,0x3f4e3f18,0x3e893f77,0xbdfb3f7e,0xbefc3f5f,0xbf4a3f1d
.long 0x3f808000,0x3f808000,0x3f808000,0x3f808000,0x3dfb3f7e,0x3efc3f5f,0x3f4a3f1d,0x3f773e89,0xbf783e79,0xbf043f5c,0x3e793f78,0x3f5c3f04,0xbeb8bf6f,0xbf80bcc9,0xbecf3f6a,0x3f313f39
.long 0x3f62bef1,0xbef1bf62,0xbf623ef1,0x3ef13f62,0x3f133f51,0x3f09bf58,0xbf7cbe2f,0x3e603f7a,0xbf3e3f2c,0x3f803d49,0xbf2cbf3e,0xbd493f80,0xbf42bf27,0x3ee63f65,0xbd97bf7f,0xbea13f73
.long 0x3f0ebf55,0xbf0e3f55,0x3f0ebf55,0xbf0e3f55,0x3f653ee6,0xbf7fbd97,0x3f73bea1,0xbf423f27,0xbeac3f71,0xbedbbf67,0x3f713eac,0xbf673edb,0xbf7abe60,0x3f13bf51,0x3f093f58,0xbf7c3e2f
.long 0x3dc9bf7f,0x3f7f3dc9,0xbdc93f7f,0xbf7fbdc9,0x3f80bcc9,0x3ecf3f6a,0xbf313f39,0xbf6fbeb8,0x3e163f7d,0xbf183f4e,0xbf7d3e16,0xbf4ebf18,0xbf773e89,0xbf7ebdfb,0xbf5fbefc,0xbf1dbf4a
.long 0x3f80,0x3f80,0x3f80,0x3f80,0x3e163f7d,0x3f043f5c,0x3f4e3f18,0x3f783e79,0x3e953f75,0x3f623ef1,0x3f75be95,0x3ef1bf62,0x3edb3f67,0x3f80bd49,0x3eacbf71,0xbf3ebf2c
.long 0x3f0e3f55,0x3f55bf0e,0xbf0ebf55,0xbf553f0e,0x3f2c3f3e,0x3edbbf67,0xbf80bd49,0x3eac3f71,0x3f463f22,0xbdc9bf7f,0xbf223f46,0x3f7fbdc9,0x3f5c3f04,0xbf18bf4e,0x3e793f78,0x3e16bf7d
.long 0x3f6d3ec4,0xbf6dbec4,0x3f6d3ec4,0xbf6dbec4,0x3f783e79,0xbf7d3e16,0x3f5cbf04,0xbf183f4e,0x3f7f3dc9,0xbf463f22,0x3dc9bf7f,0x3f223f46,0x3f80bd49,0xbeac3f71,0xbf3ebf2c,0x3f67bedb
.long 0x3f7bbe48,0x3e483f7b,0xbf7b3e48,0xbe48bf7b,0x3f71beac,0x3f2c3f3e,0xbedb3f67,0xbf80bd49,0x3f62bef1,0x3f753e95,0x3ef13f62,0xbe953f75,0x3f4ebf18,0x3f78be79,0x3f7d3e16,0x3f5c3f04
.long 0x3f80,0x3f80,0x3f80,0x3f80,0x3f7dbe16,0x3f5cbf04,0x3f18bf4e,0x3e79bf78,0xbe95bf75,0xbf62bef1,0xbf753e95,0xbef13f62,0xbf673edb,0x3d493f80,0x3f713eac,0x3f2cbf3e
.long 0x3f0e3f55,0x3f55bf0e,0xbf0ebf55,0xbf553f0e,0x3f3ebf2c,0xbf67bedb,0xbd493f80,0x3f71beac,0xbf46bf22,0x3dc93f7f,0x3f22bf46,0xbf7f3dc9,0xbf043f5c,0x3f4ebf18,0xbf783e79,0x3f7d3e16
.long 0x3f6d3ec4,0xbf6dbec4,0x3f6d3ec4,0xbf6dbec4,0x3e79bf78,0x3e163f7d,0xbf04bf5c,0x3f4e3f18,0xbf7fbdc9,0x3f46bf22,0xbdc93f7f,0xbf22bf46,0x3d493f80,0xbf71beac,0x3f2cbf3e,0x3edb3f67
.long 0x3f7bbe48,0x3e483f7b,0xbf7b3e48,0xbe48bf7b,0xbeacbf71,0x3f3ebf2c,0x3f673edb,0xbd493f80,0xbf623ef1,0xbf75be95,0xbef1bf62,0x3e95bf75,0x3f183f4e,0x3e793f78,0xbe163f7d,0xbf043f5c
.long 0x3f80,0x3f80,0x3f80,0x3f80,0xbe16bf7d,0xbf04bf5c,0xbf4ebf18,0xbf78be79,0x3e953f75,0x3f623ef1,0x3f75be95,0x3ef1bf62,0xbedbbf67,0xbf803d49,0xbeac3f71,0x3f3e3f2c
.long 0x3f0e3f55,0x3f55bf0e,0xbf0ebf55,0xbf553f0e,0xbf2cbf3e,0xbedb3f67,0x3f803d49,0xbeacbf71,0x3f463f22,0xbdc9bf7f,0xbf223f46,0x3f7fbdc9,0xbf5cbf04,0x3f183f4e,0xbe79bf78,0xbe163f7d
.long 0x3f6d3ec4,0xbf6dbec4,0x3f6d3ec4,0xbf6dbec4,0xbf78be79,0x3f7dbe16,0xbf5c3f04,0x3f18bf4e,0x3f7f3dc9,0xbf463f22,0x3dc9bf7f,0x3f223f46,0xbf803d49,0x3eacbf71,0x3f3e3f2c,0xbf673edb
.long 0x3f7bbe48,0x3e483f7b,0xbf7b3e48,0xbe48bf7b,0xbf713eac,0xbf2cbf3e,0x3edbbf67,0x3f803d49,0x3f62bef1,0x3f753e95,0x3ef13f62,0xbe953f75,0xbf4e3f18,0xbf783e79,0xbf7dbe16,0xbf5cbf04
.long 0x3f80,0x3f80,0x3f80,0x3f80,0xbf7d3e16,0xbf5c3f04,0xbf183f4e,0xbe793f78,0xbe95bf75,0xbf62bef1,0xbf753e95,0xbef13f62,0x3f67bedb,0xbd49bf80,0xbf71beac,0xbf2c3f3e
.long 0x3f0e3f55,0x3f55bf0e,0xbf0ebf55,0xbf553f0e,0xbf3e3f2c,0x3f673edb,0x3d49bf80,0xbf713eac,0xbf46bf22,0x3dc93f7f,0x3f22bf46,0xbf7f3dc9,0x3f04bf5c,0xbf4e3f18,0x3f78be79,0xbf7dbe16
.long 0x3f6d3ec4,0xbf6dbec4,0x3f6d3ec4,0xbf6dbec4,0xbe793f78,0xbe16bf7d,0x3f043f5c,0xbf4ebf18,0xbf7fbdc9,0x3f46bf22,0xbdc93f7f,0xbf22bf46,0xbd49bf80,0x3f713eac,0xbf2c3f3e,0xbedbbf67
.long 0x3f7bbe48,0x3e483f7b,0xbf7b3e48,0xbe48bf7b,0x3eac3f71,0xbf3e3f2c,0xbf67bedb,0x3d49bf80,0xbf623ef1,0xbf75be95,0xbef1bf62,0x3e95bf75,0xbf18bf4e,0xbe79bf78,0x3e16bf7d,0x3f04bf5c
.long 0x3f808000,0x3f808000,0x3f808000,0x3f808000,0x3f7dbe16,0x3f5cbf04,0x3f18bf4e,0x3e79bf78,0x3f75be95,0x3ef1bf62,0xbe95bf75,0xbf62bef1,0x3f67bedb,0xbd49bf80,0xbf71beac,0xbf2c3f3e
.long 0x3f55bf0e,0xbf0ebf55,0xbf553f0e,0x3f0e3f55,0x3f3ebf2c,0xbf67bedb,0xbd493f80,0x3f71beac,0x3f22bf46,0xbf7f3dc9,0x3f463f22,0xbdc9bf7f,0x3f04bf5c,0xbf4e3f18,0x3f78be79,0xbf7dbe16
.long 0x3ec4bf6d,0xbec43f6d,0x3ec4bf6d,0xbec43f6d,0x3e79bf78,0x3e163f7d,0xbf04bf5c,0x3f4e3f18,0x3dc9bf7f,0x3f223f46,0xbf7fbdc9,0x3f46bf22,0xbd49bf80,0x3f713eac,0xbf2c3f3e,0xbedbbf67
.long 0xbe48bf7b,0x3f7bbe48,0x3e483f7b,0xbf7b3e48,0xbeacbf71,0x3f3ebf2c,0x3f673edb,0xbd493f80,0xbef1bf62,0x3e95bf75,0x3f62bef1,0x3f753e95,0xbf18bf4e,0xbe79bf78,0x3e16bf7d,0x3f04bf5c
.long 0x3f808000,0x3f808000,0x3f808000,0x3f808000,0xbe16bf7d,0xbf04bf5c,0xbf4ebf18,0xbf78be79,0xbf753e95,0xbef13f62,0x3e953f75,0x3f623ef1,0x3edb3f67,0x3f80bd49,0x3eacbf71,0xbf3ebf2c
.long 0x3f55bf0e,0xbf0ebf55,0xbf553f0e,0x3f0e3f55,0xbf2cbf3e,0xbedb3f67,0x3f803d49,0xbeacbf71,0xbf223f46,0x3f7fbdc9,0xbf46bf22,0x3dc93f7f,0x3f5c3f04,0xbf18bf4e,0x3e793f78,0x3e16bf7d
.long 0x3ec4bf6d,0xbec43f6d,0x3ec4bf6d,0xbec43f6d,0xbf78be79,0x3f7dbe16,0xbf5c3f04,0x3f18bf4e,0xbdc93f7f,0xbf22bf46,0x3f7f3dc9,0xbf463f22,0x3f80bd49,0xbeac3f71,0xbf3ebf2c,0x3f67bedb
.long 0xbe48bf7b,0x3f7bbe48,0x3e483f7b,0xbf7b3e48,0xbf713eac,0xbf2cbf3e,0x3edbbf67,0x3f803d49,0x3ef13f62,0xbe953f75,0xbf623ef1,0xbf75be95,0x3f4ebf18,0x3f78be79,0x3f7d3e16,0x3f5c3f04
.long 0x3f808000,0x3f808000,0x3f808000,0x3f808000,0xbf7d3e16,0xbf5c3f04,0xbf183f4e,0xbe793f78,0x3f75be95,0x3ef1bf62,0xbe95bf75,0xbf62bef1,0xbf673edb,0x3d493f80,0x3f713eac,0x3f2cbf3e
.long 0x3f55bf0e,0xbf0ebf55,0xbf553f0e,0x3f0e3f55,0xbf3e3f2c,0x3f673edb,0x3d49bf80,0xbf713eac,0x3f22bf46,0xbf7f3dc9,0x3f463f22,0xbdc9bf7f,0xbf043f5c,0x3f4ebf18,0xbf783e79,0x3f7d3e16
.long 0x3ec4bf6d,0xbec43f6d,0x3ec4bf6d,0xbec43f6d,0xbe793f78,0xbe16bf7d,0x3f043f5c,0xbf4ebf18,0x3dc9bf7f,0x3f223f46,0xbf7fbdc9,0x3f46bf22,0x3d493f80,0xbf71beac,0x3f2cbf3e,0x3edb3f67
.long 0xbe48bf7b,0x3f7bbe48,0x3e483f7b,0xbf7b3e48,0x3eac3f71,0xbf3e3f2c,0xbf67bedb,0x3d49bf80,0xbef1bf62,0x3e95bf75,0x3f62bef1,0x3f753e95,0x3f183f4e,0x3e793f78,0xbe163f7d,0xbf043f5c
.long 0x3f808000,0x3f808000,0x3f808000,0x3f808000,0x3e163f7d,0x3f043f5c,0x3f4e3f18,0x3f783e79,0xbf753e95,0xbef13f62,0x3e953f75,0x3f623ef1,0xbedbbf67,0xbf803d49,0xbeac3f71,0x3f3e3f2c
.long 0x3f55bf0e,0xbf0ebf55,0xbf553f0e,0x3f0e3f55,0x3f2c3f3e,0x3edbbf67,0xbf80bd49,0x3eac3f71,0xbf223f46,0x3f7fbdc9,0xbf46bf22,0x3dc93f7f,0xbf5cbf04,0x3f183f4e,0xbe79bf78,0xbe163f7d
.long 0x3ec4bf6d,0xbec43f6d,0x3ec4bf6d,0xbec43f6d,0x3f783e79,0xbf7d3e16,0x3f5cbf04,0xbf183f4e,0xbdc93f7f,0xbf22bf46,0x3f7f3dc9,0xbf463f22,0xbf803d49,0x3eacbf71,0x3f3e3f2c,0xbf673edb
.long 0xbe48bf7b,0x3f7bbe48,0x3e483f7b,0xbf7b3e48,0x3f71beac,0x3f2c3f3e,0xbedb3f67,0xbf80bd49,0x3ef13f62,0xbe953f75,0xbf623ef1,0xbf75be95,0xbf4e3f18,0xbf783e79,0xbf7dbe16,0xbf5cbf04
.long 0x3f80,0x3f80,0x3f80,0x3f80,0x3e2f3f7c,0x3f093f58,0x3f513f13,0x3f7a3e60,0x3eac3f71,0x3f673edb,0x3f71beac,0x3edbbf67,0x3efc3f5f,0x3f7ebdfb,0x3e89bf77,0xbf4abf1d
.long 0x3f223f46,0x3f46bf22,0xbf22bf46,0xbf463f22,0x3f423f27,0x3ea1bf73,0xbf7f3d97,0x3ee63f65,0x3f5c3f04,0xbe79bf78,0xbf043f5c,0x3f78be79,0x3f6f3eb8,0xbf39bf31,0x3ecf3f6a,0xbcc9bf80
.long 0x3f7b3e48,0xbf7bbe48,0x3f7b3e48,0xbf7bbe48,0x3f803cc9,0xbf6f3eb8,0x3f39bf31,0xbecf3f6a,0x3f7dbe16,0xbf183f4e,0xbe16bf7d,0x3f4e3f18,0x3f73bea1,0xbd973f7f,0xbf65bee6,0x3f42bf27
.long 0x3f62bef1,0x3ef13f62,0xbf623ef1,0xbef1bf62,0x3f4abf1d,0x3f5f3efc,0xbdfb3f7e,0xbf773e89,0x3f2cbf3e,0x3f80bd49,0x3f3e3f2c,0x3d493f80,0x3f09bf58,0x3f51bf13,0x3f7abe60,0x3f7c3e2f
.long 0x3f80,0x3f80,0x3f80,0x3f80,0x3f7cbe2f,0x3f58bf09,0x3f13bf51,0x3e60bf7a,0xbeacbf71,0xbf67bedb,0xbf713eac,0xbedb3f67,0xbf5f3efc,0x3dfb3f7e,0x3f773e89,0x3f1dbf4a
.long 0x3f223f46,0x3f46bf22,0xbf22bf46,0xbf463f22,0x3f27bf42,0xbf73bea1,0x3d973f7f,0x3f65bee6,0xbf5cbf04,0x3e793f78,0x3f04bf5c,0xbf783e79,0xbeb83f6f,0x3f31bf39,0xbf6a3ecf,0x3f80bcc9
.long 0x3f7b3e48,0xbf7bbe48,0x3f7b3e48,0xbf7bbe48,0x3cc9bf80,0x3eb83f6f,0xbf31bf39,0x3f6a3ecf,0xbf7d3e16,0x3f18bf4e,0x3e163f7d,0xbf4ebf18,0x3ea13f73,0xbf7fbd97,0x3ee6bf65,0x3f273f42
.long 0x3f62bef1,0x3ef13f62,0xbf623ef1,0xbef1bf62,0xbf1dbf4a,0x3efcbf5f,0x3f7e3dfb,0x3e893f77,0xbf2c3f3e,0xbf803d49,0xbf3ebf2c,0xbd49bf80,0x3f583f09,0x3f133f51,0x3e603f7a,0xbe2f3f7c
.long 0x3f80,0x3f80,0x3f80,0x3f80,0xbe2fbf7c,0xbf09bf58,0xbf51bf13,0xbf7abe60,0x3eac3f71,0x3f673edb,0x3f71beac,0x3edbbf67,0xbefcbf5f,0xbf7e3dfb,0xbe893f77,0x3f4a3f1d
.long 0x3f223f46,0x3f46bf22,0xbf22bf46,0xbf463f22,0xbf42bf27,0xbea13f73,0x3f7fbd97,0xbee6bf65,0x3f5c3f04,0xbe79bf78,0xbf043f5c,0x3f78be79,0xbf6fbeb8,0x3f393f31,0xbecfbf6a,0x3cc93f80
.long 0x3f7b3e48,0xbf7bbe48,0x3f7b3e48,0xbf7bbe48,0xbf80bcc9,0x3f6fbeb8,0xbf393f31,0x3ecfbf6a,0x3f7dbe16,0xbf183f4e,0xbe16bf7d,0x3f4e3f18,0xbf733ea1,0x3d97bf7f,0x3f653ee6,0xbf423f27
.long 0x3f62bef1,0x3ef13f62,0xbf623ef1,0xbef1bf62,0xbf4a3f1d,0xbf5fbefc,0x3dfbbf7e,0x3f77be89,0x3f2cbf3e,0x3f80bd49,0x3f3e3f2c,0x3d493f80,0xbf093f58,0xbf513f13,0xbf7a3e60,0xbf7cbe2f
.long 0x3f80,0x3f80,0x3f80,0x3f80,0xbf7c3e2f,0xbf583f09,0xbf133f51,0xbe603f7a,0xbeacbf71,0xbf67bedb,0xbf713eac,0xbedb3f67,0x3f5fbefc,0xbdfbbf7e,0xbf77be89,0xbf1d3f4a
.long 0x3f223f46,0x3f46bf22,0xbf22bf46,0xbf463f22,0xbf273f42,0x3f733ea1,0xbd97bf7f,0xbf653ee6,0xbf5cbf04,0x3e793f78,0x3f04bf5c,0xbf783e79,0x3eb8bf6f,0xbf313f39,0x3f6abecf,0xbf803cc9
.long 0x3f7b3e48,0xbf7bbe48,0x3f7b3e48,0xbf7bbe48,0xbcc93f80,0xbeb8bf6f,0x3f313f39,0xbf6abecf,0xbf7d3e16,0x3f18bf4e,0x3e163f7d,0xbf4ebf18,0xbea1bf73,0x3f7f3d97,0xbee63f65,0xbf27bf42
.long 0x3f62bef1,0x3ef13f62,0xbf623ef1,0xbef1bf62,0x3f1d3f4a,0xbefc3f5f,0xbf7ebdfb,0xbe89bf77,0xbf2c3f3e,0xbf803d49,0xbf3ebf2c,0xbd49bf80,0xbf58bf09,0xbf13bf51,0xbe60bf7a,0x3e2fbf7c
.long 0x3f808000,0x3f808000,0x3f808000,0x3f808000,0x3f7cbe2f,0x3f58bf09,0x3f13bf51,0x3e60bf7a,0x3f71beac,0x3edbbf67,0xbeacbf71,0xbf67bedb,0x3f5fbefc,0xbdfbbf7e,0xbf77be89,0xbf1d3f4a
.long 0x3f46bf22,0xbf22bf46,0xbf463f22,0x3f223f46,0x3f27bf42,0xbf73bea1,0x3d973f7f,0x3f65bee6,0x3f04bf5c,0xbf783e79,0x3f5c3f04,0xbe79bf78,0x3eb8bf6f,0xbf313f39,0x3f6abecf,0xbf803cc9
.long 0x3e48bf7b,0xbe483f7b,0x3e48bf7b,0xbe483f7b,0x3cc9bf80,0x3eb83f6f,0xbf31bf39,0x3f6a3ecf,0xbe16bf7d,0x3f4e3f18,0xbf7d3e16,0x3f18bf4e,0xbea1bf73,0x3f7f3d97,0xbee63f65,0xbf27bf42
.long 0xbef1bf62,0x3f62bef1,0x3ef13f62,0xbf623ef1,0xbf1dbf4a,0x3efcbf5f,0x3f7e3dfb,0x3e893f77,0xbf3ebf2c,0xbd49bf80,0x3f2cbf3e,0x3f80bd49,0xbf58bf09,0xbf13bf51,0xbe60bf7a,0x3e2fbf7c
.long 0x3f808000,0x3f808000,0x3f808000,0x3f808000,0xbe2fbf7c,0xbf09bf58,0xbf51bf13,0xbf7abe60,0xbf713eac,0xbedb3f67,0x3eac3f71,0x3f673edb,0x3efc3f5f,0x3f7ebdfb,0x3e89bf77,0xbf4abf1d
.long 0x3f46bf22,0xbf22bf46,0xbf463f22,0x3f223f46,0xbf42bf27,0xbea13f73,0x3f7fbd97,0xbee6bf65,0xbf043f5c,0x3f78be79,0xbf5cbf04,0x3e793f78,0x3f6f3eb8,0xbf39bf31,0x3ecf3f6a,0xbcc9bf80
.long 0x3e48bf7b,0xbe483f7b,0x3e48bf7b,0xbe483f7b,0xbf80bcc9,0x3f6fbeb8,0xbf393f31,0x3ecfbf6a,0x3e163f7d,0xbf4ebf18,0x3f7dbe16,0xbf183f4e,0x3f73bea1,0xbd973f7f,0xbf65bee6,0x3f42bf27
.long 0xbef1bf62,0x3f62bef1,0x3ef13f62,0xbf623ef1,0xbf4a3f1d,0xbf5fbefc,0x3dfbbf7e,0x3f77be89,0x3f3e3f2c,0x3d493f80,0xbf2c3f3e,0xbf803d49,0x3f09bf58,0x3f51bf13,0x3f7abe60,0x3f7c3e2f
.long 0x3f808000,0x3f808000,0x3f808000,0x3f808000,0xbf7c3e2f,0xbf583f09,0xbf133f51,0xbe603f7a,0x3f71beac,0x3edbbf67,0xbeacbf71,0xbf67bedb,0xbf5f3efc,0x3dfb3f7e,0x3f773e89,0x3f1dbf4a
.long 0x3f46bf22,0xbf22bf46,0xbf463f22,0x3f223f46,0xbf273f42,0x3f733ea1,0xbd97bf7f,0xbf653ee6,0x3f04bf5c,0xbf783e79,0x3f5c3f04,0xbe79bf78,0xbeb83f6f,0x3f31bf39,0xbf6a3ecf,0x3f80bcc9
.long 0x3e48bf7b,0xbe483f7b,0x3e48bf7b,0xbe483f7b,0xbcc93f80,0xbeb8bf6f,0x3f313f39,0xbf6abecf,0xbe16bf7d,0x3f4e3f18,0xbf7d3e16,0x3f18bf4e,0x3ea13f73,0xbf7fbd97,0x3ee6bf65,0x3f273f42
.long 0xbef1bf62,0x3f62bef1,0x3ef13f62,0xbf623ef1,0x3f1d3f4a,0xbefc3f5f,0xbf7ebdfb,0xbe89bf77,0xbf3ebf2c,0xbd49bf80,0x3f2cbf3e,0x3f80bd49,0x3f583f09,0x3f133f51,0x3e603f7a,0xbe2f3f7c
.long 0x3f808000,0x3f808000,0x3f808000,0x3f808000,0x3e2f3f7c,0x3f093f58,0x3f513f13,0x3f7a3e60,0xbf713eac,0xbedb3f67,0x3eac3f71,0x3f673edb,0xbefcbf5f,0xbf7e3dfb,0xbe893f77,0x3f4a3f1d
.long 0x3f46bf22,0xbf22bf46,0xbf463f22,0x3f223f46,0x3f423f27,0x3ea1bf73,0xbf7f3d97,0x3ee63f65,0xbf043f5c,0x3f78be79,0xbf5cbf04,0x3e793f78,0xbf6fbeb8,0x3f393f31,0xbecfbf6a,0x3cc93f80
.long 0x3e48bf7b,0xbe483f7b,0x3e48bf7b,0xbe483f7b,0x3f803cc9,0xbf6f3eb8,0x3f39bf31,0xbecf3f6a,0x3e163f7d,0xbf4ebf18,0x3f7dbe16,0xbf183f4e,0xbf733ea1,0x3d97bf7f,0x3f653ee6,0xbf423f27
.long 0xbef1bf62,0x3f62bef1,0x3ef13f62,0xbf623ef1,0x3f4abf1d,0x3f5f3efc,0xbdfb3f7e,0xbf773e89,0x3f3e3f2c,0x3d493f80,0xbf2c3f3e,0xbf803d49,0xbf093f58,0xbf513f13,0xbf7a3e60,0xbf7cbe2f
.long 0x3f80,0x3f80,0x3f80,0x3f80,0x3e483f7b,0x3f0e3f55,0x3f553f0e,0x3f7b3e48,0x3ec43f6d,0x3f6d3ec4,0x3f6dbec4,0x3ec4bf6d,0x3f0e3f55,0x3f7bbe48,0x3e48bf7b,0xbf55bf0e
.long 0x3f353f35,0x3f35bf35,0xbf35bf35,0xbf353f35,0x3f553f0e,0x3e48bf7b,0xbf7b3e48,0x3f0e3f55,0x3f6d3ec4,0xbec4bf6d,0xbec43f6d,0x3f6dbec4,0x3f7b3e48,0xbf55bf0e,0x3f0e3f55,0xbe48bf7b
.long 0x3f800000,0xbf800000,0x3f800000,0xbf800000,0x3f7bbe48,0xbf553f0e,0x3f0ebf55,0xbe483f7b,0x3f6dbec4,0xbec43f6d,0xbec4bf6d,0x3f6d3ec4,0x3f55bf0e,0x3e483f7b,0xbf7bbe48,0x3f0ebf55
.long 0x3f35bf35,0x3f353f35,0xbf353f35,0xbf35bf35,0x3f0ebf55,0x3f7b3e48,0x3e483f7b,0xbf553f0e,0x3ec4bf6d,0x3f6dbec4,0x3f6d3ec4,0x3ec43f6d,0x3e48bf7b,0x3f0ebf55,0x3f55bf0e,0x3f7bbe48
.long 0x3f80,0x3f80,0x3f80,0x3f80,0x3f7bbe48,0x3f55bf0e,0x3f0ebf55,0x3e48bf7b,0xbec4bf6d,0xbf6dbec4,0xbf6d3ec4,0xbec43f6d,0xbf553f0e,0x3e483f7b,0x3f7b3e48,0x3f0ebf55
.long 0x3f353f35,0x3f35bf35,0xbf35bf35,0xbf353f35,0x3f0ebf55,0xbf7bbe48,0x3e483f7b,0x3f55bf0e,0xbf6dbec4,0x3ec43f6d,0x3ec4bf6d,0xbf6d3ec4,0xbe483f7b,0x3f0ebf55,0xbf553f0e,0x3f7bbe48
.long 0x3f800000,0xbf800000,0x3f800000,0xbf800000,0xbe48bf7b,0x3f0e3f55,0xbf55bf0e,0x3f7b3e48,0xbf6d3ec4,0x3ec4bf6d,0x3ec43f6d,0xbf6dbec4,0x3f0e3f55,0xbf7b3e48,0x3e48bf7b,0x3f553f0e
.long 0x3f35bf35,0x3f353f35,0xbf353f35,0xbf35bf35,0xbf55bf0e,0x3e48bf7b,0x3f7bbe48,0x3f0e3f55,0xbec43f6d,0xbf6d3ec4,0xbf6dbec4,0xbec4bf6d,0x3f7b3e48,0x3f553f0e,0x3f0e3f55,0x3e483f7b
.long 0x3f80,0x3f80,0x3f80,0x3f80,0xbe48bf7b,0xbf0ebf55,0xbf55bf0e,0xbf7bbe48,0x3ec43f6d,0x3f6d3ec4,0x3f6dbec4,0x3ec4bf6d,0xbf0ebf55,0xbf7b3e48,0xbe483f7b,0x3f553f0e
.long 0x3f353f35,0x3f35bf35,0xbf35bf35,0xbf353f35,0xbf55bf0e,0xbe483f7b,0x3f7bbe48,0xbf0ebf55,0x3f6d3ec4,0xbec4bf6d,0xbec43f6d,0x3f6dbec4,0xbf7bbe48,0x3f553f0e,0xbf0ebf55,0x3e483f7b
.long 0x3f800000,0xbf800000,0x3f800000,0xbf800000,0xbf7b3e48,0x3f55bf0e,0xbf0e3f55,0x3e48bf7b,0x3f6dbec4,0xbec43f6d,0xbec4bf6d,0x3f6d3ec4,0xbf553f0e,0xbe48bf7b,0x3f7b3e48,0xbf0e3f55
.long 0x3f35bf35,0x3f353f35,0xbf353f35,0xbf35bf35,0xbf0e3f55,0xbf7bbe48,0xbe48bf7b,0x3f55bf0e,0x3ec4bf6d,0x3f6dbec4,0x3f6d3ec4,0x3ec43f6d,0xbe483f7b,0xbf0e3f55,0xbf553f0e,0xbf7b3e48
.long 0x3f80,0x3f80,0x3f80,0x3f80,0xbf7b3e48,0xbf553f0e,0xbf0e3f55,0xbe483f7b,0xbec4bf6d,0xbf6dbec4,0xbf6d3ec4,0xbec43f6d,0x3f55bf0e,0xbe48bf7b,0xbf7bbe48,0xbf0e3f55
.long 0x3f353f35,0x3f35bf35,0xbf35bf35,0xbf353f35,0xbf0e3f55,0x3f7b3e48,0xbe48bf7b,0xbf553f0e,0xbf6dbec4,0x3ec43f6d,0x3ec4bf6d,0xbf6d3ec4,0x3e48bf7b,0xbf0e3f55,0x3f55bf0e,0xbf7b3e48
.long 0x3f800000,0xbf800000,0x3f800000,0xbf800000,0x3e483f7b,0xbf0ebf55,0x3f553f0e,0xbf7bbe48,0xbf6d3ec4,0x3ec4bf6d,0x3ec43f6d,0xbf6dbec4,0xbf0ebf55,0x3f7bbe48,0xbe483f7b,0xbf55bf0e
.long 0x3f35bf35,0x3f353f35,0xbf353f35,0xbf35bf35,0x3f553f0e,0xbe483f7b,0xbf7b3e48,0xbf0ebf55,0xbec43f6d,0xbf6d3ec4,0xbf6dbec4,0xbec4bf6d,0xbf7bbe48,0xbf55bf0e,0xbf0ebf55,0xbe48bf7b
.long 0x3f808000,0x3f808000,0x3f808000,0x3f808000,0x3f7bbe48,0x3f55bf0e,0x3f0ebf55,0x3e48bf7b,0x3f6dbec4,0x3ec4bf6d,0xbec4bf6d,0xbf6dbec4,0x3f55bf0e,0xbe48bf7b,0xbf7bbe48,0xbf0e3f55
.long 0x3f35bf35,0xbf35bf35,0xbf353f35,0x3f353f35,0x3f0ebf55,0xbf7bbe48,0x3e483f7b,0x3f55bf0e,0x3ec4bf6d,0xbf6d3ec4,0x3f6d3ec4,0xbec4bf6d,0x3e48bf7b,0xbf0e3f55,0x3f55bf0e,0xbf7b3e48
.long 0xbf80,0x3f80,0xbf80,0x3f80,0xbe48bf7b,0x3f0e3f55,0xbf55bf0e,0x3f7b3e48,0xbec4bf6d,0x3f6d3ec4,0xbf6d3ec4,0x3ec4bf6d,0xbf0ebf55,0x3f7bbe48,0xbe483f7b,0xbf55bf0e
.long 0xbf35bf35,0x3f35bf35,0x3f353f35,0xbf353f35,0xbf55bf0e,0x3e48bf7b,0x3f7bbe48,0x3f0e3f55,0xbf6dbec4,0xbec4bf6d,0x3ec4bf6d,0x3f6dbec4,0xbf7bbe48,0xbf55bf0e,0xbf0ebf55,0xbe48bf7b
.long 0x3f808000,0x3f808000,0x3f808000,0x3f808000,0xbe48bf7b,0xbf0ebf55,0xbf55bf0e,0xbf7bbe48,0xbf6d3ec4,0xbec43f6d,0x3ec43f6d,0x3f6d3ec4,0x3f0e3f55,0x3f7bbe48,0x3e48bf7b,0xbf55bf0e
.long 0x3f35bf35,0xbf35bf35,0xbf353f35,0x3f353f35,0xbf55bf0e,0xbe483f7b,0x3f7bbe48,0xbf0ebf55,0xbec43f6d,0x3f6dbec4,0xbf6dbec4,0x3ec43f6d,0x3f7b3e48,0xbf55bf0e,0x3f0e3f55,0xbe48bf7b
.long 0xbf80,0x3f80,0xbf80,0x3f80,0xbf7b3e48,0x3f55bf0e,0xbf0e3f55,0x3e48bf7b,0x3ec43f6d,0xbf6dbec4,0x3f6dbec4,0xbec43f6d,0x3f55bf0e,0x3e483f7b,0xbf7bbe48,0x3f0ebf55
.long 0xbf35bf35,0x3f35bf35,0x3f353f35,0xbf353f35,0xbf0e3f55,0xbf7bbe48,0xbe48bf7b,0x3f55bf0e,0x3f6d3ec4,0x3ec43f6d,0xbec43f6d,0xbf6d3ec4,0x3e48bf7b,0x3f0ebf55,0x3f55bf0e,0x3f7bbe48
.long 0x3f808000,0x3f808000,0x3f808000,0x3f808000,0xbf7b3e48,0xbf553f0e,0xbf0e3f55,0xbe483f7b,0x3f6dbec4,0x3ec4bf6d,0xbec4bf6d,0xbf6dbec4,0xbf553f0e,0x3e483f7b,0x3f7b3e48,0x3f0ebf55
.long 0x3f35bf35,0xbf35bf35,0xbf353f35,0x3f353f35,0xbf0e3f55,0x3f7b3e48,0xbe48bf7b,0xbf553f0e,0x3ec4bf6d,0xbf6d3ec4,0x3f6d3ec4,0xbec4bf6d,0xbe483f7b,0x3f0ebf55,0xbf553f0e,0x3f7bbe48
.long 0xbf80,0x3f80,0xbf80,0x3f80,0x3e483f7b,0xbf0ebf55,0x3f553f0e,0xbf7bbe48,0xbec4bf6d,0x3f6d3ec4,0xbf6d3ec4,0x3ec4bf6d,0x3f0e3f55,0xbf7b3e48,0x3e48bf7b,0x3f553f0e
.long 0xbf35bf35,0x3f35bf35,0x3f353f35,0xbf353f35,0x3f553f0e,0xbe483f7b,0xbf7b3e48,0xbf0ebf55,0xbf6dbec4,0xbec4bf6d,0x3ec4bf6d,0x3f6dbec4,0x3f7b3e48,0x3f553f0e,0x3f0e3f55,0x3e483f7b
.long 0x3f808000,0x3f808000,0x3f808000,0x3f808000,0x3e483f7b,0x3f0e3f55,0x3f553f0e,0x3f7b3e48,0xbf6d3ec4,0xbec43f6d,0x3ec43f6d,0x3f6d3ec4,0xbf0ebf55,0xbf7b3e48,0xbe483f7b,0x3f553f0e
.long 0x3f35bf35,0xbf35bf35,0xbf353f35,0x3f353f35,0x3f553f0e,0x3e48bf7b,0xbf7b3e48,0x3f0e3f55,0xbec43f6d,0x3f6dbec4,0xbf6dbec4,0x3ec43f6d,0xbf7bbe48,0x3f553f0e,0xbf0ebf55,0x3e483f7b
.long 0xbf80,0x3f80,0xbf80,0x3f80,0x3f7bbe48,0xbf553f0e,0x3f0ebf55,0xbe483f7b,0x3ec43f6d,0xbf6dbec4,0x3f6dbec4,0xbec43f6d,0xbf553f0e,0xbe48bf7b,0x3f7b3e48,0xbf0e3f55
.long 0xbf35bf35,0x3f35bf35,0x3f353f35,0xbf353f35,0x3f0ebf55,0x3f7b3e48,0x3e483f7b,0xbf553f0e,0x3f6d3ec4,0x3ec43f6d,0xbec43f6d,0xbf6d3ec4,0xbe483f7b,0xbf0e3f55,0xbf553f0e,0xbf7b3e48
.long 0x3f80,0x3f80,0x3f80,0x3f80,0x3e603f7a,0x3f133f51,0x3f583f09,0x3f7c3e2f,0x3edb3f67,0x3f713eac,0x3f67bedb,0x3eacbf71,0x3f1d3f4a,0x3f77be89,0x3dfbbf7e,0xbf5fbefc
.long 0x3f463f22,0x3f22bf46,0xbf46bf22,0xbf223f46,0x3f653ee6,0x3d97bf7f,0xbf733ea1,0x3f273f42,0x3f783e79,0xbf04bf5c,0xbe793f78,0x3f5cbf04,0x3f803cc9,0xbf6abecf,0x3f313f39,0xbeb8bf6f
.long 0x3f7bbe48,0xbf7b3e48,0x3f7bbe48,0xbf7b3e48,0x3f6abecf,0xbf313f39,0x3eb8bf6f,0x3cc93f80,0x3f4ebf18,0xbe163f7d,0xbf18bf4e,0x3f7d3e16,0x3f27bf42,0x3ee63f65,0xbf7f3d97,0x3ea1bf73
.long 0x3ef1bf62,0x3f623ef1,0xbef13f62,0xbf62bef1,0x3e89bf77,0x3f7ebdfb,0x3efc3f5f,0xbf1d3f4a,0x3d49bf80,0x3f3ebf2c,0x3f803d49,0x3f2c3f3e,0xbe2fbf7c,0x3e60bf7a,0x3f13bf51,0x3f58bf09
.long 0x3f80,0x3f80,0x3f80,0x3f80,0x3f7abe60,0x3f51bf13,0x3f09bf58,0x3e2fbf7c,0xbedbbf67,0xbf71beac,0xbf673edb,0xbeac3f71,0xbf4a3f1d,0x3e893f77,0x3f7e3dfb,0x3efcbf5f
.long 0x3f463f22,0x3f22bf46,0xbf46bf22,0xbf223f46,0x3ee6bf65,0xbf7fbd97,0x3ea13f73,0x3f42bf27,0xbf78be79,0x3f043f5c,0x3e79bf78,0xbf5c3f04,0xbcc93f80,0x3ecfbf6a,0xbf393f31,0x3f6fbeb8
.long 0x3f7bbe48,0xbf7b3e48,0x3f7bbe48,0xbf7b3e48,0xbecfbf6a,0x3f393f31,0xbf6fbeb8,0x3f80bcc9,0xbf4e3f18,0x3e16bf7d,0x3f183f4e,0xbf7dbe16,0x3f423f27,0xbf653ee6,0xbd97bf7f,0x3f733ea1
.long 0x3ef1bf62,0x3f623ef1,0xbef13f62,0xbf62bef1,0xbf77be89,0xbdfbbf7e,0x3f5fbefc,0x3f4a3f1d,0xbd493f80,0xbf3e3f2c,0xbf80bd49,0xbf2cbf3e,0x3f7cbe2f,0x3f7a3e60,0x3f513f13,0x3f093f58
.long 0x3f80,0x3f80,0x3f80,0x3f80,0xbe60bf7a,0xbf13bf51,0xbf58bf09,0xbf7cbe2f,0x3edb3f67,0x3f713eac,0x3f67bedb,0x3eacbf71,0xbf1dbf4a,0xbf773e89,0xbdfb3f7e,0x3f5f3efc
.long 0x3f463f22,0x3f22bf46,0xbf46bf22,0xbf223f46,0xbf65bee6,0xbd973f7f,0x3f73bea1,0xbf27bf42,0x3f783e79,0xbf04bf5c,0xbe793f78,0x3f5cbf04,0xbf80bcc9,0x3f6a3ecf,0xbf31bf39,0x3eb83f6f
.long 0x3f7bbe48,0xbf7b3e48,0x3f7bbe48,0xbf7b3e48,0xbf6a3ecf,0x3f31bf39,0xbeb83f6f,0xbcc9bf80,0x3f4ebf18,0xbe163f7d,0xbf18bf4e,0x3f7d3e16,0xbf273f42,0xbee6bf65,0x3f7fbd97,0xbea13f73
.long 0x3ef1bf62,0x3f623ef1,0xbef13f62,0xbf62bef1,0xbe893f77,0xbf7e3dfb,0xbefcbf5f,0x3f1dbf4a,0x3d49bf80,0x3f3ebf2c,0x3f803d49,0x3f2c3f3e,0x3e2f3f7c,0xbe603f7a,0xbf133f51,0xbf583f09
.long 0x3f80,0x3f80,0x3f80,0x3f80,0xbf7a3e60,0xbf513f13,0xbf093f58,0xbe2f3f7c,0xbedbbf67,0xbf71beac,0xbf673edb,0xbeac3f71,0x3f4abf1d,0xbe89bf77,0xbf7ebdfb,0xbefc3f5f
.long 0x3f463f22,0x3f22bf46,0xbf46bf22,0xbf223f46,0xbee63f65,0x3f7f3d97,0xbea1bf73,0xbf423f27,0xbf78be79,0x3f043f5c,0x3e79bf78,0xbf5c3f04,0x3cc9bf80,0xbecf3f6a,0x3f39bf31,0xbf6f3eb8
.long 0x3f7bbe48,0xbf7b3e48,0x3f7bbe48,0xbf7b3e48,0x3ecf3f6a,0xbf39bf31,0x3f6f3eb8,0xbf803cc9,0xbf4e3f18,0x3e16bf7d,0x3f183f4e,0xbf7dbe16,0xbf42bf27,0x3f65bee6,0x3d973f7f,0xbf73bea1
.long 0x3ef1bf62,0x3f623ef1,0xbef13f62,0xbf62bef1,0x3f773e89,0x3dfb3f7e,0xbf5f3efc,0xbf4abf1d,0xbd493f80,0xbf3e3f2c,0xbf80bd49,0xbf2cbf3e,0xbf7c3e2f,0xbf7abe60,0xbf51bf13,0xbf09bf58
.long 0x3f808000,0x3f808000,0x3f808000,0x3f808000,0x3f7abe60,0x3f51bf13,0x3f09bf58,0x3e2fbf7c,0x3f67bedb,0x3eacbf71,0xbedbbf67,0xbf71beac,0x3f4abf1d,0xbe89bf77,0xbf7ebdfb,0xbefc3f5f
.long 0x3f22bf46,0xbf46bf22,0xbf223f46,0x3f463f22,0x3ee6bf65,0xbf7fbd97,0x3ea13f73,0x3f42bf27,0x3e79bf78,0xbf5c3f04,0x3f783e79,0xbf04bf5c,0x3cc9bf80,0xbecf3f6a,0x3f39bf31,0xbf6f3eb8
.long 0xbe48bf7b,0x3e483f7b,0xbe48bf7b,0x3e483f7b,0xbecfbf6a,0x3f393f31,0xbf6fbeb8,0x3f80bcc9,0xbf18bf4e,0x3f7d3e16,0xbf4e3f18,0x3e16bf7d,0xbf42bf27,0x3f65bee6,0x3d973f7f,0xbf73bea1
.long 0xbf62bef1,0x3ef1bf62,0x3f623ef1,0xbef13f62,0xbf77be89,0xbdfbbf7e,0x3f5fbefc,0x3f4a3f1d,0xbf80bd49,0xbf2cbf3e,0x3d49bf80,0x3f3ebf2c,0xbf7c3e2f,0xbf7abe60,0xbf51bf13,0xbf09bf58
.long 0x3f808000,0x3f808000,0x3f808000,0x3f808000,0xbe60bf7a,0xbf13bf51,0xbf58bf09,0xbf7cbe2f,0xbf673edb,0xbeac3f71,0x3edb3f67,0x3f713eac,0x3f1d3f4a,0x3f77be89,0x3dfbbf7e,0xbf5fbefc
.long 0x3f22bf46,0xbf46bf22,0xbf223f46,0x3f463f22,0xbf65bee6,0xbd973f7f,0x3f73bea1,0xbf27bf42,0xbe793f78,0x3f5cbf04,0xbf78be79,0x3f043f5c,0x3f803cc9,0xbf6abecf,0x3f313f39,0xbeb8bf6f
.long 0xbe48bf7b,0x3e483f7b,0xbe48bf7b,0x3e483f7b,0xbf6a3ecf,0x3f31bf39,0xbeb83f6f,0xbcc9bf80,0x3f183f4e,0xbf7dbe16,0x3f4ebf18,0xbe163f7d,0x3f27bf42,0x3ee63f65,0xbf7f3d97,0x3ea1bf73
.long 0xbf62bef1,0x3ef1bf62,0x3f623ef1,0xbef13f62,0xbe893f77,0xbf7e3dfb,0xbefcbf5f,0x3f1dbf4a,0x3f803d49,0x3f2c3f3e,0xbd493f80,0xbf3e3f2c,0xbe2fbf7c,0x3e60bf7a,0x3f13bf51,0x3f58bf09
.long 0x3f808000,0x3f808000,0x3f808000,0x3f808000,0xbf7a3e60,0xbf513f13,0xbf093f58,0xbe2f3f7c,0x3f67bedb,0x3eacbf71,0xbedbbf67,0xbf71beac,0xbf4a3f1d,0x3e893f77,0x3f7e3dfb,0x3efcbf5f
.long 0x3f22bf46,0xbf46bf22,0xbf223f46,0x3f463f22,0xbee63f65,0x3f7f3d97,0xbea1bf73,0xbf423f27,0x3e79bf78,0xbf5c3f04,0x3f783e79,0xbf04bf5c,0xbcc93f80,0x3ecfbf6a,0xbf393f31,0x3f6fbeb8
.long 0xbe48bf7b,0x3e483f7b,0xbe48bf7b,0x3e483f7b,0x3ecf3f6a,0xbf39bf31,0x3f6f3eb8,0xbf803cc9,0xbf18bf4e,0x3f7d3e16,0xbf4e3f18,0x3e16bf7d,0x3f423f27,0xbf653ee6,0xbd97bf7f,0x3f733ea1
.long 0xbf62bef1,0x3ef1bf62,0x3f623ef1,0xbef13f62,0x3f773e89,0x3dfb3f7e,0xbf5f3efc,0xbf4abf1d,0xbf80bd49,0xbf2cbf3e,0x3d49bf80,0x3f3ebf2c,0x3f7cbe2f,0x3f7a3e60,0x3f513f13,0x3f093f58
.long 0x3f808000,0x3f808000,0x3f808000,0x3f808000,0x3e603f7a,0x3f133f51,0x3f583f09,0x3f7c3e2f,0xbf673edb,0xbeac3f71,0x3edb3f67,0x3f713eac,0xbf1dbf4a,0xbf773e89,0xbdfb3f7e,0x3f5f3efc
.long 0x3f22bf46,0xbf46bf22,0xbf223f46,0x3f463f22,0x3f653ee6,0x3d97bf7f,0xbf733ea1,0x3f273f42,0xbe793f78,0x3f5cbf04,0xbf78be79,0x3f043f5c,0xbf80bcc9,0x3f6a3ecf,0xbf31bf39,0x3eb83f6f
.long 0xbe48bf7b,0x3e483f7b,0xbe48bf7b,0x3e483f7b,0x3f6abecf,0xbf313f39,0x3eb8bf6f,0x3cc93f80,0x3f183f4e,0xbf7dbe16,0x3f4ebf18,0xbe163f7d,0xbf273f42,0xbee6bf65,0x3f7fbd97,0xbea13f73
.long 0xbf62bef1,0x3ef1bf62,0x3f623ef1,0xbef13f62,0x3e89bf77,0x3f7ebdfb,0x3efc3f5f,0xbf1d3f4a,0x3f803d49,0x3f2c3f3e,0xbd493f80,0xbf3e3f2c,0x3e2f3f7c,0xbe603f7a,0xbf133f51,0xbf583f09
.long 0x3f80,0x3f80,0x3f80,0x3f80,0x3e793f78,0x3f183f4e,0x3f5c3f04,0x3f7d3e16,0x3ef13f62,0x3f753e95,0x3f62bef1,0x3e95bf75,0x3f2c3f3e,0x3f71beac,0x3d49bf80,0xbf67bedb
.long 0x3f553f0e,0x3f0ebf55,0xbf55bf0e,0xbf0e3f55,0x3f713eac,0xbd49bf80,0xbf673edb,0x3f3e3f2c,0x3f7f3dc9,0xbf22bf46,0xbdc93f7f,0x3f46bf22,0x3f7dbe16,0xbf78be79,0x3f4e3f18,0xbf04bf5c
.long 0x3f6dbec4,0xbf6d3ec4,0x3f6dbec4,0xbf6d3ec4,0x3f4ebf18,0xbf043f5c,0x3e16bf7d,0x3e793f78,0x3f22bf46,0x3dc93f7f,0xbf46bf22,0x3f7fbdc9,0x3edbbf67,0x3f2c3f3e,0xbf713eac,0x3d49bf80
.long 0x3e48bf7b,0x3f7b3e48,0xbe483f7b,0xbf7bbe48,0xbd49bf80,0x3f67bedb,0x3f3e3f2c,0xbeac3f71,0xbe95bf75,0x3ef1bf62,0x3f75be95,0x3f623ef1,0xbf04bf5c,0xbe16bf7d,0x3e79bf78,0x3f18bf4e
.long 0x3f80,0x3f80,0x3f80,0x3f80,0x3f78be79,0x3f4ebf18,0x3f04bf5c,0x3e16bf7d,0xbef1bf62,0xbf75be95,0xbf623ef1,0xbe953f75,0xbf3e3f2c,0x3eac3f71,0x3f803d49,0x3edbbf67
.long 0x3f553f0e,0x3f0ebf55,0xbf55bf0e,0xbf0e3f55,0x3eacbf71,0xbf803d49,0x3edb3f67,0x3f2cbf3e,0xbf7fbdc9,0x3f223f46,0x3dc9bf7f,0xbf463f22,0x3e163f7d,0x3e79bf78,0xbf183f4e,0x3f5cbf04
.long 0x3f6dbec4,0xbf6d3ec4,0x3f6dbec4,0xbf6d3ec4,0xbf18bf4e,0x3f5c3f04,0xbf7dbe16,0x3f78be79,0xbf223f46,0xbdc9bf7f,0x3f463f22,0xbf7f3dc9,0x3f673edb,0xbf3e3f2c,0xbeacbf71,0x3f803d49
.long 0x3e48bf7b,0x3f7b3e48,0xbe483f7b,0xbf7bbe48,0xbf803d49,0xbedbbf67,0x3f2cbf3e,0x3f713eac,0x3e953f75,0xbef13f62,0xbf753e95,0xbf62bef1,0x3f5cbf04,0x3f7dbe16,0x3f783e79,0x3f4e3f18
.long 0x3f80,0x3f80,0x3f80,0x3f80,0xbe79bf78,0xbf18bf4e,0xbf5cbf04,0xbf7dbe16,0x3ef13f62,0x3f753e95,0x3f62bef1,0x3e95bf75,0xbf2cbf3e,0xbf713eac,0xbd493f80,0x3f673edb
.long 0x3f553f0e,0x3f0ebf55,0xbf55bf0e,0xbf0e3f55,0xbf71beac,0x3d493f80,0x3f67bedb,0xbf3ebf2c,0x3f7f3dc9,0xbf22bf46,0xbdc93f7f,0x3f46bf22,0xbf7d3e16,0x3f783e79,0xbf4ebf18,0x3f043f5c
.long 0x3f6dbec4,0xbf6d3ec4,0x3f6dbec4,0xbf6d3ec4,0xbf4e3f18,0x3f04bf5c,0xbe163f7d,0xbe79bf78,0x3f22bf46,0x3dc93f7f,0xbf46bf22,0x3f7fbdc9,0xbedb3f67,0xbf2cbf3e,0x3f71beac,0xbd493f80
.long 0x3e48bf7b,0x3f7b3e48,0xbe483f7b,0xbf7bbe48,0x3d493f80,0xbf673edb,0xbf3ebf2c,0x3eacbf71,0xbe95bf75,0x3ef1bf62,0x3f75be95,0x3f623ef1,0x3f043f5c,0x3e163f7d,0xbe793f78,0xbf183f4e
.long 0x3f80,0x3f80,0x3f80,0x3f80,0xbf783e79,0xbf4e3f18,0xbf043f5c,0xbe163f7d,0xbef1bf62,0xbf75be95,0xbf623ef1,0xbe953f75,0x3f3ebf2c,0xbeacbf71,0xbf80bd49,0xbedb3f67
.long 0x3f553f0e,0x3f0ebf55,0xbf55bf0e,0xbf0e3f55,0xbeac3f71,0x3f80bd49,0xbedbbf67,0xbf2c3f3e,0xbf7fbdc9,0x3f223f46,0x3dc9bf7f,0xbf463f22,0xbe16bf7d,0xbe793f78,0x3f18bf4e,0xbf5c3f04
.long 0x3f6dbec4,0xbf6d3ec4,0x3f6dbec4,0xbf6d3ec4,0x3f183f4e,0xbf5cbf04,0x3f7d3e16,0xbf783e79,0xbf223f46,0xbdc9bf7f,0x3f463f22,0xbf7f3dc9,0xbf67bedb,0x3f3ebf2c,0x3eac3f71,0xbf80bd49
.long 0x3e48bf7b,0x3f7b3e48,0xbe483f7b,0xbf7bbe48,0x3f80bd49,0x3edb3f67,0xbf2c3f3e,0xbf71beac,0x3e953f75,0xbef13f62,0xbf753e95,0xbf62bef1,0xbf5c3f04,0xbf7d3e16,0xbf78be79,0xbf4ebf18
.long 0x3f808000,0x3f808000,0x3f808000,0x3f808000,0x3f78be79,0x3f4ebf18,0x3f04bf5c,0x3e16bf7d,0x3f62bef1,0x3e95bf75,0xbef1bf62,0xbf75be95,0x3f3ebf2c,0xbeacbf71,0xbf80bd49,0xbedb3f67
.long 0x3f0ebf55,0xbf55bf0e,0xbf0e3f55,0x3f553f0e,0x3eacbf71,0xbf803d49,0x3edb3f67,0x3f2cbf3e,0x3dc9bf7f,0xbf463f22,0x3f7f3dc9,0xbf22bf46,0xbe16bf7d,0xbe793f78,0x3f18bf4e,0xbf5c3f04
.long 0xbec4bf6d,0x3ec43f6d,0xbec4bf6d,0x3ec43f6d,0xbf18bf4e,0x3f5c3f04,0xbf7dbe16,0x3f78be79,0xbf46bf22,0x3f7fbdc9,0xbf223f46,0xbdc9bf7f,0xbf67bedb,0x3f3ebf2c,0x3eac3f71,0xbf80bd49
.long 0xbf7bbe48,0x3e48bf7b,0x3f7b3e48,0xbe483f7b,0xbf803d49,0xbedbbf67,0x3f2cbf3e,0x3f713eac,0xbf753e95,0xbf62bef1,0xbe95bf75,0x3ef1bf62,0xbf5c3f04,0xbf7d3e16,0xbf78be79,0xbf4ebf18
.long 0x3f808000,0x3f808000,0x3f808000,0x3f808000,0xbe79bf78,0xbf18bf4e,0xbf5cbf04,0xbf7dbe16,0xbf623ef1,0xbe953f75,0x3ef13f62,0x3f753e95,0x3f2c3f3e,0x3f71beac,0x3d49bf80,0xbf67bedb
.long 0x3f0ebf55,0xbf55bf0e,0xbf0e3f55,0x3f553f0e,0xbf71beac,0x3d493f80,0x3f67bedb,0xbf3ebf2c,0xbdc93f7f,0x3f46bf22,0xbf7fbdc9,0x3f223f46,0x3f7dbe16,0xbf78be79,0x3f4e3f18,0xbf04bf5c
.long 0xbec4bf6d,0x3ec43f6d,0xbec4bf6d,0x3ec43f6d,0xbf4e3f18,0x3f04bf5c,0xbe163f7d,0xbe79bf78,0x3f463f22,0xbf7f3dc9,0x3f22bf46,0x3dc93f7f,0x3edbbf67,0x3f2c3f3e,0xbf713eac,0x3d49bf80
.long 0xbf7bbe48,0x3e48bf7b,0x3f7b3e48,0xbe483f7b,0x3d493f80,0xbf673edb,0xbf3ebf2c,0x3eacbf71,0x3f75be95,0x3f623ef1,0x3e953f75,0xbef13f62,0xbf04bf5c,0xbe16bf7d,0x3e79bf78,0x3f18bf4e
.long 0x3f808000,0x3f808000,0x3f808000,0x3f808000,0xbf783e79,0xbf4e3f18,0xbf043f5c,0xbe163f7d,0x3f62bef1,0x3e95bf75,0xbef1bf62,0xbf75be95,0xbf3e3f2c,0x3eac3f71,0x3f803d49,0x3edbbf67
.long 0x3f0ebf55,0xbf55bf0e,0xbf0e3f55,0x3f553f0e,0xbeac3f71,0x3f80bd49,0xbedbbf67,0xbf2c3f3e,0x3dc9bf7f,0xbf463f22,0x3f7f3dc9,0xbf22bf46,0x3e163f7d,0x3e79bf78,0xbf183f4e,0x3f5cbf04
.long 0xbec4bf6d,0x3ec43f6d,0xbec4bf6d,0x3ec43f6d,0x3f183f4e,0xbf5cbf04,0x3f7d3e16,0xbf783e79,0xbf46bf22,0x3f7fbdc9,0xbf223f46,0xbdc9bf7f,0x3f673edb,0xbf3e3f2c,0xbeacbf71,0x3f803d49
.long 0xbf7bbe48,0x3e48bf7b,0x3f7b3e48,0xbe483f7b,0x3f80bd49,0x3edb3f67,0xbf2c3f3e,0xbf71beac,0xbf753e95,0xbf62bef1,0xbe95bf75,0x3ef1bf62,0x3f5cbf04,0x3f7dbe16,0x3f783e79,0x3f4e3f18
.long 0x3f808000,0x3f808000,0x3f808000,0x3f808000,0x3e793f78,0x3f183f4e,0x3f5c3f04,0x3f7d3e16,0xbf623ef1,0xbe953f75,0x3ef13f62,0x3f753e95,0xbf2cbf3e,0xbf713eac,0xbd493f80,0x3f673edb
.long 0x3f0ebf55,0xbf55bf0e,0xbf0e3f55,0x3f553f0e,0x3f713eac,0xbd49bf80,0xbf673edb,0x3f3e3f2c,0xbdc93f7f,0x3f46bf22,0xbf7fbdc9,0x3f223f46,0xbf7d3e16,0x3f783e79,0xbf4ebf18,0x3f043f5c
.long 0xbec4bf6d,0x3ec43f6d,0xbec4bf6d,0x3ec43f6d,0x3f4ebf18,0xbf043f5c,0x3e16bf7d,0x3e793f78,0x3f463f22,0xbf7f3dc9,0x3f22bf46,0x3dc93f7f,0xbedb3f67,0xbf2cbf3e,0x3f71beac,0xbd493f80
.long 0xbf7bbe48,0x3e48bf7b,0x3f7b3e48,0xbe483f7b,0xbd49bf80,0x3f67bedb,0x3f3e3f2c,0xbeac3f71,0x3f75be95,0x3f623ef1,0x3e953f75,0xbef13f62,0x3f043f5c,0x3e163f7d,0xbe793f78,0xbf183f4e
.long 0x3f80,0x3f80,0x3f80,0x3f80,0x3e893f77,0x3f1d3f4a,0x3f5f3efc,0x3f7e3dfb,0x3f043f5c,0x3f783e79,0x3f5cbf04,0x3e79bf78,0x3f393f31,0x3f6abecf,0xbcc9bf80,0xbf6fbeb8
.long 0x3f623ef1,0x3ef1bf62,0xbf62bef1,0xbef13f62,0x3f7a3e60,0xbe2fbf7c,0xbf583f09,0x3f513f13,0x3f80bd49,0xbf3ebf2c,0x3d493f80,0x3f2cbf3e,0x3f73bea1,0xbf7fbd97,0x3f653ee6,0xbf27bf42
.long 0x3f55bf0e,0xbf553f0e,0x3f55bf0e,0xbf553f0e,0x3f27bf42,0xbea13f73,0xbd97bf7f,0x3ee63f65,0x3edbbf67,0x3eac3f71,0xbf67bedb,0x3f71beac,0x3e2fbf7c,0x3f583f09,0xbf513f13,0xbe60bf7a
.long 0xbdc9bf7f,0x3f7fbdc9,0x3dc93f7f,0xbf7f3dc9,0xbeb8bf6f,0x3f39bf31,0x3f6a3ecf,0xbcc93f80,0xbf18bf4e,0x3e16bf7d,0x3f4ebf18,0x3f7d3e16,0xbf4abf1d,0xbefcbf5f,0xbdfbbf7e,0x3e89bf77
.long 0x3f80,0x3f80,0x3f80,0x3f80,0x3f77be89,0x3f4abf1d,0x3efcbf5f,0x3dfbbf7e,0xbf04bf5c,0xbf78be79,0xbf5c3f04,0xbe793f78,0xbf313f39,0x3ecf3f6a,0x3f80bcc9,0x3eb8bf6f
.long 0x3f623ef1,0x3ef1bf62,0xbf62bef1,0xbef13f62,0x3e60bf7a,0xbf7c3e2f,0x3f093f58,0x3f13bf51,0xbf803d49,0x3f3e3f2c,0xbd49bf80,0xbf2c3f3e,0x3ea13f73,0x3d97bf7f,0xbee63f65,0x3f42bf27
.long 0x3f55bf0e,0xbf553f0e,0x3f55bf0e,0xbf553f0e,0xbf42bf27,0x3f733ea1,0xbf7f3d97,0x3f65bee6,0xbedb3f67,0xbeacbf71,0x3f673edb,0xbf713eac,0x3f7c3e2f,0xbf093f58,0xbf13bf51,0x3f7abe60
.long 0xbdc9bf7f,0x3f7fbdc9,0x3dc93f7f,0xbf7f3dc9,0xbf6f3eb8,0xbf31bf39,0x3ecfbf6a,0x3f803cc9,0x3f183f4e,0xbe163f7d,0xbf4e3f18,0xbf7dbe16,0x3f1dbf4a,0x3f5fbefc,0x3f7ebdfb,0x3f773e89
.long 0x3f80,0x3f80,0x3f80,0x3f80,0xbe89bf77,0xbf1dbf4a,0xbf5fbefc,0xbf7ebdfb,0x3f043f5c,0x3f783e79,0x3f5cbf04,0x3e79bf78,0xbf39bf31,0xbf6a3ecf,0x3cc93f80,0x3f6f3eb8
.long 0x3f623ef1,0x3ef1bf62,0xbf62bef1,0xbef13f62,0xbf7abe60,0x3e2f3f7c,0x3f58bf09,0xbf51bf13,0x3f80bd49,0xbf3ebf2c,0x3d493f80,0x3f2cbf3e,0xbf733ea1,0x3f7f3d97,0xbf65bee6,0x3f273f42
.long 0x3f55bf0e,0xbf553f0e,0x3f55bf0e,0xbf553f0e,0xbf273f42,0x3ea1bf73,0x3d973f7f,0xbee6bf65,0x3edbbf67,0x3eac3f71,0xbf67bedb,0x3f71beac,0xbe2f3f7c,0xbf58bf09,0x3f51bf13,0x3e603f7a
.long 0xbdc9bf7f,0x3f7fbdc9,0x3dc93f7f,0xbf7f3dc9,0x3eb83f6f,0xbf393f31,0xbf6abecf,0x3cc9bf80,0xbf18bf4e,0x3e16bf7d,0x3f4ebf18,0x3f7d3e16,0x3f4a3f1d,0x3efc3f5f,0x3dfb3f7e,0xbe893f77
.long 0x3f80,0x3f80,0x3f80,0x3f80,0xbf773e89,0xbf4a3f1d,0xbefc3f5f,0xbdfb3f7e,0xbf04bf5c,0xbf78be79,0xbf5c3f04,0xbe793f78,0x3f31bf39,0xbecfbf6a,0xbf803cc9,0xbeb83f6f
.long 0x3f623ef1,0x3ef1bf62,0xbf62bef1,0xbef13f62,0xbe603f7a,0x3f7cbe2f,0xbf09bf58,0xbf133f51,0xbf803d49,0x3f3e3f2c,0xbd49bf80,0xbf2c3f3e,0xbea1bf73,0xbd973f7f,0x3ee6bf65,0xbf423f27
.long 0x3f55bf0e,0xbf553f0e,0x3f55bf0e,0xbf553f0e,0x3f423f27,0xbf73bea1,0x3f7fbd97,0xbf653ee6,0xbedb3f67,0xbeacbf71,0x3f673edb,0xbf713eac,0xbf7cbe2f,0x3f09bf58,0x3f133f51,0xbf7a3e60
.long 0xbdc9bf7f,0x3f7fbdc9,0x3dc93f7f,0xbf7f3dc9,0x3f6fbeb8,0x3f313f39,0xbecf3f6a,0xbf80bcc9,0x3f183f4e,0xbe163f7d,0xbf4e3f18,0xbf7dbe16,0xbf1d3f4a,0xbf5f3efc,0xbf7e3dfb,0xbf77be89
.long 0x3f808000,0x3f808000,0x3f808000,0x3f808000,0x3f77be89,0x3f4abf1d,0x3efcbf5f,0x3dfbbf7e,0x3f5cbf04,0x3e79bf78,0xbf04bf5c,0xbf78be79,0x3f31bf39,0xbecfbf6a,0xbf803cc9,0xbeb83f6f
.long 0x3ef1bf62,0xbf62bef1,0xbef13f62,0x3f623ef1,0x3e60bf7a,0xbf7c3e2f,0x3f093f58,0x3f13bf51,0xbd49bf80,0xbf2c3f3e,0x3f80bd49,0xbf3ebf2c,0xbea1bf73,0xbd973f7f,0x3ee6bf65,0xbf423f27
.long 0xbf0ebf55,0x3f0e3f55,0xbf0ebf55,0x3f0e3f55,0xbf42bf27,0x3f733ea1,0xbf7f3d97,0x3f65bee6,0xbf67bedb,0x3f71beac,0xbedb3f67,0xbeacbf71,0xbf7cbe2f,0x3f09bf58,0x3f133f51,0xbf7a3e60
.long 0xbf7f3dc9,0xbdc9bf7f,0x3f7fbdc9,0x3dc93f7f,0xbf6f3eb8,0xbf31bf39,0x3ecfbf6a,0x3f803cc9,0xbf4e3f18,0xbf7dbe16,0xbf18bf4e,0x3e16bf7d,0xbf1d3f4a,0xbf5f3efc,0xbf7e3dfb,0xbf77be89
.long 0x3f808000,0x3f808000,0x3f808000,0x3f808000,0xbe89bf77,0xbf1dbf4a,0xbf5fbefc,0xbf7ebdfb,0xbf5c3f04,0xbe793f78,0x3f043f5c,0x3f783e79,0x3f393f31,0x3f6abecf,0xbcc9bf80,0xbf6fbeb8
.long 0x3ef1bf62,0xbf62bef1,0xbef13f62,0x3f623ef1,0xbf7abe60,0x3e2f3f7c,0x3f58bf09,0xbf51bf13,0x3d493f80,0x3f2cbf3e,0xbf803d49,0x3f3e3f2c,0x3f73bea1,0xbf7fbd97,0x3f653ee6,0xbf27bf42
.long 0xbf0ebf55,0x3f0e3f55,0xbf0ebf55,0x3f0e3f55,0xbf273f42,0x3ea1bf73,0x3d973f7f,0xbee6bf65,0x3f673edb,0xbf713eac,0x3edbbf67,0x3eac3f71,0x3e2fbf7c,0x3f583f09,0xbf513f13,0xbe60bf7a
.long 0xbf7f3dc9,0xbdc9bf7f,0x3f7fbdc9,0x3dc93f7f,0x3eb83f6f,0xbf393f31,0xbf6abecf,0x3cc9bf80,0x3f4ebf18,0x3f7d3e16,0x3f183f4e,0xbe163f7d,0xbf4abf1d,0xbefcbf5f,0xbdfbbf7e,0x3e89bf77
.long 0x3f808000,0x3f808000,0x3f808000,0x3f808000,0xbf773e89,0xbf4a3f1d,0xbefc3f5f,0xbdfb3f7e,0x3f5cbf04,0x3e79bf78,0xbf04bf5c,0xbf78be79,0xbf313f39,0x3ecf3f6a,0x3f80bcc9,0x3eb8bf6f
.long 0x3ef1bf62,0xbf62bef1,0xbef13f62,0x3f623ef1,0xbe603f7a,0x3f7cbe2f,0xbf09bf58,0xbf133f51,0xbd49bf80,0xbf2c3f3e,0x3f80bd49,0xbf3ebf2c,0x3ea13f73,0x3d97bf7f,0xbee63f65,0x3f42bf27
.long 0xbf0ebf55,0x3f0e3f55,0xbf0ebf55,0x3f0e3f55,0x3f423f27,0xbf73bea1,0x3f7fbd97,0xbf653ee6,0xbf67bedb,0x3f71beac,0xbedb3f67,0xbeacbf71,0x3f7c3e2f,0xbf093f58,0xbf13bf51,0x3f7abe60
.long 0xbf7f3dc9,0xbdc9bf7f,0x3f7fbdc9,0x3dc93f7f,0x3f6fbeb8,0x3f313f39,0xbecf3f6a,0xbf80bcc9,0xbf4e3f18,0xbf7dbe16,0xbf18bf4e,0x3e16bf7d,0x3f1dbf4a,0x3f5fbefc,0x3f7ebdfb,0x3f773e89
.long 0x3f808000,0x3f808000,0x3f808000,0x3f808000,0x3e893f77,0x3f1d3f4a,0x3f5f3efc,0x3f7e3dfb,0xbf5c3f04,0xbe793f78,0x3f043f5c,0x3f783e79,0xbf39bf31,0xbf6a3ecf,0x3cc93f80,0x3f6f3eb8
.long 0x3ef1bf62,0xbf62bef1,0xbef13f62,0x3f623ef1,0x3f7a3e60,0xbe2fbf7c,0xbf583f09,0x3f513f13,0x3d493f80,0x3f2cbf3e,0xbf803d49,0x3f3e3f2c,0xbf733ea1,0x3f7f3d97,0xbf65bee6,0x3f273f42
.long 0xbf0ebf55,0x3f0e3f55,0xbf0ebf55,0x3f0e3f55,0x3f27bf42,0xbea13f73,0xbd97bf7f,0x3ee63f65,0x3f673edb,0xbf713eac,0x3edbbf67,0x3eac3f71,0xbe2f3f7c,0xbf58bf09,0x3f51bf13,0x3e603f7a
.long 0xbf7f3dc9,0xbdc9bf7f,0x3f7fbdc9,0x3dc93f7f,0xbeb8bf6f,0x3f39bf31,0x3f6a3ecf,0xbcc93f80,0x3f4ebf18,0x3f7d3e16,0x3f183f4e,0xbe163f7d,0x3f4a3f1d,0x3efc3f5f,0x3dfb3f7e,0xbe893f77
.long 0x3f80,0x3f80,0x3f80,0x3f80,0x3e953f75,0x3f223f46,0x3f623ef1,0x3f7f3dc9,0x3f0e3f55,0x3f7b3e48,0x3f55bf0e,0x3e48bf7b,0x3f463f22,0x3f62bef1,0xbdc9bf7f,0xbf75be95
.long 0x3f6d3ec4,0x3ec4bf6d,0xbf6dbec4,0xbec43f6d,0x3f7f3dc9,0xbe95bf75,0xbf463f22,0x3f623ef1,0x3f7bbe48,0xbf55bf0e,0x3e483f7b,0x3f0ebf55,0x3f62bef1,0xbf7f3dc9,0x3f753e95,0xbf46bf22
.long 0x3f35bf35,0xbf353f35,0x3f35bf35,0xbf353f35,0x3ef1bf62,0xbdc93f7f,0xbe95bf75,0x3f223f46,0x3e48bf7b,0x3f0e3f55,0xbf7bbe48,0x3f55bf0e,0xbdc9bf7f,0x3f753e95,0xbf223f46,0xbef1bf62
.long 0xbec4bf6d,0x3f6dbec4,0x3ec43f6d,0xbf6d3ec4,0xbf22bf46,0x3ef1bf62,0x3f7f3dc9,0x3e953f75,0xbf55bf0e,0xbe48bf7b,0x3f0ebf55,0x3f7bbe48,0xbf75be95,0xbf46bf22,0xbef1bf62,0xbdc9bf7f
.long 0x3f80,0x3f80,0x3f80,0x3f80,0x3f75be95,0x3f46bf22,0x3ef1bf62,0x3dc9bf7f,0xbf0ebf55,0xbf7bbe48,0xbf553f0e,0xbe483f7b,0xbf223f46,0x3ef13f62,0x3f7fbdc9,0x3e95bf75
.long 0x3f6d3ec4,0x3ec4bf6d,0xbf6dbec4,0xbec43f6d,0x3dc9bf7f,0xbf753e95,0x3f223f46,0x3ef1bf62,0xbf7b3e48,0x3f553f0e,0xbe48bf7b,0xbf0e3f55,0x3ef13f62,0xbdc9bf7f,0xbe953f75,0x3f22bf46
.long 0x3f35bf35,0xbf353f35,0x3f35bf35,0xbf353f35,0xbf62bef1,0x3f7f3dc9,0xbf753e95,0x3f46bf22,0xbe483f7b,0xbf0ebf55,0x3f7b3e48,0xbf553f0e,0x3f7fbdc9,0xbe953f75,0xbf46bf22,0x3f62bef1
.long 0xbec4bf6d,0x3f6dbec4,0x3ec43f6d,0xbf6d3ec4,0xbf463f22,0xbf62bef1,0x3dc9bf7f,0x3f75be95,0x3f553f0e,0x3e483f7b,0xbf0e3f55,0xbf7b3e48,0x3e95bf75,0x3f22bf46,0x3f62bef1,0x3f7fbdc9
.long 0x3f80,0x3f80,0x3f80,0x3f80,0xbe95bf75,0xbf22bf46,0xbf62bef1,0xbf7fbdc9,0x3f0e3f55,0x3f7b3e48,0x3f55bf0e,0x3e48bf7b,0xbf46bf22,0xbf623ef1,0x3dc93f7f,0x3f753e95
.long 0x3f6d3ec4,0x3ec4bf6d,0xbf6dbec4,0xbec43f6d,0xbf7fbdc9,0x3e953f75,0x3f46bf22,0xbf62bef1,0x3f7bbe48,0xbf55bf0e,0x3e483f7b,0x3f0ebf55,0xbf623ef1,0x3f7fbdc9,0xbf75be95,0x3f463f22
.long 0x3f35bf35,0xbf353f35,0x3f35bf35,0xbf353f35,0xbef13f62,0x3dc9bf7f,0x3e953f75,0xbf22bf46,0x3e48bf7b,0x3f0e3f55,0xbf7bbe48,0x3f55bf0e,0x3dc93f7f,0xbf75be95,0x3f22bf46,0x3ef13f62
.long 0xbec4bf6d,0x3f6dbec4,0x3ec43f6d,0xbf6d3ec4,0x3f223f46,0xbef13f62,0xbf7fbdc9,0xbe95bf75,0xbf55bf0e,0xbe48bf7b,0x3f0ebf55,0x3f7bbe48,0x3f753e95,0x3f463f22,0x3ef13f62,0x3dc93f7f
.long 0x3f80,0x3f80,0x3f80,0x3f80,0xbf753e95,0xbf463f22,0xbef13f62,0xbdc93f7f,0xbf0ebf55,0xbf7bbe48,0xbf553f0e,0xbe483f7b,0x3f22bf46,0xbef1bf62,0xbf7f3dc9,0xbe953f75
.long 0x3f6d3ec4,0x3ec4bf6d,0xbf6dbec4,0xbec43f6d,0xbdc93f7f,0x3f75be95,0xbf22bf46,0xbef13f62,0xbf7b3e48,0x3f553f0e,0xbe48bf7b,0xbf0e3f55,0xbef1bf62,0x3dc93f7f,0x3e95bf75,0xbf223f46
.long 0x3f35bf35,0xbf353f35,0x3f35bf35,0xbf353f35,0x3f623ef1,0xbf7fbdc9,0x3f75be95,0xbf463f22,0xbe483f7b,0xbf0ebf55,0x3f7b3e48,0xbf553f0e,0xbf7f3dc9,0x3e95bf75,0x3f463f22,0xbf623ef1
.long 0xbec4bf6d,0x3f6dbec4,0x3ec43f6d,0xbf6d3ec4,0x3f46bf22,0x3f623ef1,0xbdc93f7f,0xbf753e95,0x3f553f0e,0x3e483f7b,0xbf0e3f55,0xbf7b3e48,0xbe953f75,0xbf223f46,0xbf623ef1,0xbf7f3dc9
.long 0x3f808000,0x3f808000,0x3f808000,0x3f808000,0x3f75be95,0x3f46bf22,0x3ef1bf62,0x3dc9bf7f,0x3f55bf0e,0x3e48bf7b,0xbf0ebf55,0xbf7bbe48,0x3f22bf46,0xbef1bf62,0xbf7f3dc9,0xbe953f75
.long 0x3ec4bf6d,0xbf6dbec4,0xbec43f6d,0x3f6d3ec4,0x3dc9bf7f,0xbf753e95,0x3f223f46,0x3ef1bf62,0xbe48bf7b,0xbf0e3f55,0x3f7bbe48,0xbf55bf0e,0xbef1bf62,0x3dc93f7f,0x3e95bf75,0xbf223f46
.long 0xbf35bf35,0x3f353f35,0xbf35bf35,0x3f353f35,0xbf62bef1,0x3f7f3dc9,0xbf753e95,0x3f46bf22,0xbf7bbe48,0x3f55bf0e,0xbe483f7b,0xbf0ebf55,0xbf7f3dc9,0x3e95bf75,0x3f463f22,0xbf623ef1
.long 0xbf6d3ec4,0xbec4bf6d,0x3f6dbec4,0x3ec43f6d,0xbf463f22,0xbf62bef1,0x3dc9bf7f,0x3f75be95,0xbf0e3f55,0xbf7b3e48,0xbf55bf0e,0xbe48bf7b,0xbe953f75,0xbf223f46,0xbf623ef1,0xbf7f3dc9
.long 0x3f808000,0x3f808000,0x3f808000,0x3f808000,0xbe95bf75,0xbf22bf46,0xbf62bef1,0xbf7fbdc9,0xbf553f0e,0xbe483f7b,0x3f0e3f55,0x3f7b3e48,0x3f463f22,0x3f62bef1,0xbdc9bf7f,0xbf75be95
.long 0x3ec4bf6d,0xbf6dbec4,0xbec43f6d,0x3f6d3ec4,0xbf7fbdc9,0x3e953f75,0x3f46bf22,0xbf62bef1,0x3e483f7b,0x3f0ebf55,0xbf7b3e48,0x3f553f0e,0x3f62bef1,0xbf7f3dc9,0x3f753e95,0xbf46bf22
.long 0xbf35bf35,0x3f353f35,0xbf35bf35,0x3f353f35,0xbef13f62,0x3dc9bf7f,0x3e953f75,0xbf22bf46,0x3f7b3e48,0xbf553f0e,0x3e48bf7b,0x3f0e3f55,0xbdc9bf7f,0x3f753e95,0xbf223f46,0xbef1bf62
.long 0xbf6d3ec4,0xbec4bf6d,0x3f6dbec4,0x3ec43f6d,0x3f223f46,0xbef13f62,0xbf7fbdc9,0xbe95bf75,0x3f0ebf55,0x3f7bbe48,0x3f553f0e,0x3e483f7b,0xbf75be95,0xbf46bf22,0xbef1bf62,0xbdc9bf7f
.long 0x3f808000,0x3f808000,0x3f808000,0x3f808000,0xbf753e95,0xbf463f22,0xbef13f62,0xbdc93f7f,0x3f55bf0e,0x3e48bf7b,0xbf0ebf55,0xbf7bbe48,0xbf223f46,0x3ef13f62,0x3f7fbdc9,0x3e95bf75
.long 0x3ec4bf6d,0xbf6dbec4,0xbec43f6d,0x3f6d3ec4,0xbdc93f7f,0x3f75be95,0xbf22bf46,0xbef13f62,0xbe48bf7b,0xbf0e3f55,0x3f7bbe48,0xbf55bf0e,0x3ef13f62,0xbdc9bf7f,0xbe953f75,0x3f22bf46
.long 0xbf35bf35,0x3f353f35,0xbf35bf35,0x3f353f35,0x3f623ef1,0xbf7fbdc9,0x3f75be95,0xbf463f22,0xbf7bbe48,0x3f55bf0e,0xbe483f7b,0xbf0ebf55,0x3f7fbdc9,0xbe953f75,0xbf46bf22,0x3f62bef1
.long 0xbf6d3ec4,0xbec4bf6d,0x3f6dbec4,0x3ec43f6d,0x3f46bf22,0x3f623ef1,0xbdc93f7f,0xbf753e95,0xbf0e3f55,0xbf7b3e48,0xbf55bf0e,0xbe48bf7b,0x3e95bf75,0x3f22bf46,0x3f62bef1,0x3f7fbdc9
.long 0x3f808000,0x3f808000,0x3f808000,0x3f808000,0x3e953f75,0x3f223f46,0x3f623ef1,0x3f7f3dc9,0xbf553f0e,0xbe483f7b,0x3f0e3f55,0x3f7b3e48,0xbf46bf22,0xbf623ef1,0x3dc93f7f,0x3f753e95
.long 0x3ec4bf6d,0xbf6dbec4,0xbec43f6d,0x3f6d3ec4,0x3f7f3dc9,0xbe95bf75,0xbf463f22,0x3f623ef1,0x3e483f7b,0x3f0ebf55,0xbf7b3e48,0x3f553f0e,0xbf623ef1,0x3f7fbdc9,0xbf75be95,0x3f463f22
.long 0xbf35bf35,0x3f353f35,0xbf35bf35,0x3f353f35,0x3ef1bf62,0xbdc93f7f,0xbe95bf75,0x3f223f46,0x3f7b3e48,0xbf553f0e,0x3e48bf7b,0x3f0e3f55,0x3dc93f7f,0xbf75be95,0x3f22bf46,0x3ef13f62
.long 0xbf6d3ec4,0xbec4bf6d,0x3f6dbec4,0x3ec43f6d,0xbf22bf46,0x3ef1bf62,0x3f7f3dc9,0x3e953f75,0x3f0ebf55,0x3f7bbe48,0x3f553f0e,0x3e483f7b,0x3f753e95,0x3f463f22,0x3ef13f62,0x3dc93f7f
.long 0x3f80,0x3f80,0x3f80,0x3f80,0x3ea13f73,0x3f273f42,0x3f653ee6,0x3f7f3d97,0x3f183f4e,0x3f7d3e16,0x3f4ebf18,0x3e16bf7d,0x3f513f13,0x3f58bf09,0xbe2fbf7c,0xbf7abe60
.long 0x3f753e95,0x3e95bf75,0xbf75be95,0xbe953f75,0x3f80bcc9,0xbecfbf6a,0xbf313f39,0x3f6f3eb8,0x3f71beac,0xbf67bedb,0x3eac3f71,0x3edbbf67,0x3f4abf1d,0xbf773e89,0x3f7e3dfb,0xbf5fbefc
.long 0x3f0ebf55,0xbf0e3f55,0x3f0ebf55,0xbf0e3f55,0x3e89bf77,0x3dfb3f7e,0xbefcbf5f,0x3f4a3f1d,0xbd49bf80,0x3f3e3f2c,0xbf803d49,0x3f2cbf3e,0xbeb8bf6f,0x3f803cc9,0xbecf3f6a,0xbf31bf39
.long 0xbf22bf46,0x3f46bf22,0x3f223f46,0xbf463f22,0xbf58bf09,0x3e2fbf7c,0x3f7abe60,0x3f133f51,0xbf78be79,0xbf04bf5c,0x3e79bf78,0x3f5cbf04,0xbf7f3d97,0xbf73bea1,0xbf42bf27,0xbee6bf65
.long 0x3f80,0x3f80,0x3f80,0x3f80,0x3f73bea1,0x3f42bf27,0x3ee6bf65,0x3d97bf7f,0xbf18bf4e,0xbf7dbe16,0xbf4e3f18,0xbe163f7d,0xbf133f51,0x3f093f58,0x3f7cbe2f,0x3e60bf7a
.long 0x3f753e95,0x3e95bf75,0xbf75be95,0xbe953f75,0xbcc9bf80,0xbf6a3ecf,0x3f393f31,0x3eb8bf6f,0xbf713eac,0x3f673edb,0xbeacbf71,0xbedb3f67,0x3f1d3f4a,0xbe89bf77,0xbdfb3f7e,0x3efcbf5f
.long 0x3f0ebf55,0xbf0e3f55,0x3f0ebf55,0xbf0e3f55,0xbf77be89,0x3f7ebdfb,0xbf5f3efc,0x3f1dbf4a,0x3d493f80,0xbf3ebf2c,0x3f80bd49,0xbf2c3f3e,0x3f6fbeb8,0xbcc93f80,0xbf6abecf,0x3f39bf31
.long 0xbf22bf46,0x3f46bf22,0x3f223f46,0xbf463f22,0xbf093f58,0xbf7cbe2f,0xbe60bf7a,0x3f51bf13,0x3f783e79,0x3f043f5c,0xbe793f78,0xbf5c3f04,0xbd97bf7f,0x3ea1bf73,0x3f27bf42,0x3f65bee6
.long 0x3f80,0x3f80,0x3f80,0x3f80,0xbea1bf73,0xbf27bf42,0xbf65bee6,0xbf7fbd97,0x3f183f4e,0x3f7d3e16,0x3f4ebf18,0x3e16bf7d,0xbf51bf13,0xbf583f09,0x3e2f3f7c,0x3f7a3e60
.long 0x3f753e95,0x3e95bf75,0xbf75be95,0xbe953f75,0xbf803cc9,0x3ecf3f6a,0x3f31bf39,0xbf6fbeb8,0x3f71beac,0xbf67bedb,0x3eac3f71,0x3edbbf67,0xbf4a3f1d,0x3f77be89,0xbf7ebdfb,0x3f5f3efc
.long 0x3f0ebf55,0xbf0e3f55,0x3f0ebf55,0xbf0e3f55,0xbe893f77,0xbdfbbf7e,0x3efc3f5f,0xbf4abf1d,0xbd49bf80,0x3f3e3f2c,0xbf803d49,0x3f2cbf3e,0x3eb83f6f,0xbf80bcc9,0x3ecfbf6a,0x3f313f39
.long 0xbf22bf46,0x3f46bf22,0x3f223f46,0xbf463f22,0x3f583f09,0xbe2f3f7c,0xbf7a3e60,0xbf13bf51,0xbf78be79,0xbf04bf5c,0x3e79bf78,0x3f5cbf04,0x3f7fbd97,0x3f733ea1,0x3f423f27,0x3ee63f65
.long 0x3f80,0x3f80,0x3f80,0x3f80,0xbf733ea1,0xbf423f27,0xbee63f65,0xbd973f7f,0xbf18bf4e,0xbf7dbe16,0xbf4e3f18,0xbe163f7d,0x3f13bf51,0xbf09bf58,0xbf7c3e2f,0xbe603f7a
.long 0x3f753e95,0x3e95bf75,0xbf75be95,0xbe953f75,0x3cc93f80,0x3f6abecf,0xbf39bf31,0xbeb83f6f,0xbf713eac,0x3f673edb,0xbeacbf71,0xbedb3f67,0xbf1dbf4a,0x3e893f77,0x3dfbbf7e,0xbefc3f5f
.long 0x3f0ebf55,0xbf0e3f55,0x3f0ebf55,0xbf0e3f55,0x3f773e89,0xbf7e3dfb,0x3f5fbefc,0xbf1d3f4a,0x3d493f80,0xbf3ebf2c,0x3f80bd49,0xbf2c3f3e,0xbf6f3eb8,0x3cc9bf80,0x3f6a3ecf,0xbf393f31
.long 0xbf22bf46,0x3f46bf22,0x3f223f46,0xbf463f22,0x3f09bf58,0x3f7c3e2f,0x3e603f7a,0xbf513f13,0x3f783e79,0x3f043f5c,0xbe793f78,0xbf5c3f04,0x3d973f7f,0xbea13f73,0xbf273f42,0xbf653ee6
.long 0x3f808000,0x3f808000,0x3f808000,0x3f808000,0x3f73bea1,0x3f42bf27,0x3ee6bf65,0x3d97bf7f,0x3f4ebf18,0x3e16bf7d,0xbf18bf4e,0xbf7dbe16,0x3f13bf51,0xbf09bf58,0xbf7c3e2f,0xbe603f7a
.long 0x3e95bf75,0xbf75be95,0xbe953f75,0x3f753e95,0xbcc9bf80,0xbf6a3ecf,0x3f393f31,0x3eb8bf6f,0xbeacbf71,0xbedb3f67,0x3f71beac,0xbf67bedb,0xbf1dbf4a,0x3e893f77,0x3dfbbf7e,0xbefc3f5f
.long 0xbf55bf0e,0x3f553f0e,0xbf55bf0e,0x3f553f0e,0xbf77be89,0x3f7ebdfb,0xbf5f3efc,0x3f1dbf4a,0xbf803d49,0x3f2cbf3e,0x3d493f80,0xbf3ebf2c,0xbf6f3eb8,0x3cc9bf80,0x3f6a3ecf,0xbf393f31
.long 0xbf463f22,0xbf22bf46,0x3f46bf22,0x3f223f46,0xbf093f58,0xbf7cbe2f,0xbe60bf7a,0x3f51bf13,0xbe793f78,0xbf5c3f04,0xbf78be79,0xbf04bf5c,0x3d973f7f,0xbea13f73,0xbf273f42,0xbf653ee6
.long 0x3f808000,0x3f808000,0x3f808000,0x3f808000,0xbea1bf73,0xbf27bf42,0xbf65bee6,0xbf7fbd97,0xbf4e3f18,0xbe163f7d,0x3f183f4e,0x3f7d3e16,0x3f513f13,0x3f58bf09,0xbe2fbf7c,0xbf7abe60
.long 0x3e95bf75,0xbf75be95,0xbe953f75,0x3f753e95,0xbf803cc9,0x3ecf3f6a,0x3f31bf39,0xbf6fbeb8,0x3eac3f71,0x3edbbf67,0xbf713eac,0x3f673edb,0x3f4abf1d,0xbf773e89,0x3f7e3dfb,0xbf5fbefc
.long 0xbf55bf0e,0x3f553f0e,0xbf55bf0e,0x3f553f0e,0xbe893f77,0xbdfbbf7e,0x3efc3f5f,0xbf4abf1d,0x3f80bd49,0xbf2c3f3e,0xbd49bf80,0x3f3e3f2c,0xbeb8bf6f,0x3f803cc9,0xbecf3f6a,0xbf31bf39
.long 0xbf463f22,0xbf22bf46,0x3f46bf22,0x3f223f46,0x3f583f09,0xbe2f3f7c,0xbf7a3e60,0xbf13bf51,0x3e79bf78,0x3f5cbf04,0x3f783e79,0x3f043f5c,0xbf7f3d97,0xbf73bea1,0xbf42bf27,0xbee6bf65
.long 0x3f808000,0x3f808000,0x3f808000,0x3f808000,0xbf733ea1,0xbf423f27,0xbee63f65,0xbd973f7f,0x3f4ebf18,0x3e16bf7d,0xbf18bf4e,0xbf7dbe16,0xbf133f51,0x3f093f58,0x3f7cbe2f,0x3e60bf7a
.long 0x3e95bf75,0xbf75be95,0xbe953f75,0x3f753e95,0x3cc93f80,0x3f6abecf,0xbf39bf31,0xbeb83f6f,0xbeacbf71,0xbedb3f67,0x3f71beac,0xbf67bedb,0x3f1d3f4a,0xbe89bf77,0xbdfb3f7e,0x3efcbf5f
.long 0xbf55bf0e,0x3f553f0e,0xbf55bf0e,0x3f553f0e,0x3f773e89,0xbf7e3dfb,0x3f5fbefc,0xbf1d3f4a,0xbf803d49,0x3f2cbf3e,0x3d493f80,0xbf3ebf2c,0x3f6fbeb8,0xbcc93f80,0xbf6abecf,0x3f39bf31
.long 0xbf463f22,0xbf22bf46,0x3f46bf22,0x3f223f46,0x3f09bf58,0x3f7c3e2f,0x3e603f7a,0xbf513f13,0xbe793f78,0xbf5c3f04,0xbf78be79,0xbf04bf5c,0xbd97bf7f,0x3ea1bf73,0x3f27bf42,0x3f65bee6
.long 0x3f808000,0x3f808000,0x3f808000,0x3f808000,0x3ea13f73,0x3f273f42,0x3f653ee6,0x3f7f3d97,0xbf4e3f18,0xbe163f7d,0x3f183f4e,0x3f7d3e16,0xbf51bf13,0xbf583f09,0x3e2f3f7c,0x3f7a3e60
.long 0x3e95bf75,0xbf75be95,0xbe953f75,0x3f753e95,0x3f80bcc9,0xbecfbf6a,0xbf313f39,0x3f6f3eb8,0x3eac3f71,0x3edbbf67,0xbf713eac,0x3f673edb,0xbf4a3f1d,0x3f77be89,0xbf7ebdfb,0x3f5f3efc
.long 0xbf55bf0e,0x3f553f0e,0xbf55bf0e,0x3f553f0e,0x3e89bf77,0x3dfb3f7e,0xbefcbf5f,0x3f4a3f1d,0x3f80bd49,0xbf2c3f3e,0xbd49bf80,0x3f3e3f2c,0x3eb83f6f,0xbf80bcc9,0x3ecfbf6a,0x3f313f39
.long 0xbf463f22,0xbf22bf46,0x3f46bf22,0x3f223f46,0xbf58bf09,0x3e2fbf7c,0x3f7abe60,0x3f133f51,0x3e79bf78,0x3f5cbf04,0x3f783e79,0x3f043f5c,0x3f7fbd97,0x3f733ea1,0x3f423f27,0x3ee63f65
.long 0x3f80,0x3f80,0x3f80,0x3f80,0x3eac3f71,0x3f2c3f3e,0x3f673edb,0x3f803d49,0x3f223f46,0x3f7f3dc9,0x3f46bf22,0x3dc9bf7f,0x3f5c3f04,0x3f4ebf18,0xbe79bf78,0xbf7dbe16
.long 0x3f7b3e48,0x3e48bf7b,0xbf7bbe48,0xbe483f7b,0x3f7dbe16,0xbf04bf5c,0xbf183f4e,0x3f783e79,0x3f62bef1,0xbf75be95,0x3ef13f62,0x3e95bf75,0x3f2cbf3e,0xbf673edb,0x3f80bd49,0xbf71beac
.long 0x3ec4bf6d,0xbec43f6d,0x3ec4bf6d,0xbec43f6d,0x3d49bf80,0x3eac3f71,0xbf2cbf3e,0x3f673edb,0xbe95bf75,0x3f623ef1,0xbf753e95,0x3ef1bf62,0xbf18bf4e,0x3f78be79,0xbe163f7d,0xbf5cbf04
.long 0xbf55bf0e,0x3f0ebf55,0x3f553f0e,0xbf0e3f55,0xbf78be79,0xbe16bf7d,0x3f5cbf04,0x3f4e3f18,0xbf7f3dc9,0xbf46bf22,0xbdc9bf7f,0x3f22bf46,0xbf673edb,0xbf803d49,0xbf71beac,0xbf3ebf2c
.long 0x3f80,0x3f80,0x3f80,0x3f80,0x3f71beac,0x3f3ebf2c,0x3edbbf67,0x3d49bf80,0xbf22bf46,0xbf7fbdc9,0xbf463f22,0xbdc93f7f,0xbf043f5c,0x3f183f4e,0x3f78be79,0x3e16bf7d
.long 0x3f7b3e48,0x3e48bf7b,0xbf7bbe48,0xbe483f7b,0xbe16bf7d,0xbf5c3f04,0x3f4e3f18,0x3e79bf78,0xbf623ef1,0x3f753e95,0xbef1bf62,0xbe953f75,0x3f3e3f2c,0xbedbbf67,0x3d493f80,0x3eacbf71
.long 0x3ec4bf6d,0xbec43f6d,0x3ec4bf6d,0xbec43f6d,0xbf80bd49,0x3f71beac,0xbf3e3f2c,0x3edbbf67,0x3e953f75,0xbf62bef1,0x3f75be95,0xbef13f62,0x3f4ebf18,0x3e793f78,0xbf7dbe16,0x3f04bf5c
.long 0xbf55bf0e,0x3f0ebf55,0x3f553f0e,0xbf0e3f55,0xbe793f78,0xbf7d3e16,0xbf04bf5c,0x3f18bf4e,0x3f7fbdc9,0x3f463f22,0x3dc93f7f,0xbf223f46,0xbedbbf67,0xbd49bf80,0x3eacbf71,0x3f2cbf3e
.long 0x3f80,0x3f80,0x3f80,0x3f80,0xbeacbf71,0xbf2cbf3e,0xbf67bedb,0xbf80bd49,0x3f223f46,0x3f7f3dc9,0x3f46bf22,0x3dc9bf7f,0xbf5cbf04,0xbf4e3f18,0x3e793f78,0x3f7d3e16
.long 0x3f7b3e48,0x3e48bf7b,0xbf7bbe48,0xbe483f7b,0xbf7d3e16,0x3f043f5c,0x3f18bf4e,0xbf78be79,0x3f62bef1,0xbf75be95,0x3ef13f62,0x3e95bf75,0xbf2c3f3e,0x3f67bedb,0xbf803d49,0x3f713eac
.long 0x3ec4bf6d,0xbec43f6d,0x3ec4bf6d,0xbec43f6d,0xbd493f80,0xbeacbf71,0x3f2c3f3e,0xbf67bedb,0xbe95bf75,0x3f623ef1,0xbf753e95,0x3ef1bf62,0x3f183f4e,0xbf783e79,0x3e16bf7d,0x3f5c3f04
.long 0xbf55bf0e,0x3f0ebf55,0x3f553f0e,0xbf0e3f55,0x3f783e79,0x3e163f7d,0xbf5c3f04,0xbf4ebf18,0xbf7f3dc9,0xbf46bf22,0xbdc9bf7f,0x3f22bf46,0x3f67bedb,0x3f80bd49,0x3f713eac,0x3f3e3f2c
.long 0x3f80,0x3f80,0x3f80,0x3f80,0xbf713eac,0xbf3e3f2c,0xbedb3f67,0xbd493f80,0xbf22bf46,0xbf7fbdc9,0xbf463f22,0xbdc93f7f,0x3f04bf5c,0xbf18bf4e,0xbf783e79,0xbe163f7d
.long 0x3f7b3e48,0x3e48bf7b,0xbf7bbe48,0xbe483f7b,0x3e163f7d,0x3f5cbf04,0xbf4ebf18,0xbe793f78,0xbf623ef1,0x3f753e95,0xbef1bf62,0xbe953f75,0xbf3ebf2c,0x3edb3f67,0xbd49bf80,0xbeac3f71
.long 0x3ec4bf6d,0xbec43f6d,0x3ec4bf6d,0xbec43f6d,0x3f803d49,0xbf713eac,0x3f3ebf2c,0xbedb3f67,0x3e953f75,0xbf62bef1,0x3f75be95,0xbef13f62,0xbf4e3f18,0xbe79bf78,0x3f7d3e16,0xbf043f5c
.long 0xbf55bf0e,0x3f0ebf55,0x3f553f0e,0xbf0e3f55,0x3e79bf78,0x3f7dbe16,0x3f043f5c,0xbf183f4e,0x3f7fbdc9,0x3f463f22,0x3dc93f7f,0xbf223f46,0x3edb3f67,0x3d493f80,0xbeac3f71,0xbf2c3f3e
.long 0x3f808000,0x3f808000,0x3f808000,0x3f808000,0x3f71beac,0x3f3ebf2c,0x3edbbf67,0x3d49bf80,0x3f46bf22,0x3dc9bf7f,0xbf22bf46,0xbf7fbdc9,0x3f04bf5c,0xbf18bf4e,0xbf783e79,0xbe163f7d
.long 0x3e48bf7b,0xbf7bbe48,0xbe483f7b,0x3f7b3e48,0xbe16bf7d,0xbf5c3f04,0x3f4e3f18,0x3e79bf78,0xbef1bf62,0xbe953f75,0x3f62bef1,0xbf75be95,0xbf3ebf2c,0x3edb3f67,0xbd49bf80,0xbeac3f71
.long 0xbf6dbec4,0x3f6d3ec4,0xbf6dbec4,0x3f6d3ec4,0xbf80bd49,0x3f71beac,0xbf3e3f2c,0x3edbbf67,0xbf753e95,0x3ef1bf62,0x3e953f75,0xbf62bef1,0xbf4e3f18,0xbe79bf78,0x3f7d3e16,0xbf043f5c
.long 0xbf0e3f55,0xbf55bf0e,0x3f0ebf55,0x3f553f0e,0xbe793f78,0xbf7d3e16,0xbf04bf5c,0x3f18bf4e,0x3dc93f7f,0xbf223f46,0xbf7f3dc9,0xbf46bf22,0x3edb3f67,0x3d493f80,0xbeac3f71,0xbf2c3f3e
.long 0x3f808000,0x3f808000,0x3f808000,0x3f808000,0xbeacbf71,0xbf2cbf3e,0xbf67bedb,0xbf80bd49,0xbf463f22,0xbdc93f7f,0x3f223f46,0x3f7f3dc9,0x3f5c3f04,0x3f4ebf18,0xbe79bf78,0xbf7dbe16
.long 0x3e48bf7b,0xbf7bbe48,0xbe483f7b,0x3f7b3e48,0xbf7d3e16,0x3f043f5c,0x3f18bf4e,0xbf78be79,0x3ef13f62,0x3e95bf75,0xbf623ef1,0x3f753e95,0x3f2cbf3e,0xbf673edb,0x3f80bd49,0xbf71beac
.long 0xbf6dbec4,0x3f6d3ec4,0xbf6dbec4,0x3f6d3ec4,0xbd493f80,0xbeacbf71,0x3f2c3f3e,0xbf67bedb,0x3f75be95,0xbef13f62,0xbe95bf75,0x3f623ef1,0xbf18bf4e,0x3f78be79,0xbe163f7d,0xbf5cbf04
.long 0xbf0e3f55,0xbf55bf0e,0x3f0ebf55,0x3f553f0e,0x3f783e79,0x3e163f7d,0xbf5c3f04,0xbf4ebf18,0xbdc9bf7f,0x3f22bf46,0x3f7fbdc9,0x3f463f22,0xbf673edb,0xbf803d49,0xbf71beac,0xbf3ebf2c
.long 0x3f808000,0x3f808000,0x3f808000,0x3f808000,0xbf713eac,0xbf3e3f2c,0xbedb3f67,0xbd493f80,0x3f46bf22,0x3dc9bf7f,0xbf22bf46,0xbf7fbdc9,0xbf043f5c,0x3f183f4e,0x3f78be79,0x3e16bf7d
.long 0x3e48bf7b,0xbf7bbe48,0xbe483f7b,0x3f7b3e48,0x3e163f7d,0x3f5cbf04,0xbf4ebf18,0xbe793f78,0xbef1bf62,0xbe953f75,0x3f62bef1,0xbf75be95,0x3f3e3f2c,0xbedbbf67,0x3d493f80,0x3eacbf71
.long 0xbf6dbec4,0x3f6d3ec4,0xbf6dbec4,0x3f6d3ec4,0x3f803d49,0xbf713eac,0x3f3ebf2c,0xbedb3f67,0xbf753e95,0x3ef1bf62,0x3e953f75,0xbf62bef1,0x3f4ebf18,0x3e793f78,0xbf7dbe16,0x3f04bf5c
.long 0xbf0e3f55,0xbf55bf0e,0x3f0ebf55,0x3f553f0e,0x3e79bf78,0x3f7dbe16,0x3f043f5c,0xbf183f4e,0x3dc93f7f,0xbf223f46,0xbf7f3dc9,0xbf46bf22,0xbedbbf67,0xbd49bf80,0x3eacbf71,0x3f2cbf3e
.long 0x3f808000,0x3f808000,0x3f808000,0x3f808000,0x3eac3f71,0x3f2c3f3e,0x3f673edb,0x3f803d49,0xbf463f22,0xbdc93f7f,0x3f223f46,0x3f7f3dc9,0xbf5cbf04,0xbf4e3f18,0x3e793f78,0x3f7d3e16
.long 0x3e48bf7b,0xbf7bbe48,0xbe483f7b,0x3f7b3e48,0x3f7dbe16,0xbf04bf5c,0xbf183f4e,0x3f783e79,0x3ef13f62,0x3e95bf75,0xbf623ef1,0x3f753e95,0xbf2c3f3e,0x3f67bedb,0xbf803d49,0x3f713eac
.long 0xbf6dbec4,0x3f6d3ec4,0xbf6dbec4,0x3f6d3ec4,0x3d49bf80,0x3eac3f71,0xbf2cbf3e,0x3f673edb,0x3f75be95,0xbef13f62,0xbe95bf75,0x3f623ef1,0x3f183f4e,0xbf783e79,0x3e16bf7d,0x3f5c3f04
.long 0xbf0e3f55,0xbf55bf0e,0x3f0ebf55,0x3f553f0e,0xbf78be79,0xbe16bf7d,0x3f5cbf04,0x3f4e3f18,0xbdc9bf7f,0x3f22bf46,0x3f7fbdc9,0x3f463f22,0x3f67bedb,0x3f80bd49,0x3f713eac,0x3f3e3f2c
.long 0x3f80,0x3f80,0x3f80,0x3f80,0x3eb83f6f,0x3f313f39,0x3f6a3ecf,0x3f803cc9,0x3f2c3f3e,0x3f803d49,0x3f3ebf2c,0x3d49bf80,0x3f653ee6,0x3f42bf27,0xbea1bf73,0xbf7fbd97
.long 0x3f7f3dc9,0x3dc9bf7f,0xbf7fbdc9,0xbdc93f7f,0x3f77be89,0xbf1dbf4a,0xbefc3f5f,0x3f7e3dfb,0x3f4ebf18,0xbf7dbe16,0x3f183f4e,0x3e16bf7d,0x3f09bf58,0xbf513f13,0x3f7abe60,0xbf7cbe2f
.long 0x3e48bf7b,0xbe483f7b,0x3e48bf7b,0xbe483f7b,0xbe2fbf7c,0x3f093f58,0xbf51bf13,0x3f7a3e60,0xbf04bf5c,0x3f783e79,0xbf5c3f04,0x3e79bf78,0xbf4abf1d,0x3f5fbefc,0x3dfb3f7e,0xbf77be89
.long 0xbf75be95,0x3e95bf75,0x3f753e95,0xbe953f75,0xbf7f3d97,0xbee6bf65,0x3f27bf42,0x3f733ea1,0xbf673edb,0xbf71beac,0xbedbbf67,0x3eacbf71,0xbf313f39,0xbf6a3ecf,0xbf803cc9,0xbf6fbeb8
.long 0x3f80,0x3f80,0x3f80,0x3f80,0x3f6fbeb8,0x3f39bf31,0x3ecfbf6a,0x3cc9bf80,0xbf2cbf3e,0xbf80bd49,0xbf3e3f2c,0xbd493f80,0xbee63f65,0x3f273f42,0x3f73bea1,0x3d97bf7f
.long 0x3f7f3dc9,0x3dc9bf7f,0xbf7fbdc9,0xbdc93f7f,0xbe89bf77,0xbf4a3f1d,0x3f5f3efc,0x3dfbbf7e,0xbf4e3f18,0x3f7d3e16,0xbf18bf4e,0xbe163f7d,0x3f583f09,0xbf13bf51,0x3e603f7a,0x3e2fbf7c
.long 0x3e48bf7b,0xbe483f7b,0x3e48bf7b,0xbe483f7b,0xbf7c3e2f,0x3f58bf09,0xbf133f51,0x3e60bf7a,0x3f043f5c,0xbf78be79,0x3f5cbf04,0xbe793f78,0x3f1dbf4a,0x3efc3f5f,0xbf7e3dfb,0x3e89bf77
.long 0xbf75be95,0x3e95bf75,0x3f753e95,0xbe953f75,0x3d973f7f,0xbf653ee6,0xbf42bf27,0x3ea1bf73,0x3f67bedb,0x3f713eac,0x3edb3f67,0xbeac3f71,0xbf39bf31,0xbecfbf6a,0xbcc9bf80,0x3eb8bf6f
.long 0x3f80,0x3f80,0x3f80,0x3f80,0xbeb8bf6f,0xbf31bf39,0xbf6abecf,0xbf80bcc9,0x3f2c3f3e,0x3f803d49,0x3f3ebf2c,0x3d49bf80,0xbf65bee6,0xbf423f27,0x3ea13f73,0x3f7f3d97
.long 0x3f7f3dc9,0x3dc9bf7f,0xbf7fbdc9,0xbdc93f7f,0xbf773e89,0x3f1d3f4a,0x3efcbf5f,0xbf7ebdfb,0x3f4ebf18,0xbf7dbe16,0x3f183f4e,0x3e16bf7d,0xbf093f58,0x3f51bf13,0xbf7a3e60,0x3f7c3e2f
.long 0x3e48bf7b,0xbe483f7b,0x3e48bf7b,0xbe483f7b,0x3e2f3f7c,0xbf09bf58,0x3f513f13,0xbf7abe60,0xbf04bf5c,0x3f783e79,0xbf5c3f04,0x3e79bf78,0x3f4a3f1d,0xbf5f3efc,0xbdfbbf7e,0x3f773e89
.long 0xbf75be95,0x3e95bf75,0x3f753e95,0xbe953f75,0x3f7fbd97,0x3ee63f65,0xbf273f42,0xbf73bea1,0xbf673edb,0xbf71beac,0xbedbbf67,0x3eacbf71,0x3f31bf39,0x3f6abecf,0x3f80bcc9,0x3f6f3eb8
.long 0x3f80,0x3f80,0x3f80,0x3f80,0xbf6f3eb8,0xbf393f31,0xbecf3f6a,0xbcc93f80,0xbf2cbf3e,0xbf80bd49,0xbf3e3f2c,0xbd493f80,0x3ee6bf65,0xbf27bf42,0xbf733ea1,0xbd973f7f
.long 0x3f7f3dc9,0x3dc9bf7f,0xbf7fbdc9,0xbdc93f7f,0x3e893f77,0x3f4abf1d,0xbf5fbefc,0xbdfb3f7e,0xbf4e3f18,0x3f7d3e16,0xbf18bf4e,0xbe163f7d,0xbf58bf09,0x3f133f51,0xbe60bf7a,0xbe2f3f7c
.long 0x3e48bf7b,0xbe483f7b,0x3e48bf7b,0xbe483f7b,0x3f7cbe2f,0xbf583f09,0x3f13bf51,0xbe603f7a,0x3f043f5c,0xbf78be79,0x3f5cbf04,0xbe793f78,0xbf1d3f4a,0xbefcbf5f,0x3f7ebdfb,0xbe893f77
.long 0xbf75be95,0x3e95bf75,0x3f753e95,0xbe953f75,0xbd97bf7f,0x3f65bee6,0x3f423f27,0xbea13f73,0x3f67bedb,0x3f713eac,0x3edb3f67,0xbeac3f71,0x3f393f31,0x3ecf3f6a,0x3cc93f80,0xbeb83f6f
.long 0x3f808000,0x3f808000,0x3f808000,0x3f808000,0x3f6fbeb8,0x3f39bf31,0x3ecfbf6a,0x3cc9bf80,0x3f3ebf2c,0x3d49bf80,0xbf2cbf3e,0xbf80bd49,0x3ee6bf65,0xbf27bf42,0xbf733ea1,0xbd973f7f
.long 0x3dc9bf7f,0xbf7fbdc9,0xbdc93f7f,0x3f7f3dc9,0xbe89bf77,0xbf4a3f1d,0x3f5f3efc,0x3dfbbf7e,0xbf18bf4e,0xbe163f7d,0x3f4ebf18,0xbf7dbe16,0xbf58bf09,0x3f133f51,0xbe60bf7a,0xbe2f3f7c
.long 0xbf7bbe48,0x3f7b3e48,0xbf7bbe48,0x3f7b3e48,0xbf7c3e2f,0x3f58bf09,0xbf133f51,0x3e60bf7a,0xbf5c3f04,0x3e79bf78,0x3f043f5c,0xbf78be79,0xbf1d3f4a,0xbefcbf5f,0x3f7ebdfb,0xbe893f77
.long 0xbe953f75,0xbf75be95,0x3e95bf75,0x3f753e95,0x3d973f7f,0xbf653ee6,0xbf42bf27,0x3ea1bf73,0x3edb3f67,0xbeac3f71,0xbf673edb,0xbf71beac,0x3f393f31,0x3ecf3f6a,0x3cc93f80,0xbeb83f6f
.long 0x3f808000,0x3f808000,0x3f808000,0x3f808000,0xbeb8bf6f,0xbf31bf39,0xbf6abecf,0xbf80bcc9,0xbf3e3f2c,0xbd493f80,0x3f2c3f3e,0x3f803d49,0x3f653ee6,0x3f42bf27,0xbea1bf73,0xbf7fbd97
.long 0x3dc9bf7f,0xbf7fbdc9,0xbdc93f7f,0x3f7f3dc9,0xbf773e89,0x3f1d3f4a,0x3efcbf5f,0xbf7ebdfb,0x3f183f4e,0x3e16bf7d,0xbf4e3f18,0x3f7d3e16,0x3f09bf58,0xbf513f13,0x3f7abe60,0xbf7cbe2f
.long 0xbf7bbe48,0x3f7b3e48,0xbf7bbe48,0x3f7b3e48,0x3e2f3f7c,0xbf09bf58,0x3f513f13,0xbf7abe60,0x3f5cbf04,0xbe793f78,0xbf04bf5c,0x3f783e79,0xbf4abf1d,0x3f5fbefc,0x3dfb3f7e,0xbf77be89
.long 0xbe953f75,0xbf75be95,0x3e95bf75,0x3f753e95,0x3f7fbd97,0x3ee63f65,0xbf273f42,0xbf73bea1,0xbedbbf67,0x3eacbf71,0x3f67bedb,0x3f713eac,0xbf313f39,0xbf6a3ecf,0xbf803cc9,0xbf6fbeb8
.long 0x3f808000,0x3f808000,0x3f808000,0x3f808000,0xbf6f3eb8,0xbf393f31,0xbecf3f6a,0xbcc93f80,0x3f3ebf2c,0x3d49bf80,0xbf2cbf3e,0xbf80bd49,0xbee63f65,0x3f273f42,0x3f73bea1,0x3d97bf7f
.long 0x3dc9bf7f,0xbf7fbdc9,0xbdc93f7f,0x3f7f3dc9,0x3e893f77,0x3f4abf1d,0xbf5fbefc,0xbdfb3f7e,0xbf18bf4e,0xbe163f7d,0x3f4ebf18,0xbf7dbe16,0x3f583f09,0xbf13bf51,0x3e603f7a,0x3e2fbf7c
.long 0xbf7bbe48,0x3f7b3e48,0xbf7bbe48,0x3f7b3e48,0x3f7cbe2f,0xbf583f09,0x3f13bf51,0xbe603f7a,0xbf5c3f04,0x3e79bf78,0x3f043f5c,0xbf78be79,0x3f1dbf4a,0x3efc3f5f,0xbf7e3dfb,0x3e89bf77
.long 0xbe953f75,0xbf75be95,0x3e95bf75,0x3f753e95,0xbd97bf7f,0x3f65bee6,0x3f423f27,0xbea13f73,0x3edb3f67,0xbeac3f71,0xbf673edb,0xbf71beac,0xbf39bf31,0xbecfbf6a,0xbcc9bf80,0x3eb8bf6f
.long 0x3f808000,0x3f808000,0x3f808000,0x3f808000,0x3eb83f6f,0x3f313f39,0x3f6a3ecf,0x3f803cc9,0xbf3e3f2c,0xbd493f80,0x3f2c3f3e,0x3f803d49,0xbf65bee6,0xbf423f27,0x3ea13f73,0x3f7f3d97
.long 0x3dc9bf7f,0xbf7fbdc9,0xbdc93f7f,0x3f7f3dc9,0x3f77be89,0xbf1dbf4a,0xbefc3f5f,0x3f7e3dfb,0x3f183f4e,0x3e16bf7d,0xbf4e3f18,0x3f7d3e16,0xbf093f58,0x3f51bf13,0xbf7a3e60,0x3f7c3e2f
.long 0xbf7bbe48,0x3f7b3e48,0xbf7bbe48,0x3f7b3e48,0xbe2fbf7c,0x3f093f58,0xbf51bf13,0x3f7a3e60,0x3f5cbf04,0xbe793f78,0xbf04bf5c,0x3f783e79,0x3f4a3f1d,0xbf5f3efc,0xbdfbbf7e,0x3f773e89
.long 0xbe953f75,0xbf75be95,0x3e95bf75,0x3f753e95,0xbf7f3d97,0xbee6bf65,0x3f27bf42,0x3f733ea1,0xbedbbf67,0x3eacbf71,0x3f67bedb,0x3f713eac,0x3f31bf39,0x3f6abecf,0x3f80bcc9,0x3f6f3eb8
.long 0x3f80,0x3f80,0x3f80,0x3f80,0x3f80,0x3ec43f6d,0x3f353f35,0x3f6d3ec4,0x3f80,0x3f353f35,0x3f800000,0x3f35bf35,0x3f80,0x3f6d3ec4,0x3f35bf35,0xbec4bf6d
.long 0x3f80,0x3f800000,0xbf80,0xbf800000,0x3f80,0x3f6dbec4,0xbf35bf35,0xbec43f6d,0x3f80,0x3f35bf35,0xbf800000,0x3f353f35,0x3f80,0x3ec4bf6d,0xbf353f35,0x3f6dbec4
.long 0x3f80,0xbf80,0x3f80,0xbf80,0x3f80,0xbec4bf6d,0x3f353f35,0xbf6dbec4,0x3f80,0xbf35bf35,0x3f800000,0xbf353f35,0x3f80,0xbf6dbec4,0x3f35bf35,0x3ec43f6d
.long 0x3f80,0xbf800000,0xbf80,0x3f800000,0x3f80,0xbf6d3ec4,0xbf35bf35,0x3ec4bf6d,0x3f80,0xbf353f35,0xbf800000,0xbf35bf35,0x3f80,0xbec43f6d,0xbf353f35,0xbf6d3ec4
.long 0x3f80,0x3f80,0x3f80,0x3f80,0x3f800000,0x3f6dbec4,0x3f35bf35,0x3ec4bf6d,0xbf80,0xbf35bf35,0xbf800000,0xbf353f35,0xbf800000,0xbec43f6d,0x3f353f35,0x3f6dbec4
.long 0x3f80,0x3f800000,0xbf80,0xbf800000,0x3f800000,0xbec4bf6d,0xbf353f35,0x3f6d3ec4,0xbf80,0xbf353f35,0x3f800000,0xbf35bf35,0xbf800000,0x3f6d3ec4,0xbf35bf35,0x3ec43f6d
.long 0x3f80,0xbf80,0x3f80,0xbf80,0x3f800000,0xbf6d3ec4,0x3f35bf35,0xbec43f6d,0xbf80,0x3f353f35,0xbf800000,0x3f35bf35,0xbf800000,0x3ec4bf6d,0x3f353f35,0xbf6d3ec4
.long 0x3f80,0xbf800000,0xbf80,0x3f800000,0x3f800000,0x3ec43f6d,0xbf353f35,0xbf6dbec4,0xbf80,0x3f35bf35,0x3f800000,0x3f353f35,0xbf800000,0xbf6dbec4,0xbf35bf35,0xbec4bf6d
.long 0x3f80,0x3f80,0x3f80,0x3f80,0xbf80,0xbec4bf6d,0xbf35bf35,0xbf6dbec4,0x3f80,0x3f353f35,0x3f800000,0x3f35bf35,0xbf80,0xbf6dbec4,0xbf353f35,0x3ec43f6d
.long 0x3f80,0x3f800000,0xbf80,0xbf800000,0xbf80,0xbf6d3ec4,0x3f353f35,0x3ec4bf6d,0x3f80,0x3f35bf35,0xbf800000,0x3f353f35,0xbf80,0xbec43f6d,0x3f35bf35,0xbf6d3ec4
.long 0x3f80,0xbf80,0x3f80,0xbf80,0xbf80,0x3ec43f6d,0xbf35bf35,0x3f6d3ec4,0x3f80,0xbf35bf35,0x3f800000,0xbf353f35,0xbf80,0x3f6d3ec4,0xbf353f35,0xbec4bf6d
.long 0x3f80,0xbf800000,0xbf80,0x3f800000,0xbf80,0x3f6dbec4,0x3f353f35,0xbec43f6d,0x3f80,0xbf353f35,0xbf800000,0xbf35bf35,0xbf80,0x3ec4bf6d,0x3f35bf35,0x3f6dbec4
.long 0x3f80,0x3f80,0x3f80,0x3f80,0xbf800000,0xbf6d3ec4,0xbf353f35,0xbec43f6d,0xbf80,0xbf35bf35,0xbf800000,0xbf353f35,0x3f800000,0x3ec4bf6d,0xbf35bf35,0xbf6d3ec4
.long 0x3f80,0x3f800000,0xbf80,0xbf800000,0xbf800000,0x3ec43f6d,0x3f35bf35,0xbf6dbec4,0xbf80,0xbf353f35,0x3f800000,0xbf35bf35,0x3f800000,0xbf6dbec4,0x3f353f35,0xbec4bf6d
.long 0x3f80,0xbf80,0x3f80,0xbf80,0xbf800000,0x3f6dbec4,0xbf353f35,0x3ec4bf6d,0xbf80,0x3f353f35,0xbf800000,0x3f35bf35,0x3f800000,0xbec43f6d,0xbf35bf35,0x3f6dbec4
.long 0x3f80,0xbf800000,0xbf80,0x3f800000,0xbf800000,0xbec4bf6d,0x3f35bf35,0x3f6d3ec4,0xbf80,0x3f35bf35,0x3f800000,0x3f353f35,0x3f800000,0x3f6d3ec4,0x3f353f35,0x3ec43f6d
.long 0x3f808000,0x3f808000,0x3f808000,0x3f808000,0x3f808000,0x3f6dbec4,0x3f35bf35,0x3ec4bf6d,0x3f808000,0x3f35bf35,0xbf80,0xbf35bf35,0x3f808000,0x3ec4bf6d,0xbf35bf35,0xbf6d3ec4
.long 0x3f808000,0xbf80,0xbf808000,0x3f80,0x3f808000,0xbec4bf6d,0xbf353f35,0x3f6d3ec4,0x3f808000,0xbf35bf35,0x3f80,0x3f35bf35,0x3f808000,0xbf6dbec4,0x3f353f35,0xbec4bf6d
.long 0x3f808000,0xbf808000,0x3f808000,0xbf808000,0x3f808000,0xbf6d3ec4,0x3f35bf35,0xbec43f6d,0x3f808000,0xbf353f35,0xbf80,0x3f353f35,0x3f808000,0xbec43f6d,0xbf35bf35,0x3f6dbec4
.long 0x3f808000,0x3f80,0xbf808000,0xbf80,0x3f808000,0x3ec43f6d,0xbf353f35,0xbf6dbec4,0x3f808000,0x3f353f35,0x3f80,0xbf353f35,0x3f808000,0x3f6d3ec4,0x3f353f35,0x3ec43f6d
.long 0x3f808000,0x3f808000,0x3f808000,0x3f808000,0xbf80,0xbec4bf6d,0xbf35bf35,0xbf6dbec4,0xbf808000,0xbf353f35,0x3f80,0x3f353f35,0x3f80,0x3f6d3ec4,0x3f35bf35,0xbec4bf6d
.long 0x3f808000,0xbf80,0xbf808000,0x3f80,0xbf80,0xbf6d3ec4,0x3f353f35,0x3ec4bf6d,0xbf808000,0x3f353f35,0xbf80,0xbf353f35,0x3f80,0x3ec4bf6d,0xbf353f35,0x3f6dbec4
.long 0x3f808000,0xbf808000,0x3f808000,0xbf808000,0xbf80,0x3ec43f6d,0xbf35bf35,0x3f6d3ec4,0xbf808000,0x3f35bf35,0x3f80,0xbf35bf35,0x3f80,0xbf6dbec4,0x3f35bf35,0x3ec43f6d
.long 0x3f808000,0x3f80,0xbf808000,0xbf80,0xbf80,0x3f6dbec4,0x3f353f35,0xbec43f6d,0xbf808000,0xbf35bf35,0xbf80,0x3f35bf35,0x3f80,0xbec43f6d,0xbf353f35,0xbf6d3ec4
.long 0x3f808000,0x3f808000,0x3f808000,0x3f808000,0xbf808000,0xbf6d3ec4,0xbf353f35,0xbec43f6d,0x3f808000,0x3f35bf35,0xbf80,0xbf35bf35,0xbf808000,0xbec43f6d,0x3f353f35,0x3f6dbec4
.long 0x3f808000,0xbf80,0xbf808000,0x3f80,0xbf808000,0x3ec43f6d,0x3f35bf35,0xbf6dbec4,0x3f808000,0xbf35bf35,0x3f80,0x3f35bf35,0xbf808000,0x3f6d3ec4,0xbf35bf35,0x3ec43f6d
.long 0x3f808000,0xbf808000,0x3f808000,0xbf808000,0xbf808000,0x3f6dbec4,0xbf353f35,0x3ec4bf6d,0x3f808000,0xbf353f35,0xbf80,0x3f353f35,0xbf808000,0x3ec4bf6d,0x3f353f35,0xbf6d3ec4
.long 0x3f808000,0x3f80,0xbf808000,0xbf80,0xbf808000,0xbec4bf6d,0x3f35bf35,0x3f6d3ec4,0x3f808000,0x3f353f35,0x3f80,0xbf353f35,0xbf808000,0xbf6dbec4,0xbf35bf35,0xbec4bf6d
.long 0x3f808000,0x3f808000,0x3f808000,0x3f808000,0x3f80,0x3ec43f6d,0x3f353f35,0x3f6d3ec4,0xbf808000,0xbf353f35,0x3f80,0x3f353f35,0xbf80,0xbf6dbec4,0xbf353f35,0x3ec43f6d
.long 0x3f808000,0xbf80,0xbf808000,0x3f80,0x3f80,0x3f6dbec4,0xbf35bf35,0xbec43f6d,0xbf808000,0x3f353f35,0xbf80,0xbf353f35,0xbf80,0xbec43f6d,0x3f35bf35,0xbf6d3ec4
.long 0x3f808000,0xbf808000,0x3f808000,0xbf808000,0x3f80,0xbec4bf6d,0x3f353f35,0xbf6dbec4,0xbf808000,0x3f35bf35,0x3f80,0xbf35bf35,0xbf80,0x3f6d3ec4,0xbf353f35,0xbec4bf6d
.long 0x3f808000,0x3f80,0xbf808000,0xbf80,0x3f80,0xbf6d3ec4,0xbf35bf35,0x3ec4bf6d,0xbf808000,0xbf35bf35,0xbf80,0x3f35bf35,0xbf80,0x3ec4bf6d,0x3f35bf35,0x3f6dbec4
.long 0x80003f80,0x80003f80,0x80003f80,0x80003f80,0x80003f80,0xbec43f6d,0xbf353f35,0xbf6d3ec4,0x80003f80,0xbf353f35,0xbf800000,0xbf35bf35,0x80003f80,0xbf6d3ec4,0xbf35bf35,0x3ec4bf6d
.long 0x80003f80,0xbf800000,0x8000bf80,0x3f800000,0x80003f80,0xbf6dbec4,0x3f35bf35,0x3ec43f6d,0x80003f80,0xbf35bf35,0x3f800000,0xbf353f35,0x80003f80,0xbec4bf6d,0x3f353f35,0xbf6dbec4
.long 0x80003f80,0x8000bf80,0x80003f80,0x8000bf80,0x80003f80,0x3ec4bf6d,0xbf353f35,0x3f6dbec4,0x80003f80,0x3f35bf35,0xbf800000,0x3f353f35,0x80003f80,0x3f6dbec4,0xbf35bf35,0xbec43f6d
.long 0x80003f80,0x3f800000,0x8000bf80,0xbf800000,0x80003f80,0x3f6d3ec4,0x3f35bf35,0xbec4bf6d,0x80003f80,0x3f353f35,0x3f800000,0x3f35bf35,0x80003f80,0x3ec43f6d,0x3f353f35,0x3f6d3ec4
.long 0x80003f80,0x80003f80,0x80003f80,0x80003f80,0xbf800000,0xbf6dbec4,0xbf35bf35,0xbec4bf6d,0x8000bf80,0x3f35bf35,0x3f800000,0x3f353f35,0x3f800000,0x3ec43f6d,0xbf353f35,0xbf6dbec4
.long 0x80003f80,0xbf800000,0x8000bf80,0x3f800000,0xbf800000,0x3ec4bf6d,0x3f353f35,0xbf6d3ec4,0x8000bf80,0x3f353f35,0xbf800000,0x3f35bf35,0x3f800000,0xbf6d3ec4,0x3f35bf35,0xbec43f6d
.long 0x80003f80,0x8000bf80,0x80003f80,0x8000bf80,0xbf800000,0x3f6d3ec4,0xbf35bf35,0x3ec43f6d,0x8000bf80,0xbf353f35,0x3f800000,0xbf35bf35,0x3f800000,0xbec4bf6d,0xbf353f35,0x3f6d3ec4
.long 0x80003f80,0x3f800000,0x8000bf80,0xbf800000,0xbf800000,0xbec43f6d,0x3f353f35,0x3f6dbec4,0x8000bf80,0xbf35bf35,0xbf800000,0xbf353f35,0x3f800000,0x3f6dbec4,0x3f35bf35,0x3ec4bf6d
.long 0x3f80,0x3f80,0x3f80,0x3f80,0xbf80,0xbec4bf6d,0xbf35bf35,0xbf6dbec4,0x3f80,0x3f353f35,0x3f800000,0x3f35bf35,0xbf80,0xbf6dbec4,0xbf353f35,0x3ec43f6d
.long 0x3f80,0x3f800000,0xbf80,0xbf800000,0xbf80,0xbf6d3ec4,0x3f353f35,0x3ec4bf6d,0x3f80,0x3f35bf35,0xbf800000,0x3f353f35,0xbf80,0xbec43f6d,0x3f35bf35,0xbf6d3ec4
.long 0x3f80,0xbf80,0x3f80,0xbf80,0xbf80,0x3ec43f6d,0xbf35bf35,0x3f6d3ec4,0x3f80,0xbf35bf35,0x3f800000,0xbf353f35,0xbf80,0x3f6d3ec4,0xbf353f35,0xbec4bf6d
.long 0x3f80,0xbf800000,0xbf80,0x3f800000,0xbf80,0x3f6dbec4,0x3f353f35,0xbec43f6d,0x3f80,0xbf353f35,0xbf800000,0xbf35bf35,0xbf80,0x3ec4bf6d,0x3f35bf35,0x3f6dbec4
.long 0x3f80,0x3f80,0x3f80,0x3f80,0xbf800000,0xbf6d3ec4,0xbf353f35,0xbec43f6d,0xbf80,0xbf35bf35,0xbf800000,0xbf353f35,0x3f800000,0x3ec4bf6d,0xbf35bf35,0xbf6d3ec4
.long 0x3f80,0x3f800000,0xbf80,0xbf800000,0xbf800000,0x3ec43f6d,0x3f35bf35,0xbf6dbec4,0xbf80,0xbf353f35,0x3f800000,0xbf35bf35,0x3f800000,0xbf6dbec4,0x3f353f35,0xbec4bf6d
.long 0x3f80,0xbf80,0x3f80,0xbf80,0xbf800000,0x3f6dbec4,0xbf353f35,0x3ec4bf6d,0xbf80,0x3f353f35,0xbf800000,0x3f35bf35,0x3f800000,0xbec43f6d,0xbf35bf35,0x3f6dbec4
.long 0x3f80,0xbf800000,0xbf80,0x3f800000,0xbf800000,0xbec4bf6d,0x3f35bf35,0x3f6d3ec4,0xbf80,0x3f35bf35,0x3f800000,0x3f353f35,0x3f800000,0x3f6d3ec4,0x3f353f35,0x3ec43f6d
.long 0x3f800000,0x3f800000,0x3f800000,0x3f800000,0x3f800000,0x3f6d3ec4,0x3f353f35,0x3ec43f6d,0x3f800000,0x3f353f35,0x3f80,0xbf353f35,0x3f800000,0x3ec43f6d,0xbf353f35,0xbf6dbec4
.long 0x3f800000,0x3f80,0xbf800000,0xbf80,0x3f800000,0xbec43f6d,0xbf35bf35,0x3f6dbec4,0x3f800000,0xbf353f35,0xbf80,0x3f353f35,0x3f800000,0xbf6d3ec4,0x3f35bf35,0xbec43f6d
.long 0x3f800000,0xbf800000,0x3f800000,0xbf800000,0x3f800000,0xbf6dbec4,0x3f353f35,0xbec4bf6d,0x3f800000,0xbf35bf35,0x3f80,0x3f35bf35,0x3f800000,0xbec4bf6d,0xbf353f35,0x3f6d3ec4
.long 0x3f800000,0xbf80,0xbf800000,0x3f80,0x3f800000,0x3ec4bf6d,0xbf35bf35,0xbf6d3ec4,0x3f800000,0x3f35bf35,0xbf80,0xbf35bf35,0x3f800000,0x3f6dbec4,0x3f35bf35,0x3ec4bf6d
.long 0x3f800000,0x3f800000,0x3f800000,0x3f800000,0x3f80,0xbec43f6d,0xbf353f35,0xbf6d3ec4,0xbf800000,0xbf35bf35,0xbf80,0x3f35bf35,0xbf80,0x3f6dbec4,0x3f353f35,0xbec43f6d
.long 0x3f800000,0x3f80,0xbf800000,0xbf80,0x3f80,0xbf6dbec4,0x3f35bf35,0x3ec43f6d,0xbf800000,0x3f35bf35,0x3f80,0xbf35bf35,0xbf80,0x3ec43f6d,0xbf35bf35,0x3f6d3ec4
.long 0x3f800000,0xbf800000,0x3f800000,0xbf800000,0x3f80,0x3ec4bf6d,0xbf353f35,0x3f6dbec4,0xbf800000,0x3f353f35,0xbf80,0xbf353f35,0xbf80,0xbf6d3ec4,0x3f353f35,0x3ec4bf6d
.long 0x3f800000,0xbf80,0xbf800000,0x3f80,0x3f80,0x3f6d3ec4,0x3f35bf35,0xbec4bf6d,0xbf800000,0xbf353f35,0x3f80,0x3f353f35,0xbf80,0xbec4bf6d,0xbf35bf35,0xbf6dbec4
.long 0xbf800000,0xbf800000,0xbf800000,0xbf800000,0x3f800000,0x3f6dbec4,0x3f35bf35,0x3ec4bf6d,0xbf800000,0xbf353f35,0x80003f80,0x3f353f35,0x3f800000,0x3ec4bf6d,0xbf35bf35,0xbf6d3ec4
.long 0xbf800000,0x80003f80,0x3f800000,0x8000bf80,0x3f800000,0xbec4bf6d,0xbf353f35,0x3f6d3ec4,0xbf800000,0x3f353f35,0x8000bf80,0xbf353f35,0x3f800000,0xbf6dbec4,0x3f353f35,0xbec4bf6d
.long 0xbf800000,0x3f800000,0xbf800000,0x3f800000,0x3f800000,0xbf6d3ec4,0x3f35bf35,0xbec43f6d,0xbf800000,0x3f35bf35,0x80003f80,0xbf35bf35,0x3f800000,0xbec43f6d,0xbf35bf35,0x3f6dbec4
.long 0xbf800000,0x8000bf80,0x3f800000,0x80003f80,0x3f800000,0x3ec43f6d,0xbf353f35,0xbf6dbec4,0xbf800000,0xbf35bf35,0x8000bf80,0x3f35bf35,0x3f800000,0x3f6d3ec4,0x3f353f35,0x3ec43f6d
.long 0xbf800000,0xbf800000,0xbf800000,0xbf800000,0x8000bf80,0xbec4bf6d,0xbf35bf35,0xbf6dbec4,0x3f800000,0x3f35bf35,0x8000bf80,0xbf35bf35,0x80003f80,0x3f6d3ec4,0x3f35bf35,0xbec4bf6d
.long 0xbf800000,0x80003f80,0x3f800000,0x8000bf80,0x8000bf80,0xbf6d3ec4,0x3f353f35,0x3ec4bf6d,0x3f800000,0xbf35bf35,0x80003f80,0x3f35bf35,0x80003f80,0x3ec4bf6d,0xbf353f35,0x3f6dbec4
.long 0xbf800000,0x3f800000,0xbf800000,0x3f800000,0x8000bf80,0x3ec43f6d,0xbf35bf35,0x3f6d3ec4,0x3f800000,0xbf353f35,0x8000bf80,0x3f353f35,0x80003f80,0xbf6dbec4,0x3f35bf35,0x3ec43f6d
.long 0xbf800000,0x8000bf80,0x3f800000,0x80003f80,0x8000bf80,0x3f6dbec4,0x3f353f35,0xbec43f6d,0x3f800000,0x3f353f35,0x80003f80,0xbf353f35,0x80003f80,0xbec43f6d,0xbf353f35,0xbf6d3ec4
.long 0x3f80,0x80004000,0x80004000,0x80004000,0xbf80,0xbf443fed,0xbfb53fb5,0xbfed3f44,0x3f80,0xbfb53fb5,0xc0000000,0xbfb5bfb5,0xbf80,0xbfed3f44,0xbfb5bfb5,0x3f44bfed
.long 0x3f80,0xc0000000,0x8000c000,0x40000000,0xbf80,0xbfedbf44,0x3fb5bfb5,0x3f443fed,0x3f80,0xbfb5bfb5,0x40000000,0xbfb53fb5,0xbf80,0xbf44bfed,0x3fb53fb5,0xbfedbf44
.long 0x3f80,0x8000c000,0x80004000,0x8000c000,0xbf80,0x3f44bfed,0xbfb53fb5,0x3fedbf44,0x3f80,0x3fb5bfb5,0xc0000000,0x3fb53fb5,0xbf80,0x3fedbf44,0xbfb5bfb5,0xbf443fed
.long 0x3f80,0x40000000,0x8000c000,0xc0000000,0xbf80,0x3fed3f44,0x3fb5bfb5,0xbf44bfed,0x3f80,0x3fb53fb5,0x40000000,0x3fb5bfb5,0xbf80,0x3f443fed,0x3fb53fb5,0x3fed3f44
.long 0x80004000,0x80004000,0x80004000,0x80004000,0xc0000000,0xbfedbf44,0xbfb5bfb5,0xbf44bfed,0x8000c000,0x3fb5bfb5,0x40000000,0x3fb53fb5,0x40000000,0x3f443fed,0xbfb53fb5,0xbfedbf44
.long 0x80004000,0xc0000000,0x8000c000,0x40000000,0xc0000000,0x3f44bfed,0x3fb53fb5,0xbfed3f44,0x8000c000,0x3fb53fb5,0xc0000000,0x3fb5bfb5,0x40000000,0xbfed3f44,0x3fb5bfb5,0xbf443fed
.long 0x80004000,0x8000c000,0x80004000,0x8000c000,0xc0000000,0x3fed3f44,0xbfb5bfb5,0x3f443fed,0x8000c000,0xbfb53fb5,0x40000000,0xbfb5bfb5,0x40000000,0xbf44bfed,0xbfb53fb5,0x3fed3f44
.long 0x80004000,0x40000000,0x8000c000,0xc0000000,0xc0000000,0xbf443fed,0x3fb53fb5,0x3fedbf44,0x8000c000,0xbfb5bfb5,0xc0000000,0xbfb53fb5,0x40000000,0x3fedbf44,0x3fb5bfb5,0x3f44bfed
.long 0x0,0x0,0x0,0x0,0x0,0x0,0x0,0x0,0x0,0x0,0x0,0x0,0x0,0x0,0x0,0x0
.long 0x0,0x0,0x0,0x0,0x0,0x0,0x0,0x0,0x0,0x0,0x0,0x0,0x0,0x0,0x0,0x0
.long 0x0,0x0,0x0,0x0,0x0,0x0,0x0,0x0,0x0,0x0,0x0,0x0,0x0,0x0,0x0,0x0
.long 0x0,0x0,0x0,0x0,0x0,0x0,0x0,0x0,0x0,0x0,0x0,0x0,0x0,0x0,0x0,0x0
.long 0x0,0x0,0x0,0x0,0x0,0x0,0x0,0x0,0x0,0x0,0x0,0x0,0x0,0x0,0x0,0x0
.long 0x0,0x0,0x0,0x0,0x0,0x0,0x0,0x0,0x0,0x0,0x0,0x0,0x0,0x0,0x0,0x0
.long 0x0,0x0,0x0,0x0,0x0,0x0,0x0,0x0,0x0,0x0,0x0,0x0,0x0,0x0,0x0,0x0
.long 0x0,0x0,0x0,0x0,0x0,0x0,0x0,0x0,0x0,0x0,0x0,0x0,0x0,0x0,0x0,0x0
.long 0x0,0x0,0x0,0x0,0x0,0x0,0x0,0x0,0x0,0x0,0x0,0x0,0x0,0x0,0x0,0x0
.long 0x0,0x0,0x0,0x0,0x0,0x0,0x0,0x0,0x0,0x0,0x0,0x0,0x0,0x0,0x0,0x0
.long 0x0,0x0,0x0,0x0,0x0,0x0,0x0,0x0,0x0,0x0,0x0,0x0,0x0,0x0,0x0,0x0
.long 0x0,0x0,0x0,0x0,0x0,0x0,0x0,0x0,0x0,0x0,0x0,0x0,0x0,0x0,0x0,0x0
.long 0x0,0x0,0x0,0x0,0x0,0x0,0x0,0x0,0x0,0x0,0x0,0x0,0x0,0x0,0x0,0x0
.long 0x0,0x0,0x0,0x0,0x0,0x0,0x0,0x0,0x0,0x0,0x0,0x0,0x0,0x0,0x0,0x0
.long 0x0,0x0,0x0,0x0,0x0,0x0,0x0,0x0,0x0,0x0,0x0,0x0,0x0,0x0,0x0,0x0
.long 0x0,0x0,0x0,0x0,0x0,0x0,0x0,0x0,0x0,0x0,0x0,0x0,0x0,0x0,0x0,0x0
.long 0x80004000,0x80004000,0x80004000,0x80004000,0xbec8bffb,0xbf8ebfd5,0xbfd5bf8e,0xbffbbec8,0x3f443fed,0x3fed3f44,0x3fedbf44,0x3f44bfed,0xbf8ebfd5,0xbffb3ec8,0xbec83ffb,0x3fd53f8e
.long 0x3fb53fb5,0x3fb5bfb5,0xbfb5bfb5,0xbfb53fb5,0xbfd5bf8e,0xbec83ffb,0x3ffbbec8,0xbf8ebfd5,0x3fed3f44,0xbf44bfed,0xbf443fed,0x3fedbf44,0xbffbbec8,0x3fd53f8e,0xbf8ebfd5,0x3ec83ffb
.long 0x40000000,0xc0000000,0x40000000,0xc0000000,0xbffb3ec8,0x3fd5bf8e,0xbf8e3fd5,0x3ec8bffb,0x3fedbf44,0xbf443fed,0xbf44bfed,0x3fed3f44,0xbfd53f8e,0xbec8bffb,0x3ffb3ec8,0xbf8e3fd5
.long 0x3fb5bfb5,0x3fb53fb5,0xbfb53fb5,0xbfb5bfb5,0xbf8e3fd5,0xbffbbec8,0xbec8bffb,0x3fd5bf8e,0x3f44bfed,0x3fedbf44,0x3fed3f44,0x3f443fed,0xbec83ffb,0xbf8e3fd5,0xbfd53f8e,0xbffb3ec8
.long 0x80004000,0x80004000,0x80004000,0x80004000,0xbffb3ec8,0xbfd53f8e,0xbf8e3fd5,0xbec83ffb,0xbf44bfed,0xbfedbf44,0xbfed3f44,0xbf443fed,0x3fd5bf8e,0xbec8bffb,0xbffbbec8,0xbf8e3fd5
.long 0x3fb53fb5,0x3fb5bfb5,0xbfb5bfb5,0xbfb53fb5,0xbf8e3fd5,0x3ffb3ec8,0xbec8bffb,0xbfd53f8e,0xbfedbf44,0x3f443fed,0x3f44bfed,0xbfed3f44,0x3ec8bffb,0xbf8e3fd5,0x3fd5bf8e,0xbffb3ec8
.long 0x40000000,0xc0000000,0x40000000,0xc0000000,0x3ec83ffb,0xbf8ebfd5,0x3fd53f8e,0xbffbbec8,0xbfed3f44,0x3f44bfed,0x3f443fed,0xbfedbf44,0xbf8ebfd5,0x3ffbbec8,0xbec83ffb,0xbfd5bf8e
.long 0x3fb5bfb5,0x3fb53fb5,0xbfb53fb5,0xbfb5bfb5,0x3fd53f8e,0xbec83ffb,0xbffb3ec8,0xbf8ebfd5,0xbf443fed,0xbfed3f44,0xbfedbf44,0xbf44bfed,0xbffbbec8,0xbfd5bf8e,0xbf8ebfd5,0xbec8bffb
.long 0x3f803f80,0x80004000,0x80004000,0x80004000,0xbf803f80,0xbe493fff,0xbec83ffb,0xbf153ff5,0x3f803f80,0xbec83ffb,0xbf443fed,0xbf8e3fd5,0xbf803f80,0xbf153ff5,0xbf8e3fd5,0xbfc63fa2
.long 0x3f803f80,0xbf443fed,0xbfb53fb5,0xbfed3f44,0xbf803f80,0xbf713fe2,0xbfd53f8e,0xbfff3e49,0x3f803f80,0xbf8e3fd5,0xbfed3f44,0xbffbbec8,0xbf803f80,0xbfa23fc6,0xbffb3ec8,0xbfe2bf71
.long 0x3f803f80,0xbfb53fb5,0xc0000000,0xbfb5bfb5,0xbf803f80,0xbfc63fa2,0xbffbbec8,0xbf71bfe2,0x3f803f80,0xbfd53f8e,0xbfedbf44,0xbec8bffb,0xbf803f80,0xbfe23f71,0xbfd5bf8e,0x3e49bfff
.long 0x3f803f80,0xbfed3f44,0xbfb5bfb5,0x3f44bfed,0xbf803f80,0xbff53f15,0xbf8ebfd5,0x3fa2bfc6,0x3f803f80,0xbffb3ec8,0xbf44bfed,0x3fd5bf8e,0xbf803f80,0xbfff3e49,0xbec8bffb,0x3ff5bf15
.long 0x80004000,0x80004000,0x80004000,0x80004000,0xbf443fed,0xbf713fe2,0xbf8e3fd5,0xbfa23fc6,0xbfb53fb5,0xbfd53f8e,0xbfed3f44,0xbffb3ec8,0xbfed3f44,0xbfff3e49,0xbffbbec8,0xbfe2bf71
.long 0xc0000000,0xbfedbf44,0xbfb5bfb5,0xbf44bfed,0xbfedbf44,0xbfa2bfc6,0xbec8bffb,0x3f15bff5,0xbfb5bfb5,0xbec8bffb,0x3f44bfed,0x3fd5bf8e,0xbf44bfed,0x3f15bff5,0x3fd5bf8e,0x3fff3e49
.long 0x8000c000,0x3fb5bfb5,0x40000000,0x3fb53fb5,0x3f44bfed,0x3ff5bf15,0x3fd53f8e,0x3e493fff,0x3fb5bfb5,0x3ffb3ec8,0x3f443fed,0xbf8e3fd5,0x3fedbf44,0x3fc63fa2,0xbec83ffb,0xbff53f15
.long 0x40000000,0x3f443fed,0xbfb53fb5,0xbfedbf44,0x3fed3f44,0xbe493fff,0xbffb3ec8,0xbf71bfe2,0x3fb53fb5,0xbf8e3fd5,0xbfedbf44,0x3ec8bffb,0x3f443fed,0xbfe23f71,0xbf8ebfd5,0x3fc6bfa2
.long 0x80004000,0x80004000,0x80004000,0x80004000,0xbfb53fb5,0xbfc63fa2,0xbfd53f8e,0xbfe23f71,0xc0000000,0xbffbbec8,0xbfedbf44,0xbfd5bf8e,0xbfb5bfb5,0xbf71bfe2,0xbec8bffb,0x3e49bfff
.long 0x8000c000,0x3f44bfed,0x3fb5bfb5,0x3fedbf44,0x3fb5bfb5,0x3ff5bf15,0x3ffb3ec8,0x3fc63fa2,0x40000000,0x3fd53f8e,0x3f443fed,0xbec83ffb,0x3fb53fb5,0x3e493fff,0xbf8e3fd5,0xbff53f15
.long 0x80004000,0xbfb53fb5,0xc0000000,0xbfb5bfb5,0xbfb53fb5,0xbfffbe49,0xbf8ebfd5,0x3f15bff5,0xc0000000,0xbf8ebfd5,0x3f44bfed,0x3ffbbec8,0xbfb5bfb5,0x3f15bff5,0x3ffbbec8,0x3fa23fc6
.long 0x8000c000,0x3fedbf44,0x3fb53fb5,0xbf443fed,0x3fb5bfb5,0x3fe23f71,0xbec83ffb,0xbfff3e49,0x40000000,0x3ec83ffb,0xbfed3f44,0xbf8ebfd5,0x3fb53fb5,0xbfa23fc6,0xbfd5bf8e,0x3f71bfe2
.long 0x80004000,0x80004000,0x80004000,0x80004000,0xbfed3f44,0xbff53f15,0xbffb3ec8,0xbfff3e49,0xbfb5bfb5,0xbf8ebfd5,0xbf44bfed,0xbec8bffb,0x3f44bfed,0x3fa2bfc6,0x3fd5bf8e,0x3ff5bf15
.long 0x40000000,0x3fed3f44,0x3fb53fb5,0x3f443fed,0x3f443fed,0xbe493fff,0xbf8e3fd5,0xbfe23f71,0xbfb53fb5,0xbffb3ec8,0xbfedbf44,0xbf8ebfd5,0xbfedbf44,0xbf71bfe2,0x3ec8bffb,0x3fc6bfa2
.long 0x8000c000,0x3fb5bfb5,0x40000000,0x3fb53fb5,0x3fedbf44,0x3fe23f71,0x3ec83ffb,0xbfa23fc6,0x3fb53fb5,0xbec83ffb,0xbfed3f44,0xbfd5bf8e,0xbf443fed,0xbfff3e49,0xbf8ebfd5,0x3f71bfe2
.long 0xc0000000,0xbf44bfed,0x3fb5bfb5,0x3fed3f44,0xbf44bfed,0x3fc6bfa2,0x3fd53f8e,0xbf153ff5,0x3fb5bfb5,0x3fd53f8e,0xbf443fed,0xbffbbec8,0x3fed3f44,0xbf153ff5,0xbffbbec8,0x3e49bfff
.long 0x80004000,0x80004000,0x80004000,0x80004000,0xc0000000,0xbfffbe49,0xbffbbec8,0xbff5bf15,0x8000c000,0x3ec8bffb,0x3f44bfed,0x3f8ebfd5,0x40000000,0x3ff53f15,0x3fd53f8e,0x3fa23fc6
.long 0x80004000,0xbf443fed,0xbfb53fb5,0xbfed3f44,0xc0000000,0xbfe2bf71,0xbf8ebfd5,0xbe49bfff,0x8000c000,0x3f8ebfd5,0x3fedbf44,0x3ffb3ec8,0x40000000,0x3fc63fa2,0x3ec83ffb,0xbf713fe2
.long 0x80004000,0xbfb53fb5,0xc0000000,0xbfb5bfb5,0xc0000000,0xbfa2bfc6,0x3ec8bffb,0x3fe2bf71,0x8000c000,0x3fd5bf8e,0x3fed3f44,0x3ec83ffb,0x40000000,0x3f713fe2,0xbf8e3fd5,0xbfffbe49
.long 0x80004000,0xbfed3f44,0xbfb5bfb5,0x3f44bfed,0xc0000000,0xbf15bff5,0x3fd5bf8e,0x3fc63fa2,0x8000c000,0x3ffbbec8,0x3f443fed,0xbfd53f8e,0x40000000,0x3e493fff,0xbffb3ec8,0xbf15bff5
.long 0x80004000,0x80004000,0x80004000,0x80004000,0xbfedbf44,0xbfe2bf71,0xbfd5bf8e,0xbfc6bfa2,0x3fb5bfb5,0x3fd5bf8e,0x3fedbf44,0x3ffbbec8,0x3f443fed,0x3e493fff,0xbec83ffb,0xbf713fe2
.long 0xc0000000,0xbfedbf44,0xbfb5bfb5,0xbf44bfed,0x3f44bfed,0x3fc6bfa2,0x3ffbbec8,0x3ff53f15,0x3fb53fb5,0x3ec83ffb,0xbf443fed,0xbfd53f8e,0xbfed3f44,0xbff5bf15,0xbf8ebfd5,0x3e49bfff
.long 0x8000c000,0x3fb5bfb5,0x40000000,0x3fb53fb5,0x3fed3f44,0x3f153ff5,0xbf8e3fd5,0xbfff3e49,0xbfb53fb5,0xbffbbec8,0xbf44bfed,0x3f8ebfd5,0xbf44bfed,0x3fa2bfc6,0x3ffb3ec8,0x3f153ff5
.long 0x40000000,0x3f443fed,0xbfb53fb5,0xbfedbf44,0xbf443fed,0xbfffbe49,0xbec8bffb,0x3fe2bf71,0xbfb5bfb5,0x3f8ebfd5,0x3fed3f44,0xbec83ffb,0x3fedbf44,0x3f713fe2,0xbfd53f8e,0xbfa2bfc6
.long 0x80004000,0x80004000,0x80004000,0x80004000,0xbfb5bfb5,0xbfa2bfc6,0xbf8ebfd5,0xbf71bfe2,0x40000000,0x3ffb3ec8,0x3fed3f44,0x3fd53f8e,0xbfb53fb5,0xbfe23f71,0xbffb3ec8,0xbfffbe49
.long 0x8000c000,0x3f44bfed,0x3fb5bfb5,0x3fedbf44,0x3fb53fb5,0x3f153ff5,0xbec83ffb,0xbfa23fc6,0xc0000000,0xbfd5bf8e,0xbf44bfed,0x3ec8bffb,0x3fb5bfb5,0x3fffbe49,0x3fd53f8e,0x3f153ff5
.long 0x80004000,0xbfb53fb5,0xc0000000,0xbfb5bfb5,0xbfb5bfb5,0x3e49bfff,0x3fd5bf8e,0x3ff53f15,0x40000000,0x3f8e3fd5,0xbf443fed,0xbffb3ec8,0xbfb53fb5,0xbff5bf15,0xbec8bffb,0x3fc6bfa2
.long 0x8000c000,0x3fedbf44,0x3fb53fb5,0xbf443fed,0x3fb53fb5,0xbf713fe2,0xbffbbec8,0xbe49bfff,0xc0000000,0xbec8bffb,0x3fedbf44,0x3f8e3fd5,0x3fb5bfb5,0x3fc63fa2,0xbf8e3fd5,0xbfe2bf71
.long 0x80004000,0x80004000,0x80004000,0x80004000,0xbf44bfed,0xbf15bff5,0xbec8bffb,0xbe49bfff,0x3fb53fb5,0x3f8e3fd5,0x3f443fed,0x3ec83ffb,0xbfedbf44,0xbfc6bfa2,0xbf8ebfd5,0xbf15bff5
.long 0x40000000,0x3fed3f44,0x3fb53fb5,0x3f443fed,0xbfed3f44,0xbfffbe49,0xbfd5bf8e,0xbf71bfe2,0x3fb5bfb5,0x3ffbbec8,0x3fed3f44,0x3f8e3fd5,0xbf443fed,0xbfe23f71,0xbffbbec8,0xbfa2bfc6
.long 0x8000c000,0x3fb5bfb5,0x40000000,0x3fb53fb5,0x3f443fed,0xbf713fe2,0xbffb3ec8,0xbfc6bfa2,0xbfb5bfb5,0x3ec8bffb,0x3fedbf44,0x3fd53f8e,0x3fed3f44,0x3e493fff,0xbfd53f8e,0xbfe2bf71
.long 0xc0000000,0xbf44bfed,0x3fb5bfb5,0x3fed3f44,0x3fedbf44,0x3fa23fc6,0xbf8e3fd5,0xbff5bf15,0xbfb53fb5,0xbfd5bf8e,0x3f44bfed,0x3ffb3ec8,0x3f44bfed,0x3ff53f15,0xbec83ffb,0xbfffbe49
.long 0x3f803f80,0xc0000000,0x8000c000,0x40000000,0xbf803f80,0xbfffbe49,0x3ec8bffb,0x3ff53f15,0x3f803f80,0xbffbbec8,0x3f44bfed,0x3fd53f8e,0xbf803f80,0xbff5bf15,0x3f8ebfd5,0x3fa23fc6
.long 0x3f803f80,0xbfedbf44,0x3fb5bfb5,0x3f443fed,0xbf803f80,0xbfe2bf71,0x3fd5bf8e,0x3e493fff,0x3f803f80,0xbfd5bf8e,0x3fedbf44,0xbec83ffb,0xbf803f80,0xbfc6bfa2,0x3ffbbec8,0xbf713fe2
.long 0x3f803f80,0xbfb5bfb5,0x40000000,0xbfb53fb5,0xbf803f80,0xbfa2bfc6,0x3ffb3ec8,0xbfe23f71,0x3f803f80,0xbf8ebfd5,0x3fed3f44,0xbffb3ec8,0xbf803f80,0xbf71bfe2,0x3fd53f8e,0xbfffbe49
.long 0x3f803f80,0xbf44bfed,0x3fb53fb5,0xbfedbf44,0xbf803f80,0xbf15bff5,0x3f8e3fd5,0xbfc6bfa2,0x3f803f80,0xbec8bffb,0x3f443fed,0xbf8ebfd5,0xbf803f80,0xbe49bfff,0x3ec83ffb,0xbf15bff5
.long 0x80004000,0xc0000000,0x8000c000,0x40000000,0xbf443fed,0xbfe2bf71,0x3f8ebfd5,0x3fc63fa2,0xbfb53fb5,0xbf8ebfd5,0x3fedbf44,0x3ec83ffb,0xbfed3f44,0xbe49bfff,0x3ffb3ec8,0xbf713fe2
.long 0xc0000000,0x3f44bfed,0x3fb53fb5,0xbfed3f44,0xbfedbf44,0x3fc6bfa2,0x3ec83ffb,0xbff5bf15,0xbfb5bfb5,0x3ffbbec8,0xbf443fed,0xbf8ebfd5,0xbf44bfed,0x3ff53f15,0xbfd53f8e,0x3e49bfff
.long 0x8000c000,0x3fb53fb5,0xc0000000,0x3fb5bfb5,0x3f44bfed,0x3f153ff5,0xbfd5bf8e,0x3fffbe49,0x3fb5bfb5,0xbec83ffb,0xbf44bfed,0x3fd53f8e,0x3fedbf44,0xbfa23fc6,0x3ec8bffb,0x3f153ff5
.long 0x40000000,0xbfed3f44,0x3fb5bfb5,0xbf443fed,0x3fed3f44,0xbfffbe49,0x3ffbbec8,0xbfe23f71,0x3fb53fb5,0xbfd5bf8e,0x3fed3f44,0xbffbbec8,0x3f443fed,0xbf71bfe2,0x3f8e3fd5,0xbfa2bfc6
.long 0x80004000,0xc0000000,0x8000c000,0x40000000,0xbfb53fb5,0xbfa2bfc6,0x3fd5bf8e,0x3f713fe2,0xc0000000,0x3ec8bffb,0x3fed3f44,0xbf8e3fd5,0xbfb5bfb5,0x3fe2bf71,0x3ec83ffb,0xbfffbe49
.long 0x8000c000,0x3fed3f44,0xbfb53fb5,0xbf44bfed,0x3fb5bfb5,0x3f153ff5,0xbffbbec8,0x3fa2bfc6,0x40000000,0xbf8e3fd5,0xbf44bfed,0x3ffb3ec8,0x3fb53fb5,0xbfff3e49,0x3f8ebfd5,0x3f153ff5
.long 0x80004000,0xbfb5bfb5,0x40000000,0xbfb53fb5,0xbfb53fb5,0x3e49bfff,0x3f8e3fd5,0xbff5bf15,0xc0000000,0x3fd5bf8e,0xbf443fed,0xbec8bffb,0xbfb5bfb5,0x3ff53f15,0xbffb3ec8,0x3fc6bfa2
.long 0x8000c000,0x3f443fed,0xbfb5bfb5,0x3fed3f44,0x3fb5bfb5,0xbf713fe2,0x3ec8bffb,0x3e493fff,0x40000000,0xbffb3ec8,0x3fedbf44,0xbfd53f8e,0x3fb53fb5,0xbfc6bfa2,0x3fd53f8e,0xbfe2bf71
.long 0x80004000,0xc0000000,0x8000c000,0x40000000,0xbfed3f44,0xbf15bff5,0x3ffbbec8,0x3e493fff,0xbfb5bfb5,0x3fd5bf8e,0x3f443fed,0xbffb3ec8,0x3f44bfed,0x3fc63fa2,0xbfd53f8e,0xbf15bff5
.long 0x40000000,0xbf443fed,0xbfb5bfb5,0x3fedbf44,0x3f443fed,0xbfffbe49,0x3f8ebfd5,0x3f713fe2,0xbfb53fb5,0xbec8bffb,0x3fed3f44,0xbfd53f8e,0xbfedbf44,0x3fe2bf71,0xbec83ffb,0xbfa2bfc6
.long 0x8000c000,0x3fb53fb5,0xc0000000,0x3fb5bfb5,0x3fedbf44,0xbf713fe2,0xbec8bffb,0x3fc63fa2,0x3fb53fb5,0xbffbbec8,0x3fedbf44,0xbf8e3fd5,0xbf443fed,0xbe49bfff,0x3f8e3fd5,0xbfe2bf71
.long 0xc0000000,0x3fedbf44,0xbfb53fb5,0x3f44bfed,0xbf44bfed,0x3fa23fc6,0xbfd5bf8e,0x3ff53f15,0x3fb5bfb5,0xbf8e3fd5,0x3f44bfed,0xbec83ffb,0x3fed3f44,0xbff5bf15,0x3ffb3ec8,0xbfffbe49
.long 0x80004000,0xc0000000,0x8000c000,0x40000000,0xc0000000,0x3e49bfff,0x3ffb3ec8,0xbf153ff5,0x8000c000,0x3ffb3ec8,0xbf443fed,0xbfd5bf8e,0x40000000,0xbf153ff5,0xbfd5bf8e,0x3fc6bfa2
.long 0x80004000,0xbfedbf44,0x3fb5bfb5,0x3f443fed,0xc0000000,0x3f71bfe2,0x3f8e3fd5,0xbfff3e49,0x8000c000,0x3fd53f8e,0xbfed3f44,0x3ec8bffb,0x40000000,0xbfa23fc6,0xbec8bffb,0x3fe23f71
.long 0x80004000,0xbfb5bfb5,0x40000000,0xbfb53fb5,0xc0000000,0x3fc6bfa2,0xbec83ffb,0xbf71bfe2,0x8000c000,0x3f8e3fd5,0xbfedbf44,0x3ffbbec8,0x40000000,0xbfe23f71,0x3f8ebfd5,0xbe493fff
.long 0x80004000,0xbf44bfed,0x3fb53fb5,0xbfedbf44,0xc0000000,0x3ff5bf15,0xbfd53f8e,0x3fa2bfc6,0x8000c000,0x3ec83ffb,0xbf44bfed,0x3f8e3fd5,0x40000000,0xbfff3e49,0x3ffbbec8,0xbff53f15
.long 0x80004000,0xc0000000,0x8000c000,0x40000000,0xbfedbf44,0x3f71bfe2,0x3fd53f8e,0xbfa23fc6,0x3fb5bfb5,0x3f8e3fd5,0xbfed3f44,0xbec8bffb,0x3f443fed,0xbfff3e49,0x3ec8bffb,0x3fe23f71
.long 0xc0000000,0x3f44bfed,0x3fb53fb5,0xbfed3f44,0x3f44bfed,0x3fa23fc6,0xbffb3ec8,0x3f15bff5,0x3fb53fb5,0xbffb3ec8,0x3f44bfed,0x3f8e3fd5,0xbfed3f44,0x3f15bff5,0x3f8e3fd5,0xbfffbe49
.long 0x8000c000,0x3fb53fb5,0xc0000000,0x3fb5bfb5,0x3fed3f44,0xbff53f15,0x3f8ebfd5,0x3e493fff,0xbfb53fb5,0x3ec8bffb,0x3f443fed,0xbfd5bf8e,0xbf44bfed,0x3fc63fa2,0xbffbbec8,0x3ff5bf15
.long 0x40000000,0xbfed3f44,0x3fb5bfb5,0xbf443fed,0xbf443fed,0x3e49bfff,0x3ec83ffb,0xbf71bfe2,0xbfb5bfb5,0x3fd53f8e,0xbfedbf44,0x3ffb3ec8,0x3fedbf44,0xbfe23f71,0x3fd5bf8e,0xbfc63fa2
.long 0x80004000,0xc0000000,0x8000c000,0x40000000,0xbfb5bfb5,0x3fc6bfa2,0x3f8e3fd5,0xbfe23f71,0x40000000,0xbec83ffb,0xbfedbf44,0x3f8ebfd5,0xbfb53fb5,0xbf71bfe2,0x3ffbbec8,0xbe493fff
.long 0x8000c000,0x3fed3f44,0xbfb53fb5,0xbf44bfed,0x3fb53fb5,0xbff53f15,0x3ec8bffb,0x3fc63fa2,0xc0000000,0x3f8ebfd5,0x3f443fed,0xbffbbec8,0x3fb5bfb5,0x3e493fff,0xbfd5bf8e,0x3ff5bf15
.long 0x80004000,0xbfb5bfb5,0x40000000,0xbfb53fb5,0xbfb5bfb5,0x3fff3e49,0xbfd53f8e,0x3f15bff5,0x40000000,0xbfd53f8e,0x3f44bfed,0x3ec83ffb,0xbfb53fb5,0x3f15bff5,0x3ec83ffb,0xbfa2bfc6
.long 0x8000c000,0x3f443fed,0xbfb5bfb5,0x3fed3f44,0x3fb53fb5,0xbfe2bf71,0x3ffb3ec8,0xbfff3e49,0xc0000000,0x3ffbbec8,0xbfed3f44,0x3fd5bf8e,0x3fb5bfb5,0xbfa23fc6,0x3f8ebfd5,0xbf713fe2
.long 0x80004000,0xc0000000,0x8000c000,0x40000000,0xbf44bfed,0x3ff5bf15,0x3ec83ffb,0xbfff3e49,0x3fb53fb5,0xbfd53f8e,0xbf44bfed,0x3ffbbec8,0xbfedbf44,0x3fa2bfc6,0x3f8e3fd5,0xbff53f15
.long 0x40000000,0xbf443fed,0xbfb5bfb5,0x3fedbf44,0xbfed3f44,0x3e49bfff,0x3fd53f8e,0xbfe23f71,0x3fb5bfb5,0x3ec83ffb,0xbfedbf44,0x3fd5bf8e,0xbf443fed,0xbf71bfe2,0x3ffb3ec8,0xbfc63fa2
.long 0x8000c000,0x3fb53fb5,0xc0000000,0x3fb5bfb5,0x3f443fed,0xbfe2bf71,0x3ffbbec8,0xbfa23fc6,0xbfb5bfb5,0x3ffb3ec8,0xbfed3f44,0x3f8ebfd5,0x3fed3f44,0xbfff3e49,0x3fd5bf8e,0xbf713fe2
.long 0xc0000000,0x3fedbf44,0xbfb53fb5,0x3f44bfed,0x3fedbf44,0xbfc63fa2,0x3f8ebfd5,0xbf153ff5,0xbfb53fb5,0x3f8ebfd5,0xbf443fed,0x3ec8bffb,0x3f44bfed,0xbf153ff5,0x3ec8bffb,0xbe493fff
.long 0x3f803f80,0x8000c000,0x80004000,0x8000c000,0xbf803f80,0x3e49bfff,0xbec83ffb,0x3f15bff5,0x3f803f80,0x3ec8bffb,0xbf443fed,0x3f8ebfd5,0xbf803f80,0x3f15bff5,0xbf8e3fd5,0x3fc6bfa2
.long 0x3f803f80,0x3f44bfed,0xbfb53fb5,0x3fedbf44,0xbf803f80,0x3f71bfe2,0xbfd53f8e,0x3fffbe49,0x3f803f80,0x3f8ebfd5,0xbfed3f44,0x3ffb3ec8,0xbf803f80,0x3fa2bfc6,0xbffb3ec8,0x3fe23f71
.long 0x3f803f80,0x3fb5bfb5,0xc0000000,0x3fb53fb5,0xbf803f80,0x3fc6bfa2,0xbffbbec8,0x3f713fe2,0x3f803f80,0x3fd5bf8e,0xbfedbf44,0x3ec83ffb,0xbf803f80,0x3fe2bf71,0xbfd5bf8e,0xbe493fff
.long 0x3f803f80,0x3fedbf44,0xbfb5bfb5,0xbf443fed,0xbf803f80,0x3ff5bf15,0xbf8ebfd5,0xbfa23fc6,0x3f803f80,0x3ffbbec8,0xbf44bfed,0xbfd53f8e,0xbf803f80,0x3fffbe49,0xbec8bffb,0xbff53f15
.long 0x80004000,0x8000c000,0x80004000,0x8000c000,0xbf443fed,0x3f71bfe2,0xbf8e3fd5,0x3fa2bfc6,0xbfb53fb5,0x3fd5bf8e,0xbfed3f44,0x3ffbbec8,0xbfed3f44,0x3fffbe49,0xbffbbec8,0x3fe23f71
.long 0xc0000000,0x3fed3f44,0xbfb5bfb5,0x3f443fed,0xbfedbf44,0x3fa23fc6,0xbec8bffb,0xbf153ff5,0xbfb5bfb5,0x3ec83ffb,0x3f44bfed,0xbfd53f8e,0xbf44bfed,0xbf153ff5,0x3fd5bf8e,0xbfffbe49
.long 0x8000c000,0xbfb53fb5,0x40000000,0xbfb5bfb5,0x3f44bfed,0xbff53f15,0x3fd53f8e,0xbe49bfff,0x3fb5bfb5,0xbffbbec8,0x3f443fed,0x3f8ebfd5,0x3fedbf44,0xbfc6bfa2,0xbec83ffb,0x3ff5bf15
.long 0x40000000,0xbf44bfed,0xbfb53fb5,0x3fed3f44,0x3fed3f44,0x3e49bfff,0xbffb3ec8,0x3f713fe2,0x3fb53fb5,0x3f8ebfd5,0xbfedbf44,0xbec83ffb,0x3f443fed,0x3fe2bf71,0xbf8ebfd5,0xbfc63fa2
.long 0x80004000,0x8000c000,0x80004000,0x8000c000,0xbfb53fb5,0x3fc6bfa2,0xbfd53f8e,0x3fe2bf71,0xc0000000,0x3ffb3ec8,0xbfedbf44,0x3fd53f8e,0xbfb5bfb5,0x3f713fe2,0xbec8bffb,0xbe493fff
.long 0x8000c000,0xbf443fed,0x3fb5bfb5,0xbfed3f44,0x3fb5bfb5,0xbff53f15,0x3ffb3ec8,0xbfc6bfa2,0x40000000,0xbfd5bf8e,0x3f443fed,0x3ec8bffb,0x3fb53fb5,0xbe49bfff,0xbf8e3fd5,0x3ff5bf15
.long 0x80004000,0x3fb5bfb5,0xc0000000,0x3fb53fb5,0xbfb53fb5,0x3fff3e49,0xbf8ebfd5,0xbf153ff5,0xc0000000,0x3f8e3fd5,0x3f44bfed,0xbffb3ec8,0xbfb5bfb5,0xbf153ff5,0x3ffbbec8,0xbfa2bfc6
.long 0x8000c000,0xbfed3f44,0x3fb53fb5,0x3f44bfed,0x3fb5bfb5,0xbfe2bf71,0xbec83ffb,0x3fffbe49,0x40000000,0xbec8bffb,0xbfed3f44,0x3f8e3fd5,0x3fb53fb5,0x3fa2bfc6,0xbfd5bf8e,0xbf713fe2
.long 0x80004000,0x8000c000,0x80004000,0x8000c000,0xbfed3f44,0x3ff5bf15,0xbffb3ec8,0x3fffbe49,0xbfb5bfb5,0x3f8e3fd5,0xbf44bfed,0x3ec83ffb,0x3f44bfed,0xbfa23fc6,0x3fd5bf8e,0xbff53f15
.long 0x40000000,0xbfedbf44,0x3fb53fb5,0xbf44bfed,0x3f443fed,0x3e49bfff,0xbf8e3fd5,0x3fe2bf71,0xbfb53fb5,0x3ffbbec8,0xbfedbf44,0x3f8e3fd5,0xbfedbf44,0x3f713fe2,0x3ec8bffb,0xbfc63fa2
.long 0x8000c000,0xbfb53fb5,0x40000000,0xbfb5bfb5,0x3fedbf44,0xbfe2bf71,0x3ec83ffb,0x3fa2bfc6,0x3fb53fb5,0x3ec8bffb,0xbfed3f44,0x3fd53f8e,0xbf443fed,0x3fffbe49,0xbf8ebfd5,0xbf713fe2
.long 0xc0000000,0x3f443fed,0x3fb5bfb5,0xbfedbf44,0xbf44bfed,0xbfc63fa2,0x3fd53f8e,0x3f15bff5,0x3fb5bfb5,0xbfd5bf8e,0xbf443fed,0x3ffb3ec8,0x3fed3f44,0x3f15bff5,0xbffbbec8,0xbe493fff
.long 0x80004000,0x8000c000,0x80004000,0x8000c000,0xc0000000,0x3fff3e49,0xbffbbec8,0x3ff53f15,0x8000c000,0xbec83ffb,0x3f44bfed,0xbf8e3fd5,0x40000000,0xbff5bf15,0x3fd53f8e,0xbfa2bfc6
.long 0x80004000,0x3f44bfed,0xbfb53fb5,0x3fedbf44,0xc0000000,0x3fe23f71,0xbf8ebfd5,0x3e493fff,0x8000c000,0xbf8e3fd5,0x3fedbf44,0xbffbbec8,0x40000000,0xbfc6bfa2,0x3ec83ffb,0x3f71bfe2
.long 0x80004000,0x3fb5bfb5,0xc0000000,0x3fb53fb5,0xc0000000,0x3fa23fc6,0x3ec8bffb,0xbfe23f71,0x8000c000,0xbfd53f8e,0x3fed3f44,0xbec8bffb,0x40000000,0xbf71bfe2,0xbf8e3fd5,0x3fff3e49
.long 0x80004000,0x3fedbf44,0xbfb5bfb5,0xbf443fed,0xc0000000,0x3f153ff5,0x3fd5bf8e,0xbfc6bfa2,0x8000c000,0xbffb3ec8,0x3f443fed,0x3fd5bf8e,0x40000000,0xbe49bfff,0xbffb3ec8,0x3f153ff5
.long 0x80004000,0x8000c000,0x80004000,0x8000c000,0xbfedbf44,0x3fe23f71,0xbfd5bf8e,0x3fc63fa2,0x3fb5bfb5,0xbfd53f8e,0x3fedbf44,0xbffb3ec8,0x3f443fed,0xbe49bfff,0xbec83ffb,0x3f71bfe2
.long 0xc0000000,0x3fed3f44,0xbfb5bfb5,0x3f443fed,0x3f44bfed,0xbfc63fa2,0x3ffbbec8,0xbff5bf15,0x3fb53fb5,0xbec8bffb,0xbf443fed,0x3fd5bf8e,0xbfed3f44,0x3ff53f15,0xbf8ebfd5,0xbe493fff
.long 0x8000c000,0xbfb53fb5,0x40000000,0xbfb5bfb5,0x3fed3f44,0xbf15bff5,0xbf8e3fd5,0x3fffbe49,0xbfb53fb5,0x3ffb3ec8,0xbf44bfed,0xbf8e3fd5,0xbf44bfed,0xbfa23fc6,0x3ffb3ec8,0xbf15bff5
.long 0x40000000,0xbf44bfed,0xbfb53fb5,0x3fed3f44,0xbf443fed,0x3fff3e49,0xbec8bffb,0xbfe23f71,0xbfb5bfb5,0xbf8e3fd5,0x3fed3f44,0x3ec8bffb,0x3fedbf44,0xbf71bfe2,0xbfd53f8e,0x3fa23fc6
.long 0x80004000,0x8000c000,0x80004000,0x8000c000,0xbfb5bfb5,0x3fa23fc6,0xbf8ebfd5,0x3f713fe2,0x40000000,0xbffbbec8,0x3fed3f44,0xbfd5bf8e,0xbfb53fb5,0x3fe2bf71,0xbffb3ec8,0x3fff3e49
.long 0x8000c000,0xbf443fed,0x3fb5bfb5,0xbfed3f44,0x3fb53fb5,0xbf15bff5,0xbec83ffb,0x3fa2bfc6,0xc0000000,0x3fd53f8e,0xbf44bfed,0xbec83ffb,0x3fb5bfb5,0xbfff3e49,0x3fd53f8e,0xbf15bff5
.long 0x80004000,0x3fb5bfb5,0xc0000000,0x3fb53fb5,0xbfb5bfb5,0xbe493fff,0x3fd5bf8e,0xbff5bf15,0x40000000,0xbf8ebfd5,0xbf443fed,0x3ffbbec8,0xbfb53fb5,0x3ff53f15,0xbec8bffb,0xbfc63fa2
.long 0x8000c000,0xbfed3f44,0x3fb53fb5,0x3f44bfed,0x3fb53fb5,0x3f71bfe2,0xbffbbec8,0x3e493fff,0xc0000000,0x3ec83ffb,0x3fedbf44,0xbf8ebfd5,0x3fb5bfb5,0xbfc6bfa2,0xbf8e3fd5,0x3fe23f71
.long 0x80004000,0x8000c000,0x80004000,0x8000c000,0xbf44bfed,0x3f153ff5,0xbec8bffb,0x3e493fff,0x3fb53fb5,0xbf8ebfd5,0x3f443fed,0xbec8bffb,0xbfedbf44,0x3fc63fa2,0xbf8ebfd5,0x3f153ff5
.long 0x40000000,0xbfedbf44,0x3fb53fb5,0xbf44bfed,0xbfed3f44,0x3fff3e49,0xbfd5bf8e,0x3f713fe2,0x3fb5bfb5,0xbffb3ec8,0x3fed3f44,0xbf8ebfd5,0xbf443fed,0x3fe2bf71,0xbffbbec8,0x3fa23fc6
.long 0x8000c000,0xbfb53fb5,0x40000000,0xbfb5bfb5,0x3f443fed,0x3f71bfe2,0xbffb3ec8,0x3fc63fa2,0xbfb5bfb5,0xbec83ffb,0x3fedbf44,0xbfd5bf8e,0x3fed3f44,0xbe49bfff,0xbfd53f8e,0x3fe23f71
.long 0xc0000000,0x3f443fed,0x3fb5bfb5,0xbfedbf44,0x3fedbf44,0xbfa2bfc6,0xbf8e3fd5,0x3ff53f15,0xbfb53fb5,0x3fd53f8e,0x3f44bfed,0xbffbbec8,0x3f44bfed,0xbff5bf15,0xbec83ffb,0x3fff3e49
.long 0x3f803f80,0x40000000,0x8000c000,0xc0000000,0xbf803f80,0x3fff3e49,0x3ec8bffb,0xbff5bf15,0x3f803f80,0x3ffb3ec8,0x3f44bfed,0xbfd5bf8e,0xbf803f80,0x3ff53f15,0x3f8ebfd5,0xbfa2bfc6
.long 0x3f803f80,0x3fed3f44,0x3fb5bfb5,0xbf44bfed,0xbf803f80,0x3fe23f71,0x3fd5bf8e,0xbe49bfff,0x3f803f80,0x3fd53f8e,0x3fedbf44,0x3ec8bffb,0xbf803f80,0x3fc63fa2,0x3ffbbec8,0x3f71bfe2
.long 0x3f803f80,0x3fb53fb5,0x40000000,0x3fb5bfb5,0xbf803f80,0x3fa23fc6,0x3ffb3ec8,0x3fe2bf71,0x3f803f80,0x3f8e3fd5,0x3fed3f44,0x3ffbbec8,0xbf803f80,0x3f713fe2,0x3fd53f8e,0x3fff3e49
.long 0x3f803f80,0x3f443fed,0x3fb53fb5,0x3fed3f44,0xbf803f80,0x3f153ff5,0x3f8e3fd5,0x3fc63fa2,0x3f803f80,0x3ec83ffb,0x3f443fed,0x3f8e3fd5,0xbf803f80,0x3e493fff,0x3ec83ffb,0x3f153ff5
.long 0x80004000,0x40000000,0x8000c000,0xc0000000,0xbf443fed,0x3fe23f71,0x3f8ebfd5,0xbfc6bfa2,0xbfb53fb5,0x3f8e3fd5,0x3fedbf44,0xbec8bffb,0xbfed3f44,0x3e493fff,0x3ffb3ec8,0x3f71bfe2
.long 0xc0000000,0xbf443fed,0x3fb53fb5,0x3fedbf44,0xbfedbf44,0xbfc63fa2,0x3ec83ffb,0x3ff53f15,0xbfb5bfb5,0xbffb3ec8,0xbf443fed,0x3f8e3fd5,0xbf44bfed,0xbff5bf15,0xbfd53f8e,0xbe493fff
.long 0x8000c000,0xbfb5bfb5,0xc0000000,0xbfb53fb5,0x3f44bfed,0xbf15bff5,0xbfd5bf8e,0xbfff3e49,0x3fb5bfb5,0x3ec8bffb,0xbf44bfed,0xbfd5bf8e,0x3fedbf44,0x3fa2bfc6,0x3ec8bffb,0xbf15bff5
.long 0x40000000,0x3fedbf44,0x3fb5bfb5,0x3f44bfed,0x3fed3f44,0x3fff3e49,0x3ffbbec8,0x3fe2bf71,0x3fb53fb5,0x3fd53f8e,0x3fed3f44,0x3ffb3ec8,0x3f443fed,0x3f713fe2,0x3f8e3fd5,0x3fa23fc6
.long 0x80004000,0x40000000,0x8000c000,0xc0000000,0xbfb53fb5,0x3fa23fc6,0x3fd5bf8e,0xbf71bfe2,0xc0000000,0xbec83ffb,0x3fed3f44,0x3f8ebfd5,0xbfb5bfb5,0xbfe23f71,0x3ec83ffb,0x3fff3e49
.long 0x8000c000,0xbfedbf44,0xbfb53fb5,0x3f443fed,0x3fb5bfb5,0xbf15bff5,0xbffbbec8,0xbfa23fc6,0x40000000,0x3f8ebfd5,0xbf44bfed,0xbffbbec8,0x3fb53fb5,0x3fffbe49,0x3f8ebfd5,0xbf15bff5
.long 0x80004000,0x3fb53fb5,0x40000000,0x3fb5bfb5,0xbfb53fb5,0xbe493fff,0x3f8e3fd5,0x3ff53f15,0xc0000000,0xbfd53f8e,0xbf443fed,0x3ec83ffb,0xbfb5bfb5,0xbff5bf15,0xbffb3ec8,0xbfc63fa2
.long 0x8000c000,0xbf44bfed,0xbfb5bfb5,0xbfedbf44,0x3fb5bfb5,0x3f71bfe2,0x3ec8bffb,0xbe49bfff,0x40000000,0x3ffbbec8,0x3fedbf44,0x3fd5bf8e,0x3fb53fb5,0x3fc63fa2,0x3fd53f8e,0x3fe23f71
.long 0x80004000,0x40000000,0x8000c000,0xc0000000,0xbfed3f44,0x3f153ff5,0x3ffbbec8,0xbe49bfff,0xbfb5bfb5,0xbfd53f8e,0x3f443fed,0x3ffbbec8,0x3f44bfed,0xbfc6bfa2,0xbfd53f8e,0x3f153ff5
.long 0x40000000,0x3f44bfed,0xbfb5bfb5,0xbfed3f44,0x3f443fed,0x3fff3e49,0x3f8ebfd5,0xbf71bfe2,0xbfb53fb5,0x3ec83ffb,0x3fed3f44,0x3fd5bf8e,0xbfedbf44,0xbfe23f71,0xbec83ffb,0x3fa23fc6
.long 0x8000c000,0xbfb5bfb5,0xc0000000,0xbfb53fb5,0x3fedbf44,0x3f71bfe2,0xbec8bffb,0xbfc6bfa2,0x3fb53fb5,0x3ffb3ec8,0x3fedbf44,0x3f8ebfd5,0xbf443fed,0x3e493fff,0x3f8e3fd5,0x3fe23f71
.long 0xc0000000,0xbfed3f44,0xbfb53fb5,0xbf443fed,0xbf44bfed,0xbfa2bfc6,0xbfd5bf8e,0xbff5bf15,0x3fb5bfb5,0x3f8ebfd5,0x3f44bfed,0x3ec8bffb,0x3fed3f44,0x3ff53f15,0x3ffb3ec8,0x3fff3e49
.long 0x80004000,0x40000000,0x8000c000,0xc0000000,0xc0000000,0xbe493fff,0x3ffb3ec8,0x3f15bff5,0x8000c000,0xbffbbec8,0xbf443fed,0x3fd53f8e,0x40000000,0x3f15bff5,0xbfd5bf8e,0xbfc63fa2
.long 0x80004000,0x3fed3f44,0x3fb5bfb5,0xbf44bfed,0xc0000000,0xbf713fe2,0x3f8e3fd5,0x3fffbe49,0x8000c000,0xbfd5bf8e,0xbfed3f44,0xbec83ffb,0x40000000,0x3fa2bfc6,0xbec8bffb,0xbfe2bf71
.long 0x80004000,0x3fb53fb5,0x40000000,0x3fb5bfb5,0xc0000000,0xbfc63fa2,0xbec83ffb,0x3f713fe2,0x8000c000,0xbf8ebfd5,0xbfedbf44,0xbffb3ec8,0x40000000,0x3fe2bf71,0x3f8ebfd5,0x3e49bfff
.long 0x80004000,0x3f443fed,0x3fb53fb5,0x3fed3f44,0xc0000000,0xbff53f15,0xbfd53f8e,0xbfa23fc6,0x8000c000,0xbec8bffb,0xbf44bfed,0xbf8ebfd5,0x40000000,0x3fffbe49,0x3ffbbec8,0x3ff5bf15
.long 0x80004000,0x40000000,0x8000c000,0xc0000000,0xbfedbf44,0xbf713fe2,0x3fd53f8e,0x3fa2bfc6,0x3fb5bfb5,0xbf8ebfd5,0xbfed3f44,0x3ec83ffb,0x3f443fed,0x3fffbe49,0x3ec8bffb,0xbfe2bf71
.long 0xc0000000,0xbf443fed,0x3fb53fb5,0x3fedbf44,0x3f44bfed,0xbfa2bfc6,0xbffb3ec8,0xbf153ff5,0x3fb53fb5,0x3ffbbec8,0x3f44bfed,0xbf8ebfd5,0xbfed3f44,0xbf153ff5,0x3f8e3fd5,0x3fff3e49
.long 0x8000c000,0xbfb5bfb5,0xc0000000,0xbfb53fb5,0x3fed3f44,0x3ff5bf15,0x3f8ebfd5,0xbe49bfff,0xbfb53fb5,0xbec83ffb,0x3f443fed,0x3fd53f8e,0xbf44bfed,0xbfc6bfa2,0xbffbbec8,0xbff53f15
.long 0x40000000,0x3fedbf44,0x3fb5bfb5,0x3f44bfed,0xbf443fed,0xbe493fff,0x3ec83ffb,0x3f713fe2,0xbfb5bfb5,0xbfd5bf8e,0xbfedbf44,0xbffbbec8,0x3fedbf44,0x3fe2bf71,0x3fd5bf8e,0x3fc6bfa2
.long 0x80004000,0x40000000,0x8000c000,0xc0000000,0xbfb5bfb5,0xbfc63fa2,0x3f8e3fd5,0x3fe2bf71,0x40000000,0x3ec8bffb,0xbfedbf44,0xbf8e3fd5,0xbfb53fb5,0x3f713fe2,0x3ffbbec8,0x3e49bfff
.long 0x8000c000,0xbfedbf44,0xbfb53fb5,0x3f443fed,0x3fb53fb5,0x3ff5bf15,0x3ec8bffb,0xbfc6bfa2,0xc0000000,0xbf8e3fd5,0x3f443fed,0x3ffb3ec8,0x3fb5bfb5,0xbe49bfff,0xbfd5bf8e,0xbff53f15
.long 0x80004000,0x3fb53fb5,0x40000000,0x3fb5bfb5,0xbfb5bfb5,0xbfffbe49,0xbfd53f8e,0xbf153ff5,0x40000000,0x3fd5bf8e,0x3f44bfed,0xbec8bffb,0xbfb53fb5,0xbf153ff5,0x3ec83ffb,0x3fa23fc6
.long 0x8000c000,0xbf44bfed,0xbfb5bfb5,0xbfedbf44,0x3fb53fb5,0x3fe23f71,0x3ffb3ec8,0x3fffbe49,0xc0000000,0xbffb3ec8,0xbfed3f44,0xbfd53f8e,0x3fb5bfb5,0x3fa2bfc6,0x3f8ebfd5,0x3f71bfe2
.long 0x80004000,0x40000000,0x8000c000,0xc0000000,0xbf44bfed,0xbff53f15,0x3ec83ffb,0x3fffbe49,0x3fb53fb5,0x3fd5bf8e,0xbf44bfed,0xbffb3ec8,0xbfedbf44,0xbfa23fc6,0x3f8e3fd5,0x3ff5bf15
.long 0x40000000,0x3f44bfed,0xbfb5bfb5,0xbfed3f44,0xbfed3f44,0xbe493fff,0x3fd53f8e,0x3fe2bf71,0x3fb5bfb5,0xbec8bffb,0xbfedbf44,0xbfd53f8e,0xbf443fed,0x3f713fe2,0x3ffb3ec8,0x3fc6bfa2
.long 0x8000c000,0xbfb5bfb5,0xc0000000,0xbfb53fb5,0x3f443fed,0x3fe23f71,0x3ffbbec8,0x3fa2bfc6,0xbfb5bfb5,0xbffbbec8,0xbfed3f44,0xbf8e3fd5,0x3fed3f44,0x3fffbe49,0x3fd5bf8e,0x3f71bfe2
.long 0xc0000000,0xbfed3f44,0xbfb53fb5,0xbf443fed,0x3fedbf44,0x3fc6bfa2,0x3f8ebfd5,0x3f15bff5,0xbfb53fb5,0xbf8e3fd5,0xbf443fed,0xbec83ffb,0x3f44bfed,0x3f15bff5,0x3ec8bffb,0x3e49bfff
.long 0x3f800000,0x3f800000,0x3f800000,0x3f800000,0x3f800000,0x3f7ffec4,0x3f7ffb11,0x3f7ff4e6,0x3f800000,0x3f7ffb11,0x3f7fec43,0x3f7fd397,0x3f800000,0x3f7ff4e6,0x3f7fd397,0x3f7f9c18
.long 0x3f800000,0x3f7fec43,0x3f7fb10f,0x3f7f4e6d,0x3f800000,0x3f7fe129,0x3f7f84ab,0x3f7eea9d,0x3f800000,0x3f7fd397,0x3f7f4e6d,0x3f7e70b0,0x3f800000,0x3f7fc38f,0x3f7f0e58,0x3f7de0b1
.long 0x3f800000,0x3f7fb10f,0x3f7ec46d,0x3f7d3aac,0x3f800000,0x3f7f9c18,0x3f7e70b0,0x3f7c7eb0,0x3f800000,0x3f7f84ab,0x3f7e1324,0x3f7baccd,0x3f800000,0x3f7f6ac7,0x3f7dabcc,0x3f7ac516
.long 0x3f800000,0x3f7f4e6d,0x3f7d3aac,0x3f79c79d,0x3f800000,0x3f7f2f9d,0x3f7cbfc9,0x3f78b47b,0x3f800000,0x3f7f0e58,0x3f7c3b28,0x3f778bc5,0x3f800000,0x3f7eea9d,0x3f7baccd,0x3f764d97
.long 0x3f800000,0x3f800000,0x3f800000,0x3f800000,0x3f7fec43,0x3f7fe129,0x3f7fd397,0x3f7fc38f,0x3f7fb10f,0x3f7f84ab,0x3f7f4e6d,0x3f7f0e58,0x3f7f4e6d,0x3f7eea9d,0x3f7e70b0,0x3f7de0b1
.long 0x3f7ec46d,0x3f7e1324,0x3f7d3aac,0x3f7c3b28,0x3f7e1324,0x3f7cfe73,0x3f7baccd,0x3f7a1e84,0x3f7d3aac,0x3f7baccd,0x3f79c79d,0x3f778bc5,0x3f7c3b28,0x3f7a1e84,0x3f778bc5,0x3f748422
.long 0x3f7b14be,0x3f7853f8,0x3f74fa0b,0x3f710908,0x3f79c79d,0x3f764d97,0x3f721352,0x3f6d1c1d,0x3f7853f8,0x3f740bdd,0x3f6ed89e,0x3f68bf3c,0x3f76ba07,0x3f718f57,0x3f6b4b0c,0x3f63f473
.long 0x3f74fa0b,0x3f6ed89e,0x3f676bd8,0x3f5ebe05,0x3f731447,0x3f6be858,0x3f633c5a,0x3f591e6a,0x3f710908,0x3f68bf3c,0x3f5ebe05,0x3f531849,0x3f6ed89e,0x3f655e0b,0x3f59f26a,0x3f4cae79
.long 0x3f800000,0x3f800000,0x3f800000,0x3f800000,0x3f7fb10f,0x3f7f9c18,0x3f7f84ab,0x3f7f6ac7,0x3f7ec46d,0x3f7e70b0,0x3f7e1324,0x3f7dabcc,0x3f7d3aac,0x3f7c7eb0,0x3f7baccd,0x3f7ac516
.long 0x3f7b14be,0x3f79c79d,0x3f7853f8,0x3f76ba07,0x3f7853f8,0x3f764d97,0x3f740bdd,0x3f718f57,0x3f74fa0b,0x3f721352,0x3f6ed89e,0x3f6b4b0c,0x3f710908,0x3f6d1c1d,0x3f68bf3c,0x3f63f473
.long 0x3f6c835e,0x3f676bd8,0x3f61c598,0x3f5b941a,0x3f676bd8,0x3f6106f2,0x3f59f26a,0x3f5233c6,0x3f61c598,0x3f59f26a,0x3f514d3d,0x3f47de65,0x3f5b941a,0x3f5233c6,0x3f47de65,0x3f3ca003
.long 0x3f54db31,0x3f49d112,0x3f3daef9,0x3f3085bb,0x3f4d9f02,0x3f40d0da,0x3f32c8c9,0x3f239da9,0x3f45e403,0x3f373a23,0x3f273656,0x3f15f6d9,0x3f3daef9,0x3f2d1469,0x3f1b02c6,0x3f07a136
.long 0x3f800000,0x3f800000,0x3f800000,0x3f800000,0x3f7f4e6d,0x3f7f2f9d,0x3f7f0e58,0x3f7eea9d,0x3f7d3aac,0x3f7cbfc9,0x3f7c3b28,0x3f7baccd,0x3f79c79d,0x3f78b47b,0x3f778bc5,0x3f764d97
.long 0x3f74fa0b,0x3f731447,0x3f710908,0x3f6ed89e,0x3f6ed89e,0x3f6be858,0x3f68bf3c,0x3f655e0b,0x3f676bd8,0x3f633c5a,0x3f5ebe05,0x3f59f26a,0x3f5ebe05,0x3f591e6a,0x3f531849,0x3f4cae79
.long 0x3f54db31,0x3f4d9f02,0x3f45e403,0x3f3daef9,0x3f49d112,0x3f40d0da,0x3f373a23,0x3f2d1469,0x3f3daef9,0x3f32c8c9,0x3f273656,0x3f1b02c6,0x3f3085bb,0x3f239da9,0x3f15f6d9,0x3f07a136
.long 0x3f226799,0x3f13682a,0x3f039c3d,0x3ee63375,0x3f13682a,0x3f0242b1,0x3ee0924f,0x3ebb31a0,0x3f039c3d,0x3ee0924f,0x3eb8442a,0x3e8e9a22,0x3ee63375,0x3ebb31a0,0x3e8e9a22,0x3e419b37
.long 0x0,0x0,0x0,0x0,0x0,0x3bc90f88,0x3c490e90,0x3c96c9b6,0x0,0x3c490e90,0x3cc90ab0,0x3d16c32c,0x0,0x3c96c9b6,0x3d16c32c,0x3d621469
.long 0x0,0x3cc90ab0,0x3d48fb30,0x3d96a905,0x0,0x3cfb49ba,0x3d7b2b74,0x3dbc3ac3,0x0,0x3d16c32c,0x3d96a905,0x3de1bc2e,0x0,0x3d2fe007,0x3dafb680,0x3e039502
.long 0x0,0x3d48fb30,0x3dc8bd36,0x3e164083,0x0,0x3d621469,0x3de1bc2e,0x3e28defc,0x0,0x3d7b2b74,0x3dfab273,0x3e3b6ecf,0x0,0x3d8a200a,0x3e09cf86,0x3e4dee60
.long 0x0,0x3d96a905,0x3e164083,0x3e605c13,0x0,0x3da3308c,0x3e22abb6,0x3e72b651,0x0,0x3dafb680,0x3e2f10a2,0x3e827dc0,0x0,0x3dbc3ac3,0x3e3b6ecf,0x3e8b9507
.long 0x0,0x0,0x0,0x0,0x3cc90ab0,0x3cfb49ba,0x3d16c32c,0x3d2fe007,0x3d48fb30,0x3d7b2b74,0x3d96a905,0x3dafb680,0x3d96a905,0x3dbc3ac3,0x3de1bc2e,0x3e039502
.long 0x3dc8bd36,0x3dfab273,0x3e164083,0x3e2f10a2,0x3dfab273,0x3e1c76de,0x3e3b6ecf,0x3e5a3997,0x3e164083,0x3e3b6ecf,0x3e605c13,0x3e827dc0,0x3e2f10a2,0x3e5a3997,0x3e827dc0,0x3e97a117
.long 0x3e47c5c2,0x3e78cfcc,0x3e94a031,0x3eac7cd4,0x3e605c13,0x3e8b9507,0x3ea68f12,0x3ec1071e,0x3e78cfcc,0x3e9aa086,0x3eb8442a,0x3ed53641,0x3e888e93,0x3ea986c4,0x3ec9b953,0x3ee900b7
.long 0x3e94a031,0x3eb8442a,0x3edae880,0x3efc5d27,0x3ea09ae5,0x3ec6d529,0x3eebcbbb,0x3f07a136,0x3eac7cd4,0x3ed53641,0x3efc5d27,0x3f10d3cd,0x3eb8442a,0x3ee363fa,0x3f064b82,0x3f19c200
.long 0x0,0x0,0x0,0x0,0x3d48fb30,0x3d621469,0x3d7b2b74,0x3d8a200a,0x3dc8bd36,0x3de1bc2e,0x3dfab273,0x3e09cf86,0x3e164083,0x3e28defc,0x3e3b6ecf,0x3e4dee60
.long 0x3e47c5c2,0x3e605c13,0x3e78cfcc,0x3e888e93,0x3e78cfcc,0x3e8b9507,0x3e9aa086,0x3ea986c4,0x3e94a031,0x3ea68f12,0x3eb8442a,0x3ec9b953,0x3eac7cd4,0x3ec1071e,0x3ed53641,0x3ee900b7
.long 0x3ec3ef15,0x3edae880,0x3ef15aea,0x3f039c3d,0x3edae880,0x3ef41f07,0x3f064b82,0x3f121eb0,0x3ef15aea,0x3f064b82,0x3f13682a,0x3f1ff6cb,0x3f039c3d,0x3f121eb0,0x3f1ff6cb,0x3f2d1469
.long 0x3f0e39da,0x3f1d7fd1,0x3f2beb4a,0x3f396842,0x3f187fc0,0x3f286605,0x3f373a23,0x3f44e3f5,0x3f226799,0x3f32c8c9,0x3f41d870,0x3f4f7a1f,0x3f2beb4a,0x3f3ca003,0x3f4bbbf8,0x3f591e6a
.long 0x0,0x0,0x0,0x0,0x3d96a905,0x3da3308c,0x3dafb680,0x3dbc3ac3,0x3e164083,0x3e22abb6,0x3e2f10a2,0x3e3b6ecf,0x3e605c13,0x3e72b651,0x3e827dc0,0x3e8b9507
.long 0x3e94a031,0x3ea09ae5,0x3eac7cd4,0x3eb8442a,0x3eb8442a,0x3ec6d529,0x3ed53641,0x3ee363fa,0x3edae880,0x3eebcbbb,0x3efc5d27,0x3f064b82,0x3efc5d27,0x3f07a136,0x3f10d3cd,0x3f19c200
.long 0x3f0e39da,0x3f187fc0,0x3f226799,0x3f2beb4a,0x3f1d7fd1,0x3f286605,0x3f32c8c9,0x3f3ca003,0x3f2beb4a,0x3f373a23,0x3f41d870,0x3f4bbbf8,0x3f396842,0x3f44e3f5,0x3f4f7a1f,0x3f591e6a
.long 0x3f45e403,0x3f514d3d,0x3f5b941a,0x3f64aa59,0x3f514d3d,0x3f5c61c7,0x3f660f88,0x3f6e46be,0x3f5b941a,0x3f660f88,0x3f6ed89e,0x3f75dec6,0x3f64aa59,0x3f6e46be,0x3f75dec6,0x3f7b61fc
.long 0x3f800000,0x3f800000,0x3f800000,0x3f800000,0x3f7ec46d,0x3f7e9bc9,0x3f7e70b0,0x3f7e4323,0x3f7b14be,0x3f7a7302,0x3f79c79d,0x3f791298,0x3f74fa0b,0x3f73913f,0x3f721352,0x3f708066
.long 0x3f6c835e,0x3f6a09a7,0x3f676bd8,0x3f64aa59,0x3f61c598,0x3f5df6be,0x3f59f26a,0x3f55b993,0x3f54db31,0x3f4f7a1f,0x3f49d112,0x3f43e200,0x3f45e403,0x3f3ebc1b,0x3f373a23,0x3f2f61a5
.long 0x3f3504f3,0x3f2beb4a,0x3f226799,0x3f187fc0,0x3f226799,0x3f173c07,0x3f0b9a6b,0x3eff17b2,0x3f0e39da,0x3f00e7e4,0x3ee63375,0x3ec9b953,0x3ef15aea,0x3ed25a09,0x3eb263ef,0x3e919ddd
.long 0x3ec3ef15,0x3ea09ae5,0x3e78cfcc,0x3e2f10a2,0x3e94a031,0x3e5a3997,0x3e09cf86,0x3d621469,0x3e47c5c2,0x3de1bc2e,0x3cc90ab0,0xbd7b2b74,0x3dc8bd36,0x3bc90f88,0xbdafb680,0xbe354098
.long 0x3f800000,0x3f800000,0x3f800000,0x3f800000,0x3f7e1324,0x3f7de0b1,0x3f7dabcc,0x3f7d7474,0x3f7853f8,0x3f778bc5,0x3f76ba07,0x3f75dec6,0x3f6ed89e,0x3f6d1c1d,0x3f6b4b0c,0x3f696591
.long 0x3f61c598,0x3f5ebe05,0x3f5b941a,0x3f584853,0x3f514d3d,0x3f4cae79,0x3f47de65,0x3f42de29,0x3f3daef9,0x3f373a23,0x3f3085bb,0x3f299415,0x3f273656,0x3f1ebc12,0x3f15f6d9,0x3f0cead0
.long 0x3f0e39da,0x3f039c3d,0x3ef15aea,0x3edae880,0x3ee63375,0x3ecc9b8b,0x3eb263ef,0x3e97a117,0x3eac7cd4,0x3e8e9a22,0x3e605c13,0x3e22abb6,0x3e605c13,0x3e1c76de,0x3dafb680,0x3c96c9b6
.long 0x3dc8bd36,0x3cc90ab0,0xbd48fb30,0xbdfab273,0xbcc90ab0,0xbdd53db9,0xbe3b6ecf,0xbe8586ce,0xbe164083,0xbe6c9a7f,0xbea09ae5,0xbec9b953,0xbe888e93,0xbeb554ec,0xbee0924f,0xbf04f484
.long 0x3f800000,0x3f800000,0x3f800000,0x3f800000,0x3f7d3aac,0x3f7cfe73,0x3f7cbfc9,0x3f7c7eb0,0x3f74fa0b,0x3f740bdd,0x3f731447,0x3f721352,0x3f676bd8,0x3f655e0b,0x3f633c5a,0x3f6106f2
.long 0x3f54db31,0x3f514d3d,0x3f4d9f02,0x3f49d112,0x3f3daef9,0x3f385216,0x3f32c8c9,0x3f2d1469,0x3f226799,0x3f1b02c6,0x3f13682a,0x3f0b9a6b,0x3f039c3d,0x3ef41f07,0x3ee0924f,0x3ecc9b8b
.long 0x3ec3ef15,0x3eac7cd4,0x3e94a031,0x3e78cfcc,0x3e78cfcc,0x3e419b37,0x3e09cf86,0x3da3308c,0x3dc8bd36,0x3d16c32c,0xbcc90ab0,0xbdafb680,0xbd48fb30,0xbdee3876,0xbe3b6ecf,0xbe7ee6e1
.long 0xbe47c5c2,0xbe888e93,0xbeac7cd4,0xbecf7bca,0xbeac7cd4,0xbed25a09,0xbef6e0cb,0xbf0cead0,0xbef15aea,0xbf0b9a6b,0xbf1d7fd1,0xbf2e3bde,0xbf187fc0,0xbf2ac082,0xbf3b8f3b,0xbf4ac77f
.long 0x3f800000,0x3f800000,0x3f800000,0x3f800000,0x3f7c3b28,0x3f7bf531,0x3f7baccd,0x3f7b61fc,0x3f710908,0x3f6ff573,0x3f6ed89e,0x3f6db293,0x3f5ebe05,0x3f5c61c7,0x3f59f26a,0x3f577026
.long 0x3f45e403,0x3f41d870,0x3f3daef9,0x3f396842,0x3f273656,0x3f212ff9,0x3f1b02c6,0x3f14b039,0x3f039c3d,0x3ef6e0cb,0x3ee63375,0x3ed53641,0x3eb8442a,0x3ea395c5,0x3e8e9a22,0x3e72b651
.long 0x3e47c5c2,0x3e164083,0x3dc8bd36,0x3d48fb30,0x3cc90ab0,0xbcfb49ba,0xbdafb680,0xbe1008b7,0xbe164083,0xbe541501,0xbe888e93,0xbea68f12,0xbea09ae5,0xbec1071e,0xbee0924f,0xbeff17b2
.long 0xbef15aea,0xbf08f59b,0xbf187fc0,0xbf273656,0xbf1d7fd1,0xbf2d1469,0xbf3b8f3b,0xbf48d8b3,0xbf3daef9,0xbf4bbbf8,0xbf584853,0xbf633c5a,0xbf584853,0xbf63f473,0xbf6db293,0xbf756d97
.long 0x0,0x0,0x0,0x0,0x3dc8bd36,0x3dd53db9,0x3de1bc2e,0x3dee3876,0x3e47c5c2,0x3e541501,0x3e605c13,0x3e6c9a7f,0x3e94a031,0x3e9d9e78,0x3ea68f12,0x3eaf713a
.long 0x3ec3ef15,0x3ecf7bca,0x3edae880,0x3ee63375,0x3ef15aea,0x3eff17b2,0x3f064b82,0x3f0cead0,0x3f0e39da,0x3f15f6d9,0x3f1d7fd1,0x3f24d225,0x3f226799,0x3f2ac082,0x3f32c8c9,0x3f3a7ca4
.long 0x3f3504f3,0x3f3daef9,0x3f45e403,0x3f4d9f02,0x3f45e403,0x3f4e8d90,0x3f5695e5,0x3f5df6be,0x3f54db31,0x3f5d2d53,0x3f64aa59,0x3f6b4b0c,0x3f61c598,0x3f696591,0x3f6ff573,0x3f756d97
.long 0x3f6c835e,0x3f731447,0x3f7853f8,0x3f7c3b28,0x3f74fa0b,0x3f7a1e84,0x3f7dabcc,0x3f7f9c18,0x3f7b14be,0x3f7e70b0,0x3f7fec43,0x3f7f84ab,0x3f7ec46d,0x3f7ffec4,0x3f7f0e58,0x3f7bf531
.long 0x0,0x0,0x0,0x0,0x3dfab273,0x3e039502,0x3e09cf86,0x3e1008b7,0x3e78cfcc,0x3e827dc0,0x3e888e93,0x3e8e9a22,0x3eb8442a,0x3ec1071e,0x3ec9b953,0x3ed25a09
.long 0x3ef15aea,0x3efc5d27,0x3f039c3d,0x3f08f59b,0x3f13682a,0x3f19c200,0x3f1ff6cb,0x3f26050a,0x3f2beb4a,0x3f32c8c9,0x3f396842,0x3f3fc767,0x3f41d870,0x3f48d8b3,0x3f4f7a1f,0x3f55b993
.long 0x3f54db31,0x3f5b941a,0x3f61c598,0x3f676bd8,0x3f64aa59,0x3f6aab7b,0x3f6ff573,0x3f748422,0x3f710908,0x3f75dec6,0x3f79c79d,0x3f7cbfc9,0x3f79c79d,0x3f7cfe73,0x3f7f0e58,0x3f7ff4e6
.long 0x3f7ec46d,0x3f7fec43,0x3f7fb10f,0x3f7e1324,0x3f7fec43,0x3f7e9bc9,0x3f7baccd,0x3f772417,0x3f7d3aac,0x3f791298,0x3f731447,0x3f6b4b0c,0x3f76ba07,0x3f6f6830,0x3f660f88,0x3f5ac450
.long 0x0,0x0,0x0,0x0,0x3e164083,0x3e1c76de,0x3e22abb6,0x3e28defc,0x3e94a031,0x3e9aa086,0x3ea09ae5,0x3ea68f12,0x3edae880,0x3ee363fa,0x3eebcbbb,0x3ef41f07
.long 0x3f0e39da,0x3f13682a,0x3f187fc0,0x3f1d7fd1,0x3f2beb4a,0x3f31a81d,0x3f373a23,0x3f3ca003,0x3f45e403,0x3f4bbbf8,0x3f514d3d,0x3f5695e5,0x3f5b941a,0x3f6106f2,0x3f660f88,0x3f6aab7b
.long 0x3f6c835e,0x3f710908,0x3f74fa0b,0x3f7853f8,0x3f7853f8,0x3f7b61fc,0x3f7dabcc,0x3f7f2f9d,0x3f7ec46d,0x3f7fd397,0x3f7fec43,0x3f7f0e58,0x3f7fb10f,0x3f7e4323,0x3f7baccd,0x3f77f110
.long 0x3f7b14be,0x3f76ba07,0x3f710908,0x3f6a09a7,0x3f710908,0x3f696591,0x3f604621,0x3f55b993,0x3f61c598,0x3f5695e5,0x3f49d112,0x3f3b8f3b,0x3f4d9f02,0x3f3ebc1b,0x3f2e3bde,0x3f1c420c
.long 0x0,0x0,0x0,0x0,0x3e2f10a2,0x3e354098,0x3e3b6ecf,0x3e419b37,0x3eac7cd4,0x3eb263ef,0x3eb8442a,0x3ebe1d4a,0x3efc5d27,0x3f0242b1,0x3f064b82,0x3f0a48ad
.long 0x3f226799,0x3f273656,0x3f2beb4a,0x3f3085bb,0x3f41d870,0x3f46e22a,0x3f4bbbf8,0x3f5064af,0x3f5b941a,0x3f604621,0x3f64aa59,0x3f68bf3c,0x3f6ed89e,0x3f7294f8,0x3f75dec6,0x3f78b47b
.long 0x3f7b14be,0x3f7d3aac,0x3f7ec46d,0x3f7fb10f,0x3f7fec43,0x3f7fe129,0x3f7f0e58,0x3f7d7474,0x3f7d3aac,0x3f7a7302,0x3f76ba07,0x3f721352,0x3f731447,0x3f6d1c1d,0x3f660f88,0x3f5df6be
.long 0x3f61c598,0x3f584853,0x3f4d9f02,0x3f41d870,0x3f49d112,0x3f3ca003,0x3f2e3bde,0x3f1ebc12,0x3f2beb4a,0x3f1b02c6,0x3f08f59b,0x3eebcbbb,0x3f08f59b,0x3ee900b7,0x3ebe1d4a,0x3e919ddd
.size spec_tables, 67584
.section .rodata,"a"
.p2align 6
.amdhsa_kernel recurrent_scan__spectral_gfnet__geglu_ffn__prompt_kernel
  .amdhsa_next_free_vgpr 256
  .amdhsa_next_free_sgpr 102
  .amdhsa_accum_offset 256
  .amdhsa_group_segment_fixed_size 0
  .amdhsa_kernarg_size 80
  .amdhsa_user_sgpr_count 2
  .amdhsa_user_sgpr_kernarg_segment_ptr 1
  .amdhsa_system_sgpr_workgroup_id_x 1
.end_amdhsa_kernel
```
